```python
import torch

def _softmax(x, axis=-1):
    return torch.softmax(x, dim=axis)
def _gelu(x):
    return torch.nn.functional.gelu(x, approximate="tanh")
def _silu(x):
    return torch.nn.functional.silu(x)
def _sigmoid(x):
    return torch.sigmoid(x)
def _layernorm(x, axis=-1, eps=1e-5):
    m = x.mean(dim=axis, keepdim=True)
    v = x.var(dim=axis, keepdim=True, unbiased=False)
    return (x - m) / torch.sqrt(v + eps)
def _scatter_add(tgt, idx, src, axis=0):
    return tgt.clone().index_add_(axis, idx, src)
def _segment_sum(src, seg, n):
    out = torch.zeros((n,) + src.shape[1:], dtype=src.dtype)
    return out.index_add_(0, seg, src)
def _pad(x, pw):
    flat = tuple(v for pair in reversed(pw) for v in pair)
    return torch.nn.functional.pad(x, flat)

kernel_name = 'concat_heads__mha_block_cached__mha_block_cached__near_ridge'

def setup_inputs():

    _w = (lambda a: (lambda t: t.to(torch.bfloat16) if t.is_floating_point() else t)(torch.as_tensor(a)))
    def _A_setup():
        B, Sq, D = 16, 96, 512
        H, Sk, Dh = 32, 512, 128
        return {
            "x": _w((lambda *s: torch.randn(*s, dtype=torch.bfloat16) * 0.8)(B, Sq, D)),
            "k_cache": _w((lambda *s: torch.randn(*s, dtype=torch.bfloat16) * 0.8)(B, H, Sk, Dh)),
            "v_cache": _w((lambda *s: torch.randn(*s, dtype=torch.bfloat16) * 0.05)(B, H, Sk, Dh)),
            "wq": _w((lambda *s: torch.randn(*s, dtype=torch.bfloat16) * 0.8)(D, H * Dh) * (D ** -0.5)),
            "wo": _w((lambda *s: torch.randn(*s, dtype=torch.bfloat16) * 0.05)(H * Dh, D) * ((H * Dh) ** -0.5)),
        }
    _A_in = _A_setup()

    def _B_setup():
        B, Sq, D = 16, 96, 512
        H, Sk, Dh = 32, 512, 128
        return {
            "x": _w((lambda *s: torch.randn(*s, dtype=torch.bfloat16) * 0.8)(B, Sq, D)),
            "k_cache": _w((lambda *s: torch.randn(*s, dtype=torch.bfloat16) * 0.8)(B, H, Sk, Dh)),
            "v_cache": _w((lambda *s: torch.randn(*s, dtype=torch.bfloat16) * 0.05)(B, H, Sk, Dh)),
            "wq": _w((lambda *s: torch.randn(*s, dtype=torch.bfloat16) * 0.8)(D, H * Dh) * (D ** -0.5)),
            "wo": _w((lambda *s: torch.randn(*s, dtype=torch.bfloat16) * 0.05)(H * Dh, D) * ((H * Dh) ** -0.5)),
        }
    _B_in = _B_setup()

    return {
        "A_x": _A_in["x"],
        "A_k_cache": _A_in["k_cache"],
        "A_v_cache": _A_in["v_cache"],
        "A_wq": _A_in["wq"],
        "A_wo": _A_in["wo"],
        "B_x": _B_in["x"],
        "B_k_cache": _B_in["k_cache"],
        "B_v_cache": _B_in["v_cache"],
        "B_wq": _B_in["wq"],
        "B_wo": _B_in["wo"],
    }

def reference(A_x, A_k_cache, A_v_cache, A_wq, A_wo, B_x, B_k_cache, B_v_cache, B_wq, B_wo):
    def _A_ref(x, k_cache, v_cache, wq, wo):
        B, Sq, D = x.shape
        H, Dh = 32, 128
        q = (lambda x, *d: x.permute(*d))((x @ wq).reshape(B, Sq, H, Dh), 0, 2, 1, 3)
        scores = torch.einsum("bhqd,bhkd->bhqk", q, k_cache) * (Dh ** -0.5)
        p = _softmax(scores, axis=-1)
        o = torch.einsum("bhqk,bhkd->bhqd", p, v_cache)
        return (lambda x, *d: x.permute(*d))(o, 0, 2, 1, 3).reshape(B, Sq, H * Dh) @ wo

    def _B_ref(x, k_cache, v_cache, wq, wo):
        B, Sq, D = x.shape
        H, Dh = 32, 128
        q = (lambda x, *d: x.permute(*d))((x @ wq).reshape(B, Sq, H, Dh), 0, 2, 1, 3)
        scores = torch.einsum("bhqd,bhkd->bhqk", q, k_cache) * (Dh ** -0.5)
        p = _softmax(scores, axis=-1)
        o = torch.einsum("bhqk,bhkd->bhqd", p, v_cache)
        return (lambda x, *d: x.permute(*d))(o, 0, 2, 1, 3).reshape(B, Sq, H * Dh) @ wo

    a = _A_ref(A_x, A_k_cache, A_v_cache, A_wq, A_wo)
    b = _B_ref(B_x, B_k_cache, B_v_cache, B_wq, B_wo)
    return torch.concatenate([a, b], axis=-1)
```

```asm
; @launch grid=(256,1,1) block=(256,1,1) lds=163840
.amdgcn_target "amdgcn-amd-amdhsa--gfx950"
.text
.globl concat_heads__mha_block_cached__mha_block_cached__near_ridge_kernel
.p2align 8
.type concat_heads__mha_block_cached__mha_block_cached__near_ridge_kernel,@function
concat_heads__mha_block_cached__mha_block_cached__near_ridge_kernel:
s_cmp_lt_u32 s2,256
s_cbranch_scc1 L_start
s_endpgm
L_start:
s_load_dwordx16 s[64:79],s[0:1],0
s_load_dwordx8 s[80:87],s[0:1],64
s_load_dwordx2 s[88:89],s[0:1],96
v_lshrrev_b32 v1,6,v0
v_and_b32 v0,63,v0
v_readfirstlane_b32 s32,v1
s_and_b32 s41,s2,7
s_lshr_b32 s42,s2,3
s_lshr_b32 s33,s41,2
s_and_b32 s34,s42,15
s_and_b32 s35,s41,3
s_lshl_b32 s35,s35,1
s_lshr_b32 s42,s42,4
s_add_u32 s35,s35,s42
s_lshl_b32 s38,s42,2
s_xor_b32 s38,s38,s34
s_and_b32 s38,s38,7
s_and_b32 s36,s34,3
s_lshr_b32 s37,s34,2
s_lshl_b32 s37,s37,1
s_xor_b32 s37,s37,s35
s_xor_b32 s37,s37,7
s_mov_b32 s39,0x3e0293ee
s_mov_b32 s43,0x41000000
s_mov_b32 s100,0
s_mov_b32 s3,0
s_cmp_lt_u32 s32,3
s_cbranch_scc1 L_attn
s_mul_i32 s90,s34,98304
s_lshl_b32 s91,s35,10
s_xor_b32 s41,s38,0
s_lshl_b32 s42,s41,7
s_add_u32 s56,s42,s90
s_lshl_b32 s42,s41,19
s_add_u32 s48,s42,s91
v_and_b32 v16,15,v0
v_lshrrev_b32 v17,4,v0
v_bfe_u32 v18,v0,2,2
v_and_b32 v19,3,v0
v_and_b32 v15,7,v0
v_xor_b32 v15,v15,v17
v_lshlrev_b32 v15,4,v15
v_lshrrev_b32 v23,3,v0
v_lshl_add_u32 v32,v23,10,v15
v_xor_b32 v33,64,v32
v_lshlrev_b32 v15,2,v17
v_xor_b32 v15,v15,v16
v_lshlrev_b32 v15,4,v15
v_lshl_add_u32 v34,v17,13,v15
s_waitcnt lgkmcnt(0)
s_cmp_eq_u32 s33,0
s_cselect_b32 s24,s64,s74
s_cselect_b32 s25,s65,s75
s_cselect_b32 s16,s70,s80
s_cselect_b32 s17,s71,s81
s_and_b32 s25,s25,0xffff
s_mov_b32 s26,0x180000
s_mov_b32 s27,0x20000
s_and_b32 s17,s17,0xffff
s_mov_b32 s18,0x400000
s_mov_b32 s19,0x20000
s_mov_b32 m0,114688
s_add_u32 s41,s56,0
buffer_load_dwordx4 v32,s[24:27],s41 offen lds
s_add_u32 s42,s56,7168
buffer_load_dwordx4 v33,s[24:27],s42 offen offset:1024 lds
s_add_u32 s41,s56,14336
buffer_load_dwordx4 v32,s[24:27],s41 offen offset:2048 lds
s_add_u32 s42,s56,21504
buffer_load_dwordx4 v33,s[24:27],s42 offen offset:3072 lds
s_mov_b32 m0,118784
s_add_u32 s41,s56,32768
buffer_load_dwordx4 v32,s[24:27],s41 offen lds
s_add_u32 s42,s56,39936
buffer_load_dwordx4 v33,s[24:27],s42 offen offset:1024 lds
s_add_u32 s41,s56,47104
buffer_load_dwordx4 v32,s[24:27],s41 offen offset:2048 lds
s_add_u32 s42,s56,54272
buffer_load_dwordx4 v33,s[24:27],s42 offen offset:3072 lds
s_mov_b32 m0,122880
s_add_u32 s41,s56,65536
buffer_load_dwordx4 v32,s[24:27],s41 offen lds
s_add_u32 s42,s56,72704
buffer_load_dwordx4 v33,s[24:27],s42 offen offset:1024 lds
s_add_u32 s41,s56,79872
buffer_load_dwordx4 v32,s[24:27],s41 offen offset:2048 lds
s_add_u32 s42,s56,87040
buffer_load_dwordx4 v33,s[24:27],s42 offen offset:3072 lds
s_mov_b32 m0,49152
s_add_u32 s41,s48,0
buffer_load_dwordx4 v34,s[16:19],s41 offen lds
s_add_u32 s42,s48,31744
buffer_load_dwordx4 v34,s[16:19],s42 offen offset:1024 lds
s_add_u32 s41,s48,63488
buffer_load_dwordx4 v34,s[16:19],s41 offen offset:2048 lds
s_add_u32 s42,s48,95232
buffer_load_dwordx4 v34,s[16:19],s42 offen offset:3072 lds
s_mov_b32 m0,53248
s_add_u32 s41,s48,131072
buffer_load_dwordx4 v34,s[16:19],s41 offen lds
s_add_u32 s42,s48,162816
buffer_load_dwordx4 v34,s[16:19],s42 offen offset:1024 lds
s_add_u32 s41,s48,194560
buffer_load_dwordx4 v34,s[16:19],s41 offen offset:2048 lds
s_add_u32 s42,s48,226304
buffer_load_dwordx4 v34,s[16:19],s42 offen offset:3072 lds
s_mov_b32 m0,57344
s_add_u32 s41,s48,262144
buffer_load_dwordx4 v34,s[16:19],s41 offen lds
s_add_u32 s42,s48,293888
buffer_load_dwordx4 v34,s[16:19],s42 offen offset:1024 lds
s_add_u32 s41,s48,325632
buffer_load_dwordx4 v34,s[16:19],s41 offen offset:2048 lds
s_add_u32 s42,s48,357376
buffer_load_dwordx4 v34,s[16:19],s42 offen offset:3072 lds
s_mov_b32 m0,61440
s_add_u32 s41,s48,393216
buffer_load_dwordx4 v34,s[16:19],s41 offen lds
s_add_u32 s42,s48,424960
buffer_load_dwordx4 v34,s[16:19],s42 offen offset:1024 lds
s_add_u32 s41,s48,456704
buffer_load_dwordx4 v34,s[16:19],s41 offen offset:2048 lds
s_add_u32 s42,s48,488448
buffer_load_dwordx4 v34,s[16:19],s42 offen offset:3072 lds
s_cmp_eq_u32 s33,0
s_cselect_b32 s8,s66,s76
s_cselect_b32 s9,s67,s77
s_cselect_b32 s12,s68,s78
s_cselect_b32 s13,s69,s79
s_cselect_b32 s20,s72,s82
s_cselect_b32 s21,s73,s83
s_mov_b32 s4,s84
s_mov_b32 s5,s85
s_mov_b32 s96,s86
s_mov_b32 s97,s87
s_mov_b32 s28,s88
s_mov_b32 s29,s89
s_and_b32 s9,s9,0xffff
s_mov_b32 s10,0x4000000
s_mov_b32 s11,0x20000
s_and_b32 s13,s13,0xffff
s_mov_b32 s14,0x4000000
s_mov_b32 s15,0x20000
s_and_b32 s21,s21,0xffff
s_mov_b32 s22,0x400000
s_mov_b32 s23,0x20000
s_and_b32 s5,s5,0xffff
s_mov_b32 s6,0x300000
s_mov_b32 s7,0x20000
s_and_b32 s97,s97,0xffff
s_mov_b32 s98,0x100
s_mov_b32 s99,0x20000
s_and_b32 s29,s29,0xffff
s_mov_b32 s30,0x1900000
s_mov_b32 s31,0x20000
s_xor_b32 s41,s38,1
s_lshl_b32 s42,s41,7
s_add_u32 s57,s42,s90
s_lshl_b32 s42,s41,19
s_add_u32 s49,s42,s91
s_xor_b32 s41,s38,2
s_lshl_b32 s42,s41,7
s_add_u32 s58,s42,s90
s_lshl_b32 s42,s41,19
s_add_u32 s50,s42,s91
s_xor_b32 s41,s38,3
s_lshl_b32 s42,s41,7
s_add_u32 s59,s42,s90
s_lshl_b32 s42,s41,19
s_add_u32 s51,s42,s91
s_xor_b32 s41,s38,4
s_lshl_b32 s42,s41,7
s_add_u32 s60,s42,s90
s_lshl_b32 s42,s41,19
s_add_u32 s52,s42,s91
s_xor_b32 s41,s38,5
s_lshl_b32 s42,s41,7
s_add_u32 s61,s42,s90
s_lshl_b32 s42,s41,19
s_add_u32 s53,s42,s91
s_xor_b32 s41,s38,6
s_lshl_b32 s42,s41,7
s_add_u32 s62,s42,s90
s_lshl_b32 s42,s41,19
s_add_u32 s54,s42,s91
s_xor_b32 s41,s38,7
s_lshl_b32 s42,s41,7
s_add_u32 s63,s42,s90
s_lshl_b32 s42,s41,19
s_add_u32 s55,s42,s91
s_lshl_b32 s40,s34,22
s_lshl_b32 s41,s35,19
s_add_u32 s40,s40,s41
v_xor_b32 v15,v16,v17
v_lshlrev_b32 v15,4,v15
v_lshl_add_u32 v15,v17,8,v15
v_xor_b32 v1,0,v15
v_xor_b32 v2,64,v15
v_xor_b32 v3,128,v15
v_xor_b32 v4,192,v15
v_lshlrev_b32 v15,1,v17
v_xor_b32 v15,v15,v16
v_lshlrev_b32 v15,4,v15
v_lshl_add_u32 v15,v17,8,v15
s_lshl_b32 s41,s36,6
v_xor_b32 v5,s41,v15
v_xor_b32 v6,128,v5
v_and_b32 v15,1,v17
v_lshlrev_b32 v15,2,v15
v_and_b32 v23,7,v0
v_xor_b32 v15,v15,v23
v_lshlrev_b32 v15,4,v15
v_lshrrev_b32 v23,3,v0
v_lshl_add_u32 v7,v23,13,v15
v_lshlrev_b32 v15,4,v19
v_lshrrev_b32 v23,1,v18
v_lshl_add_u32 v15,v23,6,v15
v_lshl_add_u32 v23,v17,3,v18
v_lshl_add_u32 v15,v23,7,v15
v_add_u32 v8,98304,v15
v_xor_b32 v9,64,v8
v_lshlrev_b32 v15,4,v0
v_add_u32 v10,131072,v15
v_lshrrev_b32 v15,1,v16
v_xor_b32 v15,v15,v17
v_lshlrev_b32 v15,4,v15
v_lshl_add_u32 v15,v16,7,v15
v_add_u32 v11,114688,v15
v_xor_b32 v12,64,v11
s_lshl_b32 s90,s35,19
s_lshr_b32 s91,s37,1
s_mov_b32 s64,s90
s_lshl_b32 s91,s91,8
s_lshl_b32 s65,s36,15
s_or_b32 s65,s65,s91
s_and_b32 s90,s37,1
s_lshl_b32 s90,s90,7
s_lshl_b32 s41,s36,6
s_xor_b32 s90,s90,s41
s_mov_b32 m0,126976
s_add_u32 s41,s57,0
buffer_load_dwordx4 v32,s[24:27],s41 offen lds
s_add_u32 s42,s57,7168
buffer_load_dwordx4 v33,s[24:27],s42 offen offset:1024 lds
s_add_u32 s41,s57,14336
buffer_load_dwordx4 v32,s[24:27],s41 offen offset:2048 lds
s_add_u32 s42,s57,21504
buffer_load_dwordx4 v33,s[24:27],s42 offen offset:3072 lds
s_mov_b32 m0,131072
s_add_u32 s41,s57,32768
buffer_load_dwordx4 v32,s[24:27],s41 offen lds
s_add_u32 s42,s57,39936
buffer_load_dwordx4 v33,s[24:27],s42 offen offset:1024 lds
s_add_u32 s41,s57,47104
buffer_load_dwordx4 v32,s[24:27],s41 offen offset:2048 lds
s_add_u32 s42,s57,54272
buffer_load_dwordx4 v33,s[24:27],s42 offen offset:3072 lds
s_mov_b32 m0,135168
s_add_u32 s41,s57,65536
buffer_load_dwordx4 v32,s[24:27],s41 offen lds
s_add_u32 s42,s57,72704
buffer_load_dwordx4 v33,s[24:27],s42 offen offset:1024 lds
s_add_u32 s41,s57,79872
buffer_load_dwordx4 v32,s[24:27],s41 offen offset:2048 lds
s_add_u32 s42,s57,87040
buffer_load_dwordx4 v33,s[24:27],s42 offen offset:3072 lds
s_mov_b32 m0,65536
s_add_u32 s41,s49,0
buffer_load_dwordx4 v34,s[16:19],s41 offen lds
s_add_u32 s42,s49,31744
buffer_load_dwordx4 v34,s[16:19],s42 offen offset:1024 lds
s_add_u32 s41,s49,63488
buffer_load_dwordx4 v34,s[16:19],s41 offen offset:2048 lds
s_add_u32 s42,s49,95232
buffer_load_dwordx4 v34,s[16:19],s42 offen offset:3072 lds
s_mov_b32 m0,69632
s_add_u32 s41,s49,131072
buffer_load_dwordx4 v34,s[16:19],s41 offen lds
s_add_u32 s42,s49,162816
buffer_load_dwordx4 v34,s[16:19],s42 offen offset:1024 lds
s_add_u32 s41,s49,194560
buffer_load_dwordx4 v34,s[16:19],s41 offen offset:2048 lds
s_add_u32 s42,s49,226304
buffer_load_dwordx4 v34,s[16:19],s42 offen offset:3072 lds
s_mov_b32 m0,73728
s_add_u32 s41,s49,262144
buffer_load_dwordx4 v34,s[16:19],s41 offen lds
s_add_u32 s42,s49,293888
buffer_load_dwordx4 v34,s[16:19],s42 offen offset:1024 lds
s_add_u32 s41,s49,325632
buffer_load_dwordx4 v34,s[16:19],s41 offen offset:2048 lds
s_add_u32 s42,s49,357376
buffer_load_dwordx4 v34,s[16:19],s42 offen offset:3072 lds
s_mov_b32 m0,77824
s_add_u32 s41,s49,393216
buffer_load_dwordx4 v34,s[16:19],s41 offen lds
s_add_u32 s42,s49,424960
buffer_load_dwordx4 v34,s[16:19],s42 offen offset:1024 lds
s_add_u32 s41,s49,456704
buffer_load_dwordx4 v34,s[16:19],s41 offen offset:2048 lds
s_add_u32 s42,s49,488448
buffer_load_dwordx4 v34,s[16:19],s42 offen offset:3072 lds
s_mov_b32 m0,139264
s_add_u32 s41,s58,0
buffer_load_dwordx4 v32,s[24:27],s41 offen lds
s_add_u32 s42,s58,7168
buffer_load_dwordx4 v33,s[24:27],s42 offen offset:1024 lds
s_add_u32 s41,s58,14336
buffer_load_dwordx4 v32,s[24:27],s41 offen offset:2048 lds
s_add_u32 s42,s58,21504
buffer_load_dwordx4 v33,s[24:27],s42 offen offset:3072 lds
s_mov_b32 m0,143360
s_add_u32 s41,s58,32768
buffer_load_dwordx4 v32,s[24:27],s41 offen lds
s_add_u32 s42,s58,39936
buffer_load_dwordx4 v33,s[24:27],s42 offen offset:1024 lds
s_add_u32 s41,s58,47104
buffer_load_dwordx4 v32,s[24:27],s41 offen offset:2048 lds
s_add_u32 s42,s58,54272
s_waitcnt vmcnt(54)
buffer_load_dwordx4 v33,s[24:27],s42 offen offset:3072 lds
s_mov_b32 m0,147456
s_add_u32 s41,s58,65536
buffer_load_dwordx4 v32,s[24:27],s41 offen lds
s_add_u32 s42,s58,72704
buffer_load_dwordx4 v33,s[24:27],s42 offen offset:1024 lds
s_add_u32 s41,s58,79872
buffer_load_dwordx4 v32,s[24:27],s41 offen offset:2048 lds
s_add_u32 s42,s58,87040
buffer_load_dwordx4 v33,s[24:27],s42 offen offset:3072 lds
s_branch L_load
.p2align 12
L_load:
s_waitcnt vmcnt(32)
s_barrier
ds_read_b128 a[0:3],v11
ds_read_b128 a[4:7],v12
ds_read_b128 a[64:67],v11 offset:2048
ds_read_b128 a[68:71],v12 offset:2048
ds_read_b128 a[128:131],v11 offset:4096
ds_read_b128 a[132:135],v12 offset:4096
ds_read_b128 a[192:195],v11 offset:6144
ds_read_b128 a[196:199],v12 offset:6144
ds_read_b128 v[128:131],v11 offset:8192
ds_read_b128 v[132:135],v12 offset:8192
ds_read_b128 v[192:195],v11 offset:10240
ds_read_b128 v[196:199],v12 offset:10240
s_mov_b32 m0,81920
s_add_u32 s41,s50,0
buffer_load_dwordx4 v34,s[16:19],s41 offen lds
s_add_u32 s42,s50,31744
buffer_load_dwordx4 v34,s[16:19],s42 offen offset:1024 lds
s_add_u32 s41,s50,63488
buffer_load_dwordx4 v34,s[16:19],s41 offen offset:2048 lds
s_add_u32 s42,s50,95232
buffer_load_dwordx4 v34,s[16:19],s42 offen offset:3072 lds
s_mov_b32 m0,86016
s_add_u32 s41,s50,131072
buffer_load_dwordx4 v34,s[16:19],s41 offen lds
s_add_u32 s42,s50,162816
buffer_load_dwordx4 v34,s[16:19],s42 offen offset:1024 lds
s_add_u32 s41,s50,194560
buffer_load_dwordx4 v34,s[16:19],s41 offen offset:2048 lds
s_add_u32 s42,s50,226304
buffer_load_dwordx4 v34,s[16:19],s42 offen offset:3072 lds
s_mov_b32 m0,90112
s_add_u32 s41,s50,262144
buffer_load_dwordx4 v34,s[16:19],s41 offen lds
s_add_u32 s42,s50,293888
buffer_load_dwordx4 v34,s[16:19],s42 offen offset:1024 lds
s_add_u32 s41,s50,325632
buffer_load_dwordx4 v34,s[16:19],s41 offen offset:2048 lds
s_add_u32 s42,s50,357376
buffer_load_dwordx4 v34,s[16:19],s42 offen offset:3072 lds
s_mov_b32 m0,94208
s_add_u32 s41,s50,393216
buffer_load_dwordx4 v34,s[16:19],s41 offen lds
s_add_u32 s42,s50,424960
buffer_load_dwordx4 v34,s[16:19],s42 offen offset:1024 lds
s_add_u32 s41,s50,456704
buffer_load_dwordx4 v34,s[16:19],s41 offen offset:2048 lds
s_add_u32 s42,s50,488448
buffer_load_dwordx4 v34,s[16:19],s42 offen offset:3072 lds
s_mov_b32 m0,151552
s_add_u32 s41,s59,0
buffer_load_dwordx4 v32,s[24:27],s41 offen lds
s_add_u32 s42,s59,7168
buffer_load_dwordx4 v33,s[24:27],s42 offen offset:1024 lds
s_add_u32 s41,s59,14336
buffer_load_dwordx4 v32,s[24:27],s41 offen offset:2048 lds
s_add_u32 s42,s59,21504
buffer_load_dwordx4 v33,s[24:27],s42 offen offset:3072 lds
s_mov_b32 m0,155648
s_add_u32 s41,s59,32768
buffer_load_dwordx4 v32,s[24:27],s41 offen lds
s_add_u32 s42,s59,39936
buffer_load_dwordx4 v33,s[24:27],s42 offen offset:1024 lds
s_add_u32 s41,s59,47104
buffer_load_dwordx4 v32,s[24:27],s41 offen offset:2048 lds
s_add_u32 s42,s59,54272
buffer_load_dwordx4 v33,s[24:27],s42 offen offset:3072 lds
s_mov_b32 m0,159744
s_add_u32 s41,s59,65536
buffer_load_dwordx4 v32,s[24:27],s41 offen lds
s_add_u32 s42,s59,72704
buffer_load_dwordx4 v33,s[24:27],s42 offen offset:1024 lds
s_add_u32 s41,s59,79872
buffer_load_dwordx4 v32,s[24:27],s41 offen offset:2048 lds
s_add_u32 s42,s59,87040
buffer_load_dwordx4 v33,s[24:27],s42 offen offset:3072 lds
s_waitcnt vmcnt(32)
s_waitcnt lgkmcnt(0)
s_barrier
ds_read_b128 a[8:11],v11 offset:12288
ds_read_b128 a[12:15],v12 offset:12288
ds_read_b128 a[72:75],v11 offset:14336
ds_read_b128 a[76:79],v12 offset:14336
ds_read_b128 a[136:139],v11 offset:16384
ds_read_b128 a[140:143],v12 offset:16384
ds_read_b128 a[200:203],v11 offset:18432
ds_read_b128 a[204:207],v12 offset:18432
ds_read_b128 v[136:139],v11 offset:20480
ds_read_b128 v[140:143],v12 offset:20480
ds_read_b128 v[200:203],v11 offset:22528
ds_read_b128 v[204:207],v12 offset:22528
s_mov_b32 m0,49152
s_add_u32 s41,s51,0
buffer_load_dwordx4 v34,s[16:19],s41 offen lds
s_add_u32 s42,s51,31744
buffer_load_dwordx4 v34,s[16:19],s42 offen offset:1024 lds
s_add_u32 s41,s51,63488
buffer_load_dwordx4 v34,s[16:19],s41 offen offset:2048 lds
s_add_u32 s42,s51,95232
buffer_load_dwordx4 v34,s[16:19],s42 offen offset:3072 lds
s_mov_b32 m0,53248
s_add_u32 s41,s51,131072
buffer_load_dwordx4 v34,s[16:19],s41 offen lds
s_add_u32 s42,s51,162816
buffer_load_dwordx4 v34,s[16:19],s42 offen offset:1024 lds
s_add_u32 s41,s51,194560
buffer_load_dwordx4 v34,s[16:19],s41 offen offset:2048 lds
s_add_u32 s42,s51,226304
buffer_load_dwordx4 v34,s[16:19],s42 offen offset:3072 lds
s_mov_b32 m0,57344
s_add_u32 s41,s51,262144
buffer_load_dwordx4 v34,s[16:19],s41 offen lds
s_add_u32 s42,s51,293888
buffer_load_dwordx4 v34,s[16:19],s42 offen offset:1024 lds
s_add_u32 s41,s51,325632
buffer_load_dwordx4 v34,s[16:19],s41 offen offset:2048 lds
s_add_u32 s42,s51,357376
buffer_load_dwordx4 v34,s[16:19],s42 offen offset:3072 lds
s_mov_b32 m0,61440
s_add_u32 s41,s51,393216
buffer_load_dwordx4 v34,s[16:19],s41 offen lds
s_add_u32 s42,s51,424960
buffer_load_dwordx4 v34,s[16:19],s42 offen offset:1024 lds
s_add_u32 s41,s51,456704
buffer_load_dwordx4 v34,s[16:19],s41 offen offset:2048 lds
s_add_u32 s42,s51,488448
buffer_load_dwordx4 v34,s[16:19],s42 offen offset:3072 lds
s_mov_b32 m0,114688
s_add_u32 s41,s60,0
buffer_load_dwordx4 v32,s[24:27],s41 offen lds
s_add_u32 s42,s60,7168
buffer_load_dwordx4 v33,s[24:27],s42 offen offset:1024 lds
s_add_u32 s41,s60,14336
buffer_load_dwordx4 v32,s[24:27],s41 offen offset:2048 lds
s_add_u32 s42,s60,21504
buffer_load_dwordx4 v33,s[24:27],s42 offen offset:3072 lds
s_mov_b32 m0,118784
s_add_u32 s41,s60,32768
buffer_load_dwordx4 v32,s[24:27],s41 offen lds
s_add_u32 s42,s60,39936
buffer_load_dwordx4 v33,s[24:27],s42 offen offset:1024 lds
s_add_u32 s41,s60,47104
buffer_load_dwordx4 v32,s[24:27],s41 offen offset:2048 lds
s_add_u32 s42,s60,54272
buffer_load_dwordx4 v33,s[24:27],s42 offen offset:3072 lds
s_mov_b32 m0,122880
s_add_u32 s41,s60,65536
buffer_load_dwordx4 v32,s[24:27],s41 offen lds
s_add_u32 s42,s60,72704
buffer_load_dwordx4 v33,s[24:27],s42 offen offset:1024 lds
s_add_u32 s41,s60,79872
buffer_load_dwordx4 v32,s[24:27],s41 offen offset:2048 lds
s_add_u32 s42,s60,87040
buffer_load_dwordx4 v33,s[24:27],s42 offen offset:3072 lds
s_waitcnt vmcnt(32)
s_waitcnt lgkmcnt(0)
s_barrier
ds_read_b128 a[16:19],v11 offset:24576
ds_read_b128 a[20:23],v12 offset:24576
ds_read_b128 a[80:83],v11 offset:26624
ds_read_b128 a[84:87],v12 offset:26624
ds_read_b128 a[144:147],v11 offset:28672
ds_read_b128 a[148:151],v12 offset:28672
ds_read_b128 a[208:211],v11 offset:30720
ds_read_b128 a[212:215],v12 offset:30720
ds_read_b128 v[144:147],v11 offset:32768
ds_read_b128 v[148:151],v12 offset:32768
ds_read_b128 v[208:211],v11 offset:34816
ds_read_b128 v[212:215],v12 offset:34816
s_mov_b32 m0,65536
s_add_u32 s41,s52,0
buffer_load_dwordx4 v34,s[16:19],s41 offen lds
s_add_u32 s42,s52,31744
buffer_load_dwordx4 v34,s[16:19],s42 offen offset:1024 lds
s_add_u32 s41,s52,63488
buffer_load_dwordx4 v34,s[16:19],s41 offen offset:2048 lds
s_add_u32 s42,s52,95232
buffer_load_dwordx4 v34,s[16:19],s42 offen offset:3072 lds
s_mov_b32 m0,69632
s_add_u32 s41,s52,131072
buffer_load_dwordx4 v34,s[16:19],s41 offen lds
s_add_u32 s42,s52,162816
buffer_load_dwordx4 v34,s[16:19],s42 offen offset:1024 lds
s_add_u32 s41,s52,194560
buffer_load_dwordx4 v34,s[16:19],s41 offen offset:2048 lds
s_add_u32 s42,s52,226304
buffer_load_dwordx4 v34,s[16:19],s42 offen offset:3072 lds
s_mov_b32 m0,73728
s_add_u32 s41,s52,262144
buffer_load_dwordx4 v34,s[16:19],s41 offen lds
s_add_u32 s42,s52,293888
buffer_load_dwordx4 v34,s[16:19],s42 offen offset:1024 lds
s_add_u32 s41,s52,325632
buffer_load_dwordx4 v34,s[16:19],s41 offen offset:2048 lds
s_add_u32 s42,s52,357376
buffer_load_dwordx4 v34,s[16:19],s42 offen offset:3072 lds
s_mov_b32 m0,77824
s_add_u32 s41,s52,393216
buffer_load_dwordx4 v34,s[16:19],s41 offen lds
s_add_u32 s42,s52,424960
buffer_load_dwordx4 v34,s[16:19],s42 offen offset:1024 lds
s_add_u32 s41,s52,456704
buffer_load_dwordx4 v34,s[16:19],s41 offen offset:2048 lds
s_add_u32 s42,s52,488448
buffer_load_dwordx4 v34,s[16:19],s42 offen offset:3072 lds
s_mov_b32 m0,126976
s_add_u32 s41,s61,0
buffer_load_dwordx4 v32,s[24:27],s41 offen lds
s_add_u32 s42,s61,7168
buffer_load_dwordx4 v33,s[24:27],s42 offen offset:1024 lds
s_add_u32 s41,s61,14336
buffer_load_dwordx4 v32,s[24:27],s41 offen offset:2048 lds
s_add_u32 s42,s61,21504
buffer_load_dwordx4 v33,s[24:27],s42 offen offset:3072 lds
s_mov_b32 m0,131072
s_add_u32 s41,s61,32768
buffer_load_dwordx4 v32,s[24:27],s41 offen lds
s_add_u32 s42,s61,39936
buffer_load_dwordx4 v33,s[24:27],s42 offen offset:1024 lds
s_add_u32 s41,s61,47104
buffer_load_dwordx4 v32,s[24:27],s41 offen offset:2048 lds
s_add_u32 s42,s61,54272
buffer_load_dwordx4 v33,s[24:27],s42 offen offset:3072 lds
s_mov_b32 m0,135168
s_add_u32 s41,s61,65536
buffer_load_dwordx4 v32,s[24:27],s41 offen lds
s_add_u32 s42,s61,72704
buffer_load_dwordx4 v33,s[24:27],s42 offen offset:1024 lds
s_add_u32 s41,s61,79872
buffer_load_dwordx4 v32,s[24:27],s41 offen offset:2048 lds
s_add_u32 s42,s61,87040
buffer_load_dwordx4 v33,s[24:27],s42 offen offset:3072 lds
s_waitcnt vmcnt(32)
s_waitcnt lgkmcnt(0)
s_barrier
ds_read_b128 a[24:27],v11 offset:36864
ds_read_b128 a[28:31],v12 offset:36864
ds_read_b128 a[88:91],v11 offset:38912
ds_read_b128 a[92:95],v12 offset:38912
ds_read_b128 a[152:155],v11 offset:40960
ds_read_b128 a[156:159],v12 offset:40960
ds_read_b128 a[216:219],v11 offset:43008
ds_read_b128 a[220:223],v12 offset:43008
ds_read_b128 v[152:155],v11 offset:45056
ds_read_b128 v[156:159],v12 offset:45056
ds_read_b128 v[216:219],v11 offset:47104
ds_read_b128 v[220:223],v12 offset:47104
s_mov_b32 m0,81920
s_add_u32 s41,s53,0
buffer_load_dwordx4 v34,s[16:19],s41 offen lds
s_add_u32 s42,s53,31744
buffer_load_dwordx4 v34,s[16:19],s42 offen offset:1024 lds
s_add_u32 s41,s53,63488
buffer_load_dwordx4 v34,s[16:19],s41 offen offset:2048 lds
s_add_u32 s42,s53,95232
buffer_load_dwordx4 v34,s[16:19],s42 offen offset:3072 lds
s_mov_b32 m0,86016
s_add_u32 s41,s53,131072
buffer_load_dwordx4 v34,s[16:19],s41 offen lds
s_add_u32 s42,s53,162816
buffer_load_dwordx4 v34,s[16:19],s42 offen offset:1024 lds
s_add_u32 s41,s53,194560
buffer_load_dwordx4 v34,s[16:19],s41 offen offset:2048 lds
s_add_u32 s42,s53,226304
buffer_load_dwordx4 v34,s[16:19],s42 offen offset:3072 lds
s_mov_b32 m0,90112
s_add_u32 s41,s53,262144
buffer_load_dwordx4 v34,s[16:19],s41 offen lds
s_add_u32 s42,s53,293888
buffer_load_dwordx4 v34,s[16:19],s42 offen offset:1024 lds
s_add_u32 s41,s53,325632
buffer_load_dwordx4 v34,s[16:19],s41 offen offset:2048 lds
s_add_u32 s42,s53,357376
buffer_load_dwordx4 v34,s[16:19],s42 offen offset:3072 lds
s_mov_b32 m0,94208
s_add_u32 s41,s53,393216
buffer_load_dwordx4 v34,s[16:19],s41 offen lds
s_add_u32 s42,s53,424960
buffer_load_dwordx4 v34,s[16:19],s42 offen offset:1024 lds
s_add_u32 s41,s53,456704
buffer_load_dwordx4 v34,s[16:19],s41 offen offset:2048 lds
s_add_u32 s42,s53,488448
buffer_load_dwordx4 v34,s[16:19],s42 offen offset:3072 lds
s_mov_b32 m0,139264
s_add_u32 s41,s62,0
buffer_load_dwordx4 v32,s[24:27],s41 offen lds
s_add_u32 s42,s62,7168
buffer_load_dwordx4 v33,s[24:27],s42 offen offset:1024 lds
s_add_u32 s41,s62,14336
buffer_load_dwordx4 v32,s[24:27],s41 offen offset:2048 lds
s_add_u32 s42,s62,21504
buffer_load_dwordx4 v33,s[24:27],s42 offen offset:3072 lds
s_mov_b32 m0,143360
s_add_u32 s41,s62,32768
buffer_load_dwordx4 v32,s[24:27],s41 offen lds
s_add_u32 s42,s62,39936
buffer_load_dwordx4 v33,s[24:27],s42 offen offset:1024 lds
s_add_u32 s41,s62,47104
buffer_load_dwordx4 v32,s[24:27],s41 offen offset:2048 lds
s_add_u32 s42,s62,54272
buffer_load_dwordx4 v33,s[24:27],s42 offen offset:3072 lds
s_mov_b32 m0,147456
s_add_u32 s41,s62,65536
buffer_load_dwordx4 v32,s[24:27],s41 offen lds
s_add_u32 s42,s62,72704
buffer_load_dwordx4 v33,s[24:27],s42 offen offset:1024 lds
s_add_u32 s41,s62,79872
buffer_load_dwordx4 v32,s[24:27],s41 offen offset:2048 lds
s_add_u32 s42,s62,87040
buffer_load_dwordx4 v33,s[24:27],s42 offen offset:3072 lds
s_waitcnt vmcnt(32)
s_waitcnt lgkmcnt(0)
s_barrier
ds_read_b128 a[32:35],v11
ds_read_b128 a[36:39],v12
ds_read_b128 a[96:99],v11 offset:2048
ds_read_b128 a[100:103],v12 offset:2048
ds_read_b128 a[160:163],v11 offset:4096
ds_read_b128 a[164:167],v12 offset:4096
ds_read_b128 a[224:227],v11 offset:6144
ds_read_b128 a[228:231],v12 offset:6144
ds_read_b128 v[160:163],v11 offset:8192
ds_read_b128 v[164:167],v12 offset:8192
ds_read_b128 v[224:227],v11 offset:10240
ds_read_b128 v[228:231],v12 offset:10240
s_mov_b32 m0,49152
s_add_u32 s41,s54,0
buffer_load_dwordx4 v34,s[16:19],s41 offen lds
s_add_u32 s42,s54,31744
buffer_load_dwordx4 v34,s[16:19],s42 offen offset:1024 lds
s_add_u32 s41,s54,63488
buffer_load_dwordx4 v34,s[16:19],s41 offen offset:2048 lds
s_add_u32 s42,s54,95232
buffer_load_dwordx4 v34,s[16:19],s42 offen offset:3072 lds
s_mov_b32 m0,53248
s_add_u32 s41,s54,131072
buffer_load_dwordx4 v34,s[16:19],s41 offen lds
s_add_u32 s42,s54,162816
buffer_load_dwordx4 v34,s[16:19],s42 offen offset:1024 lds
s_add_u32 s41,s54,194560
buffer_load_dwordx4 v34,s[16:19],s41 offen offset:2048 lds
s_add_u32 s42,s54,226304
buffer_load_dwordx4 v34,s[16:19],s42 offen offset:3072 lds
s_mov_b32 m0,57344
s_add_u32 s41,s54,262144
buffer_load_dwordx4 v34,s[16:19],s41 offen lds
s_add_u32 s42,s54,293888
buffer_load_dwordx4 v34,s[16:19],s42 offen offset:1024 lds
s_add_u32 s41,s54,325632
buffer_load_dwordx4 v34,s[16:19],s41 offen offset:2048 lds
s_add_u32 s42,s54,357376
buffer_load_dwordx4 v34,s[16:19],s42 offen offset:3072 lds
s_mov_b32 m0,61440
s_add_u32 s41,s54,393216
buffer_load_dwordx4 v34,s[16:19],s41 offen lds
s_add_u32 s42,s54,424960
buffer_load_dwordx4 v34,s[16:19],s42 offen offset:1024 lds
s_add_u32 s41,s54,456704
buffer_load_dwordx4 v34,s[16:19],s41 offen offset:2048 lds
s_add_u32 s42,s54,488448
buffer_load_dwordx4 v34,s[16:19],s42 offen offset:3072 lds
s_mov_b32 m0,151552
s_add_u32 s41,s63,0
buffer_load_dwordx4 v32,s[24:27],s41 offen lds
s_add_u32 s42,s63,7168
buffer_load_dwordx4 v33,s[24:27],s42 offen offset:1024 lds
s_add_u32 s41,s63,14336
buffer_load_dwordx4 v32,s[24:27],s41 offen offset:2048 lds
s_add_u32 s42,s63,21504
buffer_load_dwordx4 v33,s[24:27],s42 offen offset:3072 lds
s_mov_b32 m0,155648
s_add_u32 s41,s63,32768
buffer_load_dwordx4 v32,s[24:27],s41 offen lds
s_add_u32 s42,s63,39936
buffer_load_dwordx4 v33,s[24:27],s42 offen offset:1024 lds
s_add_u32 s41,s63,47104
buffer_load_dwordx4 v32,s[24:27],s41 offen offset:2048 lds
s_add_u32 s42,s63,54272
buffer_load_dwordx4 v33,s[24:27],s42 offen offset:3072 lds
s_mov_b32 m0,159744
s_add_u32 s41,s63,65536
buffer_load_dwordx4 v32,s[24:27],s41 offen lds
s_add_u32 s42,s63,72704
buffer_load_dwordx4 v33,s[24:27],s42 offen offset:1024 lds
s_add_u32 s41,s63,79872
buffer_load_dwordx4 v32,s[24:27],s41 offen offset:2048 lds
s_add_u32 s42,s63,87040
buffer_load_dwordx4 v33,s[24:27],s42 offen offset:3072 lds
s_mov_b32 m0,98304
s_add_u32 s41,s48,256
buffer_load_dwordx4 v7,s[16:19],s41 offen lds
s_add_u32 s42,s48,64768
buffer_load_dwordx4 v7,s[16:19],s42 offen offset:1024 lds
s_add_u32 s41,s48,129280
buffer_load_dwordx4 v7,s[16:19],s41 offen offset:2048 lds
s_add_u32 s42,s48,193792
s_waitcnt vmcnt(54)
buffer_load_dwordx4 v7,s[16:19],s42 offen offset:3072 lds
s_mov_b32 m0,102400
s_add_u32 s41,s48,262400
buffer_load_dwordx4 v7,s[16:19],s41 offen lds
s_add_u32 s42,s48,326912
buffer_load_dwordx4 v7,s[16:19],s42 offen offset:1024 lds
s_add_u32 s41,s48,391424
buffer_load_dwordx4 v7,s[16:19],s41 offen offset:2048 lds
s_add_u32 s42,s48,455936
buffer_load_dwordx4 v7,s[16:19],s42 offen offset:3072 lds
s_waitcnt vmcnt(32)
s_waitcnt lgkmcnt(0)
s_barrier
ds_read_b128 a[40:43],v11 offset:12288
ds_read_b128 a[44:47],v12 offset:12288
ds_read_b128 a[104:107],v11 offset:14336
ds_read_b128 a[108:111],v12 offset:14336
ds_read_b128 a[168:171],v11 offset:16384
ds_read_b128 a[172:175],v12 offset:16384
ds_read_b128 a[232:235],v11 offset:18432
ds_read_b128 a[236:239],v12 offset:18432
ds_read_b128 v[168:171],v11 offset:20480
ds_read_b128 v[172:175],v12 offset:20480
ds_read_b128 v[232:235],v11 offset:22528
ds_read_b128 v[236:239],v12 offset:22528
s_mov_b32 m0,65536
s_add_u32 s41,s55,0
buffer_load_dwordx4 v34,s[16:19],s41 offen lds
s_add_u32 s42,s55,31744
buffer_load_dwordx4 v34,s[16:19],s42 offen offset:1024 lds
s_add_u32 s41,s55,63488
buffer_load_dwordx4 v34,s[16:19],s41 offen offset:2048 lds
s_add_u32 s42,s55,95232
buffer_load_dwordx4 v34,s[16:19],s42 offen offset:3072 lds
s_mov_b32 m0,69632
s_add_u32 s41,s55,131072
buffer_load_dwordx4 v34,s[16:19],s41 offen lds
s_add_u32 s42,s55,162816
buffer_load_dwordx4 v34,s[16:19],s42 offen offset:1024 lds
s_add_u32 s41,s55,194560
buffer_load_dwordx4 v34,s[16:19],s41 offen offset:2048 lds
s_add_u32 s42,s55,226304
buffer_load_dwordx4 v34,s[16:19],s42 offen offset:3072 lds
s_mov_b32 m0,73728
s_add_u32 s41,s55,262144
buffer_load_dwordx4 v34,s[16:19],s41 offen lds
s_add_u32 s42,s55,293888
buffer_load_dwordx4 v34,s[16:19],s42 offen offset:1024 lds
s_add_u32 s41,s55,325632
buffer_load_dwordx4 v34,s[16:19],s41 offen offset:2048 lds
s_add_u32 s42,s55,357376
buffer_load_dwordx4 v34,s[16:19],s42 offen offset:3072 lds
s_mov_b32 m0,77824
s_add_u32 s41,s55,393216
buffer_load_dwordx4 v34,s[16:19],s41 offen lds
s_add_u32 s42,s55,424960
buffer_load_dwordx4 v34,s[16:19],s42 offen offset:1024 lds
s_add_u32 s41,s55,456704
buffer_load_dwordx4 v34,s[16:19],s41 offen offset:2048 lds
s_add_u32 s42,s55,488448
buffer_load_dwordx4 v34,s[16:19],s42 offen offset:3072 lds
s_mov_b32 m0,0
s_add_u32 s41,s40,0
buffer_load_dwordx4 v1,s[8:11],s41 offen nt lds
buffer_load_dwordx4 v2,s[8:11],s41 offen offset:1024 nt lds
buffer_load_dwordx4 v3,s[8:11],s41 offen offset:2048 nt lds
buffer_load_dwordx4 v4,s[8:11],s41 offen offset:3072 nt lds
s_mov_b32 m0,4096
s_add_u32 s42,s40,4096
buffer_load_dwordx4 v1,s[8:11],s42 offen nt lds
buffer_load_dwordx4 v2,s[8:11],s42 offen offset:1024 nt lds
buffer_load_dwordx4 v3,s[8:11],s42 offen offset:2048 nt lds
buffer_load_dwordx4 v4,s[8:11],s42 offen offset:3072 nt lds
s_mov_b32 m0,106496
s_add_u32 s41,s49,256
buffer_load_dwordx4 v7,s[16:19],s41 offen lds
s_add_u32 s42,s49,64768
buffer_load_dwordx4 v7,s[16:19],s42 offen offset:1024 lds
s_add_u32 s41,s49,129280
buffer_load_dwordx4 v7,s[16:19],s41 offen offset:2048 lds
s_add_u32 s42,s49,193792
buffer_load_dwordx4 v7,s[16:19],s42 offen offset:3072 lds
s_mov_b32 m0,110592
s_add_u32 s41,s49,262400
buffer_load_dwordx4 v7,s[16:19],s41 offen lds
s_add_u32 s42,s49,326912
buffer_load_dwordx4 v7,s[16:19],s42 offen offset:1024 lds
s_add_u32 s41,s49,391424
buffer_load_dwordx4 v7,s[16:19],s41 offen offset:2048 lds
s_add_u32 s42,s49,455936
s_waitcnt vmcnt(54)
buffer_load_dwordx4 v7,s[16:19],s42 offen offset:3072 lds
s_waitcnt vmcnt(32)
s_waitcnt lgkmcnt(0)
s_barrier
ds_read_b64_tr_b16 v[16:17],v8
ds_read_b64_tr_b16 v[18:19],v8 offset:512
ds_read_b64_tr_b16 v[20:21],v8 offset:8
ds_read_b64_tr_b16 v[22:23],v8 offset:520
s_waitcnt lgkmcnt(2)
v_mfma_f32_16x16x32_bf16 v[32:35],v[16:19],a[0:3],0
ds_read_b64_tr_b16 v[24:25],v9
ds_read_b64_tr_b16 v[26:27],v9 offset:512
v_mfma_f32_16x16x32_bf16 v[40:43],v[16:19],a[64:67],0
s_mov_b32 m0,8192
s_add_u32 s41,s40,8192
buffer_load_dwordx4 v1,s[8:11],s41 offen nt lds
v_mfma_f32_16x16x32_bf16 v[48:51],v[16:19],a[128:131],0
buffer_load_dwordx4 v2,s[8:11],s41 offen offset:1024 nt lds
v_mfma_f32_16x16x32_bf16 v[56:59],v[16:19],a[192:195],0
buffer_load_dwordx4 v3,s[8:11],s41 offen offset:2048 nt lds
v_mfma_f32_16x16x32_bf16 v[64:67],v[16:19],v[128:131],0
buffer_load_dwordx4 v4,s[8:11],s41 offen offset:3072 nt lds
v_mfma_f32_16x16x32_bf16 v[72:75],v[16:19],v[192:195],0
s_mov_b32 m0,12288
s_add_u32 s42,s40,12288
buffer_load_dwordx4 v1,s[8:11],s42 offen nt lds
s_waitcnt lgkmcnt(2)
v_mfma_f32_16x16x32_bf16 v[76:79],v[20:23],v[192:195],0
ds_read_b64_tr_b16 v[28:29],v9 offset:8
ds_read_b64_tr_b16 v[30:31],v9 offset:520
v_mfma_f32_16x16x32_bf16 v[68:71],v[20:23],v[128:131],0
buffer_load_dwordx4 v2,s[8:11],s42 offen offset:1024 nt lds
v_mfma_f32_16x16x32_bf16 v[60:63],v[20:23],a[192:195],0
buffer_load_dwordx4 v3,s[8:11],s42 offen offset:2048 nt lds
v_mfma_f32_16x16x32_bf16 v[52:55],v[20:23],a[128:131],0
buffer_load_dwordx4 v4,s[8:11],s42 offen offset:3072 nt lds
v_mfma_f32_16x16x32_bf16 v[44:47],v[20:23],a[64:67],0
s_mov_b32 m0,114688
s_add_u32 s41,s50,256
buffer_load_dwordx4 v7,s[16:19],s41 offen lds
v_mfma_f32_16x16x32_bf16 v[36:39],v[20:23],a[0:3],0
s_add_u32 s42,s50,64768
L_chain1:
L_tp_q1:
s_cbranch_execz L_tp_q3
buffer_load_dwordx4 v7,s[16:19],s42 offen offset:1024 lds
s_waitcnt lgkmcnt(2)
v_mfma_f32_16x16x32_bf16 v[80:83],v[24:27],a[0:3],0
ds_read_b64_tr_b16 v[16:17],v8 offset:4096
ds_read_b64_tr_b16 v[18:19],v8 offset:4608
v_mfma_f32_16x16x32_bf16 v[88:91],v[24:27],a[64:67],0
s_add_u32 s41,s50,129280
buffer_load_dwordx4 v7,s[16:19],s41 offen offset:2048 lds
v_mfma_f32_16x16x32_bf16 v[96:99],v[24:27],a[128:131],0
s_add_u32 s42,s50,193792
buffer_load_dwordx4 v7,s[16:19],s42 offen offset:3072 lds
v_mfma_f32_16x16x32_bf16 v[104:107],v[24:27],a[192:195],0
v_mfma_f32_16x16x32_bf16 v[112:115],v[24:27],v[128:131],0
s_mov_b32 m0,118784
s_add_u32 s41,s50,262400
buffer_load_dwordx4 v7,s[16:19],s41 offen lds
v_mfma_f32_16x16x32_bf16 v[120:123],v[24:27],v[192:195],0
s_add_u32 s42,s50,326912
buffer_load_dwordx4 v7,s[16:19],s42 offen offset:1024 lds
s_waitcnt lgkmcnt(2)
v_mfma_f32_16x16x32_bf16 v[124:127],v[28:31],v[192:195],0
ds_read_b64_tr_b16 v[20:21],v8 offset:4104
ds_read_b64_tr_b16 v[22:23],v8 offset:4616
v_mfma_f32_16x16x32_bf16 v[116:119],v[28:31],v[128:131],0
s_add_u32 s41,s50,391424
buffer_load_dwordx4 v7,s[16:19],s41 offen offset:2048 lds
v_mfma_f32_16x16x32_bf16 v[108:111],v[28:31],a[192:195],0
s_add_u32 s42,s50,455936
buffer_load_dwordx4 v7,s[16:19],s42 offen offset:3072 lds
v_mfma_f32_16x16x32_bf16 v[100:103],v[28:31],a[128:131],0
ds_read_b128 a[48:51],v11 offset:24576
ds_read_b128 a[52:55],v12 offset:24576
ds_read_b128 a[112:115],v11 offset:26624
ds_read_b128 a[116:119],v12 offset:26624
v_mfma_f32_16x16x32_bf16 v[92:95],v[28:31],a[64:67],0
ds_read_b128 a[176:179],v11 offset:28672
ds_read_b128 a[180:183],v12 offset:28672
ds_read_b128 a[240:243],v11 offset:30720
ds_read_b128 a[244:247],v12 offset:30720
v_mfma_f32_16x16x32_bf16 v[84:87],v[28:31],a[0:3],0
ds_read_b128 v[176:179],v11 offset:32768
ds_read_b128 v[180:183],v12 offset:32768
ds_read_b128 v[240:243],v11 offset:34816
s_waitcnt lgkmcnt(12)
ds_read_b128 v[244:247],v12 offset:34816
s_waitcnt vmcnt(16)
s_waitcnt lgkmcnt(0)
s_barrier
v_mfma_f32_16x16x32_bf16 v[32:35],v[16:19],a[4:7],v[32:35]
ds_read_b64_tr_b16 v[24:25],v9 offset:4096
ds_read_b64_tr_b16 v[26:27],v9 offset:4608
v_mfma_f32_16x16x32_bf16 v[40:43],v[16:19],a[68:71],v[40:43]
s_mov_b32 m0,16384
s_add_u32 s41,s40,16384
buffer_load_dwordx4 v1,s[8:11],s41 offen nt lds
v_mfma_f32_16x16x32_bf16 v[48:51],v[16:19],a[132:135],v[48:51]
buffer_load_dwordx4 v2,s[8:11],s41 offen offset:1024 nt lds
v_mfma_f32_16x16x32_bf16 v[56:59],v[16:19],a[196:199],v[56:59]
buffer_load_dwordx4 v3,s[8:11],s41 offen offset:2048 nt lds
v_mfma_f32_16x16x32_bf16 v[64:67],v[16:19],v[132:135],v[64:67]
buffer_load_dwordx4 v4,s[8:11],s41 offen offset:3072 nt lds
v_mfma_f32_16x16x32_bf16 v[72:75],v[16:19],v[196:199],v[72:75]
s_mov_b32 m0,20480
s_add_u32 s42,s40,20480
buffer_load_dwordx4 v1,s[8:11],s42 offen nt lds
v_mfma_f32_16x16x32_bf16 v[76:79],v[20:23],v[196:199],v[76:79]
ds_read_b64_tr_b16 v[28:29],v9 offset:4104
ds_read_b64_tr_b16 v[30:31],v9 offset:4616
v_mfma_f32_16x16x32_bf16 v[68:71],v[20:23],v[132:135],v[68:71]
buffer_load_dwordx4 v2,s[8:11],s42 offen offset:1024 nt lds
v_mfma_f32_16x16x32_bf16 v[60:63],v[20:23],a[196:199],v[60:63]
buffer_load_dwordx4 v3,s[8:11],s42 offen offset:2048 nt lds
v_mfma_f32_16x16x32_bf16 v[52:55],v[20:23],a[132:135],v[52:55]
buffer_load_dwordx4 v4,s[8:11],s42 offen offset:3072 nt lds
v_mfma_f32_16x16x32_bf16 v[44:47],v[20:23],a[68:71],v[44:47]
v_mfma_f32_16x16x32_bf16 v[36:39],v[20:23],a[4:7],v[36:39]
s_mov_b32 m0,32768
s_add_u32 s41,s40,0
buffer_load_dwordx4 v5,s[12:15],s41 offen nt lds
s_waitcnt lgkmcnt(2)
v_mfma_f32_16x16x32_bf16 v[80:83],v[24:27],a[4:7],v[80:83]
ds_read_b64_tr_b16 v[16:17],v8 offset:8192
ds_read_b64_tr_b16 v[18:19],v8 offset:8704
v_mfma_f32_16x16x32_bf16 v[88:91],v[24:27],a[68:71],v[88:91]
buffer_load_dwordx4 v6,s[12:15],s41 offen offset:1024 nt lds
v_mfma_f32_16x16x32_bf16 v[96:99],v[24:27],a[132:135],v[96:99]
buffer_load_dwordx4 v5,s[12:15],s41 offen offset:2048 nt lds
v_mfma_f32_16x16x32_bf16 v[104:107],v[24:27],a[196:199],v[104:107]
buffer_load_dwordx4 v6,s[12:15],s41 offen offset:3072 nt lds
v_mfma_f32_16x16x32_bf16 v[112:115],v[24:27],v[132:135],v[112:115]
s_mov_b32 m0,36864
s_add_u32 s42,s40,4096
buffer_load_dwordx4 v5,s[12:15],s42 offen nt lds
v_mfma_f32_16x16x32_bf16 v[120:123],v[24:27],v[196:199],v[120:123]
buffer_load_dwordx4 v6,s[12:15],s42 offen offset:1024 nt lds
s_waitcnt lgkmcnt(2)
v_mfma_f32_16x16x32_bf16 v[124:127],v[28:31],v[196:199],v[124:127]
ds_read_b64_tr_b16 v[20:21],v8 offset:8200
ds_read_b64_tr_b16 v[22:23],v8 offset:8712
v_mfma_f32_16x16x32_bf16 v[116:119],v[28:31],v[132:135],v[116:119]
buffer_load_dwordx4 v5,s[12:15],s42 offen offset:2048 nt lds
v_mfma_f32_16x16x32_bf16 v[108:111],v[28:31],a[196:199],v[108:111]
buffer_load_dwordx4 v6,s[12:15],s42 offen offset:3072 nt lds
v_mfma_f32_16x16x32_bf16 v[100:103],v[28:31],a[132:135],v[100:103]
s_mov_b32 m0,122880
s_add_u32 s41,s51,256
buffer_load_dwordx4 v7,s[16:19],s41 offen lds
v_mfma_f32_16x16x32_bf16 v[92:95],v[28:31],a[68:71],v[92:95]
v_mfma_f32_16x16x32_bf16 v[84:87],v[28:31],a[4:7],v[84:87]
s_add_u32 s42,s51,64768
buffer_load_dwordx4 v7,s[16:19],s42 offen offset:1024 lds
s_waitcnt lgkmcnt(2)
v_mfma_f32_16x16x32_bf16 v[32:35],v[16:19],a[8:11],v[32:35]
ds_read_b64_tr_b16 v[24:25],v9 offset:8192
ds_read_b64_tr_b16 v[26:27],v9 offset:8704
v_mfma_f32_16x16x32_bf16 v[40:43],v[16:19],a[72:75],v[40:43]
s_add_u32 s41,s51,129280
buffer_load_dwordx4 v7,s[16:19],s41 offen offset:2048 lds
v_mfma_f32_16x16x32_bf16 v[48:51],v[16:19],a[136:139],v[48:51]
s_add_u32 s42,s51,193792
buffer_load_dwordx4 v7,s[16:19],s42 offen offset:3072 lds
v_mfma_f32_16x16x32_bf16 v[56:59],v[16:19],a[200:203],v[56:59]
s_mov_b32 m0,126976
s_add_u32 s41,s51,262400
buffer_load_dwordx4 v7,s[16:19],s41 offen lds
v_mfma_f32_16x16x32_bf16 v[64:67],v[16:19],v[136:139],v[64:67]
v_mfma_f32_16x16x32_bf16 v[72:75],v[16:19],v[200:203],v[72:75]
s_add_u32 s42,s51,326912
buffer_load_dwordx4 v7,s[16:19],s42 offen offset:1024 lds
s_waitcnt lgkmcnt(2)
v_mfma_f32_16x16x32_bf16 v[76:79],v[20:23],v[200:203],v[76:79]
ds_read_b64_tr_b16 v[28:29],v9 offset:8200
ds_read_b64_tr_b16 v[30:31],v9 offset:8712
v_mfma_f32_16x16x32_bf16 v[68:71],v[20:23],v[136:139],v[68:71]
s_add_u32 s41,s51,391424
buffer_load_dwordx4 v7,s[16:19],s41 offen offset:2048 lds
v_mfma_f32_16x16x32_bf16 v[60:63],v[20:23],a[200:203],v[60:63]
s_add_u32 s42,s51,455936
buffer_load_dwordx4 v7,s[16:19],s42 offen offset:3072 lds
v_mfma_f32_16x16x32_bf16 v[52:55],v[20:23],a[136:139],v[52:55]
ds_read_b128 a[56:59],v11 offset:36864
ds_read_b128 a[60:63],v12 offset:36864
ds_read_b128 a[120:123],v11 offset:38912
ds_read_b128 a[124:127],v12 offset:38912
v_mfma_f32_16x16x32_bf16 v[44:47],v[20:23],a[72:75],v[44:47]
ds_read_b128 a[184:187],v11 offset:40960
ds_read_b128 a[188:191],v12 offset:40960
ds_read_b128 a[248:251],v11 offset:43008
ds_read_b128 a[252:255],v12 offset:43008
v_mfma_f32_16x16x32_bf16 v[36:39],v[20:23],a[8:11],v[36:39]
ds_read_b128 v[184:187],v11 offset:45056
ds_read_b128 v[188:191],v12 offset:45056
ds_read_b128 v[248:251],v11 offset:47104
s_waitcnt lgkmcnt(12)
ds_read_b128 v[252:255],v12 offset:47104
s_waitcnt vmcnt(24)
s_waitcnt lgkmcnt(0)
s_barrier
v_mfma_f32_16x16x32_bf16 v[80:83],v[24:27],a[8:11],v[80:83]
ds_read_b64_tr_b16 v[16:17],v8 offset:12288
ds_read_b64_tr_b16 v[18:19],v8 offset:12800
v_mfma_f32_16x16x32_bf16 v[88:91],v[24:27],a[72:75],v[88:91]
s_mov_b32 m0,24576
s_add_u32 s41,s40,24576
buffer_load_dwordx4 v1,s[8:11],s41 offen nt lds
v_mfma_f32_16x16x32_bf16 v[96:99],v[24:27],a[136:139],v[96:99]
buffer_load_dwordx4 v2,s[8:11],s41 offen offset:1024 nt lds
buffer_load_dwordx4 v3,s[8:11],s41 offen offset:2048 nt lds
v_mfma_f32_16x16x32_bf16 v[104:107],v[24:27],a[200:203],v[104:107]
buffer_load_dwordx4 v4,s[8:11],s41 offen offset:3072 nt lds
v_mfma_f32_16x16x32_bf16 v[112:115],v[24:27],v[136:139],v[112:115]
s_mov_b32 m0,28672
s_add_u32 s42,s40,28672
buffer_load_dwordx4 v1,s[8:11],s42 offen nt lds
v_mfma_f32_16x16x32_bf16 v[120:123],v[24:27],v[200:203],v[120:123]
buffer_load_dwordx4 v2,s[8:11],s42 offen offset:1024 nt lds
buffer_load_dwordx4 v3,s[8:11],s42 offen offset:2048 nt lds
v_mfma_f32_16x16x32_bf16 v[124:127],v[28:31],v[200:203],v[124:127]
ds_read_b64_tr_b16 v[20:21],v8 offset:12296
ds_read_b64_tr_b16 v[22:23],v8 offset:12808
v_mfma_f32_16x16x32_bf16 v[116:119],v[28:31],v[136:139],v[116:119]
buffer_load_dwordx4 v4,s[8:11],s42 offen offset:3072 nt lds
s_mov_b32 m0,40960
s_add_u32 s41,s40,8192
buffer_load_dwordx4 v5,s[12:15],s41 offen nt lds
v_mfma_f32_16x16x32_bf16 v[108:111],v[28:31],a[200:203],v[108:111]
buffer_load_dwordx4 v6,s[12:15],s41 offen offset:1024 nt lds
v_mfma_f32_16x16x32_bf16 v[100:103],v[28:31],a[136:139],v[100:103]
buffer_load_dwordx4 v5,s[12:15],s41 offen offset:2048 nt lds
v_mfma_f32_16x16x32_bf16 v[92:95],v[28:31],a[72:75],v[92:95]
buffer_load_dwordx4 v6,s[12:15],s41 offen offset:3072 nt lds
s_mov_b32 m0,45056
s_add_u32 s42,s40,12288
buffer_load_dwordx4 v5,s[12:15],s42 offen nt lds
v_mfma_f32_16x16x32_bf16 v[84:87],v[28:31],a[8:11],v[84:87]
buffer_load_dwordx4 v6,s[12:15],s42 offen offset:1024 nt lds
s_waitcnt lgkmcnt(2)
v_mfma_f32_16x16x32_bf16 v[32:35],v[16:19],a[12:15],v[32:35]
ds_read_b64_tr_b16 v[24:25],v9 offset:12288
ds_read_b64_tr_b16 v[26:27],v9 offset:12800
v_mfma_f32_16x16x32_bf16 v[40:43],v[16:19],a[76:79],v[40:43]
buffer_load_dwordx4 v5,s[12:15],s42 offen offset:2048 nt lds
buffer_load_dwordx4 v6,s[12:15],s42 offen offset:3072 nt lds
v_mfma_f32_16x16x32_bf16 v[48:51],v[16:19],a[140:143],v[48:51]
s_mov_b32 m0,98304
s_add_u32 s41,s52,256
buffer_load_dwordx4 v7,s[16:19],s41 offen lds
v_mfma_f32_16x16x32_bf16 v[56:59],v[16:19],a[204:207],v[56:59]
s_add_u32 s42,s52,64768
buffer_load_dwordx4 v7,s[16:19],s42 offen offset:1024 lds
v_mfma_f32_16x16x32_bf16 v[64:67],v[16:19],v[140:143],v[64:67]
s_add_u32 s41,s52,129280
buffer_load_dwordx4 v7,s[16:19],s41 offen offset:2048 lds
v_mfma_f32_16x16x32_bf16 v[72:75],v[16:19],v[204:207],v[72:75]
s_add_u32 s42,s52,193792
buffer_load_dwordx4 v7,s[16:19],s42 offen offset:3072 lds
s_waitcnt lgkmcnt(2)
v_mfma_f32_16x16x32_bf16 v[76:79],v[20:23],v[204:207],v[76:79]
ds_read_b64_tr_b16 v[28:29],v9 offset:12296
ds_read_b64_tr_b16 v[30:31],v9 offset:12808
s_mov_b32 m0,102400
s_add_u32 s41,s52,262400
buffer_load_dwordx4 v7,s[16:19],s41 offen lds
v_mfma_f32_16x16x32_bf16 v[68:71],v[20:23],v[140:143],v[68:71]
s_add_u32 s42,s52,326912
buffer_load_dwordx4 v7,s[16:19],s42 offen offset:1024 lds
v_mfma_f32_16x16x32_bf16 v[60:63],v[20:23],a[204:207],v[60:63]
s_add_u32 s41,s52,391424
buffer_load_dwordx4 v7,s[16:19],s41 offen offset:2048 lds
v_mfma_f32_16x16x32_bf16 v[52:55],v[20:23],a[140:143],v[52:55]
s_add_u32 s42,s52,455936
buffer_load_dwordx4 v7,s[16:19],s42 offen offset:3072 lds
v_lshrrev_b32 v15,4,v0
v_mfma_f32_16x16x32_bf16 v[44:47],v[20:23],a[76:79],v[44:47]
v_mul_u32_u24 v15,768,v15
v_xor_b32 v11,s90,v5
v_add_u32 v11,v11,v15
v_xor_b32 v12,s90,v6
v_add_u32 v12,v12,v15
v_add_u32 v12,3072,v12
v_mfma_f32_16x16x32_bf16 v[36:39],v[20:23],a[12:15],v[36:39]
v_xor_b32 v13,s90,v5
v_add_u32 v13,v13,v15
v_add_u32 v13,6144,v13
v_xor_b32 v14,s90,v6
v_add_u32 v14,v14,v15
v_add_u32 v14,9216,v14
s_waitcnt vmcnt(24)
L_lloop0:
s_barrier
s_mov_b32 m0,0
s_add_u32 s41,s40,32768
buffer_load_dwordx4 v1,s[8:11],s41 offen nt lds
buffer_load_dwordx4 v2,s[8:11],s41 offen offset:1024 nt lds
buffer_load_dwordx4 v3,s[8:11],s41 offen offset:2048 nt lds
buffer_load_dwordx4 v4,s[8:11],s41 offen offset:3072 nt lds
s_waitcnt lgkmcnt(2)
v_mfma_f32_16x16x32_bf16 v[80:83],v[24:27],a[12:15],v[80:83]
ds_read_b64_tr_b16 v[16:17],v8 offset:16384
ds_read_b64_tr_b16 v[18:19],v8 offset:16896
v_mfma_f32_16x16x32_bf16 v[88:91],v[24:27],a[76:79],v[88:91]
s_mov_b32 m0,4096
s_add_u32 s42,s40,36864
v_mfma_f32_16x16x32_bf16 v[96:99],v[24:27],a[140:143],v[96:99]
buffer_load_dwordx4 v1,s[8:11],s42 offen nt lds
v_mfma_f32_16x16x32_bf16 v[104:107],v[24:27],a[204:207],v[104:107]
v_mfma_f32_16x16x32_bf16 v[112:115],v[24:27],v[140:143],v[112:115]
buffer_load_dwordx4 v2,s[8:11],s42 offen offset:1024 nt lds
v_mfma_f32_16x16x32_bf16 v[120:123],v[24:27],v[204:207],v[120:123]
buffer_load_dwordx4 v3,s[8:11],s42 offen offset:2048 nt lds
s_waitcnt lgkmcnt(2)
v_mfma_f32_16x16x32_bf16 v[124:127],v[28:31],v[204:207],v[124:127]
ds_read_b64_tr_b16 v[20:21],v8 offset:16392
ds_read_b64_tr_b16 v[22:23],v8 offset:16904
v_mfma_f32_16x16x32_bf16 v[116:119],v[28:31],v[140:143],v[116:119]
v_mfma_f32_16x16x32_bf16 v[108:111],v[28:31],a[204:207],v[108:111]
v_mfma_f32_16x16x32_bf16 v[100:103],v[28:31],a[140:143],v[100:103]
v_mfma_f32_16x16x32_bf16 v[92:95],v[28:31],a[76:79],v[92:95]
buffer_load_dwordx4 v4,s[8:11],s42 offen offset:3072 nt lds
v_mfma_f32_16x16x32_bf16 v[84:87],v[28:31],a[12:15],v[84:87]
s_mov_b32 m0,49152
s_add_u32 s41,s40,16384
buffer_load_dwordx4 v5,s[12:15],s41 offen nt lds
s_waitcnt lgkmcnt(2)
v_mfma_f32_16x16x32_bf16 v[32:35],v[16:19],a[16:19],v[32:35]
ds_read_b64_tr_b16 v[24:25],v9 offset:16384
ds_read_b64_tr_b16 v[26:27],v9 offset:16896
v_mfma_f32_16x16x32_bf16 v[40:43],v[16:19],a[80:83],v[40:43]
v_mfma_f32_16x16x32_bf16 v[48:51],v[16:19],a[144:147],v[48:51]
buffer_load_dwordx4 v6,s[12:15],s41 offen offset:1024 nt lds
v_mfma_f32_16x16x32_bf16 v[56:59],v[16:19],a[208:211],v[56:59]
v_mfma_f32_16x16x32_bf16 v[64:67],v[16:19],v[144:147],v[64:67]
v_mfma_f32_16x16x32_bf16 v[72:75],v[16:19],v[208:211],v[72:75]
buffer_load_dwordx4 v5,s[12:15],s41 offen offset:2048 nt lds
s_waitcnt lgkmcnt(2)
v_mfma_f32_16x16x32_bf16 v[76:79],v[20:23],v[208:211],v[76:79]
ds_read_b64_tr_b16 v[28:29],v9 offset:16392
ds_read_b64_tr_b16 v[30:31],v9 offset:16904
v_mfma_f32_16x16x32_bf16 v[68:71],v[20:23],v[144:147],v[68:71]
v_mfma_f32_16x16x32_bf16 v[60:63],v[20:23],a[208:211],v[60:63]
buffer_load_dwordx4 v6,s[12:15],s41 offen offset:3072 nt lds
v_mfma_f32_16x16x32_bf16 v[52:55],v[20:23],a[144:147],v[52:55]
s_mov_b32 m0,53248
s_add_u32 s42,s40,20480
v_mfma_f32_16x16x32_bf16 v[44:47],v[20:23],a[80:83],v[44:47]
buffer_load_dwordx4 v5,s[12:15],s42 offen nt lds
v_mfma_f32_16x16x32_bf16 v[36:39],v[20:23],a[16:19],v[36:39]
s_waitcnt lgkmcnt(2)
v_mfma_f32_16x16x32_bf16 v[80:83],v[24:27],a[16:19],v[80:83]
ds_read_b64_tr_b16 v[16:17],v8 offset:20480
ds_read_b64_tr_b16 v[18:19],v8 offset:20992
v_mfma_f32_16x16x32_bf16 v[88:91],v[24:27],a[80:83],v[88:91]
v_mfma_f32_16x16x32_bf16 v[96:99],v[24:27],a[144:147],v[96:99]
buffer_load_dwordx4 v6,s[12:15],s42 offen offset:1024 nt lds
v_mfma_f32_16x16x32_bf16 v[104:107],v[24:27],a[208:211],v[104:107]
v_mfma_f32_16x16x32_bf16 v[112:115],v[24:27],v[144:147],v[112:115]
buffer_load_dwordx4 v5,s[12:15],s42 offen offset:2048 nt lds
v_mfma_f32_16x16x32_bf16 v[120:123],v[24:27],v[208:211],v[120:123]
buffer_load_dwordx4 v6,s[12:15],s42 offen offset:3072 nt lds
s_waitcnt lgkmcnt(2)
v_mfma_f32_16x16x32_bf16 v[124:127],v[28:31],v[208:211],v[124:127]
ds_read_b64_tr_b16 v[20:21],v8 offset:20488
ds_read_b64_tr_b16 v[22:23],v8 offset:21000
v_mfma_f32_16x16x32_bf16 v[116:119],v[28:31],v[144:147],v[116:119]
v_mfma_f32_16x16x32_bf16 v[108:111],v[28:31],a[208:211],v[108:111]
v_mfma_f32_16x16x32_bf16 v[100:103],v[28:31],a[144:147],v[100:103]
s_mov_b32 m0,106496
s_add_u32 s41,s53,256
v_mfma_f32_16x16x32_bf16 v[92:95],v[28:31],a[80:83],v[92:95]
buffer_load_dwordx4 v7,s[16:19],s41 offen lds
v_mfma_f32_16x16x32_bf16 v[84:87],v[28:31],a[16:19],v[84:87]
s_add_u32 s42,s53,64768
buffer_load_dwordx4 v7,s[16:19],s42 offen offset:1024 lds
s_waitcnt lgkmcnt(2)
v_mfma_f32_16x16x32_bf16 v[32:35],v[16:19],a[20:23],v[32:35]
ds_read_b64_tr_b16 v[24:25],v9 offset:20480
ds_read_b64_tr_b16 v[26:27],v9 offset:20992
v_mfma_f32_16x16x32_bf16 v[40:43],v[16:19],a[84:87],v[40:43]
s_add_u32 s41,s53,129280
v_mfma_f32_16x16x32_bf16 v[48:51],v[16:19],a[148:151],v[48:51]
buffer_load_dwordx4 v7,s[16:19],s41 offen offset:2048 lds
v_mfma_f32_16x16x32_bf16 v[56:59],v[16:19],a[212:215],v[56:59]
s_add_u32 s42,s53,193792
v_mfma_f32_16x16x32_bf16 v[64:67],v[16:19],v[148:151],v[64:67]
v_mfma_f32_16x16x32_bf16 v[72:75],v[16:19],v[212:215],v[72:75]
buffer_load_dwordx4 v7,s[16:19],s42 offen offset:3072 lds
s_waitcnt lgkmcnt(2)
v_mfma_f32_16x16x32_bf16 v[76:79],v[20:23],v[212:215],v[76:79]
ds_read_b64_tr_b16 v[28:29],v9 offset:20488
ds_read_b64_tr_b16 v[30:31],v9 offset:21000
v_mfma_f32_16x16x32_bf16 v[68:71],v[20:23],v[148:151],v[68:71]
s_mov_b32 m0,110592
s_add_u32 s41,s53,262400
v_mfma_f32_16x16x32_bf16 v[60:63],v[20:23],a[212:215],v[60:63]
buffer_load_dwordx4 v7,s[16:19],s41 offen lds
v_mfma_f32_16x16x32_bf16 v[52:55],v[20:23],a[148:151],v[52:55]
s_add_u32 s42,s53,326912
v_mfma_f32_16x16x32_bf16 v[44:47],v[20:23],a[84:87],v[44:47]
buffer_load_dwordx4 v7,s[16:19],s42 offen offset:1024 lds
v_mfma_f32_16x16x32_bf16 v[36:39],v[20:23],a[20:23],v[36:39]
s_waitcnt lgkmcnt(2)
v_mfma_f32_16x16x32_bf16 v[80:83],v[24:27],a[20:23],v[80:83]
ds_read_b64_tr_b16 v[16:17],v8 offset:24576
ds_read_b64_tr_b16 v[18:19],v8 offset:25088
v_mfma_f32_16x16x32_bf16 v[88:91],v[24:27],a[84:87],v[88:91]
s_add_u32 s41,s53,391424
v_mfma_f32_16x16x32_bf16 v[96:99],v[24:27],a[148:151],v[96:99]
buffer_load_dwordx4 v7,s[16:19],s41 offen offset:2048 lds
v_mfma_f32_16x16x32_bf16 v[104:107],v[24:27],a[212:215],v[104:107]
s_add_u32 s42,s53,455936
v_mfma_f32_16x16x32_bf16 v[112:115],v[24:27],v[148:151],v[112:115]
buffer_load_dwordx4 v7,s[16:19],s42 offen offset:3072 lds
v_mfma_f32_16x16x32_bf16 v[120:123],v[24:27],v[212:215],v[120:123]
s_cmp_eq_u32 s3,0
s_cbranch_scc1 L_light1
s_waitcnt vmcnt(19)
s_branch L_heavy1
L_light1:
s_waitcnt vmcnt(24)
L_heavy1:
s_barrier
s_mov_b32 m0,8192
s_add_u32 s41,s40,40960
buffer_load_dwordx4 v1,s[8:11],s41 offen nt lds
buffer_load_dwordx4 v2,s[8:11],s41 offen offset:1024 nt lds
buffer_load_dwordx4 v3,s[8:11],s41 offen offset:2048 nt lds
buffer_load_dwordx4 v4,s[8:11],s41 offen offset:3072 nt lds
s_waitcnt lgkmcnt(2)
v_mfma_f32_16x16x32_bf16 v[124:127],v[28:31],v[212:215],v[124:127]
ds_read_b64_tr_b16 v[20:21],v8 offset:24584
ds_read_b64_tr_b16 v[22:23],v8 offset:25096
v_mfma_f32_16x16x32_bf16 v[116:119],v[28:31],v[148:151],v[116:119]
s_mov_b32 m0,12288
s_add_u32 s42,s40,45056
v_mfma_f32_16x16x32_bf16 v[108:111],v[28:31],a[212:215],v[108:111]
buffer_load_dwordx4 v1,s[8:11],s42 offen nt lds
v_mfma_f32_16x16x32_bf16 v[100:103],v[28:31],a[148:151],v[100:103]
v_mfma_f32_16x16x32_bf16 v[92:95],v[28:31],a[84:87],v[92:95]
buffer_load_dwordx4 v2,s[8:11],s42 offen offset:1024 nt lds
v_mfma_f32_16x16x32_bf16 v[84:87],v[28:31],a[20:23],v[84:87]
buffer_load_dwordx4 v3,s[8:11],s42 offen offset:2048 nt lds
s_waitcnt lgkmcnt(2)
v_mfma_f32_16x16x32_bf16 v[32:35],v[16:19],a[24:27],v[32:35]
ds_read_b64_tr_b16 v[24:25],v9 offset:24576
ds_read_b64_tr_b16 v[26:27],v9 offset:25088
v_mfma_f32_16x16x32_bf16 v[40:43],v[16:19],a[88:91],v[40:43]
v_mfma_f32_16x16x32_bf16 v[48:51],v[16:19],a[152:155],v[48:51]
v_mfma_f32_16x16x32_bf16 v[56:59],v[16:19],a[216:219],v[56:59]
v_mfma_f32_16x16x32_bf16 v[64:67],v[16:19],v[152:155],v[64:67]
buffer_load_dwordx4 v4,s[8:11],s42 offen offset:3072 nt lds
v_mfma_f32_16x16x32_bf16 v[72:75],v[16:19],v[216:219],v[72:75]
s_mov_b32 m0,57344
s_add_u32 s41,s40,24576
buffer_load_dwordx4 v5,s[12:15],s41 offen nt lds
s_waitcnt lgkmcnt(2)
v_mfma_f32_16x16x32_bf16 v[76:79],v[20:23],v[216:219],v[76:79]
ds_read_b64_tr_b16 v[28:29],v9 offset:24584
ds_read_b64_tr_b16 v[30:31],v9 offset:25096
v_mfma_f32_16x16x32_bf16 v[68:71],v[20:23],v[152:155],v[68:71]
v_mfma_f32_16x16x32_bf16 v[60:63],v[20:23],a[216:219],v[60:63]
buffer_load_dwordx4 v6,s[12:15],s41 offen offset:1024 nt lds
v_mfma_f32_16x16x32_bf16 v[52:55],v[20:23],a[152:155],v[52:55]
v_mfma_f32_16x16x32_bf16 v[44:47],v[20:23],a[88:91],v[44:47]
v_mfma_f32_16x16x32_bf16 v[36:39],v[20:23],a[24:27],v[36:39]
buffer_load_dwordx4 v5,s[12:15],s41 offen offset:2048 nt lds
s_waitcnt lgkmcnt(2)
v_mfma_f32_16x16x32_bf16 v[80:83],v[24:27],a[24:27],v[80:83]
ds_read_b64_tr_b16 v[16:17],v8 offset:28672
ds_read_b64_tr_b16 v[18:19],v8 offset:29184
v_mfma_f32_16x16x32_bf16 v[88:91],v[24:27],a[88:91],v[88:91]
v_mfma_f32_16x16x32_bf16 v[96:99],v[24:27],a[152:155],v[96:99]
buffer_load_dwordx4 v6,s[12:15],s41 offen offset:3072 nt lds
v_mfma_f32_16x16x32_bf16 v[104:107],v[24:27],a[216:219],v[104:107]
s_mov_b32 m0,61440
s_add_u32 s42,s40,28672
v_mfma_f32_16x16x32_bf16 v[112:115],v[24:27],v[152:155],v[112:115]
buffer_load_dwordx4 v5,s[12:15],s42 offen nt lds
v_mfma_f32_16x16x32_bf16 v[120:123],v[24:27],v[216:219],v[120:123]
s_waitcnt lgkmcnt(2)
v_mfma_f32_16x16x32_bf16 v[124:127],v[28:31],v[216:219],v[124:127]
ds_read_b64_tr_b16 v[20:21],v8 offset:28680
ds_read_b64_tr_b16 v[22:23],v8 offset:29192
v_mfma_f32_16x16x32_bf16 v[116:119],v[28:31],v[152:155],v[116:119]
v_mfma_f32_16x16x32_bf16 v[108:111],v[28:31],a[216:219],v[108:111]
buffer_load_dwordx4 v6,s[12:15],s42 offen offset:1024 nt lds
v_mfma_f32_16x16x32_bf16 v[100:103],v[28:31],a[152:155],v[100:103]
v_mfma_f32_16x16x32_bf16 v[92:95],v[28:31],a[88:91],v[92:95]
buffer_load_dwordx4 v5,s[12:15],s42 offen offset:2048 nt lds
v_mfma_f32_16x16x32_bf16 v[84:87],v[28:31],a[24:27],v[84:87]
buffer_load_dwordx4 v6,s[12:15],s42 offen offset:3072 nt lds
s_waitcnt lgkmcnt(2)
v_mfma_f32_16x16x32_bf16 v[32:35],v[16:19],a[28:31],v[32:35]
ds_read_b64_tr_b16 v[24:25],v9 offset:28672
ds_read_b64_tr_b16 v[26:27],v9 offset:29184
v_mfma_f32_16x16x32_bf16 v[40:43],v[16:19],a[92:95],v[40:43]
v_mfma_f32_16x16x32_bf16 v[48:51],v[16:19],a[156:159],v[48:51]
v_mfma_f32_16x16x32_bf16 v[56:59],v[16:19],a[220:223],v[56:59]
s_mov_b32 m0,114688
s_add_u32 s41,s54,256
v_mfma_f32_16x16x32_bf16 v[64:67],v[16:19],v[156:159],v[64:67]
buffer_load_dwordx4 v7,s[16:19],s41 offen lds
v_mfma_f32_16x16x32_bf16 v[72:75],v[16:19],v[220:223],v[72:75]
s_add_u32 s42,s54,64768
buffer_load_dwordx4 v7,s[16:19],s42 offen offset:1024 lds
s_waitcnt lgkmcnt(2)
v_mfma_f32_16x16x32_bf16 v[76:79],v[20:23],v[220:223],v[76:79]
ds_read_b64_tr_b16 v[28:29],v9 offset:28680
ds_read_b64_tr_b16 v[30:31],v9 offset:29192
v_mfma_f32_16x16x32_bf16 v[68:71],v[20:23],v[156:159],v[68:71]
s_add_u32 s41,s54,129280
v_mfma_f32_16x16x32_bf16 v[60:63],v[20:23],a[220:223],v[60:63]
buffer_load_dwordx4 v7,s[16:19],s41 offen offset:2048 lds
v_mfma_f32_16x16x32_bf16 v[52:55],v[20:23],a[156:159],v[52:55]
s_add_u32 s42,s54,193792
v_mfma_f32_16x16x32_bf16 v[44:47],v[20:23],a[92:95],v[44:47]
v_mfma_f32_16x16x32_bf16 v[36:39],v[20:23],a[28:31],v[36:39]
buffer_load_dwordx4 v7,s[16:19],s42 offen offset:3072 lds
s_waitcnt lgkmcnt(2)
v_mfma_f32_16x16x32_bf16 v[80:83],v[24:27],a[28:31],v[80:83]
ds_read_b64_tr_b16 v[16:17],v8
ds_read_b64_tr_b16 v[18:19],v8 offset:512
v_mfma_f32_16x16x32_bf16 v[88:91],v[24:27],a[92:95],v[88:91]
s_mov_b32 m0,118784
s_add_u32 s41,s54,262400
v_mfma_f32_16x16x32_bf16 v[96:99],v[24:27],a[156:159],v[96:99]
buffer_load_dwordx4 v7,s[16:19],s41 offen lds
v_mfma_f32_16x16x32_bf16 v[104:107],v[24:27],a[220:223],v[104:107]
s_add_u32 s42,s54,326912
v_mfma_f32_16x16x32_bf16 v[112:115],v[24:27],v[156:159],v[112:115]
buffer_load_dwordx4 v7,s[16:19],s42 offen offset:1024 lds
v_mfma_f32_16x16x32_bf16 v[120:123],v[24:27],v[220:223],v[120:123]
s_waitcnt lgkmcnt(2)
v_mfma_f32_16x16x32_bf16 v[124:127],v[28:31],v[220:223],v[124:127]
ds_read_b64_tr_b16 v[20:21],v8 offset:8
ds_read_b64_tr_b16 v[22:23],v8 offset:520
v_mfma_f32_16x16x32_bf16 v[116:119],v[28:31],v[156:159],v[116:119]
s_add_u32 s41,s54,391424
v_mfma_f32_16x16x32_bf16 v[108:111],v[28:31],a[220:223],v[108:111]
buffer_load_dwordx4 v7,s[16:19],s41 offen offset:2048 lds
v_mfma_f32_16x16x32_bf16 v[100:103],v[28:31],a[156:159],v[100:103]
s_add_u32 s42,s54,455936
v_mfma_f32_16x16x32_bf16 v[92:95],v[28:31],a[92:95],v[92:95]
buffer_load_dwordx4 v7,s[16:19],s42 offen offset:3072 lds
v_mfma_f32_16x16x32_bf16 v[84:87],v[28:31],a[28:31],v[84:87]
s_cmp_eq_u32 s3,0
s_cbranch_scc1 L_light2
s_waitcnt vmcnt(16)
s_branch L_heavy2
L_light2:
s_waitcnt vmcnt(24)
L_heavy2:
s_barrier
s_mov_b32 m0,16384
s_add_u32 s41,s40,49152
buffer_load_dwordx4 v1,s[8:11],s41 offen nt lds
buffer_load_dwordx4 v2,s[8:11],s41 offen offset:1024 nt lds
buffer_load_dwordx4 v3,s[8:11],s41 offen offset:2048 nt lds
buffer_load_dwordx4 v4,s[8:11],s41 offen offset:3072 nt lds
s_waitcnt lgkmcnt(2)
v_mfma_f32_16x16x32_bf16 v[32:35],v[16:19],a[32:35],v[32:35]
ds_read_b64_tr_b16 v[24:25],v9
ds_read_b64_tr_b16 v[26:27],v9 offset:512
v_mfma_f32_16x16x32_bf16 v[40:43],v[16:19],a[96:99],v[40:43]
s_mov_b32 m0,20480
s_add_u32 s42,s40,53248
v_mfma_f32_16x16x32_bf16 v[48:51],v[16:19],a[160:163],v[48:51]
buffer_load_dwordx4 v1,s[8:11],s42 offen nt lds
v_mfma_f32_16x16x32_bf16 v[56:59],v[16:19],a[224:227],v[56:59]
v_mfma_f32_16x16x32_bf16 v[64:67],v[16:19],v[160:163],v[64:67]
buffer_load_dwordx4 v2,s[8:11],s42 offen offset:1024 nt lds
v_mfma_f32_16x16x32_bf16 v[72:75],v[16:19],v[224:227],v[72:75]
buffer_load_dwordx4 v3,s[8:11],s42 offen offset:2048 nt lds
s_waitcnt lgkmcnt(2)
v_mfma_f32_16x16x32_bf16 v[76:79],v[20:23],v[224:227],v[76:79]
ds_read_b64_tr_b16 v[28:29],v9 offset:8
ds_read_b64_tr_b16 v[30:31],v9 offset:520
v_mfma_f32_16x16x32_bf16 v[68:71],v[20:23],v[160:163],v[68:71]
v_mfma_f32_16x16x32_bf16 v[60:63],v[20:23],a[224:227],v[60:63]
v_mfma_f32_16x16x32_bf16 v[52:55],v[20:23],a[160:163],v[52:55]
v_mfma_f32_16x16x32_bf16 v[44:47],v[20:23],a[96:99],v[44:47]
buffer_load_dwordx4 v4,s[8:11],s42 offen offset:3072 nt lds
v_mfma_f32_16x16x32_bf16 v[36:39],v[20:23],a[32:35],v[36:39]
s_mov_b32 m0,32768
s_add_u32 s41,s40,32768
buffer_load_dwordx4 v5,s[12:15],s41 offen nt lds
s_waitcnt lgkmcnt(2)
v_mfma_f32_16x16x32_bf16 v[80:83],v[24:27],a[32:35],v[80:83]
L_tp_q2:
s_cbranch_execz L_tp_q5
ds_read_b64_tr_b16 v[16:17],v8 offset:4096
ds_read_b64_tr_b16 v[18:19],v8 offset:4608
v_mfma_f32_16x16x32_bf16 v[88:91],v[24:27],a[96:99],v[88:91]
v_mfma_f32_16x16x32_bf16 v[96:99],v[24:27],a[160:163],v[96:99]
buffer_load_dwordx4 v6,s[12:15],s41 offen offset:1024 nt lds
v_mfma_f32_16x16x32_bf16 v[104:107],v[24:27],a[224:227],v[104:107]
v_mfma_f32_16x16x32_bf16 v[112:115],v[24:27],v[160:163],v[112:115]
v_mfma_f32_16x16x32_bf16 v[120:123],v[24:27],v[224:227],v[120:123]
buffer_load_dwordx4 v5,s[12:15],s41 offen offset:2048 nt lds
s_waitcnt lgkmcnt(2)
v_mfma_f32_16x16x32_bf16 v[124:127],v[28:31],v[224:227],v[124:127]
ds_read_b64_tr_b16 v[20:21],v8 offset:4104
ds_read_b64_tr_b16 v[22:23],v8 offset:4616
v_mfma_f32_16x16x32_bf16 v[116:119],v[28:31],v[160:163],v[116:119]
v_mfma_f32_16x16x32_bf16 v[108:111],v[28:31],a[224:227],v[108:111]
buffer_load_dwordx4 v6,s[12:15],s41 offen offset:3072 nt lds
v_mfma_f32_16x16x32_bf16 v[100:103],v[28:31],a[160:163],v[100:103]
s_mov_b32 m0,36864
s_add_u32 s42,s40,36864
v_mfma_f32_16x16x32_bf16 v[92:95],v[28:31],a[96:99],v[92:95]
buffer_load_dwordx4 v5,s[12:15],s42 offen nt lds
v_mfma_f32_16x16x32_bf16 v[84:87],v[28:31],a[32:35],v[84:87]
s_waitcnt lgkmcnt(2)
v_mfma_f32_16x16x32_bf16 v[32:35],v[16:19],a[36:39],v[32:35]
ds_read_b64_tr_b16 v[24:25],v9 offset:4096
ds_read_b64_tr_b16 v[26:27],v9 offset:4608
v_mfma_f32_16x16x32_bf16 v[40:43],v[16:19],a[100:103],v[40:43]
v_mfma_f32_16x16x32_bf16 v[48:51],v[16:19],a[164:167],v[48:51]
buffer_load_dwordx4 v6,s[12:15],s42 offen offset:1024 nt lds
v_mfma_f32_16x16x32_bf16 v[56:59],v[16:19],a[228:231],v[56:59]
v_mfma_f32_16x16x32_bf16 v[64:67],v[16:19],v[164:167],v[64:67]
buffer_load_dwordx4 v5,s[12:15],s42 offen offset:2048 nt lds
v_mfma_f32_16x16x32_bf16 v[72:75],v[16:19],v[228:231],v[72:75]
buffer_load_dwordx4 v6,s[12:15],s42 offen offset:3072 nt lds
s_waitcnt lgkmcnt(2)
v_mfma_f32_16x16x32_bf16 v[76:79],v[20:23],v[228:231],v[76:79]
ds_read_b64_tr_b16 v[28:29],v9 offset:4104
ds_read_b64_tr_b16 v[30:31],v9 offset:4616
v_mfma_f32_16x16x32_bf16 v[68:71],v[20:23],v[164:167],v[68:71]
v_mfma_f32_16x16x32_bf16 v[60:63],v[20:23],a[228:231],v[60:63]
v_mfma_f32_16x16x32_bf16 v[52:55],v[20:23],a[164:167],v[52:55]
s_mov_b32 m0,122880
s_add_u32 s41,s55,256
v_mfma_f32_16x16x32_bf16 v[44:47],v[20:23],a[100:103],v[44:47]
buffer_load_dwordx4 v7,s[16:19],s41 offen lds
v_mfma_f32_16x16x32_bf16 v[36:39],v[20:23],a[36:39],v[36:39]
s_add_u32 s42,s55,64768
buffer_load_dwordx4 v7,s[16:19],s42 offen offset:1024 lds
s_waitcnt lgkmcnt(2)
v_mfma_f32_16x16x32_bf16 v[80:83],v[24:27],a[36:39],v[80:83]
ds_read_b64_tr_b16 v[16:17],v8 offset:8192
ds_read_b64_tr_b16 v[18:19],v8 offset:8704
v_mfma_f32_16x16x32_bf16 v[88:91],v[24:27],a[100:103],v[88:91]
s_add_u32 s41,s55,129280
v_mfma_f32_16x16x32_bf16 v[96:99],v[24:27],a[164:167],v[96:99]
buffer_load_dwordx4 v7,s[16:19],s41 offen offset:2048 lds
v_mfma_f32_16x16x32_bf16 v[104:107],v[24:27],a[228:231],v[104:107]
s_add_u32 s42,s55,193792
v_mfma_f32_16x16x32_bf16 v[112:115],v[24:27],v[164:167],v[112:115]
v_mfma_f32_16x16x32_bf16 v[120:123],v[24:27],v[228:231],v[120:123]
buffer_load_dwordx4 v7,s[16:19],s42 offen offset:3072 lds
s_waitcnt lgkmcnt(2)
v_mfma_f32_16x16x32_bf16 v[124:127],v[28:31],v[228:231],v[124:127]
ds_read_b64_tr_b16 v[20:21],v8 offset:8200
ds_read_b64_tr_b16 v[22:23],v8 offset:8712
v_mfma_f32_16x16x32_bf16 v[116:119],v[28:31],v[164:167],v[116:119]
s_mov_b32 m0,126976
s_add_u32 s41,s55,262400
v_mfma_f32_16x16x32_bf16 v[108:111],v[28:31],a[228:231],v[108:111]
buffer_load_dwordx4 v7,s[16:19],s41 offen lds
v_mfma_f32_16x16x32_bf16 v[100:103],v[28:31],a[164:167],v[100:103]
s_add_u32 s42,s55,326912
v_mfma_f32_16x16x32_bf16 v[92:95],v[28:31],a[100:103],v[92:95]
buffer_load_dwordx4 v7,s[16:19],s42 offen offset:1024 lds
v_mfma_f32_16x16x32_bf16 v[84:87],v[28:31],a[36:39],v[84:87]
s_waitcnt lgkmcnt(2)
v_mfma_f32_16x16x32_bf16 v[32:35],v[16:19],a[40:43],v[32:35]
ds_read_b64_tr_b16 v[24:25],v9 offset:8192
ds_read_b64_tr_b16 v[26:27],v9 offset:8704
v_mfma_f32_16x16x32_bf16 v[40:43],v[16:19],a[104:107],v[40:43]
s_add_u32 s41,s55,391424
v_mfma_f32_16x16x32_bf16 v[48:51],v[16:19],a[168:171],v[48:51]
buffer_load_dwordx4 v7,s[16:19],s41 offen offset:2048 lds
v_mfma_f32_16x16x32_bf16 v[56:59],v[16:19],a[232:235],v[56:59]
s_add_u32 s42,s55,455936
v_mfma_f32_16x16x32_bf16 v[64:67],v[16:19],v[168:171],v[64:67]
buffer_load_dwordx4 v7,s[16:19],s42 offen offset:3072 lds
v_mfma_f32_16x16x32_bf16 v[72:75],v[16:19],v[232:235],v[72:75]
s_cmp_eq_u32 s3,0
s_cbranch_scc1 L_light3
s_waitcnt vmcnt(16)
s_branch L_heavy3
L_light3:
s_waitcnt vmcnt(24)
L_heavy3:
s_barrier
s_mov_b32 m0,24576
s_add_u32 s41,s40,57344
buffer_load_dwordx4 v1,s[8:11],s41 offen nt lds
buffer_load_dwordx4 v2,s[8:11],s41 offen offset:1024 nt lds
buffer_load_dwordx4 v3,s[8:11],s41 offen offset:2048 nt lds
buffer_load_dwordx4 v4,s[8:11],s41 offen offset:3072 nt lds
s_waitcnt lgkmcnt(2)
v_mfma_f32_16x16x32_bf16 v[76:79],v[20:23],v[232:235],v[76:79]
ds_read_b64_tr_b16 v[28:29],v9 offset:8200
ds_read_b64_tr_b16 v[30:31],v9 offset:8712
v_mfma_f32_16x16x32_bf16 v[68:71],v[20:23],v[168:171],v[68:71]
s_mov_b32 m0,28672
s_add_u32 s42,s40,61440
v_mfma_f32_16x16x32_bf16 v[60:63],v[20:23],a[232:235],v[60:63]
buffer_load_dwordx4 v1,s[8:11],s42 offen nt lds
v_mfma_f32_16x16x32_bf16 v[52:55],v[20:23],a[168:171],v[52:55]
v_mfma_f32_16x16x32_bf16 v[44:47],v[20:23],a[104:107],v[44:47]
buffer_load_dwordx4 v2,s[8:11],s42 offen offset:1024 nt lds
v_mfma_f32_16x16x32_bf16 v[36:39],v[20:23],a[40:43],v[36:39]
buffer_load_dwordx4 v3,s[8:11],s42 offen offset:2048 nt lds
s_waitcnt lgkmcnt(2)
v_mfma_f32_16x16x32_bf16 v[80:83],v[24:27],a[40:43],v[80:83]
ds_read_b64_tr_b16 v[16:17],v8 offset:12288
ds_read_b64_tr_b16 v[18:19],v8 offset:12800
v_mfma_f32_16x16x32_bf16 v[88:91],v[24:27],a[104:107],v[88:91]
v_mfma_f32_16x16x32_bf16 v[96:99],v[24:27],a[168:171],v[96:99]
v_mfma_f32_16x16x32_bf16 v[104:107],v[24:27],a[232:235],v[104:107]
v_mfma_f32_16x16x32_bf16 v[112:115],v[24:27],v[168:171],v[112:115]
buffer_load_dwordx4 v4,s[8:11],s42 offen offset:3072 nt lds
v_mfma_f32_16x16x32_bf16 v[120:123],v[24:27],v[232:235],v[120:123]
s_mov_b32 m0,40960
s_add_u32 s41,s40,40960
buffer_load_dwordx4 v5,s[12:15],s41 offen nt lds
s_waitcnt lgkmcnt(2)
v_mfma_f32_16x16x32_bf16 v[124:127],v[28:31],v[232:235],v[124:127]
ds_read_b64_tr_b16 v[20:21],v8 offset:12296
ds_read_b64_tr_b16 v[22:23],v8 offset:12808
v_mfma_f32_16x16x32_bf16 v[116:119],v[28:31],v[168:171],v[116:119]
v_mfma_f32_16x16x32_bf16 v[108:111],v[28:31],a[232:235],v[108:111]
buffer_load_dwordx4 v6,s[12:15],s41 offen offset:1024 nt lds
v_mfma_f32_16x16x32_bf16 v[100:103],v[28:31],a[168:171],v[100:103]
v_mfma_f32_16x16x32_bf16 v[92:95],v[28:31],a[104:107],v[92:95]
v_mfma_f32_16x16x32_bf16 v[84:87],v[28:31],a[40:43],v[84:87]
buffer_load_dwordx4 v5,s[12:15],s41 offen offset:2048 nt lds
s_waitcnt lgkmcnt(2)
v_mfma_f32_16x16x32_bf16 v[32:35],v[16:19],a[44:47],v[32:35]
ds_read_b64_tr_b16 v[24:25],v9 offset:12288
ds_read_b64_tr_b16 v[26:27],v9 offset:12800
v_mfma_f32_16x16x32_bf16 v[40:43],v[16:19],a[108:111],v[40:43]
v_mfma_f32_16x16x32_bf16 v[48:51],v[16:19],a[172:175],v[48:51]
buffer_load_dwordx4 v6,s[12:15],s41 offen offset:3072 nt lds
v_mfma_f32_16x16x32_bf16 v[56:59],v[16:19],a[236:239],v[56:59]
s_mov_b32 m0,45056
s_add_u32 s42,s40,45056
v_mfma_f32_16x16x32_bf16 v[64:67],v[16:19],v[172:175],v[64:67]
buffer_load_dwordx4 v5,s[12:15],s42 offen nt lds
v_mfma_f32_16x16x32_bf16 v[72:75],v[16:19],v[236:239],v[72:75]
s_waitcnt lgkmcnt(2)
v_mfma_f32_16x16x32_bf16 v[76:79],v[20:23],v[236:239],v[76:79]
ds_read_b64_tr_b16 v[28:29],v9 offset:12296
ds_read_b64_tr_b16 v[30:31],v9 offset:12808
v_mfma_f32_16x16x32_bf16 v[68:71],v[20:23],v[172:175],v[68:71]
v_mfma_f32_16x16x32_bf16 v[60:63],v[20:23],a[236:239],v[60:63]
buffer_load_dwordx4 v6,s[12:15],s42 offen offset:1024 nt lds
v_mfma_f32_16x16x32_bf16 v[52:55],v[20:23],a[172:175],v[52:55]
v_mfma_f32_16x16x32_bf16 v[44:47],v[20:23],a[108:111],v[44:47]
buffer_load_dwordx4 v5,s[12:15],s42 offen offset:2048 nt lds
v_mfma_f32_16x16x32_bf16 v[36:39],v[20:23],a[44:47],v[36:39]
buffer_load_dwordx4 v6,s[12:15],s42 offen offset:3072 nt lds
s_waitcnt lgkmcnt(2)
v_mfma_f32_16x16x32_bf16 v[80:83],v[24:27],a[44:47],v[80:83]
ds_read_b64_tr_b16 v[16:17],v8 offset:16384
ds_read_b64_tr_b16 v[18:19],v8 offset:16896
v_mfma_f32_16x16x32_bf16 v[88:91],v[24:27],a[108:111],v[88:91]
v_mfma_f32_16x16x32_bf16 v[96:99],v[24:27],a[172:175],v[96:99]
v_mfma_f32_16x16x32_bf16 v[104:107],v[24:27],a[236:239],v[104:107]
s_mov_b32 m0,98304
s_add_u32 s41,s48,384
v_mfma_f32_16x16x32_bf16 v[112:115],v[24:27],v[172:175],v[112:115]
buffer_load_dwordx4 v7,s[16:19],s41 offen lds
v_mfma_f32_16x16x32_bf16 v[120:123],v[24:27],v[236:239],v[120:123]
s_add_u32 s42,s48,64896
buffer_load_dwordx4 v7,s[16:19],s42 offen offset:1024 lds
s_waitcnt lgkmcnt(2)
v_mfma_f32_16x16x32_bf16 v[124:127],v[28:31],v[236:239],v[124:127]
ds_read_b64_tr_b16 v[20:21],v8 offset:16392
ds_read_b64_tr_b16 v[22:23],v8 offset:16904
v_mfma_f32_16x16x32_bf16 v[116:119],v[28:31],v[172:175],v[116:119]
s_add_u32 s41,s48,129408
v_mfma_f32_16x16x32_bf16 v[108:111],v[28:31],a[236:239],v[108:111]
buffer_load_dwordx4 v7,s[16:19],s41 offen offset:2048 lds
v_mfma_f32_16x16x32_bf16 v[100:103],v[28:31],a[172:175],v[100:103]
s_add_u32 s42,s48,193920
v_mfma_f32_16x16x32_bf16 v[92:95],v[28:31],a[108:111],v[92:95]
v_mfma_f32_16x16x32_bf16 v[84:87],v[28:31],a[44:47],v[84:87]
buffer_load_dwordx4 v7,s[16:19],s42 offen offset:3072 lds
s_waitcnt lgkmcnt(2)
v_mfma_f32_16x16x32_bf16 v[32:35],v[16:19],a[48:51],v[32:35]
ds_read_b64_tr_b16 v[24:25],v9 offset:16384
ds_read_b64_tr_b16 v[26:27],v9 offset:16896
v_mfma_f32_16x16x32_bf16 v[40:43],v[16:19],a[112:115],v[40:43]
s_mov_b32 m0,102400
s_add_u32 s41,s48,262528
v_mfma_f32_16x16x32_bf16 v[48:51],v[16:19],a[176:179],v[48:51]
buffer_load_dwordx4 v7,s[16:19],s41 offen lds
v_mfma_f32_16x16x32_bf16 v[56:59],v[16:19],a[240:243],v[56:59]
s_add_u32 s42,s48,327040
v_mfma_f32_16x16x32_bf16 v[64:67],v[16:19],v[176:179],v[64:67]
buffer_load_dwordx4 v7,s[16:19],s42 offen offset:1024 lds
v_mfma_f32_16x16x32_bf16 v[72:75],v[16:19],v[240:243],v[72:75]
s_waitcnt lgkmcnt(2)
v_mfma_f32_16x16x32_bf16 v[76:79],v[20:23],v[240:243],v[76:79]
ds_read_b64_tr_b16 v[28:29],v9 offset:16392
ds_read_b64_tr_b16 v[30:31],v9 offset:16904
v_mfma_f32_16x16x32_bf16 v[68:71],v[20:23],v[176:179],v[68:71]
s_add_u32 s41,s48,391552
v_mfma_f32_16x16x32_bf16 v[60:63],v[20:23],a[240:243],v[60:63]
buffer_load_dwordx4 v7,s[16:19],s41 offen offset:2048 lds
v_mfma_f32_16x16x32_bf16 v[52:55],v[20:23],a[176:179],v[52:55]
s_add_u32 s42,s48,456064
v_mfma_f32_16x16x32_bf16 v[44:47],v[20:23],a[112:115],v[44:47]
buffer_load_dwordx4 v7,s[16:19],s42 offen offset:3072 lds
v_mfma_f32_16x16x32_bf16 v[36:39],v[20:23],a[48:51],v[36:39]
s_cmp_eq_u32 s3,0
s_cbranch_scc1 L_light4
s_waitcnt vmcnt(16)
s_branch L_heavy4
L_light4:
s_waitcnt vmcnt(24)
L_heavy4:
s_barrier
s_mov_b32 m0,0
s_add_u32 s41,s40,65536
buffer_load_dwordx4 v1,s[8:11],s41 offen nt lds
buffer_load_dwordx4 v2,s[8:11],s41 offen offset:1024 nt lds
buffer_load_dwordx4 v3,s[8:11],s41 offen offset:2048 nt lds
buffer_load_dwordx4 v4,s[8:11],s41 offen offset:3072 nt lds
s_waitcnt lgkmcnt(2)
v_mfma_f32_16x16x32_bf16 v[80:83],v[24:27],a[48:51],v[80:83]
ds_read_b64_tr_b16 v[16:17],v8 offset:20480
ds_read_b64_tr_b16 v[18:19],v8 offset:20992
v_mfma_f32_16x16x32_bf16 v[88:91],v[24:27],a[112:115],v[88:91]
s_mov_b32 m0,4096
s_add_u32 s42,s40,69632
v_mfma_f32_16x16x32_bf16 v[96:99],v[24:27],a[176:179],v[96:99]
buffer_load_dwordx4 v1,s[8:11],s42 offen nt lds
v_mfma_f32_16x16x32_bf16 v[104:107],v[24:27],a[240:243],v[104:107]
v_mfma_f32_16x16x32_bf16 v[112:115],v[24:27],v[176:179],v[112:115]
buffer_load_dwordx4 v2,s[8:11],s42 offen offset:1024 nt lds
v_mfma_f32_16x16x32_bf16 v[120:123],v[24:27],v[240:243],v[120:123]
s_waitcnt lgkmcnt(2)
v_mfma_f32_16x16x32_bf16 v[124:127],v[28:31],v[240:243],v[124:127]
ds_read_b64_tr_b16 v[20:21],v8 offset:20488
ds_read_b64_tr_b16 v[22:23],v8 offset:21000
v_mfma_f32_16x16x32_bf16 v[116:119],v[28:31],v[176:179],v[116:119]
v_mfma_f32_16x16x32_bf16 v[108:111],v[28:31],a[240:243],v[108:111]
buffer_load_dwordx4 v3,s[8:11],s42 offen offset:2048 nt lds
v_mfma_f32_16x16x32_bf16 v[100:103],v[28:31],a[176:179],v[100:103]
v_mfma_f32_16x16x32_bf16 v[92:95],v[28:31],a[112:115],v[92:95]
buffer_load_dwordx4 v4,s[8:11],s42 offen offset:3072 nt lds
v_mfma_f32_16x16x32_bf16 v[84:87],v[28:31],a[48:51],v[84:87]
s_waitcnt lgkmcnt(2)
v_mfma_f32_16x16x32_bf16 v[32:35],v[16:19],a[52:55],v[32:35]
ds_read_b64_tr_b16 v[24:25],v9 offset:20480
ds_read_b64_tr_b16 v[26:27],v9 offset:20992
v_mfma_f32_16x16x32_bf16 v[40:43],v[16:19],a[116:119],v[40:43]
s_mov_b32 m0,49152
s_add_u32 s41,s40,49152
v_mfma_f32_16x16x32_bf16 v[48:51],v[16:19],a[180:183],v[48:51]
buffer_load_dwordx4 v5,s[12:15],s41 offen nt lds
v_mfma_f32_16x16x32_bf16 v[56:59],v[16:19],a[244:247],v[56:59]
v_mfma_f32_16x16x32_bf16 v[64:67],v[16:19],v[180:183],v[64:67]
buffer_load_dwordx4 v6,s[12:15],s41 offen offset:1024 nt lds
v_mfma_f32_16x16x32_bf16 v[72:75],v[16:19],v[244:247],v[72:75]
s_waitcnt lgkmcnt(2)
v_mfma_f32_16x16x32_bf16 v[76:79],v[20:23],v[244:247],v[76:79]
ds_read_b64_tr_b16 v[28:29],v9 offset:20488
ds_read_b64_tr_b16 v[30:31],v9 offset:21000
v_mfma_f32_16x16x32_bf16 v[68:71],v[20:23],v[180:183],v[68:71]
v_mfma_f32_16x16x32_bf16 v[60:63],v[20:23],a[244:247],v[60:63]
buffer_load_dwordx4 v5,s[12:15],s41 offen offset:2048 nt lds
v_mfma_f32_16x16x32_bf16 v[52:55],v[20:23],a[180:183],v[52:55]
v_mfma_f32_16x16x32_bf16 v[44:47],v[20:23],a[116:119],v[44:47]
buffer_load_dwordx4 v6,s[12:15],s41 offen offset:3072 nt lds
v_mfma_f32_16x16x32_bf16 v[36:39],v[20:23],a[52:55],v[36:39]
s_waitcnt lgkmcnt(2)
v_mfma_f32_16x16x32_bf16 v[80:83],v[24:27],a[52:55],v[80:83]
ds_read_b64_tr_b16 v[16:17],v8 offset:24576
ds_read_b64_tr_b16 v[18:19],v8 offset:25088
v_mfma_f32_16x16x32_bf16 v[88:91],v[24:27],a[116:119],v[88:91]
s_mov_b32 m0,53248
s_add_u32 s42,s40,53248
v_mfma_f32_16x16x32_bf16 v[96:99],v[24:27],a[180:183],v[96:99]
buffer_load_dwordx4 v5,s[12:15],s42 offen nt lds
v_mfma_f32_16x16x32_bf16 v[104:107],v[24:27],a[244:247],v[104:107]
v_mfma_f32_16x16x32_bf16 v[112:115],v[24:27],v[180:183],v[112:115]
buffer_load_dwordx4 v6,s[12:15],s42 offen offset:1024 nt lds
v_mfma_f32_16x16x32_bf16 v[120:123],v[24:27],v[244:247],v[120:123]
s_waitcnt lgkmcnt(2)
v_mfma_f32_16x16x32_bf16 v[124:127],v[28:31],v[244:247],v[124:127]
ds_read_b64_tr_b16 v[20:21],v8 offset:24584
ds_read_b64_tr_b16 v[22:23],v8 offset:25096
v_mfma_f32_16x16x32_bf16 v[116:119],v[28:31],v[180:183],v[116:119]
v_mfma_f32_16x16x32_bf16 v[108:111],v[28:31],a[244:247],v[108:111]
buffer_load_dwordx4 v5,s[12:15],s42 offen offset:2048 nt lds
v_mfma_f32_16x16x32_bf16 v[100:103],v[28:31],a[180:183],v[100:103]
v_mfma_f32_16x16x32_bf16 v[92:95],v[28:31],a[116:119],v[92:95]
buffer_load_dwordx4 v6,s[12:15],s42 offen offset:3072 nt lds
v_mfma_f32_16x16x32_bf16 v[84:87],v[28:31],a[52:55],v[84:87]
s_waitcnt lgkmcnt(2)
v_mfma_f32_16x16x32_bf16 v[32:35],v[16:19],a[56:59],v[32:35]
ds_read_b64_tr_b16 v[24:25],v9 offset:24576
ds_read_b64_tr_b16 v[26:27],v9 offset:25088
v_mfma_f32_16x16x32_bf16 v[40:43],v[16:19],a[120:123],v[40:43]
s_mov_b32 m0,106496
s_add_u32 s41,s49,384
v_mfma_f32_16x16x32_bf16 v[48:51],v[16:19],a[184:187],v[48:51]
buffer_load_dwordx4 v7,s[16:19],s41 offen lds
v_mfma_f32_16x16x32_bf16 v[56:59],v[16:19],a[248:251],v[56:59]
s_add_u32 s42,s49,64896
v_mfma_f32_16x16x32_bf16 v[64:67],v[16:19],v[184:187],v[64:67]
buffer_load_dwordx4 v7,s[16:19],s42 offen offset:1024 lds
v_mfma_f32_16x16x32_bf16 v[72:75],v[16:19],v[248:251],v[72:75]
s_waitcnt lgkmcnt(2)
v_mfma_f32_16x16x32_bf16 v[76:79],v[20:23],v[248:251],v[76:79]
ds_read_b64_tr_b16 v[28:29],v9 offset:24584
ds_read_b64_tr_b16 v[30:31],v9 offset:25096
v_mfma_f32_16x16x32_bf16 v[68:71],v[20:23],v[184:187],v[68:71]
s_add_u32 s41,s49,129408
v_mfma_f32_16x16x32_bf16 v[60:63],v[20:23],a[248:251],v[60:63]
buffer_load_dwordx4 v7,s[16:19],s41 offen offset:2048 lds
v_mfma_f32_16x16x32_bf16 v[52:55],v[20:23],a[184:187],v[52:55]
s_add_u32 s42,s49,193920
v_mfma_f32_16x16x32_bf16 v[44:47],v[20:23],a[120:123],v[44:47]
buffer_load_dwordx4 v7,s[16:19],s42 offen offset:3072 lds
v_mfma_f32_16x16x32_bf16 v[36:39],v[20:23],a[56:59],v[36:39]
s_waitcnt lgkmcnt(2)
v_mfma_f32_16x16x32_bf16 v[80:83],v[24:27],a[56:59],v[80:83]
ds_read_b64_tr_b16 v[16:17],v8 offset:28672
ds_read_b64_tr_b16 v[18:19],v8 offset:29184
v_mfma_f32_16x16x32_bf16 v[88:91],v[24:27],a[120:123],v[88:91]
s_mov_b32 m0,110592
s_add_u32 s41,s49,262528
v_mfma_f32_16x16x32_bf16 v[96:99],v[24:27],a[184:187],v[96:99]
buffer_load_dwordx4 v7,s[16:19],s41 offen lds
v_mfma_f32_16x16x32_bf16 v[104:107],v[24:27],a[248:251],v[104:107]
s_add_u32 s42,s49,327040
v_mfma_f32_16x16x32_bf16 v[112:115],v[24:27],v[184:187],v[112:115]
buffer_load_dwordx4 v7,s[16:19],s42 offen offset:1024 lds
v_mfma_f32_16x16x32_bf16 v[120:123],v[24:27],v[248:251],v[120:123]
s_waitcnt lgkmcnt(2)
v_mfma_f32_16x16x32_bf16 v[124:127],v[28:31],v[248:251],v[124:127]
ds_read_b64_tr_b16 v[20:21],v8 offset:28680
ds_read_b64_tr_b16 v[22:23],v8 offset:29192
v_mfma_f32_16x16x32_bf16 v[116:119],v[28:31],v[184:187],v[116:119]
s_add_u32 s41,s49,391552
v_mfma_f32_16x16x32_bf16 v[108:111],v[28:31],a[248:251],v[108:111]
buffer_load_dwordx4 v7,s[16:19],s41 offen offset:2048 lds
v_mfma_f32_16x16x32_bf16 v[100:103],v[28:31],a[184:187],v[100:103]
s_add_u32 s42,s49,456064
v_mfma_f32_16x16x32_bf16 v[92:95],v[28:31],a[120:123],v[92:95]
buffer_load_dwordx4 v7,s[16:19],s42 offen offset:3072 lds
v_mfma_f32_16x16x32_bf16 v[84:87],v[28:31],a[56:59],v[84:87]
s_cmp_eq_u32 s3,0
s_cbranch_scc1 L_light5
s_waitcnt vmcnt(16)
s_branch L_heavy5
L_light5:
s_waitcnt vmcnt(24)
L_heavy5:
s_barrier
s_mov_b32 m0,8192
s_add_u32 s41,s40,73728
buffer_load_dwordx4 v1,s[8:11],s41 offen nt lds
buffer_load_dwordx4 v2,s[8:11],s41 offen offset:1024 nt lds
buffer_load_dwordx4 v3,s[8:11],s41 offen offset:2048 nt lds
buffer_load_dwordx4 v4,s[8:11],s41 offen offset:3072 nt lds
s_waitcnt lgkmcnt(2)
v_mfma_f32_16x16x32_bf16 v[32:35],v[16:19],a[60:63],v[32:35]
ds_read_b64_tr_b16 v[24:25],v9 offset:28672
ds_read_b64_tr_b16 v[26:27],v9 offset:29184
v_mfma_f32_16x16x32_bf16 v[40:43],v[16:19],a[124:127],v[40:43]
s_mov_b32 m0,12288
s_add_u32 s42,s40,77824
buffer_load_dwordx4 v1,s[8:11],s42 offen nt lds
v_mfma_f32_16x16x32_bf16 v[48:51],v[16:19],a[188:191],v[48:51]
buffer_load_dwordx4 v2,s[8:11],s42 offen offset:1024 nt lds
v_mfma_f32_16x16x32_bf16 v[56:59],v[16:19],a[252:255],v[56:59]
buffer_load_dwordx4 v3,s[8:11],s42 offen offset:2048 nt lds
v_mfma_f32_16x16x32_bf16 v[64:67],v[16:19],v[188:191],v[64:67]
buffer_load_dwordx4 v4,s[8:11],s42 offen offset:3072 nt lds
v_mfma_f32_16x16x32_bf16 v[72:75],v[16:19],v[252:255],v[72:75]
s_mov_b32 m0,57344
s_add_u32 s41,s40,57344
buffer_load_dwordx4 v5,s[12:15],s41 offen nt lds
s_waitcnt lgkmcnt(2)
v_mfma_f32_16x16x32_bf16 v[76:79],v[20:23],v[252:255],v[76:79]
ds_read_b64_tr_b16 v[28:29],v9 offset:28680
ds_read_b64_tr_b16 v[30:31],v9 offset:29192
v_mfma_f32_16x16x32_bf16 v[68:71],v[20:23],v[188:191],v[68:71]
buffer_load_dwordx4 v6,s[12:15],s41 offen offset:1024 nt lds
v_mfma_f32_16x16x32_bf16 v[60:63],v[20:23],a[252:255],v[60:63]
buffer_load_dwordx4 v5,s[12:15],s41 offen offset:2048 nt lds
buffer_load_dwordx4 v6,s[12:15],s41 offen offset:3072 nt lds
v_mfma_f32_16x16x32_bf16 v[52:55],v[20:23],a[188:191],v[52:55]
v_mfma_f32_16x16x32_bf16 v[44:47],v[20:23],a[124:127],v[44:47]
s_mov_b32 m0,61440
s_add_u32 s42,s40,61440
buffer_load_dwordx4 v5,s[12:15],s42 offen nt lds
v_mfma_f32_16x16x32_bf16 v[36:39],v[20:23],a[60:63],v[36:39]
buffer_load_dwordx4 v6,s[12:15],s42 offen offset:1024 nt lds
buffer_load_dwordx4 v5,s[12:15],s42 offen offset:2048 nt lds
s_waitcnt lgkmcnt(2)
v_mfma_f32_16x16x32_bf16 v[80:83],v[24:27],a[60:63],v[80:83]
ds_read_b64_tr_b16 v[16:17],v8
ds_read_b64_tr_b16 v[18:19],v8 offset:512
v_mfma_f32_16x16x32_bf16 v[88:91],v[24:27],a[124:127],v[88:91]
v_mul_f32 v32,s39,v32
v_mul_f32 v33,s39,v33
v_mul_f32 v34,s39,v34
v_mul_f32 v35,s39,v35
v_mul_f32 v36,s39,v36
v_mul_f32 v37,s39,v37
v_mul_f32 v38,s39,v38
v_mul_f32 v39,s39,v39
v_cvt_pk_bf16_f32 v32,v32,v33
v_cvt_pk_bf16_f32 v33,v34,v35
v_cvt_pk_bf16_f32 v34,v36,v37
v_cvt_pk_bf16_f32 v35,v38,v39
ds_write_b128 v10,v[32:35]
buffer_load_dwordx4 v6,s[12:15],s42 offen offset:3072 nt lds
v_mfma_f32_16x16x32_bf16 v[96:99],v[24:27],a[188:191],v[96:99]
s_mov_b32 m0,114688
s_add_u32 s41,s50,384
buffer_load_dwordx4 v7,s[16:19],s41 offen lds
v_mfma_f32_16x16x32_bf16 v[104:107],v[24:27],a[252:255],v[104:107]
v_mul_f32 v40,s39,v40
v_mul_f32 v41,s39,v41
v_mul_f32 v42,s39,v42
v_mul_f32 v43,s39,v43
v_mul_f32 v44,s39,v44
v_mul_f32 v45,s39,v45
v_mul_f32 v46,s39,v46
v_mul_f32 v47,s39,v47
v_cvt_pk_bf16_f32 v40,v40,v41
v_cvt_pk_bf16_f32 v41,v42,v43
v_cvt_pk_bf16_f32 v42,v44,v45
v_cvt_pk_bf16_f32 v43,v46,v47
ds_write_b128 v10,v[40:43] offset:4096
s_add_u32 s42,s50,64896
buffer_load_dwordx4 v7,s[16:19],s42 offen offset:1024 lds
v_mfma_f32_16x16x32_bf16 v[112:115],v[24:27],v[188:191],v[112:115]
v_mfma_f32_16x16x32_bf16 v[120:123],v[24:27],v[252:255],v[120:123]
v_mul_f32 v48,s39,v48
v_mul_f32 v49,s39,v49
v_mul_f32 v50,s39,v50
v_mul_f32 v51,s39,v51
v_mul_f32 v52,s39,v52
v_mul_f32 v53,s39,v53
v_mul_f32 v54,s39,v54
v_mul_f32 v55,s39,v55
v_cvt_pk_bf16_f32 v48,v48,v49
v_cvt_pk_bf16_f32 v49,v50,v51
v_cvt_pk_bf16_f32 v50,v52,v53
v_cvt_pk_bf16_f32 v51,v54,v55
ds_write_b128 v10,v[48:51] offset:8192
s_add_u32 s41,s50,129408
buffer_load_dwordx4 v7,s[16:19],s41 offen offset:2048 lds
s_waitcnt lgkmcnt(5)
v_mfma_f32_16x16x32_bf16 v[124:127],v[28:31],v[252:255],v[124:127]
ds_read_b64_tr_b16 v[20:21],v8 offset:8
ds_read_b64_tr_b16 v[22:23],v8 offset:520
s_add_u32 s42,s50,193920
buffer_load_dwordx4 v7,s[16:19],s42 offen offset:3072 lds
v_mfma_f32_16x16x32_bf16 v[116:119],v[28:31],v[188:191],v[116:119]
v_mul_f32 v56,s39,v56
v_mul_f32 v57,s39,v57
v_mul_f32 v58,s39,v58
v_mul_f32 v59,s39,v59
v_mul_f32 v60,s39,v60
v_mul_f32 v61,s39,v61
v_mul_f32 v62,s39,v62
v_mul_f32 v63,s39,v63
v_cvt_pk_bf16_f32 v56,v56,v57
v_cvt_pk_bf16_f32 v57,v58,v59
v_cvt_pk_bf16_f32 v58,v60,v61
v_cvt_pk_bf16_f32 v59,v62,v63
ds_write_b128 v10,v[56:59] offset:12288
v_mfma_f32_16x16x32_bf16 v[108:111],v[28:31],a[252:255],v[108:111]
s_mov_b32 m0,118784
s_add_u32 s41,s50,262528
buffer_load_dwordx4 v7,s[16:19],s41 offen lds
v_mfma_f32_16x16x32_bf16 v[100:103],v[28:31],a[188:191],v[100:103]
v_mul_f32 v64,s39,v64
v_mul_f32 v65,s39,v65
v_mul_f32 v66,s39,v66
v_mul_f32 v67,s39,v67
v_mul_f32 v68,s39,v68
v_mul_f32 v69,s39,v69
v_mul_f32 v70,s39,v70
v_mul_f32 v71,s39,v71
v_cvt_pk_bf16_f32 v64,v64,v65
v_cvt_pk_bf16_f32 v65,v66,v67
v_cvt_pk_bf16_f32 v66,v68,v69
v_cvt_pk_bf16_f32 v67,v70,v71
ds_write_b128 v10,v[64:67] offset:16384
s_add_u32 s42,s50,327040
buffer_load_dwordx4 v7,s[16:19],s42 offen offset:1024 lds
v_mfma_f32_16x16x32_bf16 v[92:95],v[28:31],a[124:127],v[92:95]
s_add_u32 s41,s50,391552
buffer_load_dwordx4 v7,s[16:19],s41 offen offset:2048 lds
v_mfma_f32_16x16x32_bf16 v[84:87],v[28:31],a[60:63],v[84:87]
v_mul_f32 v72,s39,v72
v_mul_f32 v73,s39,v73
v_mul_f32 v74,s39,v74
v_mul_f32 v75,s39,v75
v_mul_f32 v76,s39,v76
v_mul_f32 v77,s39,v77
v_mul_f32 v78,s39,v78
v_mul_f32 v79,s39,v79
v_cvt_pk_bf16_f32 v72,v72,v73
v_cvt_pk_bf16_f32 v73,v74,v75
v_cvt_pk_bf16_f32 v74,v76,v77
v_cvt_pk_bf16_f32 v75,v78,v79
ds_write_b128 v10,v[72:75] offset:20480
s_add_u32 s42,s50,456064
buffer_load_dwordx4 v7,s[16:19],s42 offen offset:3072 lds
s_cmp_eq_u32 s3,0
s_cbranch_scc1 L_light6
s_waitcnt vmcnt(22)
s_branch L_heavy6
L_light6:
s_waitcnt vmcnt(24)
L_heavy6:
s_waitcnt lgkmcnt(0)
s_barrier
s_mov_b32 m0,16384
s_add_u32 s41,s40,81920
buffer_load_dwordx4 v1,s[8:11],s41 offen nt lds
buffer_load_dwordx4 v2,s[8:11],s41 offen offset:1024 nt lds
buffer_load_dwordx4 v3,s[8:11],s41 offen offset:2048 nt lds
buffer_load_dwordx4 v4,s[8:11],s41 offen offset:3072 nt lds
v_mfma_f32_16x16x32_bf16 v[32:35],v[16:19],a[0:3],0
ds_read_b64_tr_b16 v[24:25],v9
ds_read_b64_tr_b16 v[26:27],v9 offset:512
v_mfma_f32_16x16x32_bf16 v[40:43],v[16:19],a[64:67],0
v_mul_f32 v80,s39,v80
v_mul_f32 v81,s39,v81
v_mul_f32 v82,s39,v82
v_mul_f32 v83,s39,v83
v_mul_f32 v84,s39,v84
v_mul_f32 v85,s39,v85
v_mul_f32 v86,s39,v86
v_mul_f32 v87,s39,v87
v_cvt_pk_bf16_f32 v80,v80,v81
v_cvt_pk_bf16_f32 v81,v82,v83
v_cvt_pk_bf16_f32 v82,v84,v85
v_cvt_pk_bf16_f32 v83,v86,v87
ds_write_b128 v10,v[80:83] offset:1024
s_mov_b32 m0,20480
s_add_u32 s42,s40,86016
buffer_load_dwordx4 v1,s[8:11],s42 offen nt lds
v_mfma_f32_16x16x32_bf16 v[48:51],v[16:19],a[128:131],0
buffer_load_dwordx4 v2,s[8:11],s42 offen offset:1024 nt lds
v_mfma_f32_16x16x32_bf16 v[56:59],v[16:19],a[192:195],0
v_mul_f32 v88,s39,v88
v_mul_f32 v89,s39,v89
v_mul_f32 v90,s39,v90
v_mul_f32 v91,s39,v91
v_mul_f32 v92,s39,v92
v_mul_f32 v93,s39,v93
v_mul_f32 v94,s39,v94
v_mul_f32 v95,s39,v95
v_cvt_pk_bf16_f32 v88,v88,v89
v_cvt_pk_bf16_f32 v89,v90,v91
v_cvt_pk_bf16_f32 v90,v92,v93
v_cvt_pk_bf16_f32 v91,v94,v95
ds_write_b128 v10,v[88:91] offset:5120
buffer_load_dwordx4 v3,s[8:11],s42 offen offset:2048 nt lds
v_mfma_f32_16x16x32_bf16 v[64:67],v[16:19],v[128:131],0
buffer_load_dwordx4 v4,s[8:11],s42 offen offset:3072 nt lds
v_mfma_f32_16x16x32_bf16 v[72:75],v[16:19],v[192:195],0
v_mul_f32 v96,s39,v96
v_mul_f32 v97,s39,v97
L_tp_q3:
s_cbranch_execz L_tp_a3
v_mul_f32 v98,s39,v98
v_mul_f32 v99,s39,v99
v_mul_f32 v100,s39,v100
v_mul_f32 v101,s39,v101
v_mul_f32 v102,s39,v102
v_mul_f32 v103,s39,v103
v_cvt_pk_bf16_f32 v96,v96,v97
v_cvt_pk_bf16_f32 v97,v98,v99
v_cvt_pk_bf16_f32 v98,v100,v101
v_cvt_pk_bf16_f32 v99,v102,v103
ds_write_b128 v10,v[96:99] offset:9216
s_mov_b32 m0,32768
s_add_u32 s41,s40,65536
buffer_load_dwordx4 v5,s[12:15],s41 offen nt lds
v_mfma_f32_16x16x32_bf16 v[76:79],v[20:23],v[192:195],0
ds_read_b64_tr_b16 v[28:29],v9 offset:8
ds_read_b64_tr_b16 v[30:31],v9 offset:520
v_mfma_f32_16x16x32_bf16 v[68:71],v[20:23],v[128:131],0
v_mul_f32 v104,s39,v104
v_mul_f32 v105,s39,v105
v_mul_f32 v106,s39,v106
v_mul_f32 v107,s39,v107
v_mul_f32 v108,s39,v108
v_mul_f32 v109,s39,v109
v_mul_f32 v110,s39,v110
v_mul_f32 v111,s39,v111
v_cvt_pk_bf16_f32 v104,v104,v105
v_cvt_pk_bf16_f32 v105,v106,v107
v_cvt_pk_bf16_f32 v106,v108,v109
v_cvt_pk_bf16_f32 v107,v110,v111
ds_write_b128 v10,v[104:107] offset:13312
buffer_load_dwordx4 v6,s[12:15],s41 offen offset:1024 nt lds
v_mfma_f32_16x16x32_bf16 v[60:63],v[20:23],a[192:195],0
buffer_load_dwordx4 v5,s[12:15],s41 offen offset:2048 nt lds
buffer_load_dwordx4 v6,s[12:15],s41 offen offset:3072 nt lds
v_mfma_f32_16x16x32_bf16 v[52:55],v[20:23],a[128:131],0
v_mul_f32 v112,s39,v112
v_mul_f32 v113,s39,v113
v_mul_f32 v114,s39,v114
v_mul_f32 v115,s39,v115
v_mul_f32 v116,s39,v116
v_mul_f32 v117,s39,v117
v_mul_f32 v118,s39,v118
v_mul_f32 v119,s39,v119
v_cvt_pk_bf16_f32 v112,v112,v113
v_cvt_pk_bf16_f32 v113,v114,v115
v_cvt_pk_bf16_f32 v114,v116,v117
v_cvt_pk_bf16_f32 v115,v118,v119
ds_write_b128 v10,v[112:115] offset:17408
v_mfma_f32_16x16x32_bf16 v[44:47],v[20:23],a[64:67],0
s_mov_b32 m0,36864
s_add_u32 s42,s40,69632
buffer_load_dwordx4 v5,s[12:15],s42 offen nt lds
v_mfma_f32_16x16x32_bf16 v[36:39],v[20:23],a[0:3],0
v_mul_f32 v120,s39,v120
v_mul_f32 v121,s39,v121
v_mul_f32 v122,s39,v122
v_mul_f32 v123,s39,v123
v_mul_f32 v124,s39,v124
v_mul_f32 v125,s39,v125
v_mul_f32 v126,s39,v126
v_mul_f32 v127,s39,v127
v_cvt_pk_bf16_f32 v120,v120,v121
v_cvt_pk_bf16_f32 v121,v122,v123
v_cvt_pk_bf16_f32 v122,v124,v125
v_cvt_pk_bf16_f32 v123,v126,v127
ds_write_b128 v10,v[120:123] offset:21504
buffer_load_dwordx4 v6,s[12:15],s42 offen offset:1024 nt lds
buffer_load_dwordx4 v5,s[12:15],s42 offen offset:2048 nt lds
s_waitcnt lgkmcnt(8)
v_mfma_f32_16x16x32_bf16 v[80:83],v[24:27],a[0:3],0
ds_read_b64_tr_b16 v[16:17],v8 offset:4096
ds_read_b64_tr_b16 v[18:19],v8 offset:4608
v_mfma_f32_16x16x32_bf16 v[88:91],v[24:27],a[64:67],0
buffer_load_dwordx4 v6,s[12:15],s42 offen offset:3072 nt lds
v_mfma_f32_16x16x32_bf16 v[96:99],v[24:27],a[128:131],0
s_mov_b32 m0,122880
s_add_u32 s41,s51,384
buffer_load_dwordx4 v7,s[16:19],s41 offen lds
v_mfma_f32_16x16x32_bf16 v[104:107],v[24:27],a[192:195],0
s_add_u32 s42,s51,64896
buffer_load_dwordx4 v7,s[16:19],s42 offen offset:1024 lds
v_mfma_f32_16x16x32_bf16 v[112:115],v[24:27],v[128:131],0
v_mfma_f32_16x16x32_bf16 v[120:123],v[24:27],v[192:195],0
s_add_u32 s41,s51,129408
buffer_load_dwordx4 v7,s[16:19],s41 offen offset:2048 lds
s_waitcnt lgkmcnt(5)
v_mfma_f32_16x16x32_bf16 v[124:127],v[28:31],v[192:195],0
ds_read_b64_tr_b16 v[20:21],v8 offset:4104
ds_read_b64_tr_b16 v[22:23],v8 offset:4616
s_add_u32 s42,s51,193920
buffer_load_dwordx4 v7,s[16:19],s42 offen offset:3072 lds
v_mfma_f32_16x16x32_bf16 v[116:119],v[28:31],v[128:131],0
v_mfma_f32_16x16x32_bf16 v[108:111],v[28:31],a[192:195],0
s_mov_b32 m0,126976
s_add_u32 s41,s51,262528
buffer_load_dwordx4 v7,s[16:19],s41 offen lds
v_mfma_f32_16x16x32_bf16 v[100:103],v[28:31],a[128:131],0
s_add_u32 s42,s51,327040
buffer_load_dwordx4 v7,s[16:19],s42 offen offset:1024 lds
v_mfma_f32_16x16x32_bf16 v[92:95],v[28:31],a[64:67],0
s_add_u32 s41,s51,391552
buffer_load_dwordx4 v7,s[16:19],s41 offen offset:2048 lds
v_mfma_f32_16x16x32_bf16 v[84:87],v[28:31],a[0:3],0
s_add_u32 s42,s51,456064
buffer_load_dwordx4 v7,s[16:19],s42 offen offset:3072 lds
s_cmp_eq_u32 s3,0
s_cbranch_scc1 L_light7
s_waitcnt vmcnt(22)
s_branch L_heavy7
L_light7:
s_waitcnt vmcnt(24)
L_heavy7:
s_waitcnt lgkmcnt(0)
s_barrier
s_mov_b32 m0,24576
s_add_u32 s41,s40,90112
buffer_load_dwordx4 v1,s[8:11],s41 offen nt lds
buffer_load_dwordx4 v2,s[8:11],s41 offen offset:1024 nt lds
buffer_load_dwordx4 v3,s[8:11],s41 offen offset:2048 nt lds
buffer_load_dwordx4 v4,s[8:11],s41 offen offset:3072 nt lds
v_mfma_f32_16x16x32_bf16 v[32:35],v[16:19],a[4:7],v[32:35]
ds_read_b64_tr_b16 v[24:25],v9 offset:4096
ds_read_b64_tr_b16 v[26:27],v9 offset:4608
v_mfma_f32_16x16x32_bf16 v[40:43],v[16:19],a[68:71],v[40:43]
s_mov_b32 m0,28672
s_add_u32 s42,s40,94208
v_mfma_f32_16x16x32_bf16 v[48:51],v[16:19],a[132:135],v[48:51]
buffer_load_dwordx4 v1,s[8:11],s42 offen nt lds
v_mfma_f32_16x16x32_bf16 v[56:59],v[16:19],a[196:199],v[56:59]
v_mfma_f32_16x16x32_bf16 v[64:67],v[16:19],v[132:135],v[64:67]
buffer_load_dwordx4 v2,s[8:11],s42 offen offset:1024 nt lds
v_mfma_f32_16x16x32_bf16 v[72:75],v[16:19],v[196:199],v[72:75]
v_mfma_f32_16x16x32_bf16 v[76:79],v[20:23],v[196:199],v[76:79]
ds_read_b64_tr_b16 v[28:29],v9 offset:4104
ds_read_b64_tr_b16 v[30:31],v9 offset:4616
v_mfma_f32_16x16x32_bf16 v[68:71],v[20:23],v[132:135],v[68:71]
v_mfma_f32_16x16x32_bf16 v[60:63],v[20:23],a[196:199],v[60:63]
buffer_load_dwordx4 v3,s[8:11],s42 offen offset:2048 nt lds
v_mfma_f32_16x16x32_bf16 v[52:55],v[20:23],a[132:135],v[52:55]
v_mfma_f32_16x16x32_bf16 v[44:47],v[20:23],a[68:71],v[44:47]
buffer_load_dwordx4 v4,s[8:11],s42 offen offset:3072 nt lds
v_mfma_f32_16x16x32_bf16 v[36:39],v[20:23],a[4:7],v[36:39]
s_waitcnt lgkmcnt(2)
v_mfma_f32_16x16x32_bf16 v[80:83],v[24:27],a[4:7],v[80:83]
ds_read_b64_tr_b16 v[16:17],v8 offset:8192
ds_read_b64_tr_b16 v[18:19],v8 offset:8704
v_mfma_f32_16x16x32_bf16 v[88:91],v[24:27],a[68:71],v[88:91]
s_mov_b32 m0,40960
s_add_u32 s41,s40,73728
v_mfma_f32_16x16x32_bf16 v[96:99],v[24:27],a[132:135],v[96:99]
buffer_load_dwordx4 v5,s[12:15],s41 offen nt lds
v_mfma_f32_16x16x32_bf16 v[104:107],v[24:27],a[196:199],v[104:107]
v_mfma_f32_16x16x32_bf16 v[112:115],v[24:27],v[132:135],v[112:115]
buffer_load_dwordx4 v6,s[12:15],s41 offen offset:1024 nt lds
v_mfma_f32_16x16x32_bf16 v[120:123],v[24:27],v[196:199],v[120:123]
s_waitcnt lgkmcnt(2)
v_mfma_f32_16x16x32_bf16 v[124:127],v[28:31],v[196:199],v[124:127]
ds_read_b64_tr_b16 v[20:21],v8 offset:8200
ds_read_b64_tr_b16 v[22:23],v8 offset:8712
v_mfma_f32_16x16x32_bf16 v[116:119],v[28:31],v[132:135],v[116:119]
v_mfma_f32_16x16x32_bf16 v[108:111],v[28:31],a[196:199],v[108:111]
buffer_load_dwordx4 v5,s[12:15],s41 offen offset:2048 nt lds
v_mfma_f32_16x16x32_bf16 v[100:103],v[28:31],a[132:135],v[100:103]
v_mfma_f32_16x16x32_bf16 v[92:95],v[28:31],a[68:71],v[92:95]
buffer_load_dwordx4 v6,s[12:15],s41 offen offset:3072 nt lds
v_mfma_f32_16x16x32_bf16 v[84:87],v[28:31],a[4:7],v[84:87]
s_waitcnt lgkmcnt(2)
v_mfma_f32_16x16x32_bf16 v[32:35],v[16:19],a[8:11],v[32:35]
ds_read_b64_tr_b16 v[24:25],v9 offset:8192
ds_read_b64_tr_b16 v[26:27],v9 offset:8704
v_mfma_f32_16x16x32_bf16 v[40:43],v[16:19],a[72:75],v[40:43]
s_mov_b32 m0,45056
s_add_u32 s42,s40,77824
v_mfma_f32_16x16x32_bf16 v[48:51],v[16:19],a[136:139],v[48:51]
buffer_load_dwordx4 v5,s[12:15],s42 offen nt lds
v_mfma_f32_16x16x32_bf16 v[56:59],v[16:19],a[200:203],v[56:59]
v_mfma_f32_16x16x32_bf16 v[64:67],v[16:19],v[136:139],v[64:67]
buffer_load_dwordx4 v6,s[12:15],s42 offen offset:1024 nt lds
v_mfma_f32_16x16x32_bf16 v[72:75],v[16:19],v[200:203],v[72:75]
s_waitcnt lgkmcnt(2)
v_mfma_f32_16x16x32_bf16 v[76:79],v[20:23],v[200:203],v[76:79]
ds_read_b64_tr_b16 v[28:29],v9 offset:8200
ds_read_b64_tr_b16 v[30:31],v9 offset:8712
v_mfma_f32_16x16x32_bf16 v[68:71],v[20:23],v[136:139],v[68:71]
v_mfma_f32_16x16x32_bf16 v[60:63],v[20:23],a[200:203],v[60:63]
buffer_load_dwordx4 v5,s[12:15],s42 offen offset:2048 nt lds
v_mfma_f32_16x16x32_bf16 v[52:55],v[20:23],a[136:139],v[52:55]
v_mfma_f32_16x16x32_bf16 v[44:47],v[20:23],a[72:75],v[44:47]
buffer_load_dwordx4 v6,s[12:15],s42 offen offset:3072 nt lds
v_mfma_f32_16x16x32_bf16 v[36:39],v[20:23],a[8:11],v[36:39]
s_waitcnt lgkmcnt(2)
v_mfma_f32_16x16x32_bf16 v[80:83],v[24:27],a[8:11],v[80:83]
ds_read_b64_tr_b16 v[16:17],v8 offset:12288
ds_read_b64_tr_b16 v[18:19],v8 offset:12800
v_mfma_f32_16x16x32_bf16 v[88:91],v[24:27],a[72:75],v[88:91]
s_mov_b32 m0,98304
s_add_u32 s41,s52,384
v_mfma_f32_16x16x32_bf16 v[96:99],v[24:27],a[136:139],v[96:99]
buffer_load_dwordx4 v7,s[16:19],s41 offen lds
v_mfma_f32_16x16x32_bf16 v[104:107],v[24:27],a[200:203],v[104:107]
s_add_u32 s42,s52,64896
v_mfma_f32_16x16x32_bf16 v[112:115],v[24:27],v[136:139],v[112:115]
buffer_load_dwordx4 v7,s[16:19],s42 offen offset:1024 lds
v_mfma_f32_16x16x32_bf16 v[120:123],v[24:27],v[200:203],v[120:123]
s_waitcnt lgkmcnt(2)
v_mfma_f32_16x16x32_bf16 v[124:127],v[28:31],v[200:203],v[124:127]
ds_read_b64_tr_b16 v[20:21],v8 offset:12296
ds_read_b64_tr_b16 v[22:23],v8 offset:12808
v_mfma_f32_16x16x32_bf16 v[116:119],v[28:31],v[136:139],v[116:119]
s_add_u32 s41,s52,129408
v_mfma_f32_16x16x32_bf16 v[108:111],v[28:31],a[200:203],v[108:111]
buffer_load_dwordx4 v7,s[16:19],s41 offen offset:2048 lds
v_mfma_f32_16x16x32_bf16 v[100:103],v[28:31],a[136:139],v[100:103]
s_add_u32 s42,s52,193920
v_mfma_f32_16x16x32_bf16 v[92:95],v[28:31],a[72:75],v[92:95]
buffer_load_dwordx4 v7,s[16:19],s42 offen offset:3072 lds
v_mfma_f32_16x16x32_bf16 v[84:87],v[28:31],a[8:11],v[84:87]
s_waitcnt lgkmcnt(2)
v_mfma_f32_16x16x32_bf16 v[32:35],v[16:19],a[12:15],v[32:35]
ds_read_b64_tr_b16 v[24:25],v9 offset:12288
ds_read_b64_tr_b16 v[26:27],v9 offset:12800
v_mfma_f32_16x16x32_bf16 v[40:43],v[16:19],a[76:79],v[40:43]
s_mov_b32 m0,102400
s_add_u32 s41,s52,262528
v_mfma_f32_16x16x32_bf16 v[48:51],v[16:19],a[140:143],v[48:51]
buffer_load_dwordx4 v7,s[16:19],s41 offen lds
v_mfma_f32_16x16x32_bf16 v[56:59],v[16:19],a[204:207],v[56:59]
s_add_u32 s42,s52,327040
v_mfma_f32_16x16x32_bf16 v[64:67],v[16:19],v[140:143],v[64:67]
buffer_load_dwordx4 v7,s[16:19],s42 offen offset:1024 lds
v_mfma_f32_16x16x32_bf16 v[72:75],v[16:19],v[204:207],v[72:75]
s_waitcnt lgkmcnt(2)
v_mfma_f32_16x16x32_bf16 v[76:79],v[20:23],v[204:207],v[76:79]
ds_read_b64_tr_b16 v[28:29],v9 offset:12296
ds_read_b64_tr_b16 v[30:31],v9 offset:12808
v_mfma_f32_16x16x32_bf16 v[68:71],v[20:23],v[140:143],v[68:71]
s_add_u32 s41,s52,391552
v_mfma_f32_16x16x32_bf16 v[60:63],v[20:23],a[204:207],v[60:63]
buffer_load_dwordx4 v7,s[16:19],s41 offen offset:2048 lds
v_mfma_f32_16x16x32_bf16 v[52:55],v[20:23],a[140:143],v[52:55]
s_add_u32 s42,s52,456064
v_mfma_f32_16x16x32_bf16 v[44:47],v[20:23],a[76:79],v[44:47]
buffer_load_dwordx4 v7,s[16:19],s42 offen offset:3072 lds
v_mfma_f32_16x16x32_bf16 v[36:39],v[20:23],a[12:15],v[36:39]
s_cmp_eq_u32 s3,0
s_cbranch_scc1 L_light8
s_waitcnt vmcnt(18)
s_branch L_heavy8
L_light8:
s_waitcnt vmcnt(24)
L_heavy8:
s_barrier
s_mov_b32 m0,0
s_add_u32 s41,s40,98304
buffer_load_dwordx4 v1,s[8:11],s41 offen nt lds
buffer_load_dwordx4 v2,s[8:11],s41 offen offset:1024 nt lds
buffer_load_dwordx4 v3,s[8:11],s41 offen offset:2048 nt lds
buffer_load_dwordx4 v4,s[8:11],s41 offen offset:3072 nt lds
s_waitcnt lgkmcnt(2)
v_mfma_f32_16x16x32_bf16 v[80:83],v[24:27],a[12:15],v[80:83]
ds_read_b64_tr_b16 v[16:17],v8 offset:16384
ds_read_b64_tr_b16 v[18:19],v8 offset:16896
v_mfma_f32_16x16x32_bf16 v[88:91],v[24:27],a[76:79],v[88:91]
s_mov_b32 m0,4096
s_add_u32 s42,s40,102400
v_mfma_f32_16x16x32_bf16 v[96:99],v[24:27],a[140:143],v[96:99]
buffer_load_dwordx4 v1,s[8:11],s42 offen nt lds
v_mfma_f32_16x16x32_bf16 v[104:107],v[24:27],a[204:207],v[104:107]
v_mfma_f32_16x16x32_bf16 v[112:115],v[24:27],v[140:143],v[112:115]
buffer_load_dwordx4 v2,s[8:11],s42 offen offset:1024 nt lds
v_mfma_f32_16x16x32_bf16 v[120:123],v[24:27],v[204:207],v[120:123]
buffer_load_dwordx4 v3,s[8:11],s42 offen offset:2048 nt lds
s_waitcnt lgkmcnt(2)
v_mfma_f32_16x16x32_bf16 v[124:127],v[28:31],v[204:207],v[124:127]
ds_read_b64_tr_b16 v[20:21],v8 offset:16392
ds_read_b64_tr_b16 v[22:23],v8 offset:16904
v_mfma_f32_16x16x32_bf16 v[116:119],v[28:31],v[140:143],v[116:119]
v_mfma_f32_16x16x32_bf16 v[108:111],v[28:31],a[204:207],v[108:111]
v_mfma_f32_16x16x32_bf16 v[100:103],v[28:31],a[140:143],v[100:103]
v_mfma_f32_16x16x32_bf16 v[92:95],v[28:31],a[76:79],v[92:95]
buffer_load_dwordx4 v4,s[8:11],s42 offen offset:3072 nt lds
v_mfma_f32_16x16x32_bf16 v[84:87],v[28:31],a[12:15],v[84:87]
s_mov_b32 m0,49152
s_add_u32 s41,s40,81920
buffer_load_dwordx4 v5,s[12:15],s41 offen nt lds
s_waitcnt lgkmcnt(2)
v_mfma_f32_16x16x32_bf16 v[32:35],v[16:19],a[16:19],v[32:35]
ds_read_b64_tr_b16 v[24:25],v9 offset:16384
ds_read_b64_tr_b16 v[26:27],v9 offset:16896
v_mfma_f32_16x16x32_bf16 v[40:43],v[16:19],a[80:83],v[40:43]
v_mfma_f32_16x16x32_bf16 v[48:51],v[16:19],a[144:147],v[48:51]
buffer_load_dwordx4 v6,s[12:15],s41 offen offset:1024 nt lds
v_mfma_f32_16x16x32_bf16 v[56:59],v[16:19],a[208:211],v[56:59]
v_mfma_f32_16x16x32_bf16 v[64:67],v[16:19],v[144:147],v[64:67]
v_mfma_f32_16x16x32_bf16 v[72:75],v[16:19],v[208:211],v[72:75]
buffer_load_dwordx4 v5,s[12:15],s41 offen offset:2048 nt lds
s_waitcnt lgkmcnt(2)
v_mfma_f32_16x16x32_bf16 v[76:79],v[20:23],v[208:211],v[76:79]
ds_read_b64_tr_b16 v[28:29],v9 offset:16392
ds_read_b64_tr_b16 v[30:31],v9 offset:16904
v_mfma_f32_16x16x32_bf16 v[68:71],v[20:23],v[144:147],v[68:71]
v_mfma_f32_16x16x32_bf16 v[60:63],v[20:23],a[208:211],v[60:63]
buffer_load_dwordx4 v6,s[12:15],s41 offen offset:3072 nt lds
v_mfma_f32_16x16x32_bf16 v[52:55],v[20:23],a[144:147],v[52:55]
s_mov_b32 m0,53248
s_add_u32 s42,s40,86016
v_mfma_f32_16x16x32_bf16 v[44:47],v[20:23],a[80:83],v[44:47]
buffer_load_dwordx4 v5,s[12:15],s42 offen nt lds
v_mfma_f32_16x16x32_bf16 v[36:39],v[20:23],a[16:19],v[36:39]
s_waitcnt lgkmcnt(2)
v_mfma_f32_16x16x32_bf16 v[80:83],v[24:27],a[16:19],v[80:83]
ds_read_b64_tr_b16 v[16:17],v8 offset:20480
ds_read_b64_tr_b16 v[18:19],v8 offset:20992
v_mfma_f32_16x16x32_bf16 v[88:91],v[24:27],a[80:83],v[88:91]
v_mfma_f32_16x16x32_bf16 v[96:99],v[24:27],a[144:147],v[96:99]
buffer_load_dwordx4 v6,s[12:15],s42 offen offset:1024 nt lds
v_mfma_f32_16x16x32_bf16 v[104:107],v[24:27],a[208:211],v[104:107]
v_mfma_f32_16x16x32_bf16 v[112:115],v[24:27],v[144:147],v[112:115]
buffer_load_dwordx4 v5,s[12:15],s42 offen offset:2048 nt lds
v_mfma_f32_16x16x32_bf16 v[120:123],v[24:27],v[208:211],v[120:123]
buffer_load_dwordx4 v6,s[12:15],s42 offen offset:3072 nt lds
s_waitcnt lgkmcnt(2)
v_mfma_f32_16x16x32_bf16 v[124:127],v[28:31],v[208:211],v[124:127]
ds_read_b64_tr_b16 v[20:21],v8 offset:20488
ds_read_b64_tr_b16 v[22:23],v8 offset:21000
v_mfma_f32_16x16x32_bf16 v[116:119],v[28:31],v[144:147],v[116:119]
v_mfma_f32_16x16x32_bf16 v[108:111],v[28:31],a[208:211],v[108:111]
v_mfma_f32_16x16x32_bf16 v[100:103],v[28:31],a[144:147],v[100:103]
s_mov_b32 m0,106496
s_add_u32 s41,s53,384
v_mfma_f32_16x16x32_bf16 v[92:95],v[28:31],a[80:83],v[92:95]
buffer_load_dwordx4 v7,s[16:19],s41 offen lds
v_mfma_f32_16x16x32_bf16 v[84:87],v[28:31],a[16:19],v[84:87]
s_add_u32 s42,s53,64896
buffer_load_dwordx4 v7,s[16:19],s42 offen offset:1024 lds
s_waitcnt lgkmcnt(2)
v_mfma_f32_16x16x32_bf16 v[32:35],v[16:19],a[20:23],v[32:35]
ds_read_b64_tr_b16 v[24:25],v9 offset:20480
ds_read_b64_tr_b16 v[26:27],v9 offset:20992
v_mfma_f32_16x16x32_bf16 v[40:43],v[16:19],a[84:87],v[40:43]
s_add_u32 s41,s53,129408
v_mfma_f32_16x16x32_bf16 v[48:51],v[16:19],a[148:151],v[48:51]
buffer_load_dwordx4 v7,s[16:19],s41 offen offset:2048 lds
v_mfma_f32_16x16x32_bf16 v[56:59],v[16:19],a[212:215],v[56:59]
s_add_u32 s42,s53,193920
v_mfma_f32_16x16x32_bf16 v[64:67],v[16:19],v[148:151],v[64:67]
v_mfma_f32_16x16x32_bf16 v[72:75],v[16:19],v[212:215],v[72:75]
buffer_load_dwordx4 v7,s[16:19],s42 offen offset:3072 lds
s_waitcnt lgkmcnt(2)
v_mfma_f32_16x16x32_bf16 v[76:79],v[20:23],v[212:215],v[76:79]
ds_read_b64_tr_b16 v[28:29],v9 offset:20488
ds_read_b64_tr_b16 v[30:31],v9 offset:21000
v_mfma_f32_16x16x32_bf16 v[68:71],v[20:23],v[148:151],v[68:71]
s_mov_b32 m0,110592
s_add_u32 s41,s53,262528
v_mfma_f32_16x16x32_bf16 v[60:63],v[20:23],a[212:215],v[60:63]
buffer_load_dwordx4 v7,s[16:19],s41 offen lds
v_mfma_f32_16x16x32_bf16 v[52:55],v[20:23],a[148:151],v[52:55]
s_add_u32 s42,s53,327040
v_mfma_f32_16x16x32_bf16 v[44:47],v[20:23],a[84:87],v[44:47]
buffer_load_dwordx4 v7,s[16:19],s42 offen offset:1024 lds
v_mfma_f32_16x16x32_bf16 v[36:39],v[20:23],a[20:23],v[36:39]
s_waitcnt lgkmcnt(2)
v_mfma_f32_16x16x32_bf16 v[80:83],v[24:27],a[20:23],v[80:83]
ds_read_b64_tr_b16 v[16:17],v8 offset:24576
ds_read_b64_tr_b16 v[18:19],v8 offset:25088
v_mfma_f32_16x16x32_bf16 v[88:91],v[24:27],a[84:87],v[88:91]
s_add_u32 s41,s53,391552
v_mfma_f32_16x16x32_bf16 v[96:99],v[24:27],a[148:151],v[96:99]
buffer_load_dwordx4 v7,s[16:19],s41 offen offset:2048 lds
v_mfma_f32_16x16x32_bf16 v[104:107],v[24:27],a[212:215],v[104:107]
s_add_u32 s42,s53,456064
v_mfma_f32_16x16x32_bf16 v[112:115],v[24:27],v[148:151],v[112:115]
buffer_load_dwordx4 v7,s[16:19],s42 offen offset:3072 lds
v_mfma_f32_16x16x32_bf16 v[120:123],v[24:27],v[212:215],v[120:123]
s_add_u32 s53,s53,256
s_cmp_eq_u32 s3,0
s_cbranch_scc1 L_light9
s_waitcnt vmcnt(18)
s_branch L_heavy9
L_light9:
s_waitcnt vmcnt(24)
L_heavy9:
s_barrier
s_mov_b32 m0,8192
s_add_u32 s41,s40,106496
buffer_load_dwordx4 v1,s[8:11],s41 offen nt lds
buffer_load_dwordx4 v2,s[8:11],s41 offen offset:1024 nt lds
buffer_load_dwordx4 v3,s[8:11],s41 offen offset:2048 nt lds
buffer_load_dwordx4 v4,s[8:11],s41 offen offset:3072 nt lds
s_waitcnt lgkmcnt(2)
v_mfma_f32_16x16x32_bf16 v[124:127],v[28:31],v[212:215],v[124:127]
ds_read_b64_tr_b16 v[20:21],v8 offset:24584
ds_read_b64_tr_b16 v[22:23],v8 offset:25096
v_mfma_f32_16x16x32_bf16 v[116:119],v[28:31],v[148:151],v[116:119]
s_mov_b32 m0,12288
s_add_u32 s42,s40,110592
v_mfma_f32_16x16x32_bf16 v[108:111],v[28:31],a[212:215],v[108:111]
buffer_load_dwordx4 v1,s[8:11],s42 offen nt lds
v_mfma_f32_16x16x32_bf16 v[100:103],v[28:31],a[148:151],v[100:103]
v_mfma_f32_16x16x32_bf16 v[92:95],v[28:31],a[84:87],v[92:95]
buffer_load_dwordx4 v2,s[8:11],s42 offen offset:1024 nt lds
v_mfma_f32_16x16x32_bf16 v[84:87],v[28:31],a[20:23],v[84:87]
buffer_load_dwordx4 v3,s[8:11],s42 offen offset:2048 nt lds
s_waitcnt lgkmcnt(2)
v_mfma_f32_16x16x32_bf16 v[32:35],v[16:19],a[24:27],v[32:35]
ds_read_b64_tr_b16 v[24:25],v9 offset:24576
ds_read_b64_tr_b16 v[26:27],v9 offset:25088
v_mfma_f32_16x16x32_bf16 v[40:43],v[16:19],a[88:91],v[40:43]
v_mfma_f32_16x16x32_bf16 v[48:51],v[16:19],a[152:155],v[48:51]
v_mfma_f32_16x16x32_bf16 v[56:59],v[16:19],a[216:219],v[56:59]
v_mfma_f32_16x16x32_bf16 v[64:67],v[16:19],v[152:155],v[64:67]
buffer_load_dwordx4 v4,s[8:11],s42 offen offset:3072 nt lds
v_mfma_f32_16x16x32_bf16 v[72:75],v[16:19],v[216:219],v[72:75]
s_mov_b32 m0,57344
s_add_u32 s41,s40,90112
buffer_load_dwordx4 v5,s[12:15],s41 offen nt lds
s_waitcnt lgkmcnt(2)
v_mfma_f32_16x16x32_bf16 v[76:79],v[20:23],v[216:219],v[76:79]
ds_read_b64_tr_b16 v[28:29],v9 offset:24584
ds_read_b64_tr_b16 v[30:31],v9 offset:25096
v_mfma_f32_16x16x32_bf16 v[68:71],v[20:23],v[152:155],v[68:71]
v_mfma_f32_16x16x32_bf16 v[60:63],v[20:23],a[216:219],v[60:63]
buffer_load_dwordx4 v6,s[12:15],s41 offen offset:1024 nt lds
v_mfma_f32_16x16x32_bf16 v[52:55],v[20:23],a[152:155],v[52:55]
v_mfma_f32_16x16x32_bf16 v[44:47],v[20:23],a[88:91],v[44:47]
v_mfma_f32_16x16x32_bf16 v[36:39],v[20:23],a[24:27],v[36:39]
buffer_load_dwordx4 v5,s[12:15],s41 offen offset:2048 nt lds
s_waitcnt lgkmcnt(2)
v_mfma_f32_16x16x32_bf16 v[80:83],v[24:27],a[24:27],v[80:83]
ds_read_b64_tr_b16 v[16:17],v8 offset:28672
ds_read_b64_tr_b16 v[18:19],v8 offset:29184
v_mfma_f32_16x16x32_bf16 v[88:91],v[24:27],a[88:91],v[88:91]
v_mfma_f32_16x16x32_bf16 v[96:99],v[24:27],a[152:155],v[96:99]
buffer_load_dwordx4 v6,s[12:15],s41 offen offset:3072 nt lds
v_mfma_f32_16x16x32_bf16 v[104:107],v[24:27],a[216:219],v[104:107]
s_mov_b32 m0,61440
s_add_u32 s42,s40,94208
v_mfma_f32_16x16x32_bf16 v[112:115],v[24:27],v[152:155],v[112:115]
buffer_load_dwordx4 v5,s[12:15],s42 offen nt lds
v_mfma_f32_16x16x32_bf16 v[120:123],v[24:27],v[216:219],v[120:123]
s_waitcnt lgkmcnt(2)
v_mfma_f32_16x16x32_bf16 v[124:127],v[28:31],v[216:219],v[124:127]
ds_read_b64_tr_b16 v[20:21],v8 offset:28680
ds_read_b64_tr_b16 v[22:23],v8 offset:29192
v_mfma_f32_16x16x32_bf16 v[116:119],v[28:31],v[152:155],v[116:119]
v_mfma_f32_16x16x32_bf16 v[108:111],v[28:31],a[216:219],v[108:111]
buffer_load_dwordx4 v6,s[12:15],s42 offen offset:1024 nt lds
v_mfma_f32_16x16x32_bf16 v[100:103],v[28:31],a[152:155],v[100:103]
v_mfma_f32_16x16x32_bf16 v[92:95],v[28:31],a[88:91],v[92:95]
buffer_load_dwordx4 v5,s[12:15],s42 offen offset:2048 nt lds
v_mfma_f32_16x16x32_bf16 v[84:87],v[28:31],a[24:27],v[84:87]
buffer_load_dwordx4 v6,s[12:15],s42 offen offset:3072 nt lds
s_waitcnt lgkmcnt(2)
v_mfma_f32_16x16x32_bf16 v[32:35],v[16:19],a[28:31],v[32:35]
ds_read_b64_tr_b16 v[24:25],v9 offset:28672
ds_read_b64_tr_b16 v[26:27],v9 offset:29184
v_mfma_f32_16x16x32_bf16 v[40:43],v[16:19],a[92:95],v[40:43]
v_mfma_f32_16x16x32_bf16 v[48:51],v[16:19],a[156:159],v[48:51]
v_mfma_f32_16x16x32_bf16 v[56:59],v[16:19],a[220:223],v[56:59]
s_mov_b32 m0,114688
s_add_u32 s41,s54,384
v_mfma_f32_16x16x32_bf16 v[64:67],v[16:19],v[156:159],v[64:67]
buffer_load_dwordx4 v7,s[16:19],s41 offen lds
v_mfma_f32_16x16x32_bf16 v[72:75],v[16:19],v[220:223],v[72:75]
s_add_u32 s42,s54,64896
buffer_load_dwordx4 v7,s[16:19],s42 offen offset:1024 lds
s_waitcnt lgkmcnt(2)
v_mfma_f32_16x16x32_bf16 v[76:79],v[20:23],v[220:223],v[76:79]
ds_read_b64_tr_b16 v[28:29],v9 offset:28680
ds_read_b64_tr_b16 v[30:31],v9 offset:29192
v_mfma_f32_16x16x32_bf16 v[68:71],v[20:23],v[156:159],v[68:71]
s_add_u32 s41,s54,129408
v_mfma_f32_16x16x32_bf16 v[60:63],v[20:23],a[220:223],v[60:63]
buffer_load_dwordx4 v7,s[16:19],s41 offen offset:2048 lds
v_mfma_f32_16x16x32_bf16 v[52:55],v[20:23],a[156:159],v[52:55]
s_add_u32 s42,s54,193920
v_mfma_f32_16x16x32_bf16 v[44:47],v[20:23],a[92:95],v[44:47]
v_mfma_f32_16x16x32_bf16 v[36:39],v[20:23],a[28:31],v[36:39]
buffer_load_dwordx4 v7,s[16:19],s42 offen offset:3072 lds
s_waitcnt lgkmcnt(2)
v_mfma_f32_16x16x32_bf16 v[80:83],v[24:27],a[28:31],v[80:83]
ds_read_b64_tr_b16 v[16:17],v8
ds_read_b64_tr_b16 v[18:19],v8 offset:512
v_mfma_f32_16x16x32_bf16 v[88:91],v[24:27],a[92:95],v[88:91]
s_mov_b32 m0,118784
s_add_u32 s41,s54,262528
v_mfma_f32_16x16x32_bf16 v[96:99],v[24:27],a[156:159],v[96:99]
buffer_load_dwordx4 v7,s[16:19],s41 offen lds
v_mfma_f32_16x16x32_bf16 v[104:107],v[24:27],a[220:223],v[104:107]
s_add_u32 s42,s54,327040
v_mfma_f32_16x16x32_bf16 v[112:115],v[24:27],v[156:159],v[112:115]
buffer_load_dwordx4 v7,s[16:19],s42 offen offset:1024 lds
v_mfma_f32_16x16x32_bf16 v[120:123],v[24:27],v[220:223],v[120:123]
s_waitcnt lgkmcnt(2)
v_mfma_f32_16x16x32_bf16 v[124:127],v[28:31],v[220:223],v[124:127]
ds_read_b64_tr_b16 v[20:21],v8 offset:8
ds_read_b64_tr_b16 v[22:23],v8 offset:520
v_mfma_f32_16x16x32_bf16 v[116:119],v[28:31],v[156:159],v[116:119]
s_add_u32 s41,s54,391552
v_mfma_f32_16x16x32_bf16 v[108:111],v[28:31],a[220:223],v[108:111]
buffer_load_dwordx4 v7,s[16:19],s41 offen offset:2048 lds
v_mfma_f32_16x16x32_bf16 v[100:103],v[28:31],a[156:159],v[100:103]
s_add_u32 s42,s54,456064
v_mfma_f32_16x16x32_bf16 v[92:95],v[28:31],a[92:95],v[92:95]
buffer_load_dwordx4 v7,s[16:19],s42 offen offset:3072 lds
v_mfma_f32_16x16x32_bf16 v[84:87],v[28:31],a[28:31],v[84:87]
s_add_u32 s54,s54,256
s_cmp_eq_u32 s3,0
s_cbranch_scc1 L_light10
s_waitcnt vmcnt(18)
s_branch L_heavy10
L_light10:
s_waitcnt vmcnt(24)
L_heavy10:
s_barrier
s_mov_b32 m0,16384
s_add_u32 s41,s40,114688
buffer_load_dwordx4 v1,s[8:11],s41 offen nt lds
buffer_load_dwordx4 v2,s[8:11],s41 offen offset:1024 nt lds
buffer_load_dwordx4 v3,s[8:11],s41 offen offset:2048 nt lds
buffer_load_dwordx4 v4,s[8:11],s41 offen offset:3072 nt lds
s_waitcnt lgkmcnt(2)
v_mfma_f32_16x16x32_bf16 v[32:35],v[16:19],a[32:35],v[32:35]
ds_read_b64_tr_b16 v[24:25],v9
ds_read_b64_tr_b16 v[26:27],v9 offset:512
v_mfma_f32_16x16x32_bf16 v[40:43],v[16:19],a[96:99],v[40:43]
s_mov_b32 m0,20480
s_add_u32 s42,s40,118784
v_mfma_f32_16x16x32_bf16 v[48:51],v[16:19],a[160:163],v[48:51]
buffer_load_dwordx4 v1,s[8:11],s42 offen nt lds
v_mfma_f32_16x16x32_bf16 v[56:59],v[16:19],a[224:227],v[56:59]
v_mfma_f32_16x16x32_bf16 v[64:67],v[16:19],v[160:163],v[64:67]
buffer_load_dwordx4 v2,s[8:11],s42 offen offset:1024 nt lds
v_mfma_f32_16x16x32_bf16 v[72:75],v[16:19],v[224:227],v[72:75]
buffer_load_dwordx4 v3,s[8:11],s42 offen offset:2048 nt lds
s_waitcnt lgkmcnt(2)
v_mfma_f32_16x16x32_bf16 v[76:79],v[20:23],v[224:227],v[76:79]
ds_read_b64_tr_b16 v[28:29],v9 offset:8
ds_read_b64_tr_b16 v[30:31],v9 offset:520
v_mfma_f32_16x16x32_bf16 v[68:71],v[20:23],v[160:163],v[68:71]
v_mfma_f32_16x16x32_bf16 v[60:63],v[20:23],a[224:227],v[60:63]
v_mfma_f32_16x16x32_bf16 v[52:55],v[20:23],a[160:163],v[52:55]
v_mfma_f32_16x16x32_bf16 v[44:47],v[20:23],a[96:99],v[44:47]
buffer_load_dwordx4 v4,s[8:11],s42 offen offset:3072 nt lds
v_mfma_f32_16x16x32_bf16 v[36:39],v[20:23],a[32:35],v[36:39]
s_mov_b32 m0,32768
s_add_u32 s41,s40,98304
buffer_load_dwordx4 v5,s[12:15],s41 offen nt lds
s_waitcnt lgkmcnt(2)
v_mfma_f32_16x16x32_bf16 v[80:83],v[24:27],a[32:35],v[80:83]
ds_read_b64_tr_b16 v[16:17],v8 offset:4096
ds_read_b64_tr_b16 v[18:19],v8 offset:4608
v_mfma_f32_16x16x32_bf16 v[88:91],v[24:27],a[96:99],v[88:91]
v_mfma_f32_16x16x32_bf16 v[96:99],v[24:27],a[160:163],v[96:99]
buffer_load_dwordx4 v6,s[12:15],s41 offen offset:1024 nt lds
v_mfma_f32_16x16x32_bf16 v[104:107],v[24:27],a[224:227],v[104:107]
v_mfma_f32_16x16x32_bf16 v[112:115],v[24:27],v[160:163],v[112:115]
v_mfma_f32_16x16x32_bf16 v[120:123],v[24:27],v[224:227],v[120:123]
buffer_load_dwordx4 v5,s[12:15],s41 offen offset:2048 nt lds
s_waitcnt lgkmcnt(2)
v_mfma_f32_16x16x32_bf16 v[124:127],v[28:31],v[224:227],v[124:127]
ds_read_b64_tr_b16 v[20:21],v8 offset:4104
L_tp_q4:
s_cbranch_execz L_tp_a4
ds_read_b64_tr_b16 v[22:23],v8 offset:4616
v_mfma_f32_16x16x32_bf16 v[116:119],v[28:31],v[160:163],v[116:119]
v_mfma_f32_16x16x32_bf16 v[108:111],v[28:31],a[224:227],v[108:111]
buffer_load_dwordx4 v6,s[12:15],s41 offen offset:3072 nt lds
v_mfma_f32_16x16x32_bf16 v[100:103],v[28:31],a[160:163],v[100:103]
s_mov_b32 m0,36864
s_add_u32 s42,s40,102400
v_mfma_f32_16x16x32_bf16 v[92:95],v[28:31],a[96:99],v[92:95]
buffer_load_dwordx4 v5,s[12:15],s42 offen nt lds
v_mfma_f32_16x16x32_bf16 v[84:87],v[28:31],a[32:35],v[84:87]
s_waitcnt lgkmcnt(2)
v_mfma_f32_16x16x32_bf16 v[32:35],v[16:19],a[36:39],v[32:35]
ds_read_b64_tr_b16 v[24:25],v9 offset:4096
ds_read_b64_tr_b16 v[26:27],v9 offset:4608
v_mfma_f32_16x16x32_bf16 v[40:43],v[16:19],a[100:103],v[40:43]
v_mfma_f32_16x16x32_bf16 v[48:51],v[16:19],a[164:167],v[48:51]
buffer_load_dwordx4 v6,s[12:15],s42 offen offset:1024 nt lds
v_mfma_f32_16x16x32_bf16 v[56:59],v[16:19],a[228:231],v[56:59]
v_mfma_f32_16x16x32_bf16 v[64:67],v[16:19],v[164:167],v[64:67]
buffer_load_dwordx4 v5,s[12:15],s42 offen offset:2048 nt lds
v_mfma_f32_16x16x32_bf16 v[72:75],v[16:19],v[228:231],v[72:75]
buffer_load_dwordx4 v6,s[12:15],s42 offen offset:3072 nt lds
s_waitcnt lgkmcnt(2)
v_mfma_f32_16x16x32_bf16 v[76:79],v[20:23],v[228:231],v[76:79]
ds_read_b64_tr_b16 v[28:29],v9 offset:4104
ds_read_b64_tr_b16 v[30:31],v9 offset:4616
v_mfma_f32_16x16x32_bf16 v[68:71],v[20:23],v[164:167],v[68:71]
v_mfma_f32_16x16x32_bf16 v[60:63],v[20:23],a[228:231],v[60:63]
v_mfma_f32_16x16x32_bf16 v[52:55],v[20:23],a[164:167],v[52:55]
s_mov_b32 m0,122880
s_add_u32 s41,s55,384
v_mfma_f32_16x16x32_bf16 v[44:47],v[20:23],a[100:103],v[44:47]
buffer_load_dwordx4 v7,s[16:19],s41 offen lds
v_mfma_f32_16x16x32_bf16 v[36:39],v[20:23],a[36:39],v[36:39]
s_add_u32 s42,s55,64896
buffer_load_dwordx4 v7,s[16:19],s42 offen offset:1024 lds
s_waitcnt lgkmcnt(2)
v_mfma_f32_16x16x32_bf16 v[80:83],v[24:27],a[36:39],v[80:83]
ds_read_b64_tr_b16 v[16:17],v8 offset:8192
ds_read_b64_tr_b16 v[18:19],v8 offset:8704
v_mfma_f32_16x16x32_bf16 v[88:91],v[24:27],a[100:103],v[88:91]
s_add_u32 s41,s55,129408
v_mfma_f32_16x16x32_bf16 v[96:99],v[24:27],a[164:167],v[96:99]
buffer_load_dwordx4 v7,s[16:19],s41 offen offset:2048 lds
v_mfma_f32_16x16x32_bf16 v[104:107],v[24:27],a[228:231],v[104:107]
s_add_u32 s42,s55,193920
v_mfma_f32_16x16x32_bf16 v[112:115],v[24:27],v[164:167],v[112:115]
v_mfma_f32_16x16x32_bf16 v[120:123],v[24:27],v[228:231],v[120:123]
buffer_load_dwordx4 v7,s[16:19],s42 offen offset:3072 lds
s_waitcnt lgkmcnt(2)
v_mfma_f32_16x16x32_bf16 v[124:127],v[28:31],v[228:231],v[124:127]
ds_read_b64_tr_b16 v[20:21],v8 offset:8200
ds_read_b64_tr_b16 v[22:23],v8 offset:8712
v_mfma_f32_16x16x32_bf16 v[116:119],v[28:31],v[164:167],v[116:119]
s_mov_b32 m0,126976
s_add_u32 s41,s55,262528
v_mfma_f32_16x16x32_bf16 v[108:111],v[28:31],a[228:231],v[108:111]
buffer_load_dwordx4 v7,s[16:19],s41 offen lds
v_mfma_f32_16x16x32_bf16 v[100:103],v[28:31],a[164:167],v[100:103]
s_add_u32 s42,s55,327040
v_mfma_f32_16x16x32_bf16 v[92:95],v[28:31],a[100:103],v[92:95]
buffer_load_dwordx4 v7,s[16:19],s42 offen offset:1024 lds
v_mfma_f32_16x16x32_bf16 v[84:87],v[28:31],a[36:39],v[84:87]
s_waitcnt lgkmcnt(2)
v_mfma_f32_16x16x32_bf16 v[32:35],v[16:19],a[40:43],v[32:35]
ds_read_b64_tr_b16 v[24:25],v9 offset:8192
ds_read_b64_tr_b16 v[26:27],v9 offset:8704
v_mfma_f32_16x16x32_bf16 v[40:43],v[16:19],a[104:107],v[40:43]
s_add_u32 s41,s55,391552
v_mfma_f32_16x16x32_bf16 v[48:51],v[16:19],a[168:171],v[48:51]
buffer_load_dwordx4 v7,s[16:19],s41 offen offset:2048 lds
v_mfma_f32_16x16x32_bf16 v[56:59],v[16:19],a[232:235],v[56:59]
s_add_u32 s42,s55,456064
v_mfma_f32_16x16x32_bf16 v[64:67],v[16:19],v[168:171],v[64:67]
buffer_load_dwordx4 v7,s[16:19],s42 offen offset:3072 lds
v_mfma_f32_16x16x32_bf16 v[72:75],v[16:19],v[232:235],v[72:75]
s_add_u32 s55,s55,256
s_cmp_eq_u32 s3,0
s_cbranch_scc1 L_light11
s_waitcnt vmcnt(18)
s_branch L_heavy11
L_light11:
s_waitcnt vmcnt(24)
L_heavy11:
s_add_u32 s100,s100,1
s_cmp_eq_u32 s100,3
s_cbranch_scc1 L_lloop0_end
s_barrier
s_mov_b32 m0,24576
s_add_u32 s41,s40,122880
buffer_load_dwordx4 v1,s[8:11],s41 offen nt lds
buffer_load_dwordx4 v2,s[8:11],s41 offen offset:1024 nt lds
buffer_load_dwordx4 v3,s[8:11],s41 offen offset:2048 nt lds
buffer_load_dwordx4 v4,s[8:11],s41 offen offset:3072 nt lds
s_waitcnt lgkmcnt(2)
v_mfma_f32_16x16x32_bf16 v[76:79],v[20:23],v[232:235],v[76:79]
ds_read_b64_tr_b16 v[28:29],v9 offset:8200
ds_read_b64_tr_b16 v[30:31],v9 offset:8712
v_mfma_f32_16x16x32_bf16 v[68:71],v[20:23],v[168:171],v[68:71]
s_mov_b32 m0,28672
s_add_u32 s42,s40,126976
v_mfma_f32_16x16x32_bf16 v[60:63],v[20:23],a[232:235],v[60:63]
buffer_load_dwordx4 v1,s[8:11],s42 offen nt lds
v_mfma_f32_16x16x32_bf16 v[52:55],v[20:23],a[168:171],v[52:55]
v_mfma_f32_16x16x32_bf16 v[44:47],v[20:23],a[104:107],v[44:47]
buffer_load_dwordx4 v2,s[8:11],s42 offen offset:1024 nt lds
v_mfma_f32_16x16x32_bf16 v[36:39],v[20:23],a[40:43],v[36:39]
buffer_load_dwordx4 v3,s[8:11],s42 offen offset:2048 nt lds
s_waitcnt lgkmcnt(2)
v_mfma_f32_16x16x32_bf16 v[80:83],v[24:27],a[40:43],v[80:83]
ds_read_b64_tr_b16 v[16:17],v8 offset:12288
ds_read_b64_tr_b16 v[18:19],v8 offset:12800
v_mfma_f32_16x16x32_bf16 v[88:91],v[24:27],a[104:107],v[88:91]
v_mfma_f32_16x16x32_bf16 v[96:99],v[24:27],a[168:171],v[96:99]
v_mfma_f32_16x16x32_bf16 v[104:107],v[24:27],a[232:235],v[104:107]
v_mfma_f32_16x16x32_bf16 v[112:115],v[24:27],v[168:171],v[112:115]
buffer_load_dwordx4 v4,s[8:11],s42 offen offset:3072 nt lds
v_mfma_f32_16x16x32_bf16 v[120:123],v[24:27],v[232:235],v[120:123]
s_mov_b32 m0,40960
s_add_u32 s41,s40,106496
buffer_load_dwordx4 v5,s[12:15],s41 offen nt lds
s_waitcnt lgkmcnt(2)
v_mfma_f32_16x16x32_bf16 v[124:127],v[28:31],v[232:235],v[124:127]
ds_read_b64_tr_b16 v[20:21],v8 offset:12296
ds_read_b64_tr_b16 v[22:23],v8 offset:12808
v_mfma_f32_16x16x32_bf16 v[116:119],v[28:31],v[168:171],v[116:119]
v_mfma_f32_16x16x32_bf16 v[108:111],v[28:31],a[232:235],v[108:111]
buffer_load_dwordx4 v6,s[12:15],s41 offen offset:1024 nt lds
v_mfma_f32_16x16x32_bf16 v[100:103],v[28:31],a[168:171],v[100:103]
v_mfma_f32_16x16x32_bf16 v[92:95],v[28:31],a[104:107],v[92:95]
v_mfma_f32_16x16x32_bf16 v[84:87],v[28:31],a[40:43],v[84:87]
buffer_load_dwordx4 v5,s[12:15],s41 offen offset:2048 nt lds
s_waitcnt lgkmcnt(2)
v_mfma_f32_16x16x32_bf16 v[32:35],v[16:19],a[44:47],v[32:35]
ds_read_b64_tr_b16 v[24:25],v9 offset:12288
ds_read_b64_tr_b16 v[26:27],v9 offset:12800
v_mfma_f32_16x16x32_bf16 v[40:43],v[16:19],a[108:111],v[40:43]
v_mfma_f32_16x16x32_bf16 v[48:51],v[16:19],a[172:175],v[48:51]
buffer_load_dwordx4 v6,s[12:15],s41 offen offset:3072 nt lds
v_mfma_f32_16x16x32_bf16 v[56:59],v[16:19],a[236:239],v[56:59]
s_mov_b32 m0,45056
s_add_u32 s42,s40,110592
v_mfma_f32_16x16x32_bf16 v[64:67],v[16:19],v[172:175],v[64:67]
buffer_load_dwordx4 v5,s[12:15],s42 offen nt lds
v_mfma_f32_16x16x32_bf16 v[72:75],v[16:19],v[236:239],v[72:75]
s_waitcnt lgkmcnt(2)
v_mfma_f32_16x16x32_bf16 v[76:79],v[20:23],v[236:239],v[76:79]
ds_read_b64_tr_b16 v[28:29],v9 offset:12296
ds_read_b64_tr_b16 v[30:31],v9 offset:12808
v_mfma_f32_16x16x32_bf16 v[68:71],v[20:23],v[172:175],v[68:71]
v_mfma_f32_16x16x32_bf16 v[60:63],v[20:23],a[236:239],v[60:63]
buffer_load_dwordx4 v6,s[12:15],s42 offen offset:1024 nt lds
v_mfma_f32_16x16x32_bf16 v[52:55],v[20:23],a[172:175],v[52:55]
v_mfma_f32_16x16x32_bf16 v[44:47],v[20:23],a[108:111],v[44:47]
buffer_load_dwordx4 v5,s[12:15],s42 offen offset:2048 nt lds
v_mfma_f32_16x16x32_bf16 v[36:39],v[20:23],a[44:47],v[36:39]
buffer_load_dwordx4 v6,s[12:15],s42 offen offset:3072 nt lds
s_waitcnt lgkmcnt(2)
v_mfma_f32_16x16x32_bf16 v[80:83],v[24:27],a[44:47],v[80:83]
ds_read_b64_tr_b16 v[16:17],v8 offset:16384
ds_read_b64_tr_b16 v[18:19],v8 offset:16896
v_mfma_f32_16x16x32_bf16 v[88:91],v[24:27],a[108:111],v[88:91]
v_mfma_f32_16x16x32_bf16 v[96:99],v[24:27],a[172:175],v[96:99]
v_mfma_f32_16x16x32_bf16 v[104:107],v[24:27],a[236:239],v[104:107]
s_mov_b32 m0,98304
s_add_u32 s41,s48,512
v_mfma_f32_16x16x32_bf16 v[112:115],v[24:27],v[172:175],v[112:115]
buffer_load_dwordx4 v7,s[16:19],s41 offen lds
v_mfma_f32_16x16x32_bf16 v[120:123],v[24:27],v[236:239],v[120:123]
s_add_u32 s42,s48,65024
buffer_load_dwordx4 v7,s[16:19],s42 offen offset:1024 lds
s_waitcnt lgkmcnt(2)
v_mfma_f32_16x16x32_bf16 v[124:127],v[28:31],v[236:239],v[124:127]
ds_read_b64_tr_b16 v[20:21],v8 offset:16392
ds_read_b64_tr_b16 v[22:23],v8 offset:16904
v_mfma_f32_16x16x32_bf16 v[116:119],v[28:31],v[172:175],v[116:119]
s_add_u32 s41,s48,129536
v_mfma_f32_16x16x32_bf16 v[108:111],v[28:31],a[236:239],v[108:111]
buffer_load_dwordx4 v7,s[16:19],s41 offen offset:2048 lds
v_mfma_f32_16x16x32_bf16 v[100:103],v[28:31],a[172:175],v[100:103]
s_add_u32 s42,s48,194048
v_mfma_f32_16x16x32_bf16 v[92:95],v[28:31],a[108:111],v[92:95]
v_mfma_f32_16x16x32_bf16 v[84:87],v[28:31],a[44:47],v[84:87]
buffer_load_dwordx4 v7,s[16:19],s42 offen offset:3072 lds
s_waitcnt lgkmcnt(2)
v_mfma_f32_16x16x32_bf16 v[32:35],v[16:19],a[48:51],v[32:35]
ds_read_b64_tr_b16 v[24:25],v9 offset:16384
ds_read_b64_tr_b16 v[26:27],v9 offset:16896
v_mfma_f32_16x16x32_bf16 v[40:43],v[16:19],a[112:115],v[40:43]
s_mov_b32 m0,102400
s_add_u32 s41,s48,262656
v_mfma_f32_16x16x32_bf16 v[48:51],v[16:19],a[176:179],v[48:51]
buffer_load_dwordx4 v7,s[16:19],s41 offen lds
v_mfma_f32_16x16x32_bf16 v[56:59],v[16:19],a[240:243],v[56:59]
s_add_u32 s42,s48,327168
v_mfma_f32_16x16x32_bf16 v[64:67],v[16:19],v[176:179],v[64:67]
buffer_load_dwordx4 v7,s[16:19],s42 offen offset:1024 lds
v_mfma_f32_16x16x32_bf16 v[72:75],v[16:19],v[240:243],v[72:75]
s_waitcnt lgkmcnt(2)
v_mfma_f32_16x16x32_bf16 v[76:79],v[20:23],v[240:243],v[76:79]
ds_read_b64_tr_b16 v[28:29],v9 offset:16392
ds_read_b64_tr_b16 v[30:31],v9 offset:16904
v_mfma_f32_16x16x32_bf16 v[68:71],v[20:23],v[176:179],v[68:71]
s_add_u32 s41,s48,391680
v_mfma_f32_16x16x32_bf16 v[60:63],v[20:23],a[240:243],v[60:63]
buffer_load_dwordx4 v7,s[16:19],s41 offen offset:2048 lds
v_mfma_f32_16x16x32_bf16 v[52:55],v[20:23],a[176:179],v[52:55]
s_add_u32 s42,s48,456192
v_mfma_f32_16x16x32_bf16 v[44:47],v[20:23],a[112:115],v[44:47]
buffer_load_dwordx4 v7,s[16:19],s42 offen offset:3072 lds
v_mfma_f32_16x16x32_bf16 v[36:39],v[20:23],a[48:51],v[36:39]
s_add_u32 s48,s48,256
s_cmp_eq_u32 s3,0
s_cbranch_scc1 L_light12
s_waitcnt vmcnt(18)
s_branch L_heavy12
L_light12:
s_waitcnt vmcnt(24)
L_heavy12:
s_barrier
s_mov_b32 m0,0
s_add_u32 s41,s40,131072
buffer_load_dwordx4 v1,s[8:11],s41 offen nt lds
buffer_load_dwordx4 v2,s[8:11],s41 offen offset:1024 nt lds
buffer_load_dwordx4 v3,s[8:11],s41 offen offset:2048 nt lds
buffer_load_dwordx4 v4,s[8:11],s41 offen offset:3072 nt lds
s_waitcnt lgkmcnt(2)
v_mfma_f32_16x16x32_bf16 v[80:83],v[24:27],a[48:51],v[80:83]
ds_read_b64_tr_b16 v[16:17],v8 offset:20480
ds_read_b64_tr_b16 v[18:19],v8 offset:20992
v_mfma_f32_16x16x32_bf16 v[88:91],v[24:27],a[112:115],v[88:91]
s_mov_b32 m0,4096
s_add_u32 s42,s40,135168
v_mfma_f32_16x16x32_bf16 v[96:99],v[24:27],a[176:179],v[96:99]
buffer_load_dwordx4 v1,s[8:11],s42 offen nt lds
v_mfma_f32_16x16x32_bf16 v[104:107],v[24:27],a[240:243],v[104:107]
v_mfma_f32_16x16x32_bf16 v[112:115],v[24:27],v[176:179],v[112:115]
buffer_load_dwordx4 v2,s[8:11],s42 offen offset:1024 nt lds
v_mfma_f32_16x16x32_bf16 v[120:123],v[24:27],v[240:243],v[120:123]
s_waitcnt lgkmcnt(2)
v_mfma_f32_16x16x32_bf16 v[124:127],v[28:31],v[240:243],v[124:127]
ds_read_b64_tr_b16 v[20:21],v8 offset:20488
ds_read_b64_tr_b16 v[22:23],v8 offset:21000
v_mfma_f32_16x16x32_bf16 v[116:119],v[28:31],v[176:179],v[116:119]
v_mfma_f32_16x16x32_bf16 v[108:111],v[28:31],a[240:243],v[108:111]
buffer_load_dwordx4 v3,s[8:11],s42 offen offset:2048 nt lds
v_mfma_f32_16x16x32_bf16 v[100:103],v[28:31],a[176:179],v[100:103]
v_mfma_f32_16x16x32_bf16 v[92:95],v[28:31],a[112:115],v[92:95]
buffer_load_dwordx4 v4,s[8:11],s42 offen offset:3072 nt lds
v_mfma_f32_16x16x32_bf16 v[84:87],v[28:31],a[48:51],v[84:87]
s_waitcnt lgkmcnt(2)
v_mfma_f32_16x16x32_bf16 v[32:35],v[16:19],a[52:55],v[32:35]
ds_read_b64_tr_b16 v[24:25],v9 offset:20480
ds_read_b64_tr_b16 v[26:27],v9 offset:20992
v_mfma_f32_16x16x32_bf16 v[40:43],v[16:19],a[116:119],v[40:43]
s_mov_b32 m0,49152
s_add_u32 s41,s40,114688
v_mfma_f32_16x16x32_bf16 v[48:51],v[16:19],a[180:183],v[48:51]
buffer_load_dwordx4 v5,s[12:15],s41 offen nt lds
v_mfma_f32_16x16x32_bf16 v[56:59],v[16:19],a[244:247],v[56:59]
v_mfma_f32_16x16x32_bf16 v[64:67],v[16:19],v[180:183],v[64:67]
buffer_load_dwordx4 v6,s[12:15],s41 offen offset:1024 nt lds
v_mfma_f32_16x16x32_bf16 v[72:75],v[16:19],v[244:247],v[72:75]
s_waitcnt lgkmcnt(2)
v_mfma_f32_16x16x32_bf16 v[76:79],v[20:23],v[244:247],v[76:79]
ds_read_b64_tr_b16 v[28:29],v9 offset:20488
ds_read_b64_tr_b16 v[30:31],v9 offset:21000
v_mfma_f32_16x16x32_bf16 v[68:71],v[20:23],v[180:183],v[68:71]
v_mfma_f32_16x16x32_bf16 v[60:63],v[20:23],a[244:247],v[60:63]
buffer_load_dwordx4 v5,s[12:15],s41 offen offset:2048 nt lds
v_mfma_f32_16x16x32_bf16 v[52:55],v[20:23],a[180:183],v[52:55]
v_mfma_f32_16x16x32_bf16 v[44:47],v[20:23],a[116:119],v[44:47]
buffer_load_dwordx4 v6,s[12:15],s41 offen offset:3072 nt lds
v_mfma_f32_16x16x32_bf16 v[36:39],v[20:23],a[52:55],v[36:39]
s_waitcnt lgkmcnt(2)
v_mfma_f32_16x16x32_bf16 v[80:83],v[24:27],a[52:55],v[80:83]
ds_read_b64_tr_b16 v[16:17],v8 offset:24576
ds_read_b64_tr_b16 v[18:19],v8 offset:25088
v_mfma_f32_16x16x32_bf16 v[88:91],v[24:27],a[116:119],v[88:91]
s_mov_b32 m0,53248
s_add_u32 s42,s40,118784
v_mfma_f32_16x16x32_bf16 v[96:99],v[24:27],a[180:183],v[96:99]
buffer_load_dwordx4 v5,s[12:15],s42 offen nt lds
v_mfma_f32_16x16x32_bf16 v[104:107],v[24:27],a[244:247],v[104:107]
v_mfma_f32_16x16x32_bf16 v[112:115],v[24:27],v[180:183],v[112:115]
buffer_load_dwordx4 v6,s[12:15],s42 offen offset:1024 nt lds
v_mfma_f32_16x16x32_bf16 v[120:123],v[24:27],v[244:247],v[120:123]
s_waitcnt lgkmcnt(2)
v_mfma_f32_16x16x32_bf16 v[124:127],v[28:31],v[244:247],v[124:127]
ds_read_b64_tr_b16 v[20:21],v8 offset:24584
ds_read_b64_tr_b16 v[22:23],v8 offset:25096
v_mfma_f32_16x16x32_bf16 v[116:119],v[28:31],v[180:183],v[116:119]
v_mfma_f32_16x16x32_bf16 v[108:111],v[28:31],a[244:247],v[108:111]
buffer_load_dwordx4 v5,s[12:15],s42 offen offset:2048 nt lds
v_mfma_f32_16x16x32_bf16 v[100:103],v[28:31],a[180:183],v[100:103]
v_mfma_f32_16x16x32_bf16 v[92:95],v[28:31],a[116:119],v[92:95]
buffer_load_dwordx4 v6,s[12:15],s42 offen offset:3072 nt lds
v_mfma_f32_16x16x32_bf16 v[84:87],v[28:31],a[52:55],v[84:87]
s_waitcnt lgkmcnt(2)
v_mfma_f32_16x16x32_bf16 v[32:35],v[16:19],a[56:59],v[32:35]
ds_read_b64_tr_b16 v[24:25],v9 offset:24576
ds_read_b64_tr_b16 v[26:27],v9 offset:25088
v_mfma_f32_16x16x32_bf16 v[40:43],v[16:19],a[120:123],v[40:43]
s_mov_b32 m0,106496
s_add_u32 s41,s49,512
v_mfma_f32_16x16x32_bf16 v[48:51],v[16:19],a[184:187],v[48:51]
buffer_load_dwordx4 v7,s[16:19],s41 offen lds
v_mfma_f32_16x16x32_bf16 v[56:59],v[16:19],a[248:251],v[56:59]
s_add_u32 s42,s49,65024
v_mfma_f32_16x16x32_bf16 v[64:67],v[16:19],v[184:187],v[64:67]
buffer_load_dwordx4 v7,s[16:19],s42 offen offset:1024 lds
v_mfma_f32_16x16x32_bf16 v[72:75],v[16:19],v[248:251],v[72:75]
s_waitcnt lgkmcnt(2)
v_mfma_f32_16x16x32_bf16 v[76:79],v[20:23],v[248:251],v[76:79]
ds_read_b64_tr_b16 v[28:29],v9 offset:24584
ds_read_b64_tr_b16 v[30:31],v9 offset:25096
v_mfma_f32_16x16x32_bf16 v[68:71],v[20:23],v[184:187],v[68:71]
s_add_u32 s41,s49,129536
v_mfma_f32_16x16x32_bf16 v[60:63],v[20:23],a[248:251],v[60:63]
buffer_load_dwordx4 v7,s[16:19],s41 offen offset:2048 lds
v_mfma_f32_16x16x32_bf16 v[52:55],v[20:23],a[184:187],v[52:55]
s_add_u32 s42,s49,194048
v_mfma_f32_16x16x32_bf16 v[44:47],v[20:23],a[120:123],v[44:47]
buffer_load_dwordx4 v7,s[16:19],s42 offen offset:3072 lds
v_mfma_f32_16x16x32_bf16 v[36:39],v[20:23],a[56:59],v[36:39]
s_waitcnt lgkmcnt(2)
v_mfma_f32_16x16x32_bf16 v[80:83],v[24:27],a[56:59],v[80:83]
ds_read_b64_tr_b16 v[16:17],v8 offset:28672
ds_read_b64_tr_b16 v[18:19],v8 offset:29184
v_mfma_f32_16x16x32_bf16 v[88:91],v[24:27],a[120:123],v[88:91]
s_mov_b32 m0,110592
s_add_u32 s41,s49,262656
v_mfma_f32_16x16x32_bf16 v[96:99],v[24:27],a[184:187],v[96:99]
buffer_load_dwordx4 v7,s[16:19],s41 offen lds
v_mfma_f32_16x16x32_bf16 v[104:107],v[24:27],a[248:251],v[104:107]
s_add_u32 s42,s49,327168
v_mfma_f32_16x16x32_bf16 v[112:115],v[24:27],v[184:187],v[112:115]
buffer_load_dwordx4 v7,s[16:19],s42 offen offset:1024 lds
v_mfma_f32_16x16x32_bf16 v[120:123],v[24:27],v[248:251],v[120:123]
s_waitcnt lgkmcnt(2)
v_mfma_f32_16x16x32_bf16 v[124:127],v[28:31],v[248:251],v[124:127]
ds_read_b64_tr_b16 v[20:21],v8 offset:28680
ds_read_b64_tr_b16 v[22:23],v8 offset:29192
v_mfma_f32_16x16x32_bf16 v[116:119],v[28:31],v[184:187],v[116:119]
s_add_u32 s41,s49,391680
v_mfma_f32_16x16x32_bf16 v[108:111],v[28:31],a[248:251],v[108:111]
buffer_load_dwordx4 v7,s[16:19],s41 offen offset:2048 lds
v_mfma_f32_16x16x32_bf16 v[100:103],v[28:31],a[184:187],v[100:103]
s_add_u32 s42,s49,456192
v_mfma_f32_16x16x32_bf16 v[92:95],v[28:31],a[120:123],v[92:95]
buffer_load_dwordx4 v7,s[16:19],s42 offen offset:3072 lds
v_mfma_f32_16x16x32_bf16 v[84:87],v[28:31],a[56:59],v[84:87]
s_add_u32 s49,s49,256
s_cmp_eq_u32 s3,0
s_cbranch_scc1 L_light13
s_waitcnt vmcnt(22)
s_branch L_heavy13
L_light13:
s_waitcnt vmcnt(24)
L_heavy13:
s_barrier
s_mov_b32 m0,8192
s_add_u32 s41,s40,139264
buffer_load_dwordx4 v1,s[8:11],s41 offen nt lds
buffer_load_dwordx4 v2,s[8:11],s41 offen offset:1024 nt lds
buffer_load_dwordx4 v3,s[8:11],s41 offen offset:2048 nt lds
buffer_load_dwordx4 v4,s[8:11],s41 offen offset:3072 nt lds
s_waitcnt lgkmcnt(2)
v_mfma_f32_16x16x32_bf16 v[32:35],v[16:19],a[60:63],v[32:35]
ds_read_b64_tr_b16 v[24:25],v9 offset:28672
ds_read_b64_tr_b16 v[26:27],v9 offset:29184
v_mfma_f32_16x16x32_bf16 v[40:43],v[16:19],a[124:127],v[40:43]
s_mov_b32 m0,12288
s_add_u32 s42,s40,143360
buffer_load_dwordx4 v1,s[8:11],s42 offen nt lds
v_mfma_f32_16x16x32_bf16 v[48:51],v[16:19],a[188:191],v[48:51]
buffer_load_dwordx4 v2,s[8:11],s42 offen offset:1024 nt lds
v_mfma_f32_16x16x32_bf16 v[56:59],v[16:19],a[252:255],v[56:59]
buffer_load_dwordx4 v3,s[8:11],s42 offen offset:2048 nt lds
v_mfma_f32_16x16x32_bf16 v[64:67],v[16:19],v[188:191],v[64:67]
buffer_load_dwordx4 v4,s[8:11],s42 offen offset:3072 nt lds
v_mfma_f32_16x16x32_bf16 v[72:75],v[16:19],v[252:255],v[72:75]
s_mov_b32 m0,57344
s_add_u32 s41,s40,122880
buffer_load_dwordx4 v5,s[12:15],s41 offen nt lds
s_waitcnt lgkmcnt(2)
v_mfma_f32_16x16x32_bf16 v[76:79],v[20:23],v[252:255],v[76:79]
ds_read_b64_tr_b16 v[28:29],v9 offset:28680
ds_read_b64_tr_b16 v[30:31],v9 offset:29192
v_mfma_f32_16x16x32_bf16 v[68:71],v[20:23],v[188:191],v[68:71]
buffer_load_dwordx4 v6,s[12:15],s41 offen offset:1024 nt lds
buffer_load_dwordx4 v5,s[12:15],s41 offen offset:2048 nt lds
v_mfma_f32_16x16x32_bf16 v[60:63],v[20:23],a[252:255],v[60:63]
buffer_load_dwordx4 v6,s[12:15],s41 offen offset:3072 nt lds
v_mfma_f32_16x16x32_bf16 v[52:55],v[20:23],a[188:191],v[52:55]
s_mov_b32 m0,61440
s_add_u32 s42,s40,126976
buffer_load_dwordx4 v5,s[12:15],s42 offen nt lds
v_mfma_f32_16x16x32_bf16 v[44:47],v[20:23],a[124:127],v[44:47]
v_mfma_f32_16x16x32_bf16 v[36:39],v[20:23],a[60:63],v[36:39]
buffer_load_dwordx4 v6,s[12:15],s42 offen offset:1024 nt lds
buffer_load_dwordx4 v5,s[12:15],s42 offen offset:2048 nt lds
s_waitcnt lgkmcnt(2)
v_mfma_f32_16x16x32_bf16 v[80:83],v[24:27],a[60:63],v[80:83]
ds_read_b64_tr_b16 v[16:17],v8
ds_read_b64_tr_b16 v[18:19],v8 offset:512
v_mfma_f32_16x16x32_bf16 v[88:91],v[24:27],a[124:127],v[88:91]
v_mul_f32 v32,s39,v32
v_mul_f32 v33,s39,v33
v_mul_f32 v34,s39,v34
v_mul_f32 v35,s39,v35
v_mul_f32 v36,s39,v36
v_mul_f32 v37,s39,v37
v_mul_f32 v38,s39,v38
v_mul_f32 v39,s39,v39
v_cvt_pk_bf16_f32 v32,v32,v33
v_cvt_pk_bf16_f32 v33,v34,v35
v_cvt_pk_bf16_f32 v34,v36,v37
v_cvt_pk_bf16_f32 v35,v38,v39
ds_write_b128 v10,v[32:35] offset:2048
buffer_load_dwordx4 v6,s[12:15],s42 offen offset:3072 nt lds
v_mfma_f32_16x16x32_bf16 v[96:99],v[24:27],a[188:191],v[96:99]
s_mov_b32 m0,114688
s_add_u32 s41,s50,512
buffer_load_dwordx4 v7,s[16:19],s41 offen lds
v_mfma_f32_16x16x32_bf16 v[104:107],v[24:27],a[252:255],v[104:107]
v_mul_f32 v40,s39,v40
v_mul_f32 v41,s39,v41
v_mul_f32 v42,s39,v42
v_mul_f32 v43,s39,v43
v_mul_f32 v44,s39,v44
v_mul_f32 v45,s39,v45
v_mul_f32 v46,s39,v46
v_mul_f32 v47,s39,v47
v_cvt_pk_bf16_f32 v40,v40,v41
v_cvt_pk_bf16_f32 v41,v42,v43
v_cvt_pk_bf16_f32 v42,v44,v45
v_cvt_pk_bf16_f32 v43,v46,v47
ds_write_b128 v10,v[40:43] offset:6144
s_add_u32 s42,s50,65024
buffer_load_dwordx4 v7,s[16:19],s42 offen offset:1024 lds
v_mfma_f32_16x16x32_bf16 v[112:115],v[24:27],v[188:191],v[112:115]
s_add_u32 s41,s50,129536
buffer_load_dwordx4 v7,s[16:19],s41 offen offset:2048 lds
v_mfma_f32_16x16x32_bf16 v[120:123],v[24:27],v[252:255],v[120:123]
v_mul_f32 v48,s39,v48
v_mul_f32 v49,s39,v49
v_mul_f32 v50,s39,v50
v_mul_f32 v51,s39,v51
v_mul_f32 v52,s39,v52
v_mul_f32 v53,s39,v53
v_mul_f32 v54,s39,v54
v_mul_f32 v55,s39,v55
v_cvt_pk_bf16_f32 v48,v48,v49
v_cvt_pk_bf16_f32 v49,v50,v51
v_cvt_pk_bf16_f32 v50,v52,v53
v_cvt_pk_bf16_f32 v51,v54,v55
ds_write_b128 v10,v[48:51] offset:10240
s_add_u32 s42,s50,194048
buffer_load_dwordx4 v7,s[16:19],s42 offen offset:3072 lds
s_waitcnt lgkmcnt(5)
v_mfma_f32_16x16x32_bf16 v[124:127],v[28:31],v[252:255],v[124:127]
ds_read_b64_tr_b16 v[20:21],v8 offset:8
ds_read_b64_tr_b16 v[22:23],v8 offset:520
v_mfma_f32_16x16x32_bf16 v[116:119],v[28:31],v[188:191],v[116:119]
v_mul_f32 v56,s39,v56
v_mul_f32 v57,s39,v57
v_mul_f32 v58,s39,v58
v_mul_f32 v59,s39,v59
v_mul_f32 v60,s39,v60
v_mul_f32 v61,s39,v61
v_mul_f32 v62,s39,v62
v_mul_f32 v63,s39,v63
v_cvt_pk_bf16_f32 v56,v56,v57
v_cvt_pk_bf16_f32 v57,v58,v59
v_cvt_pk_bf16_f32 v58,v60,v61
v_cvt_pk_bf16_f32 v59,v62,v63
ds_write_b128 v10,v[56:59] offset:14336
s_mov_b32 m0,118784
s_add_u32 s41,s50,262656
buffer_load_dwordx4 v7,s[16:19],s41 offen lds
v_mfma_f32_16x16x32_bf16 v[108:111],v[28:31],a[252:255],v[108:111]
v_mfma_f32_16x16x32_bf16 v[100:103],v[28:31],a[188:191],v[100:103]
v_mul_f32 v64,s39,v64
v_mul_f32 v65,s39,v65
v_mul_f32 v66,s39,v66
v_mul_f32 v67,s39,v67
v_mul_f32 v68,s39,v68
v_mul_f32 v69,s39,v69
v_mul_f32 v70,s39,v70
v_mul_f32 v71,s39,v71
v_cvt_pk_bf16_f32 v64,v64,v65
v_cvt_pk_bf16_f32 v65,v66,v67
v_cvt_pk_bf16_f32 v66,v68,v69
v_cvt_pk_bf16_f32 v67,v70,v71
ds_write_b128 v10,v[64:67] offset:18432
s_add_u32 s42,s50,327168
buffer_load_dwordx4 v7,s[16:19],s42 offen offset:1024 lds
v_mfma_f32_16x16x32_bf16 v[92:95],v[28:31],a[124:127],v[92:95]
s_add_u32 s41,s50,391680
buffer_load_dwordx4 v7,s[16:19],s41 offen offset:2048 lds
v_mfma_f32_16x16x32_bf16 v[84:87],v[28:31],a[60:63],v[84:87]
v_mul_f32 v72,s39,v72
v_mul_f32 v73,s39,v73
v_mul_f32 v74,s39,v74
v_mul_f32 v75,s39,v75
v_mul_f32 v76,s39,v76
v_mul_f32 v77,s39,v77
v_mul_f32 v78,s39,v78
v_mul_f32 v79,s39,v79
v_cvt_pk_bf16_f32 v72,v72,v73
v_cvt_pk_bf16_f32 v73,v74,v75
v_cvt_pk_bf16_f32 v74,v76,v77
v_cvt_pk_bf16_f32 v75,v78,v79
ds_write_b128 v10,v[72:75] offset:22528
s_add_u32 s42,s50,456192
buffer_load_dwordx4 v7,s[16:19],s42 offen offset:3072 lds
s_add_u32 s50,s50,256
s_cmp_eq_u32 s3,0
s_cbranch_scc1 L_light14
s_waitcnt vmcnt(22)
s_branch L_heavy14
L_light14:
s_waitcnt vmcnt(24)
L_heavy14:
s_waitcnt lgkmcnt(0)
s_barrier
s_mov_b32 m0,16384
s_add_u32 s41,s40,147456
buffer_load_dwordx4 v1,s[8:11],s41 offen nt lds
buffer_load_dwordx4 v2,s[8:11],s41 offen offset:1024 nt lds
buffer_load_dwordx4 v3,s[8:11],s41 offen offset:2048 nt lds
buffer_load_dwordx4 v4,s[8:11],s41 offen offset:3072 nt lds
v_mfma_f32_16x16x32_bf16 v[32:35],v[16:19],a[0:3],0
ds_read_b64_tr_b16 v[24:25],v9
ds_read_b64_tr_b16 v[26:27],v9 offset:512
v_mfma_f32_16x16x32_bf16 v[40:43],v[16:19],a[64:67],0
v_mul_f32 v80,s39,v80
v_mul_f32 v81,s39,v81
v_mul_f32 v82,s39,v82
v_mul_f32 v83,s39,v83
v_mul_f32 v84,s39,v84
v_mul_f32 v85,s39,v85
v_mul_f32 v86,s39,v86
v_mul_f32 v87,s39,v87
v_cvt_pk_bf16_f32 v80,v80,v81
v_cvt_pk_bf16_f32 v81,v82,v83
v_cvt_pk_bf16_f32 v82,v84,v85
v_cvt_pk_bf16_f32 v83,v86,v87
ds_write_b128 v10,v[80:83] offset:3072
s_mov_b32 m0,20480
s_add_u32 s42,s40,151552
buffer_load_dwordx4 v1,s[8:11],s42 offen nt lds
v_mfma_f32_16x16x32_bf16 v[48:51],v[16:19],a[128:131],0
buffer_load_dwordx4 v2,s[8:11],s42 offen offset:1024 nt lds
v_mfma_f32_16x16x32_bf16 v[56:59],v[16:19],a[192:195],0
v_mul_f32 v88,s39,v88
v_mul_f32 v89,s39,v89
v_mul_f32 v90,s39,v90
v_mul_f32 v91,s39,v91
v_mul_f32 v92,s39,v92
v_mul_f32 v93,s39,v93
v_mul_f32 v94,s39,v94
v_mul_f32 v95,s39,v95
v_cvt_pk_bf16_f32 v88,v88,v89
v_cvt_pk_bf16_f32 v89,v90,v91
v_cvt_pk_bf16_f32 v90,v92,v93
v_cvt_pk_bf16_f32 v91,v94,v95
ds_write_b128 v10,v[88:91] offset:7168
buffer_load_dwordx4 v3,s[8:11],s42 offen offset:2048 nt lds
v_mfma_f32_16x16x32_bf16 v[64:67],v[16:19],v[128:131],0
buffer_load_dwordx4 v4,s[8:11],s42 offen offset:3072 nt lds
v_mfma_f32_16x16x32_bf16 v[72:75],v[16:19],v[192:195],0
v_mul_f32 v96,s39,v96
v_mul_f32 v97,s39,v97
v_mul_f32 v98,s39,v98
v_mul_f32 v99,s39,v99
v_mul_f32 v100,s39,v100
v_mul_f32 v101,s39,v101
v_mul_f32 v102,s39,v102
v_mul_f32 v103,s39,v103
v_cvt_pk_bf16_f32 v96,v96,v97
v_cvt_pk_bf16_f32 v97,v98,v99
v_cvt_pk_bf16_f32 v98,v100,v101
L_tp_q5:
s_cbranch_execz L_tp_a5
v_cvt_pk_bf16_f32 v99,v102,v103
ds_write_b128 v10,v[96:99] offset:11264
s_mov_b32 m0,32768
s_add_u32 s41,s40,131072
buffer_load_dwordx4 v5,s[12:15],s41 offen nt lds
v_mfma_f32_16x16x32_bf16 v[76:79],v[20:23],v[192:195],0
ds_read_b64_tr_b16 v[28:29],v9 offset:8
ds_read_b64_tr_b16 v[30:31],v9 offset:520
v_mfma_f32_16x16x32_bf16 v[68:71],v[20:23],v[128:131],0
v_mul_f32 v104,s39,v104
v_mul_f32 v105,s39,v105
v_mul_f32 v106,s39,v106
v_mul_f32 v107,s39,v107
v_mul_f32 v108,s39,v108
v_mul_f32 v109,s39,v109
v_mul_f32 v110,s39,v110
v_mul_f32 v111,s39,v111
v_cvt_pk_bf16_f32 v104,v104,v105
v_cvt_pk_bf16_f32 v105,v106,v107
v_cvt_pk_bf16_f32 v106,v108,v109
v_cvt_pk_bf16_f32 v107,v110,v111
ds_write_b128 v10,v[104:107] offset:15360
buffer_load_dwordx4 v6,s[12:15],s41 offen offset:1024 nt lds
buffer_load_dwordx4 v5,s[12:15],s41 offen offset:2048 nt lds
v_mfma_f32_16x16x32_bf16 v[60:63],v[20:23],a[192:195],0
buffer_load_dwordx4 v6,s[12:15],s41 offen offset:3072 nt lds
v_mfma_f32_16x16x32_bf16 v[52:55],v[20:23],a[128:131],0
v_mul_f32 v112,s39,v112
v_mul_f32 v113,s39,v113
v_mul_f32 v114,s39,v114
v_mul_f32 v115,s39,v115
v_mul_f32 v116,s39,v116
v_mul_f32 v117,s39,v117
v_mul_f32 v118,s39,v118
v_mul_f32 v119,s39,v119
v_cvt_pk_bf16_f32 v112,v112,v113
v_cvt_pk_bf16_f32 v113,v114,v115
v_cvt_pk_bf16_f32 v114,v116,v117
v_cvt_pk_bf16_f32 v115,v118,v119
ds_write_b128 v10,v[112:115] offset:19456
s_mov_b32 m0,36864
s_add_u32 s42,s40,135168
buffer_load_dwordx4 v5,s[12:15],s42 offen nt lds
v_mfma_f32_16x16x32_bf16 v[44:47],v[20:23],a[64:67],0
v_mfma_f32_16x16x32_bf16 v[36:39],v[20:23],a[0:3],0
v_mul_f32 v120,s39,v120
v_mul_f32 v121,s39,v121
v_mul_f32 v122,s39,v122
v_mul_f32 v123,s39,v123
v_mul_f32 v124,s39,v124
v_mul_f32 v125,s39,v125
v_mul_f32 v126,s39,v126
v_mul_f32 v127,s39,v127
v_cvt_pk_bf16_f32 v120,v120,v121
v_cvt_pk_bf16_f32 v121,v122,v123
v_cvt_pk_bf16_f32 v122,v124,v125
v_cvt_pk_bf16_f32 v123,v126,v127
ds_write_b128 v10,v[120:123] offset:23552
buffer_load_dwordx4 v6,s[12:15],s42 offen offset:1024 nt lds
buffer_load_dwordx4 v5,s[12:15],s42 offen offset:2048 nt lds
s_waitcnt lgkmcnt(8)
v_mfma_f32_16x16x32_bf16 v[80:83],v[24:27],a[0:3],0
ds_read_b64_tr_b16 v[16:17],v8 offset:4096
ds_read_b64_tr_b16 v[18:19],v8 offset:4608
v_mfma_f32_16x16x32_bf16 v[88:91],v[24:27],a[64:67],0
buffer_load_dwordx4 v6,s[12:15],s42 offen offset:3072 nt lds
v_mfma_f32_16x16x32_bf16 v[96:99],v[24:27],a[128:131],0
s_mov_b32 m0,122880
s_add_u32 s41,s51,512
buffer_load_dwordx4 v7,s[16:19],s41 offen lds
v_mfma_f32_16x16x32_bf16 v[104:107],v[24:27],a[192:195],0
s_add_u32 s42,s51,65024
buffer_load_dwordx4 v7,s[16:19],s42 offen offset:1024 lds
v_mfma_f32_16x16x32_bf16 v[112:115],v[24:27],v[128:131],0
s_add_u32 s41,s51,129536
buffer_load_dwordx4 v7,s[16:19],s41 offen offset:2048 lds
v_mfma_f32_16x16x32_bf16 v[120:123],v[24:27],v[192:195],0
s_add_u32 s42,s51,194048
buffer_load_dwordx4 v7,s[16:19],s42 offen offset:3072 lds
s_waitcnt lgkmcnt(5)
v_mfma_f32_16x16x32_bf16 v[124:127],v[28:31],v[192:195],0
ds_read_b64_tr_b16 v[20:21],v8 offset:4104
ds_read_b64_tr_b16 v[22:23],v8 offset:4616
v_mfma_f32_16x16x32_bf16 v[116:119],v[28:31],v[128:131],0
s_mov_b32 m0,126976
s_add_u32 s41,s51,262656
buffer_load_dwordx4 v7,s[16:19],s41 offen lds
v_mfma_f32_16x16x32_bf16 v[108:111],v[28:31],a[192:195],0
v_mfma_f32_16x16x32_bf16 v[100:103],v[28:31],a[128:131],0
s_add_u32 s42,s51,327168
buffer_load_dwordx4 v7,s[16:19],s42 offen offset:1024 lds
v_mfma_f32_16x16x32_bf16 v[92:95],v[28:31],a[64:67],0
s_add_u32 s41,s51,391680
buffer_load_dwordx4 v7,s[16:19],s41 offen offset:2048 lds
v_mfma_f32_16x16x32_bf16 v[84:87],v[28:31],a[0:3],0
s_add_u32 s42,s51,456192
buffer_load_dwordx4 v7,s[16:19],s42 offen offset:3072 lds
s_add_u32 s51,s51,256
s_cmp_eq_u32 s3,0
s_cbranch_scc1 L_light15
s_waitcnt vmcnt(22)
s_branch L_heavy15
L_light15:
s_waitcnt vmcnt(24)
L_heavy15:
s_waitcnt lgkmcnt(0)
s_barrier
s_mov_b32 m0,24576
s_add_u32 s41,s40,155648
buffer_load_dwordx4 v1,s[8:11],s41 offen nt lds
buffer_load_dwordx4 v2,s[8:11],s41 offen offset:1024 nt lds
buffer_load_dwordx4 v3,s[8:11],s41 offen offset:2048 nt lds
buffer_load_dwordx4 v4,s[8:11],s41 offen offset:3072 nt lds
s_mov_b32 s3,1
v_mfma_f32_16x16x32_bf16 v[32:35],v[16:19],a[4:7],v[32:35]
ds_read_b64_tr_b16 v[24:25],v9 offset:4096
ds_read_b64_tr_b16 v[26:27],v9 offset:4608
v_mfma_f32_16x16x32_bf16 v[40:43],v[16:19],a[68:71],v[40:43]
s_mov_b32 m0,28672
s_add_u32 s42,s40,159744
v_mfma_f32_16x16x32_bf16 v[48:51],v[16:19],a[132:135],v[48:51]
buffer_load_dwordx4 v1,s[8:11],s42 offen nt lds
v_mfma_f32_16x16x32_bf16 v[56:59],v[16:19],a[196:199],v[56:59]
v_mfma_f32_16x16x32_bf16 v[64:67],v[16:19],v[132:135],v[64:67]
buffer_load_dwordx4 v2,s[8:11],s42 offen offset:1024 nt lds
v_mfma_f32_16x16x32_bf16 v[72:75],v[16:19],v[196:199],v[72:75]
v_mfma_f32_16x16x32_bf16 v[76:79],v[20:23],v[196:199],v[76:79]
ds_read_b64_tr_b16 v[28:29],v9 offset:4104
ds_read_b64_tr_b16 v[30:31],v9 offset:4616
v_mfma_f32_16x16x32_bf16 v[68:71],v[20:23],v[132:135],v[68:71]
v_mfma_f32_16x16x32_bf16 v[60:63],v[20:23],a[196:199],v[60:63]
buffer_load_dwordx4 v3,s[8:11],s42 offen offset:2048 nt lds
v_mfma_f32_16x16x32_bf16 v[52:55],v[20:23],a[132:135],v[52:55]
v_mfma_f32_16x16x32_bf16 v[44:47],v[20:23],a[68:71],v[44:47]
buffer_load_dwordx4 v4,s[8:11],s42 offen offset:3072 nt lds
v_mfma_f32_16x16x32_bf16 v[36:39],v[20:23],a[4:7],v[36:39]
s_waitcnt lgkmcnt(2)
v_mfma_f32_16x16x32_bf16 v[80:83],v[24:27],a[4:7],v[80:83]
ds_read_b64_tr_b16 v[16:17],v8 offset:8192
ds_read_b64_tr_b16 v[18:19],v8 offset:8704
v_mfma_f32_16x16x32_bf16 v[88:91],v[24:27],a[68:71],v[88:91]
s_mov_b32 m0,40960
s_add_u32 s41,s40,139264
v_mfma_f32_16x16x32_bf16 v[96:99],v[24:27],a[132:135],v[96:99]
buffer_load_dwordx4 v5,s[12:15],s41 offen nt lds
v_mfma_f32_16x16x32_bf16 v[104:107],v[24:27],a[196:199],v[104:107]
v_mfma_f32_16x16x32_bf16 v[112:115],v[24:27],v[132:135],v[112:115]
buffer_load_dwordx4 v6,s[12:15],s41 offen offset:1024 nt lds
v_mfma_f32_16x16x32_bf16 v[120:123],v[24:27],v[196:199],v[120:123]
s_waitcnt lgkmcnt(2)
v_mfma_f32_16x16x32_bf16 v[124:127],v[28:31],v[196:199],v[124:127]
ds_read_b64_tr_b16 v[20:21],v8 offset:8200
ds_read_b64_tr_b16 v[22:23],v8 offset:8712
v_mfma_f32_16x16x32_bf16 v[116:119],v[28:31],v[132:135],v[116:119]
v_mfma_f32_16x16x32_bf16 v[108:111],v[28:31],a[196:199],v[108:111]
buffer_load_dwordx4 v5,s[12:15],s41 offen offset:2048 nt lds
v_mfma_f32_16x16x32_bf16 v[100:103],v[28:31],a[132:135],v[100:103]
v_mfma_f32_16x16x32_bf16 v[92:95],v[28:31],a[68:71],v[92:95]
buffer_load_dwordx4 v6,s[12:15],s41 offen offset:3072 nt lds
v_mfma_f32_16x16x32_bf16 v[84:87],v[28:31],a[4:7],v[84:87]
s_waitcnt lgkmcnt(2)
v_mfma_f32_16x16x32_bf16 v[32:35],v[16:19],a[8:11],v[32:35]
ds_read_b64_tr_b16 v[24:25],v9 offset:8192
ds_read_b64_tr_b16 v[26:27],v9 offset:8704
v_mfma_f32_16x16x32_bf16 v[40:43],v[16:19],a[72:75],v[40:43]
s_mov_b32 m0,45056
s_add_u32 s42,s40,143360
v_mfma_f32_16x16x32_bf16 v[48:51],v[16:19],a[136:139],v[48:51]
buffer_load_dwordx4 v5,s[12:15],s42 offen nt lds
v_mfma_f32_16x16x32_bf16 v[56:59],v[16:19],a[200:203],v[56:59]
v_mfma_f32_16x16x32_bf16 v[64:67],v[16:19],v[136:139],v[64:67]
buffer_load_dwordx4 v6,s[12:15],s42 offen offset:1024 nt lds
v_mfma_f32_16x16x32_bf16 v[72:75],v[16:19],v[200:203],v[72:75]
s_waitcnt lgkmcnt(2)
v_mfma_f32_16x16x32_bf16 v[76:79],v[20:23],v[200:203],v[76:79]
ds_read_b64_tr_b16 v[28:29],v9 offset:8200
ds_read_b64_tr_b16 v[30:31],v9 offset:8712
v_mfma_f32_16x16x32_bf16 v[68:71],v[20:23],v[136:139],v[68:71]
v_mfma_f32_16x16x32_bf16 v[60:63],v[20:23],a[200:203],v[60:63]
buffer_load_dwordx4 v5,s[12:15],s42 offen offset:2048 nt lds
v_mfma_f32_16x16x32_bf16 v[52:55],v[20:23],a[136:139],v[52:55]
v_mfma_f32_16x16x32_bf16 v[44:47],v[20:23],a[72:75],v[44:47]
buffer_load_dwordx4 v6,s[12:15],s42 offen offset:3072 nt lds
v_mfma_f32_16x16x32_bf16 v[36:39],v[20:23],a[8:11],v[36:39]
s_waitcnt lgkmcnt(2)
v_mfma_f32_16x16x32_bf16 v[80:83],v[24:27],a[8:11],v[80:83]
ds_read_b64_tr_b16 v[16:17],v8 offset:12288
ds_read_b64_tr_b16 v[18:19],v8 offset:12800
v_mfma_f32_16x16x32_bf16 v[88:91],v[24:27],a[72:75],v[88:91]
s_mov_b32 m0,98304
s_add_u32 s41,s52,512
v_mfma_f32_16x16x32_bf16 v[96:99],v[24:27],a[136:139],v[96:99]
buffer_load_dwordx4 v7,s[16:19],s41 offen lds
v_mfma_f32_16x16x32_bf16 v[104:107],v[24:27],a[200:203],v[104:107]
s_add_u32 s42,s52,65024
v_mfma_f32_16x16x32_bf16 v[112:115],v[24:27],v[136:139],v[112:115]
buffer_load_dwordx4 v7,s[16:19],s42 offen offset:1024 lds
v_mfma_f32_16x16x32_bf16 v[120:123],v[24:27],v[200:203],v[120:123]
s_waitcnt lgkmcnt(2)
v_mfma_f32_16x16x32_bf16 v[124:127],v[28:31],v[200:203],v[124:127]
ds_read_b64_tr_b16 v[20:21],v8 offset:12296
ds_read_b64_tr_b16 v[22:23],v8 offset:12808
v_mfma_f32_16x16x32_bf16 v[116:119],v[28:31],v[136:139],v[116:119]
s_add_u32 s41,s52,129536
v_mfma_f32_16x16x32_bf16 v[108:111],v[28:31],a[200:203],v[108:111]
buffer_load_dwordx4 v7,s[16:19],s41 offen offset:2048 lds
v_mfma_f32_16x16x32_bf16 v[100:103],v[28:31],a[136:139],v[100:103]
s_add_u32 s42,s52,194048
v_mfma_f32_16x16x32_bf16 v[92:95],v[28:31],a[72:75],v[92:95]
buffer_load_dwordx4 v7,s[16:19],s42 offen offset:3072 lds
v_mfma_f32_16x16x32_bf16 v[84:87],v[28:31],a[8:11],v[84:87]
s_waitcnt lgkmcnt(2)
v_mfma_f32_16x16x32_bf16 v[32:35],v[16:19],a[12:15],v[32:35]
ds_read_b64_tr_b16 v[24:25],v9 offset:12288
ds_read_b64_tr_b16 v[26:27],v9 offset:12800
v_mfma_f32_16x16x32_bf16 v[40:43],v[16:19],a[76:79],v[40:43]
s_mov_b32 m0,102400
s_add_u32 s41,s52,262656
v_mfma_f32_16x16x32_bf16 v[48:51],v[16:19],a[140:143],v[48:51]
buffer_load_dwordx4 v7,s[16:19],s41 offen lds
v_mfma_f32_16x16x32_bf16 v[56:59],v[16:19],a[204:207],v[56:59]
s_add_u32 s42,s52,327168
v_mfma_f32_16x16x32_bf16 v[64:67],v[16:19],v[140:143],v[64:67]
buffer_load_dwordx4 v7,s[16:19],s42 offen offset:1024 lds
v_mfma_f32_16x16x32_bf16 v[72:75],v[16:19],v[204:207],v[72:75]
s_waitcnt lgkmcnt(2)
v_mfma_f32_16x16x32_bf16 v[76:79],v[20:23],v[204:207],v[76:79]
ds_read_b64_tr_b16 v[28:29],v9 offset:12296
ds_read_b64_tr_b16 v[30:31],v9 offset:12808
v_mfma_f32_16x16x32_bf16 v[68:71],v[20:23],v[140:143],v[68:71]
s_add_u32 s41,s52,391680
v_mfma_f32_16x16x32_bf16 v[60:63],v[20:23],a[204:207],v[60:63]
buffer_load_dwordx4 v7,s[16:19],s41 offen offset:2048 lds
v_mfma_f32_16x16x32_bf16 v[52:55],v[20:23],a[140:143],v[52:55]
s_add_u32 s42,s52,456192
v_mfma_f32_16x16x32_bf16 v[44:47],v[20:23],a[76:79],v[44:47]
buffer_load_dwordx4 v7,s[16:19],s42 offen offset:3072 lds
v_mfma_f32_16x16x32_bf16 v[36:39],v[20:23],a[12:15],v[36:39]
s_add_u32 s52,s52,256
s_add_u32 s40,s40,131072
s_cmp_eq_u32 s3,0
s_cbranch_scc1 L_light16
s_waitcnt vmcnt(22)
s_branch L_heavy16
L_light16:
s_waitcnt vmcnt(24)
L_heavy16:
s_branch L_lloop0
L_lloop0_end:
s_barrier
s_mov_b32 m0,24576
s_add_u32 s41,s40,122880
buffer_load_dwordx4 v1,s[8:11],s41 offen nt lds
buffer_load_dwordx4 v2,s[8:11],s41 offen offset:1024 nt lds
buffer_load_dwordx4 v3,s[8:11],s41 offen offset:2048 nt lds
buffer_load_dwordx4 v4,s[8:11],s41 offen offset:3072 nt lds
s_waitcnt lgkmcnt(2)
v_mfma_f32_16x16x32_bf16 v[76:79],v[20:23],v[232:235],v[76:79]
ds_read_b64_tr_b16 v[28:29],v9 offset:8200
ds_read_b64_tr_b16 v[30:31],v9 offset:8712
v_mfma_f32_16x16x32_bf16 v[68:71],v[20:23],v[168:171],v[68:71]
s_mov_b32 m0,28672
s_add_u32 s42,s40,126976
v_mfma_f32_16x16x32_bf16 v[60:63],v[20:23],a[232:235],v[60:63]
buffer_load_dwordx4 v1,s[8:11],s42 offen nt lds
v_mfma_f32_16x16x32_bf16 v[52:55],v[20:23],a[168:171],v[52:55]
v_mfma_f32_16x16x32_bf16 v[44:47],v[20:23],a[104:107],v[44:47]
v_mfma_f32_16x16x32_bf16 v[36:39],v[20:23],a[40:43],v[36:39]
buffer_load_dwordx4 v2,s[8:11],s42 offen offset:1024 nt lds
s_waitcnt lgkmcnt(2)
v_mfma_f32_16x16x32_bf16 v[80:83],v[24:27],a[40:43],v[80:83]
ds_read_b64_tr_b16 v[16:17],v8 offset:12288
ds_read_b64_tr_b16 v[18:19],v8 offset:12800
v_mfma_f32_16x16x32_bf16 v[88:91],v[24:27],a[104:107],v[88:91]
v_mfma_f32_16x16x32_bf16 v[96:99],v[24:27],a[168:171],v[96:99]
v_mfma_f32_16x16x32_bf16 v[104:107],v[24:27],a[232:235],v[104:107]
v_mfma_f32_16x16x32_bf16 v[112:115],v[24:27],v[168:171],v[112:115]
buffer_load_dwordx4 v3,s[8:11],s42 offen offset:2048 nt lds
v_mfma_f32_16x16x32_bf16 v[120:123],v[24:27],v[232:235],v[120:123]
s_waitcnt lgkmcnt(2)
v_mfma_f32_16x16x32_bf16 v[124:127],v[28:31],v[232:235],v[124:127]
ds_read_b64_tr_b16 v[20:21],v8 offset:12296
ds_read_b64_tr_b16 v[22:23],v8 offset:12808
v_mfma_f32_16x16x32_bf16 v[116:119],v[28:31],v[168:171],v[116:119]
v_mfma_f32_16x16x32_bf16 v[108:111],v[28:31],a[232:235],v[108:111]
buffer_load_dwordx4 v4,s[8:11],s42 offen offset:3072 nt lds
v_mfma_f32_16x16x32_bf16 v[100:103],v[28:31],a[168:171],v[100:103]
v_mfma_f32_16x16x32_bf16 v[92:95],v[28:31],a[104:107],v[92:95]
v_mfma_f32_16x16x32_bf16 v[84:87],v[28:31],a[40:43],v[84:87]
s_waitcnt lgkmcnt(2)
v_mfma_f32_16x16x32_bf16 v[32:35],v[16:19],a[44:47],v[32:35]
ds_read_b64_tr_b16 v[24:25],v9 offset:12288
ds_read_b64_tr_b16 v[26:27],v9 offset:12800
v_mfma_f32_16x16x32_bf16 v[40:43],v[16:19],a[108:111],v[40:43]
s_mov_b32 m0,40960
s_add_u32 s41,s40,106496
v_mfma_f32_16x16x32_bf16 v[48:51],v[16:19],a[172:175],v[48:51]
buffer_load_dwordx4 v5,s[12:15],s41 offen nt lds
v_mfma_f32_16x16x32_bf16 v[56:59],v[16:19],a[236:239],v[56:59]
v_mfma_f32_16x16x32_bf16 v[64:67],v[16:19],v[172:175],v[64:67]
v_mfma_f32_16x16x32_bf16 v[72:75],v[16:19],v[236:239],v[72:75]
buffer_load_dwordx4 v6,s[12:15],s41 offen offset:1024 nt lds
s_waitcnt lgkmcnt(2)
v_mfma_f32_16x16x32_bf16 v[76:79],v[20:23],v[236:239],v[76:79]
ds_read_b64_tr_b16 v[28:29],v9 offset:12296
ds_read_b64_tr_b16 v[30:31],v9 offset:12808
v_mfma_f32_16x16x32_bf16 v[68:71],v[20:23],v[172:175],v[68:71]
v_mfma_f32_16x16x32_bf16 v[60:63],v[20:23],a[236:239],v[60:63]
v_mfma_f32_16x16x32_bf16 v[52:55],v[20:23],a[172:175],v[52:55]
v_mfma_f32_16x16x32_bf16 v[44:47],v[20:23],a[108:111],v[44:47]
buffer_load_dwordx4 v5,s[12:15],s41 offen offset:2048 nt lds
v_mfma_f32_16x16x32_bf16 v[36:39],v[20:23],a[44:47],v[36:39]
s_waitcnt lgkmcnt(2)
v_mfma_f32_16x16x32_bf16 v[80:83],v[24:27],a[44:47],v[80:83]
ds_read_b64_tr_b16 v[16:17],v8 offset:16384
ds_read_b64_tr_b16 v[18:19],v8 offset:16896
v_mfma_f32_16x16x32_bf16 v[88:91],v[24:27],a[108:111],v[88:91]
v_mfma_f32_16x16x32_bf16 v[96:99],v[24:27],a[172:175],v[96:99]
buffer_load_dwordx4 v6,s[12:15],s41 offen offset:3072 nt lds
v_mfma_f32_16x16x32_bf16 v[104:107],v[24:27],a[236:239],v[104:107]
v_mfma_f32_16x16x32_bf16 v[112:115],v[24:27],v[172:175],v[112:115]
v_mfma_f32_16x16x32_bf16 v[120:123],v[24:27],v[236:239],v[120:123]
s_waitcnt lgkmcnt(2)
v_mfma_f32_16x16x32_bf16 v[124:127],v[28:31],v[236:239],v[124:127]
ds_read_b64_tr_b16 v[20:21],v8 offset:16392
ds_read_b64_tr_b16 v[22:23],v8 offset:16904
v_mfma_f32_16x16x32_bf16 v[116:119],v[28:31],v[172:175],v[116:119]
s_mov_b32 m0,45056
s_add_u32 s42,s40,110592
v_mfma_f32_16x16x32_bf16 v[108:111],v[28:31],a[236:239],v[108:111]
buffer_load_dwordx4 v5,s[12:15],s42 offen nt lds
v_mfma_f32_16x16x32_bf16 v[100:103],v[28:31],a[172:175],v[100:103]
v_mfma_f32_16x16x32_bf16 v[92:95],v[28:31],a[108:111],v[92:95]
v_mfma_f32_16x16x32_bf16 v[84:87],v[28:31],a[44:47],v[84:87]
buffer_load_dwordx4 v6,s[12:15],s42 offen offset:1024 nt lds
s_waitcnt lgkmcnt(2)
v_mfma_f32_16x16x32_bf16 v[32:35],v[16:19],a[48:51],v[32:35]
ds_read_b64_tr_b16 v[24:25],v9 offset:16384
ds_read_b64_tr_b16 v[26:27],v9 offset:16896
v_mfma_f32_16x16x32_bf16 v[40:43],v[16:19],a[112:115],v[40:43]
v_mfma_f32_16x16x32_bf16 v[48:51],v[16:19],a[176:179],v[48:51]
v_mfma_f32_16x16x32_bf16 v[56:59],v[16:19],a[240:243],v[56:59]
v_mfma_f32_16x16x32_bf16 v[64:67],v[16:19],v[176:179],v[64:67]
buffer_load_dwordx4 v5,s[12:15],s42 offen offset:2048 nt lds
v_mfma_f32_16x16x32_bf16 v[72:75],v[16:19],v[240:243],v[72:75]
s_waitcnt lgkmcnt(2)
v_mfma_f32_16x16x32_bf16 v[76:79],v[20:23],v[240:243],v[76:79]
ds_read_b64_tr_b16 v[28:29],v9 offset:16392
ds_read_b64_tr_b16 v[30:31],v9 offset:16904
v_mfma_f32_16x16x32_bf16 v[68:71],v[20:23],v[176:179],v[68:71]
v_mfma_f32_16x16x32_bf16 v[60:63],v[20:23],a[240:243],v[60:63]
buffer_load_dwordx4 v6,s[12:15],s42 offen offset:3072 nt lds
v_mfma_f32_16x16x32_bf16 v[52:55],v[20:23],a[176:179],v[52:55]
v_mfma_f32_16x16x32_bf16 v[44:47],v[20:23],a[112:115],v[44:47]
v_mfma_f32_16x16x32_bf16 v[36:39],v[20:23],a[48:51],v[36:39]
s_cmp_eq_u32 s3,0
s_cbranch_scc1 L_light44
s_waitcnt vmcnt(10)
s_branch L_heavy44
L_light44:
s_waitcnt vmcnt(16)
L_heavy44:
s_barrier
s_mov_b32 m0,0
s_add_u32 s41,s40,131072
buffer_load_dwordx4 v1,s[8:11],s41 offen nt lds
buffer_load_dwordx4 v2,s[8:11],s41 offen offset:1024 nt lds
buffer_load_dwordx4 v3,s[8:11],s41 offen offset:2048 nt lds
buffer_load_dwordx4 v4,s[8:11],s41 offen offset:3072 nt lds
s_waitcnt lgkmcnt(2)
v_mfma_f32_16x16x32_bf16 v[80:83],v[24:27],a[48:51],v[80:83]
ds_read_b64_tr_b16 v[16:17],v8 offset:20480
ds_read_b64_tr_b16 v[18:19],v8 offset:20992
v_mfma_f32_16x16x32_bf16 v[88:91],v[24:27],a[112:115],v[88:91]
s_mov_b32 m0,4096
s_add_u32 s42,s40,135168
v_mfma_f32_16x16x32_bf16 v[96:99],v[24:27],a[176:179],v[96:99]
buffer_load_dwordx4 v1,s[8:11],s42 offen nt lds
v_mfma_f32_16x16x32_bf16 v[104:107],v[24:27],a[240:243],v[104:107]
v_mfma_f32_16x16x32_bf16 v[112:115],v[24:27],v[176:179],v[112:115]
buffer_load_dwordx4 v2,s[8:11],s42 offen offset:1024 nt lds
v_mfma_f32_16x16x32_bf16 v[120:123],v[24:27],v[240:243],v[120:123]
s_waitcnt lgkmcnt(2)
v_mfma_f32_16x16x32_bf16 v[124:127],v[28:31],v[240:243],v[124:127]
ds_read_b64_tr_b16 v[20:21],v8 offset:20488
ds_read_b64_tr_b16 v[22:23],v8 offset:21000
v_mfma_f32_16x16x32_bf16 v[116:119],v[28:31],v[176:179],v[116:119]
v_mfma_f32_16x16x32_bf16 v[108:111],v[28:31],a[240:243],v[108:111]
buffer_load_dwordx4 v3,s[8:11],s42 offen offset:2048 nt lds
v_mfma_f32_16x16x32_bf16 v[100:103],v[28:31],a[176:179],v[100:103]
v_mfma_f32_16x16x32_bf16 v[92:95],v[28:31],a[112:115],v[92:95]
buffer_load_dwordx4 v4,s[8:11],s42 offen offset:3072 nt lds
v_mfma_f32_16x16x32_bf16 v[84:87],v[28:31],a[48:51],v[84:87]
s_waitcnt lgkmcnt(2)
v_mfma_f32_16x16x32_bf16 v[32:35],v[16:19],a[52:55],v[32:35]
ds_read_b64_tr_b16 v[24:25],v9 offset:20480
ds_read_b64_tr_b16 v[26:27],v9 offset:20992
v_mfma_f32_16x16x32_bf16 v[40:43],v[16:19],a[116:119],v[40:43]
s_mov_b32 m0,49152
s_add_u32 s41,s40,114688
v_mfma_f32_16x16x32_bf16 v[48:51],v[16:19],a[180:183],v[48:51]
buffer_load_dwordx4 v5,s[12:15],s41 offen nt lds
v_mfma_f32_16x16x32_bf16 v[56:59],v[16:19],a[244:247],v[56:59]
v_mfma_f32_16x16x32_bf16 v[64:67],v[16:19],v[180:183],v[64:67]
buffer_load_dwordx4 v6,s[12:15],s41 offen offset:1024 nt lds
v_mfma_f32_16x16x32_bf16 v[72:75],v[16:19],v[244:247],v[72:75]
s_waitcnt lgkmcnt(2)
v_mfma_f32_16x16x32_bf16 v[76:79],v[20:23],v[244:247],v[76:79]
ds_read_b64_tr_b16 v[28:29],v9 offset:20488
ds_read_b64_tr_b16 v[30:31],v9 offset:21000
v_mfma_f32_16x16x32_bf16 v[68:71],v[20:23],v[180:183],v[68:71]
v_mfma_f32_16x16x32_bf16 v[60:63],v[20:23],a[244:247],v[60:63]
buffer_load_dwordx4 v5,s[12:15],s41 offen offset:2048 nt lds
v_mfma_f32_16x16x32_bf16 v[52:55],v[20:23],a[180:183],v[52:55]
v_mfma_f32_16x16x32_bf16 v[44:47],v[20:23],a[116:119],v[44:47]
buffer_load_dwordx4 v6,s[12:15],s41 offen offset:3072 nt lds
v_mfma_f32_16x16x32_bf16 v[36:39],v[20:23],a[52:55],v[36:39]
s_waitcnt lgkmcnt(2)
v_mfma_f32_16x16x32_bf16 v[80:83],v[24:27],a[52:55],v[80:83]
ds_read_b64_tr_b16 v[16:17],v8 offset:24576
ds_read_b64_tr_b16 v[18:19],v8 offset:25088
v_mfma_f32_16x16x32_bf16 v[88:91],v[24:27],a[116:119],v[88:91]
s_mov_b32 m0,53248
s_add_u32 s42,s40,118784
v_mfma_f32_16x16x32_bf16 v[96:99],v[24:27],a[180:183],v[96:99]
buffer_load_dwordx4 v5,s[12:15],s42 offen nt lds
v_mfma_f32_16x16x32_bf16 v[104:107],v[24:27],a[244:247],v[104:107]
v_mfma_f32_16x16x32_bf16 v[112:115],v[24:27],v[180:183],v[112:115]
buffer_load_dwordx4 v6,s[12:15],s42 offen offset:1024 nt lds
v_mfma_f32_16x16x32_bf16 v[120:123],v[24:27],v[244:247],v[120:123]
s_waitcnt lgkmcnt(2)
v_mfma_f32_16x16x32_bf16 v[124:127],v[28:31],v[244:247],v[124:127]
ds_read_b64_tr_b16 v[20:21],v8 offset:24584
ds_read_b64_tr_b16 v[22:23],v8 offset:25096
v_mfma_f32_16x16x32_bf16 v[116:119],v[28:31],v[180:183],v[116:119]
v_mfma_f32_16x16x32_bf16 v[108:111],v[28:31],a[244:247],v[108:111]
buffer_load_dwordx4 v5,s[12:15],s42 offen offset:2048 nt lds
v_mfma_f32_16x16x32_bf16 v[100:103],v[28:31],a[180:183],v[100:103]
v_mfma_f32_16x16x32_bf16 v[92:95],v[28:31],a[116:119],v[92:95]
buffer_load_dwordx4 v6,s[12:15],s42 offen offset:3072 nt lds
v_mfma_f32_16x16x32_bf16 v[84:87],v[28:31],a[52:55],v[84:87]
s_waitcnt lgkmcnt(2)
v_mfma_f32_16x16x32_bf16 v[32:35],v[16:19],a[56:59],v[32:35]
ds_read_b64_tr_b16 v[24:25],v9 offset:24576
ds_read_b64_tr_b16 v[26:27],v9 offset:25088
v_mfma_f32_16x16x32_bf16 v[40:43],v[16:19],a[120:123],v[40:43]
s_xor_b32 s66,s65,32768
s_add_u32 s66,s66,s64
s_mov_b32 m0,106496
s_add_u32 s41,s66,393216
v_mfma_f32_16x16x32_bf16 v[48:51],v[16:19],a[184:187],v[48:51]
buffer_load_dwordx4 v11,s[20:23],s41 offen lds
v_mfma_f32_16x16x32_bf16 v[56:59],v[16:19],a[248:251],v[56:59]
v_mfma_f32_16x16x32_bf16 v[64:67],v[16:19],v[184:187],v[64:67]
buffer_load_dwordx4 v12,s[20:23],s41 offen offset:1024 lds
v_mfma_f32_16x16x32_bf16 v[72:75],v[16:19],v[248:251],v[72:75]
s_waitcnt lgkmcnt(2)
v_mfma_f32_16x16x32_bf16 v[76:79],v[20:23],v[248:251],v[76:79]
ds_read_b64_tr_b16 v[28:29],v9 offset:24584
ds_read_b64_tr_b16 v[30:31],v9 offset:25096
v_mfma_f32_16x16x32_bf16 v[68:71],v[20:23],v[184:187],v[68:71]
v_mfma_f32_16x16x32_bf16 v[60:63],v[20:23],a[248:251],v[60:63]
buffer_load_dwordx4 v13,s[20:23],s41 offen offset:2048 lds
v_mfma_f32_16x16x32_bf16 v[52:55],v[20:23],a[184:187],v[52:55]
v_mfma_f32_16x16x32_bf16 v[44:47],v[20:23],a[120:123],v[44:47]
buffer_load_dwordx4 v14,s[20:23],s41 offen offset:3072 lds
v_mfma_f32_16x16x32_bf16 v[36:39],v[20:23],a[56:59],v[36:39]
s_waitcnt lgkmcnt(2)
v_mfma_f32_16x16x32_bf16 v[80:83],v[24:27],a[56:59],v[80:83]
ds_read_b64_tr_b16 v[16:17],v8 offset:28672
ds_read_b64_tr_b16 v[18:19],v8 offset:29184
v_mfma_f32_16x16x32_bf16 v[88:91],v[24:27],a[120:123],v[88:91]
s_mov_b32 m0,110592
s_add_u32 s42,s66,409600
v_mfma_f32_16x16x32_bf16 v[96:99],v[24:27],a[184:187],v[96:99]
buffer_load_dwordx4 v11,s[20:23],s42 offen lds
v_mfma_f32_16x16x32_bf16 v[104:107],v[24:27],a[248:251],v[104:107]
v_mfma_f32_16x16x32_bf16 v[112:115],v[24:27],v[184:187],v[112:115]
buffer_load_dwordx4 v12,s[20:23],s42 offen offset:1024 lds
v_mfma_f32_16x16x32_bf16 v[120:123],v[24:27],v[248:251],v[120:123]
s_waitcnt lgkmcnt(2)
v_mfma_f32_16x16x32_bf16 v[124:127],v[28:31],v[248:251],v[124:127]
ds_read_b64_tr_b16 v[20:21],v8 offset:28680
ds_read_b64_tr_b16 v[22:23],v8 offset:29192
v_mfma_f32_16x16x32_bf16 v[116:119],v[28:31],v[184:187],v[116:119]
v_mfma_f32_16x16x32_bf16 v[108:111],v[28:31],a[248:251],v[108:111]
buffer_load_dwordx4 v13,s[20:23],s42 offen offset:2048 lds
v_mfma_f32_16x16x32_bf16 v[100:103],v[28:31],a[184:187],v[100:103]
v_mfma_f32_16x16x32_bf16 v[92:95],v[28:31],a[120:123],v[92:95]
buffer_load_dwordx4 v14,s[20:23],s42 offen offset:3072 lds
v_mfma_f32_16x16x32_bf16 v[84:87],v[28:31],a[56:59],v[84:87]
s_cmp_eq_u32 s3,0
s_cbranch_scc1 L_light45
s_waitcnt vmcnt(22)
s_branch L_heavy45
L_light45:
s_waitcnt vmcnt(24)
L_heavy45:
s_barrier
s_mov_b32 m0,8192
s_add_u32 s41,s40,139264
buffer_load_dwordx4 v1,s[8:11],s41 offen nt lds
buffer_load_dwordx4 v2,s[8:11],s41 offen offset:1024 nt lds
buffer_load_dwordx4 v3,s[8:11],s41 offen offset:2048 nt lds
buffer_load_dwordx4 v4,s[8:11],s41 offen offset:3072 nt lds
s_waitcnt lgkmcnt(2)
v_mfma_f32_16x16x32_bf16 v[32:35],v[16:19],a[60:63],v[32:35]
ds_read_b64_tr_b16 v[24:25],v9 offset:28672
ds_read_b64_tr_b16 v[26:27],v9 offset:29184
v_mfma_f32_16x16x32_bf16 v[40:43],v[16:19],a[124:127],v[40:43]
s_mov_b32 m0,12288
s_add_u32 s42,s40,143360
buffer_load_dwordx4 v1,s[8:11],s42 offen nt lds
v_mfma_f32_16x16x32_bf16 v[48:51],v[16:19],a[188:191],v[48:51]
buffer_load_dwordx4 v2,s[8:11],s42 offen offset:1024 nt lds
v_mfma_f32_16x16x32_bf16 v[56:59],v[16:19],a[252:255],v[56:59]
buffer_load_dwordx4 v3,s[8:11],s42 offen offset:2048 nt lds
v_mfma_f32_16x16x32_bf16 v[64:67],v[16:19],v[188:191],v[64:67]
buffer_load_dwordx4 v4,s[8:11],s42 offen offset:3072 nt lds
v_mfma_f32_16x16x32_bf16 v[72:75],v[16:19],v[252:255],v[72:75]
s_mov_b32 m0,57344
s_add_u32 s41,s40,122880
buffer_load_dwordx4 v5,s[12:15],s41 offen nt lds
s_waitcnt lgkmcnt(2)
v_mfma_f32_16x16x32_bf16 v[76:79],v[20:23],v[252:255],v[76:79]
ds_read_b64_tr_b16 v[28:29],v9 offset:28680
ds_read_b64_tr_b16 v[30:31],v9 offset:29192
v_mfma_f32_16x16x32_bf16 v[68:71],v[20:23],v[188:191],v[68:71]
buffer_load_dwordx4 v6,s[12:15],s41 offen offset:1024 nt lds
v_mfma_f32_16x16x32_bf16 v[60:63],v[20:23],a[252:255],v[60:63]
buffer_load_dwordx4 v5,s[12:15],s41 offen offset:2048 nt lds
v_mfma_f32_16x16x32_bf16 v[52:55],v[20:23],a[188:191],v[52:55]
buffer_load_dwordx4 v6,s[12:15],s41 offen offset:3072 nt lds
v_mfma_f32_16x16x32_bf16 v[44:47],v[20:23],a[124:127],v[44:47]
s_mov_b32 m0,61440
s_add_u32 s42,s40,126976
buffer_load_dwordx4 v5,s[12:15],s42 offen nt lds
v_mfma_f32_16x16x32_bf16 v[36:39],v[20:23],a[60:63],v[36:39]
buffer_load_dwordx4 v6,s[12:15],s42 offen offset:1024 nt lds
s_waitcnt lgkmcnt(2)
v_mfma_f32_16x16x32_bf16 v[80:83],v[24:27],a[60:63],v[80:83]
v_mfma_f32_16x16x32_bf16 v[88:91],v[24:27],a[124:127],v[88:91]
v_mul_f32 v32,s39,v32
v_mul_f32 v33,s39,v33
v_mul_f32 v34,s39,v34
v_mul_f32 v35,s39,v35
v_mul_f32 v36,s39,v36
v_mul_f32 v37,s39,v37
v_mul_f32 v38,s39,v38
v_mul_f32 v39,s39,v39
v_cvt_pk_bf16_f32 v32,v32,v33
v_cvt_pk_bf16_f32 v33,v34,v35
v_cvt_pk_bf16_f32 v34,v36,v37
v_cvt_pk_bf16_f32 v35,v38,v39
ds_write_b128 v10,v[32:35] offset:2048
buffer_load_dwordx4 v5,s[12:15],s42 offen offset:2048 nt lds
v_mfma_f32_16x16x32_bf16 v[96:99],v[24:27],a[188:191],v[96:99]
buffer_load_dwordx4 v6,s[12:15],s42 offen offset:3072 nt lds
v_mfma_f32_16x16x32_bf16 v[104:107],v[24:27],a[252:255],v[104:107]
v_mul_f32 v40,s39,v40
v_mul_f32 v41,s39,v41
v_mul_f32 v42,s39,v42
v_mul_f32 v43,s39,v43
v_mul_f32 v44,s39,v44
v_mul_f32 v45,s39,v45
v_mul_f32 v46,s39,v46
v_mul_f32 v47,s39,v47
v_cvt_pk_bf16_f32 v40,v40,v41
v_cvt_pk_bf16_f32 v41,v42,v43
v_cvt_pk_bf16_f32 v42,v44,v45
v_cvt_pk_bf16_f32 v43,v46,v47
L_tp_q6:
s_cbranch_execz L_chain_done
ds_write_b128 v10,v[40:43] offset:6144
s_xor_b32 s66,s65,65536
s_add_u32 s66,s66,s64
s_mov_b32 m0,114688
s_add_u32 s41,s66,393216
buffer_load_dwordx4 v11,s[20:23],s41 offen lds
v_mfma_f32_16x16x32_bf16 v[112:115],v[24:27],v[188:191],v[112:115]
buffer_load_dwordx4 v12,s[20:23],s41 offen offset:1024 lds
v_mfma_f32_16x16x32_bf16 v[120:123],v[24:27],v[252:255],v[120:123]
v_mul_f32 v48,s39,v48
v_mul_f32 v49,s39,v49
v_mul_f32 v50,s39,v50
v_mul_f32 v51,s39,v51
v_mul_f32 v52,s39,v52
v_mul_f32 v53,s39,v53
v_mul_f32 v54,s39,v54
v_mul_f32 v55,s39,v55
v_cvt_pk_bf16_f32 v48,v48,v49
v_cvt_pk_bf16_f32 v49,v50,v51
v_cvt_pk_bf16_f32 v50,v52,v53
v_cvt_pk_bf16_f32 v51,v54,v55
ds_write_b128 v10,v[48:51] offset:10240
buffer_load_dwordx4 v13,s[20:23],s41 offen offset:2048 lds
s_waitcnt lgkmcnt(3)
v_mfma_f32_16x16x32_bf16 v[124:127],v[28:31],v[252:255],v[124:127]
v_mfma_f32_16x16x32_bf16 v[116:119],v[28:31],v[188:191],v[116:119]
v_mul_f32 v56,s39,v56
v_mul_f32 v57,s39,v57
v_mul_f32 v58,s39,v58
v_mul_f32 v59,s39,v59
v_mul_f32 v60,s39,v60
v_mul_f32 v61,s39,v61
v_mul_f32 v62,s39,v62
v_mul_f32 v63,s39,v63
v_cvt_pk_bf16_f32 v56,v56,v57
v_cvt_pk_bf16_f32 v57,v58,v59
v_cvt_pk_bf16_f32 v58,v60,v61
v_cvt_pk_bf16_f32 v59,v62,v63
ds_write_b128 v10,v[56:59] offset:14336
buffer_load_dwordx4 v14,s[20:23],s41 offen offset:3072 lds
v_mfma_f32_16x16x32_bf16 v[108:111],v[28:31],a[252:255],v[108:111]
s_mov_b32 m0,118784
s_add_u32 s42,s66,409600
buffer_load_dwordx4 v11,s[20:23],s42 offen lds
v_mfma_f32_16x16x32_bf16 v[100:103],v[28:31],a[188:191],v[100:103]
v_mul_f32 v64,s39,v64
v_mul_f32 v65,s39,v65
v_mul_f32 v66,s39,v66
v_mul_f32 v67,s39,v67
v_mul_f32 v68,s39,v68
v_mul_f32 v69,s39,v69
v_mul_f32 v70,s39,v70
v_mul_f32 v71,s39,v71
v_cvt_pk_bf16_f32 v64,v64,v65
v_cvt_pk_bf16_f32 v65,v66,v67
v_cvt_pk_bf16_f32 v66,v68,v69
v_cvt_pk_bf16_f32 v67,v70,v71
ds_write_b128 v10,v[64:67] offset:18432
buffer_load_dwordx4 v12,s[20:23],s42 offen offset:1024 lds
v_mfma_f32_16x16x32_bf16 v[92:95],v[28:31],a[124:127],v[92:95]
buffer_load_dwordx4 v13,s[20:23],s42 offen offset:2048 lds
v_mfma_f32_16x16x32_bf16 v[84:87],v[28:31],a[60:63],v[84:87]
v_mul_f32 v72,s39,v72
v_mul_f32 v73,s39,v73
v_mul_f32 v74,s39,v74
v_mul_f32 v75,s39,v75
v_mul_f32 v76,s39,v76
v_mul_f32 v77,s39,v77
v_mul_f32 v78,s39,v78
v_mul_f32 v79,s39,v79
v_cvt_pk_bf16_f32 v72,v72,v73
v_cvt_pk_bf16_f32 v73,v74,v75
v_cvt_pk_bf16_f32 v74,v76,v77
v_cvt_pk_bf16_f32 v75,v78,v79
ds_write_b128 v10,v[72:75] offset:22528
buffer_load_dwordx4 v14,s[20:23],s42 offen offset:3072 lds
s_cmp_eq_u32 s3,0
s_cbranch_scc1 L_light46
s_waitcnt vmcnt(22)
s_branch L_heavy46
L_light46:
s_waitcnt vmcnt(24)
L_heavy46:
s_waitcnt lgkmcnt(0)
s_barrier
s_mov_b32 m0,16384
s_add_u32 s41,s40,147456
buffer_load_dwordx4 v1,s[8:11],s41 offen nt lds
buffer_load_dwordx4 v2,s[8:11],s41 offen offset:1024 nt lds
buffer_load_dwordx4 v3,s[8:11],s41 offen offset:2048 nt lds
buffer_load_dwordx4 v4,s[8:11],s41 offen offset:3072 nt lds
s_mov_b32 m0,20480
s_add_u32 s42,s40,151552
buffer_load_dwordx4 v1,s[8:11],s42 offen nt lds
buffer_load_dwordx4 v2,s[8:11],s42 offen offset:1024 nt lds
buffer_load_dwordx4 v3,s[8:11],s42 offen offset:2048 nt lds
v_mul_f32 v80,s39,v80
v_mul_f32 v81,s39,v81
v_mul_f32 v82,s39,v82
v_mul_f32 v83,s39,v83
v_mul_f32 v84,s39,v84
v_mul_f32 v85,s39,v85
v_mul_f32 v86,s39,v86
v_mul_f32 v87,s39,v87
v_cvt_pk_bf16_f32 v80,v80,v81
v_cvt_pk_bf16_f32 v81,v82,v83
v_cvt_pk_bf16_f32 v82,v84,v85
v_cvt_pk_bf16_f32 v83,v86,v87
ds_write_b128 v10,v[80:83] offset:3072
buffer_load_dwordx4 v4,s[8:11],s42 offen offset:3072 nt lds
s_mov_b32 m0,32768
s_add_u32 s41,s40,131072
buffer_load_dwordx4 v5,s[12:15],s41 offen nt lds
buffer_load_dwordx4 v6,s[12:15],s41 offen offset:1024 nt lds
buffer_load_dwordx4 v5,s[12:15],s41 offen offset:2048 nt lds
v_mul_f32 v88,s39,v88
v_mul_f32 v89,s39,v89
v_mul_f32 v90,s39,v90
v_mul_f32 v91,s39,v91
v_mul_f32 v92,s39,v92
v_mul_f32 v93,s39,v93
v_mul_f32 v94,s39,v94
v_mul_f32 v95,s39,v95
v_cvt_pk_bf16_f32 v88,v88,v89
v_cvt_pk_bf16_f32 v89,v90,v91
v_cvt_pk_bf16_f32 v90,v92,v93
v_cvt_pk_bf16_f32 v91,v94,v95
ds_write_b128 v10,v[88:91] offset:7168
buffer_load_dwordx4 v6,s[12:15],s41 offen offset:3072 nt lds
s_mov_b32 m0,36864
s_add_u32 s42,s40,135168
buffer_load_dwordx4 v5,s[12:15],s42 offen nt lds
buffer_load_dwordx4 v6,s[12:15],s42 offen offset:1024 nt lds
v_mul_f32 v96,s39,v96
v_mul_f32 v97,s39,v97
v_mul_f32 v98,s39,v98
v_mul_f32 v99,s39,v99
v_mul_f32 v100,s39,v100
v_mul_f32 v101,s39,v101
v_mul_f32 v102,s39,v102
v_mul_f32 v103,s39,v103
v_cvt_pk_bf16_f32 v96,v96,v97
v_cvt_pk_bf16_f32 v97,v98,v99
v_cvt_pk_bf16_f32 v98,v100,v101
v_cvt_pk_bf16_f32 v99,v102,v103
ds_write_b128 v10,v[96:99] offset:11264
buffer_load_dwordx4 v5,s[12:15],s42 offen offset:2048 nt lds
buffer_load_dwordx4 v6,s[12:15],s42 offen offset:3072 nt lds
s_xor_b32 s66,s65,98304
s_add_u32 s66,s66,s64
s_mov_b32 m0,122880
s_add_u32 s41,s66,393216
buffer_load_dwordx4 v11,s[20:23],s41 offen lds
v_mul_f32 v104,s39,v104
v_mul_f32 v105,s39,v105
v_mul_f32 v106,s39,v106
v_mul_f32 v107,s39,v107
v_mul_f32 v108,s39,v108
v_mul_f32 v109,s39,v109
v_mul_f32 v110,s39,v110
v_mul_f32 v111,s39,v111
v_cvt_pk_bf16_f32 v104,v104,v105
v_cvt_pk_bf16_f32 v105,v106,v107
v_cvt_pk_bf16_f32 v106,v108,v109
v_cvt_pk_bf16_f32 v107,v110,v111
ds_write_b128 v10,v[104:107] offset:15360
buffer_load_dwordx4 v12,s[20:23],s41 offen offset:1024 lds
buffer_load_dwordx4 v13,s[20:23],s41 offen offset:2048 lds
buffer_load_dwordx4 v14,s[20:23],s41 offen offset:3072 lds
v_mul_f32 v112,s39,v112
v_mul_f32 v113,s39,v113
v_mul_f32 v114,s39,v114
v_mul_f32 v115,s39,v115
v_mul_f32 v116,s39,v116
v_mul_f32 v117,s39,v117
v_mul_f32 v118,s39,v118
v_mul_f32 v119,s39,v119
v_cvt_pk_bf16_f32 v112,v112,v113
v_cvt_pk_bf16_f32 v113,v114,v115
v_cvt_pk_bf16_f32 v114,v116,v117
v_cvt_pk_bf16_f32 v115,v118,v119
ds_write_b128 v10,v[112:115] offset:19456
s_mov_b32 m0,126976
s_add_u32 s42,s66,409600
buffer_load_dwordx4 v11,s[20:23],s42 offen lds
buffer_load_dwordx4 v12,s[20:23],s42 offen offset:1024 lds
buffer_load_dwordx4 v13,s[20:23],s42 offen offset:2048 lds
buffer_load_dwordx4 v14,s[20:23],s42 offen offset:3072 lds
v_mul_f32 v120,s39,v120
v_mul_f32 v121,s39,v121
v_mul_f32 v122,s39,v122
v_mul_f32 v123,s39,v123
v_mul_f32 v124,s39,v124
v_mul_f32 v125,s39,v125
v_mul_f32 v126,s39,v126
v_mul_f32 v127,s39,v127
v_cvt_pk_bf16_f32 v120,v120,v121
v_cvt_pk_bf16_f32 v121,v122,v123
v_cvt_pk_bf16_f32 v122,v124,v125
v_cvt_pk_bf16_f32 v123,v126,v127
ds_write_b128 v10,v[120:123] offset:23552
s_cmp_eq_u32 s3,0
s_cbranch_scc1 L_light47
s_waitcnt vmcnt(22)
s_branch L_heavy47
L_light47:
s_waitcnt vmcnt(24)
L_heavy47:
s_waitcnt lgkmcnt(0)
s_barrier
s_lshl_b32 s90,s33,4
s_add_u32 s90,s90,s34
s_lshl_b32 s90,s90,2
s_mov_b32 m0,24576
s_add_u32 s41,s40,155648
buffer_load_dwordx4 v1,s[8:11],s41 offen nt lds
buffer_load_dwordx4 v2,s[8:11],s41 offen offset:1024 nt lds
buffer_load_dwordx4 v3,s[8:11],s41 offen offset:2048 nt lds
buffer_load_dwordx4 v4,s[8:11],s41 offen offset:3072 nt lds
s_mov_b32 m0,28672
s_add_u32 s42,s40,159744
buffer_load_dwordx4 v1,s[8:11],s42 offen nt lds
buffer_load_dwordx4 v2,s[8:11],s42 offen offset:1024 nt lds
buffer_load_dwordx4 v3,s[8:11],s42 offen offset:2048 nt lds
buffer_load_dwordx4 v4,s[8:11],s42 offen offset:3072 nt lds
s_mov_b32 m0,40960
s_add_u32 s41,s40,139264
buffer_load_dwordx4 v5,s[12:15],s41 offen nt lds
buffer_load_dwordx4 v6,s[12:15],s41 offen offset:1024 nt lds
buffer_load_dwordx4 v5,s[12:15],s41 offen offset:2048 nt lds
buffer_load_dwordx4 v6,s[12:15],s41 offen offset:3072 nt lds
s_mov_b32 m0,45056
s_add_u32 s42,s40,143360
buffer_load_dwordx4 v5,s[12:15],s42 offen nt lds
buffer_load_dwordx4 v6,s[12:15],s42 offen offset:1024 nt lds
buffer_load_dwordx4 v5,s[12:15],s42 offen offset:2048 nt lds
buffer_load_dwordx4 v6,s[12:15],s42 offen offset:3072 nt lds
s_xor_b32 s66,s65,32768
s_add_u32 s66,s66,s64
s_mov_b32 m0,81920
s_add_u32 s41,s66,262144
buffer_load_dwordx4 v11,s[20:23],s41 offen lds
buffer_load_dwordx4 v12,s[20:23],s41 offen offset:1024 lds
buffer_load_dwordx4 v13,s[20:23],s41 offen offset:2048 lds
buffer_load_dwordx4 v14,s[20:23],s41 offen offset:3072 lds
s_mov_b32 m0,86016
s_add_u32 s42,s66,278528
buffer_load_dwordx4 v11,s[20:23],s42 offen lds
buffer_load_dwordx4 v12,s[20:23],s42 offen offset:1024 lds
buffer_load_dwordx4 v13,s[20:23],s42 offen offset:2048 lds
buffer_load_dwordx4 v14,s[20:23],s42 offen offset:3072 lds
s_waitcnt vmcnt(32)
s_barrier
s_cmp_eq_u32 s34,0
s_cbranch_scc0 L_nochk48
buffer_load_dword v19,off,s[96:99],s90 sc1
L_nochk48:
s_mov_b32 m0,0
s_add_u32 s41,s40,163840
buffer_load_dwordx4 v1,s[8:11],s41 offen nt lds
buffer_load_dwordx4 v2,s[8:11],s41 offen offset:1024 nt lds
buffer_load_dwordx4 v3,s[8:11],s41 offen offset:2048 nt lds
buffer_load_dwordx4 v4,s[8:11],s41 offen offset:3072 nt lds
s_mov_b32 m0,4096
s_add_u32 s42,s40,167936
buffer_load_dwordx4 v1,s[8:11],s42 offen nt lds
buffer_load_dwordx4 v2,s[8:11],s42 offen offset:1024 nt lds
buffer_load_dwordx4 v3,s[8:11],s42 offen offset:2048 nt lds
buffer_load_dwordx4 v4,s[8:11],s42 offen offset:3072 nt lds
s_mov_b32 m0,49152
s_add_u32 s41,s40,147456
buffer_load_dwordx4 v5,s[12:15],s41 offen nt lds
buffer_load_dwordx4 v6,s[12:15],s41 offen offset:1024 nt lds
buffer_load_dwordx4 v5,s[12:15],s41 offen offset:2048 nt lds
buffer_load_dwordx4 v6,s[12:15],s41 offen offset:3072 nt lds
s_mov_b32 m0,53248
s_add_u32 s42,s40,151552
buffer_load_dwordx4 v5,s[12:15],s42 offen nt lds
buffer_load_dwordx4 v6,s[12:15],s42 offen offset:1024 nt lds
buffer_load_dwordx4 v5,s[12:15],s42 offen offset:2048 nt lds
buffer_load_dwordx4 v6,s[12:15],s42 offen offset:3072 nt lds
s_xor_b32 s66,s65,65536
s_add_u32 s66,s66,s64
s_mov_b32 m0,90112
s_add_u32 s41,s66,262144
buffer_load_dwordx4 v11,s[20:23],s41 offen lds
buffer_load_dwordx4 v12,s[20:23],s41 offen offset:1024 lds
buffer_load_dwordx4 v13,s[20:23],s41 offen offset:2048 lds
buffer_load_dwordx4 v14,s[20:23],s41 offen offset:3072 lds
s_mov_b32 m0,94208
s_add_u32 s42,s66,278528
buffer_load_dwordx4 v11,s[20:23],s42 offen lds
buffer_load_dwordx4 v12,s[20:23],s42 offen offset:1024 lds
buffer_load_dwordx4 v13,s[20:23],s42 offen offset:2048 lds
buffer_load_dwordx4 v14,s[20:23],s42 offen offset:3072 lds
s_xor_b32 s66,s65,256
s_add_u32 s66,s66,s64
s_mov_b32 m0,131072
s_add_u32 s41,s66,393216
buffer_load_dwordx4 v11,s[20:23],s41 offen lds
buffer_load_dwordx4 v12,s[20:23],s41 offen offset:1024 lds
buffer_load_dwordx4 v13,s[20:23],s41 offen offset:2048 lds
buffer_load_dwordx4 v14,s[20:23],s41 offen offset:3072 lds
s_mov_b32 m0,135168
s_add_u32 s42,s66,409600
buffer_load_dwordx4 v11,s[20:23],s42 offen lds
buffer_load_dwordx4 v12,s[20:23],s42 offen offset:1024 lds
buffer_load_dwordx4 v13,s[20:23],s42 offen offset:2048 lds
s_waitcnt vmcnt(54)
buffer_load_dwordx4 v14,s[20:23],s42 offen offset:3072 lds
s_waitcnt vmcnt(32)
s_barrier
s_cmp_eq_u32 s34,1
s_cbranch_scc0 L_nochk49
buffer_load_dword v19,off,s[96:99],s90 sc1
L_nochk49:
s_mov_b32 m0,8192
s_add_u32 s41,s40,172032
buffer_load_dwordx4 v1,s[8:11],s41 offen nt lds
buffer_load_dwordx4 v2,s[8:11],s41 offen offset:1024 nt lds
buffer_load_dwordx4 v3,s[8:11],s41 offen offset:2048 nt lds
buffer_load_dwordx4 v4,s[8:11],s41 offen offset:3072 nt lds
s_mov_b32 m0,12288
s_add_u32 s42,s40,176128
buffer_load_dwordx4 v1,s[8:11],s42 offen nt lds
buffer_load_dwordx4 v2,s[8:11],s42 offen offset:1024 nt lds
buffer_load_dwordx4 v3,s[8:11],s42 offen offset:2048 nt lds
buffer_load_dwordx4 v4,s[8:11],s42 offen offset:3072 nt lds
s_mov_b32 m0,57344
s_add_u32 s41,s40,155648
buffer_load_dwordx4 v5,s[12:15],s41 offen nt lds
buffer_load_dwordx4 v6,s[12:15],s41 offen offset:1024 nt lds
buffer_load_dwordx4 v5,s[12:15],s41 offen offset:2048 nt lds
buffer_load_dwordx4 v6,s[12:15],s41 offen offset:3072 nt lds
s_mov_b32 m0,61440
s_add_u32 s42,s40,159744
buffer_load_dwordx4 v5,s[12:15],s42 offen nt lds
buffer_load_dwordx4 v6,s[12:15],s42 offen offset:1024 nt lds
buffer_load_dwordx4 v5,s[12:15],s42 offen offset:2048 nt lds
buffer_load_dwordx4 v6,s[12:15],s42 offen offset:3072 nt lds
s_xor_b32 s66,s65,98304
s_add_u32 s66,s66,s64
s_mov_b32 m0,65536
s_add_u32 s41,s66,262144
buffer_load_dwordx4 v11,s[20:23],s41 offen lds
buffer_load_dwordx4 v12,s[20:23],s41 offen offset:1024 lds
buffer_load_dwordx4 v13,s[20:23],s41 offen offset:2048 lds
buffer_load_dwordx4 v14,s[20:23],s41 offen offset:3072 lds
s_mov_b32 m0,69632
s_add_u32 s42,s66,278528
buffer_load_dwordx4 v11,s[20:23],s42 offen lds
buffer_load_dwordx4 v12,s[20:23],s42 offen offset:1024 lds
buffer_load_dwordx4 v13,s[20:23],s42 offen offset:2048 lds
buffer_load_dwordx4 v14,s[20:23],s42 offen offset:3072 lds
s_xor_b32 s66,s65,33024
s_add_u32 s66,s66,s64
s_mov_b32 m0,139264
s_add_u32 s41,s66,393216
buffer_load_dwordx4 v11,s[20:23],s41 offen lds
buffer_load_dwordx4 v12,s[20:23],s41 offen offset:1024 lds
buffer_load_dwordx4 v13,s[20:23],s41 offen offset:2048 lds
buffer_load_dwordx4 v14,s[20:23],s41 offen offset:3072 lds
s_mov_b32 m0,143360
s_add_u32 s42,s66,409600
buffer_load_dwordx4 v11,s[20:23],s42 offen lds
buffer_load_dwordx4 v12,s[20:23],s42 offen offset:1024 lds
buffer_load_dwordx4 v13,s[20:23],s42 offen offset:2048 lds
s_waitcnt vmcnt(54)
buffer_load_dwordx4 v14,s[20:23],s42 offen offset:3072 lds
s_mov_b64 exec,0
s_branch L_tp_a8
L_tr_a8:
s_mov_b64 exec,-1
s_waitcnt vmcnt(32)
s_barrier
s_cmp_eq_u32 s34,2
s_cbranch_scc0 L_nochk50
buffer_load_dword v19,off,s[96:99],s90 sc1
L_nochk50:
s_mov_b32 m0,16384
s_add_u32 s41,s40,180224
buffer_load_dwordx4 v1,s[8:11],s41 offen nt lds
buffer_load_dwordx4 v2,s[8:11],s41 offen offset:1024 nt lds
buffer_load_dwordx4 v3,s[8:11],s41 offen offset:2048 nt lds
buffer_load_dwordx4 v4,s[8:11],s41 offen offset:3072 nt lds
s_mov_b32 m0,20480
s_add_u32 s42,s40,184320
buffer_load_dwordx4 v1,s[8:11],s42 offen nt lds
buffer_load_dwordx4 v2,s[8:11],s42 offen offset:1024 nt lds
buffer_load_dwordx4 v3,s[8:11],s42 offen offset:2048 nt lds
buffer_load_dwordx4 v4,s[8:11],s42 offen offset:3072 nt lds
s_mov_b32 m0,32768
s_add_u32 s41,s40,163840
buffer_load_dwordx4 v5,s[12:15],s41 offen nt lds
buffer_load_dwordx4 v6,s[12:15],s41 offen offset:1024 nt lds
buffer_load_dwordx4 v5,s[12:15],s41 offen offset:2048 nt lds
buffer_load_dwordx4 v6,s[12:15],s41 offen offset:3072 nt lds
s_mov_b32 m0,36864
s_add_u32 s42,s40,167936
buffer_load_dwordx4 v5,s[12:15],s42 offen nt lds
buffer_load_dwordx4 v6,s[12:15],s42 offen offset:1024 nt lds
buffer_load_dwordx4 v5,s[12:15],s42 offen offset:2048 nt lds
buffer_load_dwordx4 v6,s[12:15],s42 offen offset:3072 nt lds
s_xor_b32 s66,s65,256
s_add_u32 s66,s66,s64
s_mov_b32 m0,73728
s_add_u32 s41,s66,262144
buffer_load_dwordx4 v11,s[20:23],s41 offen lds
buffer_load_dwordx4 v12,s[20:23],s41 offen offset:1024 lds
buffer_load_dwordx4 v13,s[20:23],s41 offen offset:2048 lds
buffer_load_dwordx4 v14,s[20:23],s41 offen offset:3072 lds
s_mov_b32 m0,77824
s_add_u32 s42,s66,278528
buffer_load_dwordx4 v11,s[20:23],s42 offen lds
buffer_load_dwordx4 v12,s[20:23],s42 offen offset:1024 lds
buffer_load_dwordx4 v13,s[20:23],s42 offen offset:2048 lds
buffer_load_dwordx4 v14,s[20:23],s42 offen offset:3072 lds
s_xor_b32 s66,s65,65792
s_add_u32 s66,s66,s64
s_mov_b32 m0,147456
s_add_u32 s41,s66,393216
buffer_load_dwordx4 v11,s[20:23],s41 offen lds
buffer_load_dwordx4 v12,s[20:23],s41 offen offset:1024 lds
buffer_load_dwordx4 v13,s[20:23],s41 offen offset:2048 lds
buffer_load_dwordx4 v14,s[20:23],s41 offen offset:3072 lds
s_mov_b32 m0,151552
s_add_u32 s42,s66,409600
buffer_load_dwordx4 v11,s[20:23],s42 offen lds
buffer_load_dwordx4 v12,s[20:23],s42 offen offset:1024 lds
buffer_load_dwordx4 v13,s[20:23],s42 offen offset:2048 lds
s_waitcnt vmcnt(54)
buffer_load_dwordx4 v14,s[20:23],s42 offen offset:3072 lds
s_waitcnt vmcnt(32)
s_barrier
s_cmp_eq_u32 s34,3
s_cbranch_scc0 L_nochk51
buffer_load_dword v19,off,s[96:99],s90 sc1
L_nochk51:
s_mov_b32 m0,24576
s_add_u32 s41,s40,188416
buffer_load_dwordx4 v1,s[8:11],s41 offen nt lds
buffer_load_dwordx4 v2,s[8:11],s41 offen offset:1024 nt lds
buffer_load_dwordx4 v3,s[8:11],s41 offen offset:2048 nt lds
buffer_load_dwordx4 v4,s[8:11],s41 offen offset:3072 nt lds
s_mov_b32 m0,28672
s_add_u32 s42,s40,192512
buffer_load_dwordx4 v1,s[8:11],s42 offen nt lds
buffer_load_dwordx4 v2,s[8:11],s42 offen offset:1024 nt lds
buffer_load_dwordx4 v3,s[8:11],s42 offen offset:2048 nt lds
buffer_load_dwordx4 v4,s[8:11],s42 offen offset:3072 nt lds
s_mov_b32 m0,40960
s_add_u32 s41,s40,172032
buffer_load_dwordx4 v5,s[12:15],s41 offen nt lds
buffer_load_dwordx4 v6,s[12:15],s41 offen offset:1024 nt lds
buffer_load_dwordx4 v5,s[12:15],s41 offen offset:2048 nt lds
buffer_load_dwordx4 v6,s[12:15],s41 offen offset:3072 nt lds
s_mov_b32 m0,45056
s_add_u32 s42,s40,176128
buffer_load_dwordx4 v5,s[12:15],s42 offen nt lds
buffer_load_dwordx4 v6,s[12:15],s42 offen offset:1024 nt lds
buffer_load_dwordx4 v5,s[12:15],s42 offen offset:2048 nt lds
buffer_load_dwordx4 v6,s[12:15],s42 offen offset:3072 nt lds
s_xor_b32 s66,s65,33024
s_add_u32 s66,s66,s64
s_mov_b32 m0,81920
s_add_u32 s41,s66,262144
buffer_load_dwordx4 v11,s[20:23],s41 offen lds
buffer_load_dwordx4 v12,s[20:23],s41 offen offset:1024 lds
buffer_load_dwordx4 v13,s[20:23],s41 offen offset:2048 lds
buffer_load_dwordx4 v14,s[20:23],s41 offen offset:3072 lds
s_mov_b32 m0,86016
s_add_u32 s42,s66,278528
buffer_load_dwordx4 v11,s[20:23],s42 offen lds
buffer_load_dwordx4 v12,s[20:23],s42 offen offset:1024 lds
buffer_load_dwordx4 v13,s[20:23],s42 offen offset:2048 lds
buffer_load_dwordx4 v14,s[20:23],s42 offen offset:3072 lds
s_waitcnt vmcnt(32)
s_barrier
s_cmp_eq_u32 s34,4
s_cbranch_scc0 L_nochk52
buffer_load_dword v19,off,s[96:99],s90 sc1
L_nochk52:
s_mov_b32 m0,0
s_add_u32 s41,s40,196608
buffer_load_dwordx4 v1,s[8:11],s41 offen nt lds
buffer_load_dwordx4 v2,s[8:11],s41 offen offset:1024 nt lds
buffer_load_dwordx4 v3,s[8:11],s41 offen offset:2048 nt lds
buffer_load_dwordx4 v4,s[8:11],s41 offen offset:3072 nt lds
s_mov_b32 m0,4096
s_add_u32 s42,s40,200704
buffer_load_dwordx4 v1,s[8:11],s42 offen nt lds
buffer_load_dwordx4 v2,s[8:11],s42 offen offset:1024 nt lds
buffer_load_dwordx4 v3,s[8:11],s42 offen offset:2048 nt lds
buffer_load_dwordx4 v4,s[8:11],s42 offen offset:3072 nt lds
s_mov_b32 m0,49152
s_add_u32 s41,s40,180224
buffer_load_dwordx4 v5,s[12:15],s41 offen nt lds
buffer_load_dwordx4 v6,s[12:15],s41 offen offset:1024 nt lds
buffer_load_dwordx4 v5,s[12:15],s41 offen offset:2048 nt lds
buffer_load_dwordx4 v6,s[12:15],s41 offen offset:3072 nt lds
s_mov_b32 m0,53248
s_add_u32 s42,s40,184320
buffer_load_dwordx4 v5,s[12:15],s42 offen nt lds
buffer_load_dwordx4 v6,s[12:15],s42 offen offset:1024 nt lds
buffer_load_dwordx4 v5,s[12:15],s42 offen offset:2048 nt lds
buffer_load_dwordx4 v6,s[12:15],s42 offen offset:3072 nt lds
s_xor_b32 s66,s65,65792
s_add_u32 s66,s66,s64
s_mov_b32 m0,90112
s_add_u32 s41,s66,262144
buffer_load_dwordx4 v11,s[20:23],s41 offen lds
buffer_load_dwordx4 v12,s[20:23],s41 offen offset:1024 lds
buffer_load_dwordx4 v13,s[20:23],s41 offen offset:2048 lds
buffer_load_dwordx4 v14,s[20:23],s41 offen offset:3072 lds
s_mov_b32 m0,94208
s_add_u32 s42,s66,278528
buffer_load_dwordx4 v11,s[20:23],s42 offen lds
buffer_load_dwordx4 v12,s[20:23],s42 offen offset:1024 lds
buffer_load_dwordx4 v13,s[20:23],s42 offen offset:2048 lds
buffer_load_dwordx4 v14,s[20:23],s42 offen offset:3072 lds
s_mov_b64 exec,0
s_branch L_tp_a9
L_tr_a9:
s_mov_b64 exec,-1
s_waitcnt vmcnt(24)
s_barrier
s_cmp_eq_u32 s34,5
s_cbranch_scc0 L_nochk53
buffer_load_dword v19,off,s[96:99],s90 sc1
L_nochk53:
s_mov_b32 m0,8192
s_add_u32 s41,s40,204800
buffer_load_dwordx4 v1,s[8:11],s41 offen nt lds
buffer_load_dwordx4 v2,s[8:11],s41 offen offset:1024 nt lds
buffer_load_dwordx4 v3,s[8:11],s41 offen offset:2048 nt lds
buffer_load_dwordx4 v4,s[8:11],s41 offen offset:3072 nt lds
s_mov_b32 m0,12288
s_add_u32 s42,s40,208896
buffer_load_dwordx4 v1,s[8:11],s42 offen nt lds
buffer_load_dwordx4 v2,s[8:11],s42 offen offset:1024 nt lds
buffer_load_dwordx4 v3,s[8:11],s42 offen offset:2048 nt lds
buffer_load_dwordx4 v4,s[8:11],s42 offen offset:3072 nt lds
s_mov_b32 m0,57344
s_add_u32 s41,s40,188416
buffer_load_dwordx4 v5,s[12:15],s41 offen nt lds
buffer_load_dwordx4 v6,s[12:15],s41 offen offset:1024 nt lds
buffer_load_dwordx4 v5,s[12:15],s41 offen offset:2048 nt lds
buffer_load_dwordx4 v6,s[12:15],s41 offen offset:3072 nt lds
s_mov_b32 m0,61440
s_add_u32 s42,s40,192512
buffer_load_dwordx4 v5,s[12:15],s42 offen nt lds
buffer_load_dwordx4 v6,s[12:15],s42 offen offset:1024 nt lds
buffer_load_dwordx4 v5,s[12:15],s42 offen offset:2048 nt lds
buffer_load_dwordx4 v6,s[12:15],s42 offen offset:3072 nt lds
s_xor_b32 s66,s65,98560
s_add_u32 s66,s66,s64
s_mov_b32 m0,65536
s_add_u32 s41,s66,262144
buffer_load_dwordx4 v11,s[20:23],s41 offen lds
buffer_load_dwordx4 v12,s[20:23],s41 offen offset:1024 lds
buffer_load_dwordx4 v13,s[20:23],s41 offen offset:2048 lds
buffer_load_dwordx4 v14,s[20:23],s41 offen offset:3072 lds
s_mov_b32 m0,69632
s_add_u32 s42,s66,278528
buffer_load_dwordx4 v11,s[20:23],s42 offen lds
buffer_load_dwordx4 v12,s[20:23],s42 offen offset:1024 lds
buffer_load_dwordx4 v13,s[20:23],s42 offen offset:2048 lds
buffer_load_dwordx4 v14,s[20:23],s42 offen offset:3072 lds
s_waitcnt vmcnt(24)
s_barrier
s_cmp_eq_u32 s34,6
s_cbranch_scc0 L_nochk54
buffer_load_dword v19,off,s[96:99],s90 sc1
L_nochk54:
s_mov_b32 m0,16384
s_add_u32 s41,s40,212992
buffer_load_dwordx4 v1,s[8:11],s41 offen nt lds
buffer_load_dwordx4 v2,s[8:11],s41 offen offset:1024 nt lds
buffer_load_dwordx4 v3,s[8:11],s41 offen offset:2048 nt lds
buffer_load_dwordx4 v4,s[8:11],s41 offen offset:3072 nt lds
s_mov_b32 m0,20480
s_add_u32 s42,s40,217088
buffer_load_dwordx4 v1,s[8:11],s42 offen nt lds
buffer_load_dwordx4 v2,s[8:11],s42 offen offset:1024 nt lds
buffer_load_dwordx4 v3,s[8:11],s42 offen offset:2048 nt lds
buffer_load_dwordx4 v4,s[8:11],s42 offen offset:3072 nt lds
s_mov_b32 m0,32768
s_add_u32 s41,s40,196608
buffer_load_dwordx4 v5,s[12:15],s41 offen nt lds
buffer_load_dwordx4 v6,s[12:15],s41 offen offset:1024 nt lds
buffer_load_dwordx4 v5,s[12:15],s41 offen offset:2048 nt lds
buffer_load_dwordx4 v6,s[12:15],s41 offen offset:3072 nt lds
s_mov_b32 m0,36864
s_add_u32 s42,s40,200704
buffer_load_dwordx4 v5,s[12:15],s42 offen nt lds
buffer_load_dwordx4 v6,s[12:15],s42 offen offset:1024 nt lds
buffer_load_dwordx4 v5,s[12:15],s42 offen offset:2048 nt lds
buffer_load_dwordx4 v6,s[12:15],s42 offen offset:3072 nt lds
s_xor_b32 s66,s65,512
s_add_u32 s66,s66,s64
s_mov_b32 m0,73728
s_add_u32 s41,s66,262144
buffer_load_dwordx4 v11,s[20:23],s41 offen lds
buffer_load_dwordx4 v12,s[20:23],s41 offen offset:1024 lds
buffer_load_dwordx4 v13,s[20:23],s41 offen offset:2048 lds
buffer_load_dwordx4 v14,s[20:23],s41 offen offset:3072 lds
s_mov_b32 m0,77824
s_add_u32 s42,s66,278528
buffer_load_dwordx4 v11,s[20:23],s42 offen lds
buffer_load_dwordx4 v12,s[20:23],s42 offen offset:1024 lds
buffer_load_dwordx4 v13,s[20:23],s42 offen offset:2048 lds
buffer_load_dwordx4 v14,s[20:23],s42 offen offset:3072 lds
s_waitcnt vmcnt(24)
s_barrier
s_cmp_eq_u32 s34,7
s_cbranch_scc0 L_nochk55
buffer_load_dword v19,off,s[96:99],s90 sc1
L_nochk55:
s_mov_b32 m0,24576
s_add_u32 s41,s40,221184
buffer_load_dwordx4 v1,s[8:11],s41 offen nt lds
buffer_load_dwordx4 v2,s[8:11],s41 offen offset:1024 nt lds
buffer_load_dwordx4 v3,s[8:11],s41 offen offset:2048 nt lds
buffer_load_dwordx4 v4,s[8:11],s41 offen offset:3072 nt lds
s_mov_b32 m0,28672
s_add_u32 s42,s40,225280
buffer_load_dwordx4 v1,s[8:11],s42 offen nt lds
buffer_load_dwordx4 v2,s[8:11],s42 offen offset:1024 nt lds
buffer_load_dwordx4 v3,s[8:11],s42 offen offset:2048 nt lds
buffer_load_dwordx4 v4,s[8:11],s42 offen offset:3072 nt lds
s_mov_b32 m0,40960
s_add_u32 s41,s40,204800
buffer_load_dwordx4 v5,s[12:15],s41 offen nt lds
buffer_load_dwordx4 v6,s[12:15],s41 offen offset:1024 nt lds
buffer_load_dwordx4 v5,s[12:15],s41 offen offset:2048 nt lds
buffer_load_dwordx4 v6,s[12:15],s41 offen offset:3072 nt lds
s_mov_b32 m0,45056
s_add_u32 s42,s40,208896
buffer_load_dwordx4 v5,s[12:15],s42 offen nt lds
buffer_load_dwordx4 v6,s[12:15],s42 offen offset:1024 nt lds
buffer_load_dwordx4 v5,s[12:15],s42 offen offset:2048 nt lds
buffer_load_dwordx4 v6,s[12:15],s42 offen offset:3072 nt lds
s_xor_b32 s66,s65,33280
s_add_u32 s66,s66,s64
s_mov_b32 m0,81920
s_add_u32 s41,s66,262144
buffer_load_dwordx4 v11,s[20:23],s41 offen lds
buffer_load_dwordx4 v12,s[20:23],s41 offen offset:1024 lds
buffer_load_dwordx4 v13,s[20:23],s41 offen offset:2048 lds
buffer_load_dwordx4 v14,s[20:23],s41 offen offset:3072 lds
s_mov_b32 m0,86016
s_add_u32 s42,s66,278528
buffer_load_dwordx4 v11,s[20:23],s42 offen lds
buffer_load_dwordx4 v12,s[20:23],s42 offen offset:1024 lds
buffer_load_dwordx4 v13,s[20:23],s42 offen offset:2048 lds
buffer_load_dwordx4 v14,s[20:23],s42 offen offset:3072 lds
s_mov_b64 exec,0
s_branch L_tp_a10
L_tr_a10:
s_mov_b64 exec,-1
s_waitcnt vmcnt(24)
s_barrier
s_cmp_eq_u32 s34,8
s_cbranch_scc0 L_nochk56
buffer_load_dword v19,off,s[96:99],s90 sc1
L_nochk56:
s_mov_b32 m0,0
s_add_u32 s41,s40,229376
buffer_load_dwordx4 v1,s[8:11],s41 offen nt lds
buffer_load_dwordx4 v2,s[8:11],s41 offen offset:1024 nt lds
buffer_load_dwordx4 v3,s[8:11],s41 offen offset:2048 nt lds
buffer_load_dwordx4 v4,s[8:11],s41 offen offset:3072 nt lds
s_mov_b32 m0,4096
s_add_u32 s42,s40,233472
buffer_load_dwordx4 v1,s[8:11],s42 offen nt lds
buffer_load_dwordx4 v2,s[8:11],s42 offen offset:1024 nt lds
buffer_load_dwordx4 v3,s[8:11],s42 offen offset:2048 nt lds
buffer_load_dwordx4 v4,s[8:11],s42 offen offset:3072 nt lds
s_mov_b32 m0,49152
s_add_u32 s41,s40,212992
buffer_load_dwordx4 v5,s[12:15],s41 offen nt lds
buffer_load_dwordx4 v6,s[12:15],s41 offen offset:1024 nt lds
buffer_load_dwordx4 v5,s[12:15],s41 offen offset:2048 nt lds
buffer_load_dwordx4 v6,s[12:15],s41 offen offset:3072 nt lds
s_mov_b32 m0,53248
s_add_u32 s42,s40,217088
buffer_load_dwordx4 v5,s[12:15],s42 offen nt lds
buffer_load_dwordx4 v6,s[12:15],s42 offen offset:1024 nt lds
buffer_load_dwordx4 v5,s[12:15],s42 offen offset:2048 nt lds
buffer_load_dwordx4 v6,s[12:15],s42 offen offset:3072 nt lds
s_xor_b32 s66,s65,66048
s_add_u32 s66,s66,s64
s_mov_b32 m0,90112
s_add_u32 s41,s66,262144
buffer_load_dwordx4 v11,s[20:23],s41 offen lds
buffer_load_dwordx4 v12,s[20:23],s41 offen offset:1024 lds
buffer_load_dwordx4 v13,s[20:23],s41 offen offset:2048 lds
buffer_load_dwordx4 v14,s[20:23],s41 offen offset:3072 lds
s_mov_b32 m0,94208
s_add_u32 s42,s66,278528
buffer_load_dwordx4 v11,s[20:23],s42 offen lds
buffer_load_dwordx4 v12,s[20:23],s42 offen offset:1024 lds
buffer_load_dwordx4 v13,s[20:23],s42 offen offset:2048 lds
buffer_load_dwordx4 v14,s[20:23],s42 offen offset:3072 lds
s_waitcnt vmcnt(24)
s_barrier
s_cmp_eq_u32 s34,9
s_cbranch_scc0 L_nochk57
buffer_load_dword v19,off,s[96:99],s90 sc1
L_nochk57:
s_mov_b32 m0,8192
s_add_u32 s41,s40,237568
buffer_load_dwordx4 v1,s[8:11],s41 offen nt lds
buffer_load_dwordx4 v2,s[8:11],s41 offen offset:1024 nt lds
buffer_load_dwordx4 v3,s[8:11],s41 offen offset:2048 nt lds
buffer_load_dwordx4 v4,s[8:11],s41 offen offset:3072 nt lds
s_mov_b32 m0,12288
s_add_u32 s42,s40,241664
buffer_load_dwordx4 v1,s[8:11],s42 offen nt lds
buffer_load_dwordx4 v2,s[8:11],s42 offen offset:1024 nt lds
buffer_load_dwordx4 v3,s[8:11],s42 offen offset:2048 nt lds
buffer_load_dwordx4 v4,s[8:11],s42 offen offset:3072 nt lds
s_mov_b32 m0,57344
s_add_u32 s41,s40,221184
buffer_load_dwordx4 v5,s[12:15],s41 offen nt lds
buffer_load_dwordx4 v6,s[12:15],s41 offen offset:1024 nt lds
buffer_load_dwordx4 v5,s[12:15],s41 offen offset:2048 nt lds
buffer_load_dwordx4 v6,s[12:15],s41 offen offset:3072 nt lds
s_mov_b32 m0,61440
s_add_u32 s42,s40,225280
buffer_load_dwordx4 v5,s[12:15],s42 offen nt lds
buffer_load_dwordx4 v6,s[12:15],s42 offen offset:1024 nt lds
buffer_load_dwordx4 v5,s[12:15],s42 offen offset:2048 nt lds
buffer_load_dwordx4 v6,s[12:15],s42 offen offset:3072 nt lds
s_xor_b32 s66,s65,98816
s_add_u32 s66,s66,s64
s_mov_b32 m0,65536
s_add_u32 s41,s66,262144
buffer_load_dwordx4 v11,s[20:23],s41 offen lds
buffer_load_dwordx4 v12,s[20:23],s41 offen offset:1024 lds
buffer_load_dwordx4 v13,s[20:23],s41 offen offset:2048 lds
buffer_load_dwordx4 v14,s[20:23],s41 offen offset:3072 lds
s_mov_b32 m0,69632
s_add_u32 s42,s66,278528
buffer_load_dwordx4 v11,s[20:23],s42 offen lds
buffer_load_dwordx4 v12,s[20:23],s42 offen offset:1024 lds
buffer_load_dwordx4 v13,s[20:23],s42 offen offset:2048 lds
buffer_load_dwordx4 v14,s[20:23],s42 offen offset:3072 lds
s_waitcnt vmcnt(24)
s_barrier
s_cmp_eq_u32 s34,10
s_cbranch_scc0 L_nochk58
buffer_load_dword v19,off,s[96:99],s90 sc1
L_nochk58:
s_mov_b32 m0,16384
s_add_u32 s41,s40,245760
buffer_load_dwordx4 v1,s[8:11],s41 offen nt lds
buffer_load_dwordx4 v2,s[8:11],s41 offen offset:1024 nt lds
buffer_load_dwordx4 v3,s[8:11],s41 offen offset:2048 nt lds
buffer_load_dwordx4 v4,s[8:11],s41 offen offset:3072 nt lds
s_mov_b32 m0,20480
s_add_u32 s42,s40,249856
buffer_load_dwordx4 v1,s[8:11],s42 offen nt lds
buffer_load_dwordx4 v2,s[8:11],s42 offen offset:1024 nt lds
buffer_load_dwordx4 v3,s[8:11],s42 offen offset:2048 nt lds
buffer_load_dwordx4 v4,s[8:11],s42 offen offset:3072 nt lds
s_mov_b32 m0,32768
s_add_u32 s41,s40,229376
buffer_load_dwordx4 v5,s[12:15],s41 offen nt lds
buffer_load_dwordx4 v6,s[12:15],s41 offen offset:1024 nt lds
buffer_load_dwordx4 v5,s[12:15],s41 offen offset:2048 nt lds
buffer_load_dwordx4 v6,s[12:15],s41 offen offset:3072 nt lds
s_mov_b32 m0,36864
s_add_u32 s42,s40,233472
buffer_load_dwordx4 v5,s[12:15],s42 offen nt lds
buffer_load_dwordx4 v6,s[12:15],s42 offen offset:1024 nt lds
buffer_load_dwordx4 v5,s[12:15],s42 offen offset:2048 nt lds
buffer_load_dwordx4 v6,s[12:15],s42 offen offset:3072 nt lds
s_xor_b32 s66,s65,768
s_add_u32 s66,s66,s64
s_mov_b32 m0,73728
s_add_u32 s41,s66,262144
buffer_load_dwordx4 v11,s[20:23],s41 offen lds
buffer_load_dwordx4 v12,s[20:23],s41 offen offset:1024 lds
buffer_load_dwordx4 v13,s[20:23],s41 offen offset:2048 lds
buffer_load_dwordx4 v14,s[20:23],s41 offen offset:3072 lds
s_mov_b32 m0,77824
s_add_u32 s42,s66,278528
buffer_load_dwordx4 v11,s[20:23],s42 offen lds
buffer_load_dwordx4 v12,s[20:23],s42 offen offset:1024 lds
buffer_load_dwordx4 v13,s[20:23],s42 offen offset:2048 lds
buffer_load_dwordx4 v14,s[20:23],s42 offen offset:3072 lds
s_waitcnt vmcnt(24)
s_barrier
s_cmp_eq_u32 s34,11
s_cbranch_scc0 L_nochk59
buffer_load_dword v19,off,s[96:99],s90 sc1
L_nochk59:
s_mov_b32 m0,24576
s_add_u32 s41,s40,253952
buffer_load_dwordx4 v1,s[8:11],s41 offen nt lds
buffer_load_dwordx4 v2,s[8:11],s41 offen offset:1024 nt lds
buffer_load_dwordx4 v3,s[8:11],s41 offen offset:2048 nt lds
buffer_load_dwordx4 v4,s[8:11],s41 offen offset:3072 nt lds
s_mov_b32 m0,28672
s_add_u32 s42,s40,258048
buffer_load_dwordx4 v1,s[8:11],s42 offen nt lds
buffer_load_dwordx4 v2,s[8:11],s42 offen offset:1024 nt lds
buffer_load_dwordx4 v3,s[8:11],s42 offen offset:2048 nt lds
buffer_load_dwordx4 v4,s[8:11],s42 offen offset:3072 nt lds
s_mov_b32 m0,40960
s_add_u32 s41,s40,237568
buffer_load_dwordx4 v5,s[12:15],s41 offen nt lds
buffer_load_dwordx4 v6,s[12:15],s41 offen offset:1024 nt lds
buffer_load_dwordx4 v5,s[12:15],s41 offen offset:2048 nt lds
buffer_load_dwordx4 v6,s[12:15],s41 offen offset:3072 nt lds
s_mov_b32 m0,45056
s_add_u32 s42,s40,241664
buffer_load_dwordx4 v5,s[12:15],s42 offen nt lds
buffer_load_dwordx4 v6,s[12:15],s42 offen offset:1024 nt lds
buffer_load_dwordx4 v5,s[12:15],s42 offen offset:2048 nt lds
buffer_load_dwordx4 v6,s[12:15],s42 offen offset:3072 nt lds
s_mov_b32 m0,98304
s_add_u32 s41,s40,245760
buffer_load_dwordx4 v5,s[12:15],s41 offen nt lds
buffer_load_dwordx4 v6,s[12:15],s41 offen offset:1024 nt lds
buffer_load_dwordx4 v5,s[12:15],s41 offen offset:2048 nt lds
buffer_load_dwordx4 v6,s[12:15],s41 offen offset:3072 nt lds
s_mov_b32 m0,102400
s_add_u32 s42,s40,249856
buffer_load_dwordx4 v5,s[12:15],s42 offen nt lds
buffer_load_dwordx4 v6,s[12:15],s42 offen offset:1024 nt lds
buffer_load_dwordx4 v5,s[12:15],s42 offen offset:2048 nt lds
buffer_load_dwordx4 v6,s[12:15],s42 offen offset:3072 nt lds
s_xor_b32 s66,s65,33536
s_add_u32 s66,s66,s64
s_mov_b32 m0,81920
s_add_u32 s41,s66,262144
buffer_load_dwordx4 v11,s[20:23],s41 offen lds
buffer_load_dwordx4 v12,s[20:23],s41 offen offset:1024 lds
buffer_load_dwordx4 v13,s[20:23],s41 offen offset:2048 lds
buffer_load_dwordx4 v14,s[20:23],s41 offen offset:3072 lds
s_mov_b32 m0,86016
s_add_u32 s42,s66,278528
buffer_load_dwordx4 v11,s[20:23],s42 offen lds
buffer_load_dwordx4 v12,s[20:23],s42 offen offset:1024 lds
buffer_load_dwordx4 v13,s[20:23],s42 offen offset:2048 lds
buffer_load_dwordx4 v14,s[20:23],s42 offen offset:3072 lds
s_waitcnt vmcnt(32)
s_barrier
s_cmp_eq_u32 s34,12
s_cbranch_scc0 L_nochk60
buffer_load_dword v19,off,s[96:99],s90 sc1
L_nochk60:
s_mov_b32 m0,155648
s_add_u32 s41,s40,253952
buffer_load_dwordx4 v5,s[12:15],s41 offen nt lds
buffer_load_dwordx4 v6,s[12:15],s41 offen offset:1024 nt lds
buffer_load_dwordx4 v5,s[12:15],s41 offen offset:2048 nt lds
buffer_load_dwordx4 v6,s[12:15],s41 offen offset:3072 nt lds
s_mov_b32 m0,159744
s_add_u32 s42,s40,258048
buffer_load_dwordx4 v5,s[12:15],s42 offen nt lds
buffer_load_dwordx4 v6,s[12:15],s42 offen offset:1024 nt lds
buffer_load_dwordx4 v5,s[12:15],s42 offen offset:2048 nt lds
buffer_load_dwordx4 v6,s[12:15],s42 offen offset:3072 nt lds
s_xor_b32 s66,s65,66304
s_add_u32 s66,s66,s64
s_mov_b32 m0,90112
s_add_u32 s41,s66,262144
buffer_load_dwordx4 v11,s[20:23],s41 offen lds
buffer_load_dwordx4 v12,s[20:23],s41 offen offset:1024 lds
buffer_load_dwordx4 v13,s[20:23],s41 offen offset:2048 lds
buffer_load_dwordx4 v14,s[20:23],s41 offen offset:3072 lds
s_mov_b32 m0,94208
s_add_u32 s42,s66,278528
buffer_load_dwordx4 v11,s[20:23],s42 offen lds
buffer_load_dwordx4 v12,s[20:23],s42 offen offset:1024 lds
buffer_load_dwordx4 v13,s[20:23],s42 offen offset:2048 lds
buffer_load_dwordx4 v14,s[20:23],s42 offen offset:3072 lds
s_xor_b32 s66,s65,98560
s_add_u32 s66,s66,s64
s_mov_b32 m0,49152
s_add_u32 s41,s66,393216
buffer_load_dwordx4 v11,s[20:23],s41 offen lds
buffer_load_dwordx4 v12,s[20:23],s41 offen offset:1024 lds
buffer_load_dwordx4 v13,s[20:23],s41 offen offset:2048 lds
buffer_load_dwordx4 v14,s[20:23],s41 offen offset:3072 lds
s_mov_b32 m0,53248
s_add_u32 s42,s66,409600
buffer_load_dwordx4 v11,s[20:23],s42 offen lds
buffer_load_dwordx4 v12,s[20:23],s42 offen offset:1024 lds
buffer_load_dwordx4 v13,s[20:23],s42 offen offset:2048 lds
buffer_load_dwordx4 v14,s[20:23],s42 offen offset:3072 lds
s_xor_b32 s66,s65,512
s_add_u32 s66,s66,s64
s_mov_b32 m0,0
s_add_u32 s41,s66,393216
buffer_load_dwordx4 v11,s[20:23],s41 offen lds
buffer_load_dwordx4 v12,s[20:23],s41 offen offset:1024 lds
buffer_load_dwordx4 v13,s[20:23],s41 offen offset:2048 lds
buffer_load_dwordx4 v14,s[20:23],s41 offen offset:3072 lds
s_mov_b32 m0,4096
s_add_u32 s42,s66,409600
buffer_load_dwordx4 v11,s[20:23],s42 offen lds
buffer_load_dwordx4 v12,s[20:23],s42 offen offset:1024 lds
buffer_load_dwordx4 v13,s[20:23],s42 offen offset:2048 lds
s_waitcnt vmcnt(54)
buffer_load_dwordx4 v14,s[20:23],s42 offen offset:3072 lds
s_waitcnt vmcnt(32)
s_barrier
s_cmp_eq_u32 s34,13
s_cbranch_scc0 L_nochk61
buffer_load_dword v19,off,s[96:99],s90 sc1
L_nochk61:
s_xor_b32 s66,s65,99072
s_add_u32 s66,s66,s64
s_mov_b32 m0,65536
s_add_u32 s41,s66,262144
buffer_load_dwordx4 v11,s[20:23],s41 offen lds
buffer_load_dwordx4 v12,s[20:23],s41 offen offset:1024 lds
buffer_load_dwordx4 v13,s[20:23],s41 offen offset:2048 lds
buffer_load_dwordx4 v14,s[20:23],s41 offen offset:3072 lds
s_mov_b32 m0,69632
s_add_u32 s42,s66,278528
buffer_load_dwordx4 v11,s[20:23],s42 offen lds
buffer_load_dwordx4 v12,s[20:23],s42 offen offset:1024 lds
buffer_load_dwordx4 v13,s[20:23],s42 offen offset:2048 lds
buffer_load_dwordx4 v14,s[20:23],s42 offen offset:3072 lds
s_xor_b32 s66,s65,33280
s_add_u32 s66,s66,s64
s_mov_b32 m0,8192
s_add_u32 s41,s66,393216
buffer_load_dwordx4 v11,s[20:23],s41 offen lds
buffer_load_dwordx4 v12,s[20:23],s41 offen offset:1024 lds
buffer_load_dwordx4 v13,s[20:23],s41 offen offset:2048 lds
buffer_load_dwordx4 v14,s[20:23],s41 offen offset:3072 lds
s_mov_b32 m0,12288
s_add_u32 s42,s66,409600
buffer_load_dwordx4 v11,s[20:23],s42 offen lds
buffer_load_dwordx4 v12,s[20:23],s42 offen offset:1024 lds
buffer_load_dwordx4 v13,s[20:23],s42 offen offset:2048 lds
buffer_load_dwordx4 v14,s[20:23],s42 offen offset:3072 lds
s_waitcnt vmcnt(32)
s_barrier
s_cmp_eq_u32 s34,14
s_cbranch_scc0 L_nochk62
buffer_load_dword v19,off,s[96:99],s90 sc1
L_nochk62:
s_xor_b32 s66,s65,0
s_add_u32 s66,s66,s64
s_mov_b32 m0,73728
s_add_u32 s41,s66,393216
buffer_load_dwordx4 v11,s[20:23],s41 offen lds
buffer_load_dwordx4 v12,s[20:23],s41 offen offset:1024 lds
buffer_load_dwordx4 v13,s[20:23],s41 offen offset:2048 lds
buffer_load_dwordx4 v14,s[20:23],s41 offen offset:3072 lds
s_mov_b32 m0,77824
s_add_u32 s42,s66,409600
buffer_load_dwordx4 v11,s[20:23],s42 offen lds
buffer_load_dwordx4 v12,s[20:23],s42 offen offset:1024 lds
buffer_load_dwordx4 v13,s[20:23],s42 offen offset:2048 lds
buffer_load_dwordx4 v14,s[20:23],s42 offen offset:3072 lds
s_xor_b32 s66,s65,66048
s_add_u32 s66,s66,s64
s_mov_b32 m0,16384
s_add_u32 s41,s66,393216
buffer_load_dwordx4 v11,s[20:23],s41 offen lds
buffer_load_dwordx4 v12,s[20:23],s41 offen offset:1024 lds
buffer_load_dwordx4 v13,s[20:23],s41 offen offset:2048 lds
buffer_load_dwordx4 v14,s[20:23],s41 offen offset:3072 lds
s_mov_b32 m0,20480
s_add_u32 s42,s66,409600
buffer_load_dwordx4 v11,s[20:23],s42 offen lds
buffer_load_dwordx4 v12,s[20:23],s42 offen offset:1024 lds
buffer_load_dwordx4 v13,s[20:23],s42 offen offset:2048 lds
buffer_load_dwordx4 v14,s[20:23],s42 offen offset:3072 lds
s_xor_b32 s66,s65,768
s_add_u32 s66,s66,s64
s_mov_b32 m0,32768
s_add_u32 s41,s66,393216
buffer_load_dwordx4 v11,s[20:23],s41 offen lds
buffer_load_dwordx4 v12,s[20:23],s41 offen offset:1024 lds
buffer_load_dwordx4 v13,s[20:23],s41 offen offset:2048 lds
buffer_load_dwordx4 v14,s[20:23],s41 offen offset:3072 lds
s_mov_b32 m0,36864
s_add_u32 s42,s66,409600
buffer_load_dwordx4 v11,s[20:23],s42 offen lds
buffer_load_dwordx4 v12,s[20:23],s42 offen offset:1024 lds
buffer_load_dwordx4 v13,s[20:23],s42 offen offset:2048 lds
buffer_load_dwordx4 v14,s[20:23],s42 offen offset:3072 lds
s_waitcnt vmcnt(32)
s_barrier
s_cmp_eq_u32 s34,15
s_cbranch_scc0 L_nochk63
buffer_load_dword v19,off,s[96:99],s90 sc1
L_nochk63:
s_xor_b32 s66,s65,98816
s_add_u32 s66,s66,s64
s_mov_b32 m0,24576
s_add_u32 s41,s66,393216
buffer_load_dwordx4 v11,s[20:23],s41 offen lds
buffer_load_dwordx4 v12,s[20:23],s41 offen offset:1024 lds
buffer_load_dwordx4 v13,s[20:23],s41 offen offset:2048 lds
buffer_load_dwordx4 v14,s[20:23],s41 offen offset:3072 lds
s_mov_b32 m0,28672
s_add_u32 s42,s66,409600
buffer_load_dwordx4 v11,s[20:23],s42 offen lds
buffer_load_dwordx4 v12,s[20:23],s42 offen offset:1024 lds
buffer_load_dwordx4 v13,s[20:23],s42 offen offset:2048 lds
buffer_load_dwordx4 v14,s[20:23],s42 offen offset:3072 lds
s_xor_b32 s66,s65,33536
s_add_u32 s66,s66,s64
s_mov_b32 m0,40960
s_add_u32 s41,s66,393216
buffer_load_dwordx4 v11,s[20:23],s41 offen lds
buffer_load_dwordx4 v12,s[20:23],s41 offen offset:1024 lds
buffer_load_dwordx4 v13,s[20:23],s41 offen offset:2048 lds
buffer_load_dwordx4 v14,s[20:23],s41 offen offset:3072 lds
s_mov_b32 m0,45056
s_add_u32 s42,s66,409600
buffer_load_dwordx4 v11,s[20:23],s42 offen lds
buffer_load_dwordx4 v12,s[20:23],s42 offen offset:1024 lds
buffer_load_dwordx4 v13,s[20:23],s42 offen offset:2048 lds
buffer_load_dwordx4 v14,s[20:23],s42 offen offset:3072 lds
s_xor_b32 s66,s65,99072
s_add_u32 s66,s66,s64
s_mov_b32 m0,81920
s_add_u32 s41,s66,393216
buffer_load_dwordx4 v11,s[20:23],s41 offen lds
buffer_load_dwordx4 v12,s[20:23],s41 offen offset:1024 lds
buffer_load_dwordx4 v13,s[20:23],s41 offen offset:2048 lds
buffer_load_dwordx4 v14,s[20:23],s41 offen offset:3072 lds
s_mov_b32 m0,86016
s_add_u32 s42,s66,409600
buffer_load_dwordx4 v11,s[20:23],s42 offen lds
buffer_load_dwordx4 v12,s[20:23],s42 offen offset:1024 lds
buffer_load_dwordx4 v13,s[20:23],s42 offen offset:2048 lds
buffer_load_dwordx4 v14,s[20:23],s42 offen offset:3072 lds
s_waitcnt vmcnt(32)
s_barrier
s_waitcnt vmcnt(0)
v_readfirstlane_b32 s41,v19
s_nop 1
s_cmp_ge_u32 s41,8
s_cbranch_scc1 L_ready_ok
s_mov_b32 s45,0
L_ready:
buffer_load_dword v19,off,s[96:99],s90 sc1
s_waitcnt vmcnt(0)
v_cmp_gt_u32 vcc,8,v19
s_add_u32 s45,s45,1
s_cmp_lt_u32 s45,1048576
s_cbranch_vccz L_ready_ok
s_cbranch_scc1 L_ready
L_ready_ok:
s_xor_b32 s66,s65,66304
s_add_u32 s66,s66,s64
s_mov_b32 m0,90112
s_add_u32 s41,s66,393216
buffer_load_dwordx4 v11,s[20:23],s41 offen lds
buffer_load_dwordx4 v12,s[20:23],s41 offen offset:1024 lds
buffer_load_dwordx4 v13,s[20:23],s41 offen offset:2048 lds
buffer_load_dwordx4 v14,s[20:23],s41 offen offset:3072 lds
s_mov_b32 m0,94208
s_add_u32 s42,s66,409600
buffer_load_dwordx4 v11,s[20:23],s42 offen lds
buffer_load_dwordx4 v12,s[20:23],s42 offen offset:1024 lds
buffer_load_dwordx4 v13,s[20:23],s42 offen offset:2048 lds
buffer_load_dwordx4 v14,s[20:23],s42 offen offset:3072 lds
s_barrier
s_waitcnt vmcnt(0)
s_barrier
s_lshl_b32 s41,s33,4
s_add_u32 s41,s41,s34
s_mul_i32 s41,s41,3
s_lshl_b32 s48,s41,18
s_lshl_b32 s42,s35,15
s_add_u32 s48,s48,s42
s_lshl_b32 s49,s41,10
s_lshl_b32 s42,s35,7
s_add_u32 s49,s49,s42
s_add_u32 s49,s49,25165824
v_subrev_u32 v16,131072,v10
v_lshrrev_b32 v17,7,v16
v_min_u32 v17,2,v17
v_bfe_u32 v18,v16,4,3
v_lshlrev_b32 v18,2,v18
v_lshl_add_u32 v17,v17,10,v18
s_mov_b32 s51,0
s_barrier
s_xor_b32 s50,s35,7
s_lshl_b32 s52,0x10101,s50
s_lshl_b32 s50,s50,12
s_add_u32 s50,s50,s48
s_mov_b32 s45,0
L_poll0:
s_and_b32 s41,s51,s52
s_cmp_eq_u32 s41,s52
s_cbranch_scc1 L_poll0_ok
buffer_load_dword v18,v17,s[28:31],s49 offen sc1
s_waitcnt vmcnt(0)
v_cmp_ne_u32 vcc,0,v18
s_add_u32 s45,s45,1
s_nop 0
s_mov_b32 s51,vcc_lo
s_cmp_lt_u32 s45,1048576
s_cbranch_scc1 L_poll0
L_poll0_ok:
s_mov_b32 m0,49152
s_add_u32 s42,s50,0
buffer_load_dwordx4 v16,s[28:31],s42 offen sc1 lds
buffer_load_dwordx4 v16,s[28:31],s42 offen offset:1024 sc1 lds
buffer_load_dwordx4 v16,s[28:31],s42 offen offset:2048 sc1 lds
buffer_load_dwordx4 v16,s[28:31],s42 offen offset:3072 sc1 lds
s_mov_b32 m0,53248
s_add_u32 s42,s50,262144
buffer_load_dwordx4 v16,s[28:31],s42 offen sc1 lds
buffer_load_dwordx4 v16,s[28:31],s42 offen offset:1024 sc1 lds
buffer_load_dwordx4 v16,s[28:31],s42 offen offset:2048 sc1 lds
buffer_load_dwordx4 v16,s[28:31],s42 offen offset:3072 sc1 lds
s_mov_b32 m0,57344
s_add_u32 s42,s50,524288
buffer_load_dwordx4 v16,s[28:31],s42 offen sc1 lds
buffer_load_dwordx4 v16,s[28:31],s42 offen offset:1024 sc1 lds
buffer_load_dwordx4 v16,s[28:31],s42 offen offset:2048 sc1 lds
buffer_load_dwordx4 v16,s[28:31],s42 offen offset:3072 sc1 lds
s_xor_b32 s50,s35,6
s_lshl_b32 s52,0x10101,s50
s_lshl_b32 s50,s50,12
s_add_u32 s50,s50,s48
s_mov_b32 s45,0
L_poll1:
s_and_b32 s41,s51,s52
s_cmp_eq_u32 s41,s52
s_cbranch_scc1 L_poll1_ok
buffer_load_dword v18,v17,s[28:31],s49 offen sc1
s_waitcnt vmcnt(0)
v_cmp_ne_u32 vcc,0,v18
s_add_u32 s45,s45,1
s_nop 0
s_mov_b32 s51,vcc_lo
s_cmp_lt_u32 s45,1048576
s_cbranch_scc1 L_poll1
L_poll1_ok:
s_mov_b32 m0,61440
s_add_u32 s42,s50,0
buffer_load_dwordx4 v16,s[28:31],s42 offen sc1 lds
buffer_load_dwordx4 v16,s[28:31],s42 offen offset:1024 sc1 lds
buffer_load_dwordx4 v16,s[28:31],s42 offen offset:2048 sc1 lds
buffer_load_dwordx4 v16,s[28:31],s42 offen offset:3072 sc1 lds
s_mov_b32 m0,65536
s_add_u32 s42,s50,262144
buffer_load_dwordx4 v16,s[28:31],s42 offen sc1 lds
buffer_load_dwordx4 v16,s[28:31],s42 offen offset:1024 sc1 lds
buffer_load_dwordx4 v16,s[28:31],s42 offen offset:2048 sc1 lds
buffer_load_dwordx4 v16,s[28:31],s42 offen offset:3072 sc1 lds
s_mov_b32 m0,69632
s_add_u32 s42,s50,524288
buffer_load_dwordx4 v16,s[28:31],s42 offen sc1 lds
buffer_load_dwordx4 v16,s[28:31],s42 offen offset:1024 sc1 lds
buffer_load_dwordx4 v16,s[28:31],s42 offen offset:2048 sc1 lds
buffer_load_dwordx4 v16,s[28:31],s42 offen offset:3072 sc1 lds
s_xor_b32 s50,s35,5
s_lshl_b32 s52,0x10101,s50
s_lshl_b32 s50,s50,12
s_add_u32 s50,s50,s48
s_mov_b32 s45,0
L_poll2:
s_and_b32 s41,s51,s52
s_cmp_eq_u32 s41,s52
s_cbranch_scc1 L_poll2_ok
buffer_load_dword v18,v17,s[28:31],s49 offen sc1
s_waitcnt vmcnt(0)
v_cmp_ne_u32 vcc,0,v18
s_add_u32 s45,s45,1
s_nop 0
s_mov_b32 s51,vcc_lo
s_cmp_lt_u32 s45,1048576
s_cbranch_scc1 L_poll2
L_poll2_ok:
s_mov_b32 m0,98304
s_add_u32 s42,s50,0
buffer_load_dwordx4 v16,s[28:31],s42 offen sc1 lds
buffer_load_dwordx4 v16,s[28:31],s42 offen offset:1024 sc1 lds
buffer_load_dwordx4 v16,s[28:31],s42 offen offset:2048 sc1 lds
buffer_load_dwordx4 v16,s[28:31],s42 offen offset:3072 sc1 lds
s_mov_b32 m0,102400
s_add_u32 s42,s50,262144
buffer_load_dwordx4 v16,s[28:31],s42 offen sc1 lds
buffer_load_dwordx4 v16,s[28:31],s42 offen offset:1024 sc1 lds
buffer_load_dwordx4 v16,s[28:31],s42 offen offset:2048 sc1 lds
buffer_load_dwordx4 v16,s[28:31],s42 offen offset:3072 sc1 lds
s_mov_b32 m0,106496
s_add_u32 s42,s50,524288
buffer_load_dwordx4 v16,s[28:31],s42 offen sc1 lds
buffer_load_dwordx4 v16,s[28:31],s42 offen offset:1024 sc1 lds
buffer_load_dwordx4 v16,s[28:31],s42 offen offset:2048 sc1 lds
buffer_load_dwordx4 v16,s[28:31],s42 offen offset:3072 sc1 lds
s_xor_b32 s50,s35,4
s_lshl_b32 s52,0x10101,s50
s_lshl_b32 s50,s50,12
s_add_u32 s50,s50,s48
s_mov_b32 s45,0
L_poll3:
s_and_b32 s41,s51,s52
s_cmp_eq_u32 s41,s52
s_cbranch_scc1 L_poll3_ok
buffer_load_dword v18,v17,s[28:31],s49 offen sc1
s_waitcnt vmcnt(0)
v_cmp_ne_u32 vcc,0,v18
s_add_u32 s45,s45,1
s_nop 0
s_mov_b32 s51,vcc_lo
s_cmp_lt_u32 s45,1048576
s_cbranch_scc1 L_poll3
L_poll3_ok:
s_mov_b32 m0,110592
s_add_u32 s42,s50,0
buffer_load_dwordx4 v16,s[28:31],s42 offen sc1 lds
buffer_load_dwordx4 v16,s[28:31],s42 offen offset:1024 sc1 lds
buffer_load_dwordx4 v16,s[28:31],s42 offen offset:2048 sc1 lds
buffer_load_dwordx4 v16,s[28:31],s42 offen offset:3072 sc1 lds
s_mov_b32 m0,114688
s_add_u32 s42,s50,262144
buffer_load_dwordx4 v16,s[28:31],s42 offen sc1 lds
buffer_load_dwordx4 v16,s[28:31],s42 offen offset:1024 sc1 lds
buffer_load_dwordx4 v16,s[28:31],s42 offen offset:2048 sc1 lds
buffer_load_dwordx4 v16,s[28:31],s42 offen offset:3072 sc1 lds
s_mov_b32 m0,118784
s_add_u32 s42,s50,524288
buffer_load_dwordx4 v16,s[28:31],s42 offen sc1 lds
buffer_load_dwordx4 v16,s[28:31],s42 offen offset:1024 sc1 lds
buffer_load_dwordx4 v16,s[28:31],s42 offen offset:2048 sc1 lds
buffer_load_dwordx4 v16,s[28:31],s42 offen offset:3072 sc1 lds
s_xor_b32 s50,s35,3
s_lshl_b32 s52,0x10101,s50
s_lshl_b32 s50,s50,12
s_add_u32 s50,s50,s48
s_mov_b32 s45,0
L_poll4:
s_and_b32 s41,s51,s52
s_cmp_eq_u32 s41,s52
s_cbranch_scc1 L_poll4_ok
buffer_load_dword v18,v17,s[28:31],s49 offen sc1
s_waitcnt vmcnt(0)
v_cmp_ne_u32 vcc,0,v18
s_add_u32 s45,s45,1
s_nop 0
s_mov_b32 s51,vcc_lo
s_cmp_lt_u32 s45,1048576
s_cbranch_scc1 L_poll4
L_poll4_ok:
s_mov_b32 m0,122880
s_add_u32 s42,s50,0
buffer_load_dwordx4 v16,s[28:31],s42 offen sc1 lds
buffer_load_dwordx4 v16,s[28:31],s42 offen offset:1024 sc1 lds
buffer_load_dwordx4 v16,s[28:31],s42 offen offset:2048 sc1 lds
buffer_load_dwordx4 v16,s[28:31],s42 offen offset:3072 sc1 lds
s_mov_b32 m0,126976
s_add_u32 s42,s50,262144
buffer_load_dwordx4 v16,s[28:31],s42 offen sc1 lds
buffer_load_dwordx4 v16,s[28:31],s42 offen offset:1024 sc1 lds
buffer_load_dwordx4 v16,s[28:31],s42 offen offset:2048 sc1 lds
buffer_load_dwordx4 v16,s[28:31],s42 offen offset:3072 sc1 lds
s_mov_b32 m0,131072
s_add_u32 s42,s50,524288
buffer_load_dwordx4 v16,s[28:31],s42 offen sc1 lds
buffer_load_dwordx4 v16,s[28:31],s42 offen offset:1024 sc1 lds
buffer_load_dwordx4 v16,s[28:31],s42 offen offset:2048 sc1 lds
buffer_load_dwordx4 v16,s[28:31],s42 offen offset:3072 sc1 lds
s_xor_b32 s50,s35,2
s_lshl_b32 s52,0x10101,s50
s_lshl_b32 s50,s50,12
s_add_u32 s50,s50,s48
s_mov_b32 s45,0
L_poll5:
s_and_b32 s41,s51,s52
s_cmp_eq_u32 s41,s52
s_cbranch_scc1 L_poll5_ok
buffer_load_dword v18,v17,s[28:31],s49 offen sc1
s_waitcnt vmcnt(0)
v_cmp_ne_u32 vcc,0,v18
s_add_u32 s45,s45,1
s_nop 0
s_mov_b32 s51,vcc_lo
s_cmp_lt_u32 s45,1048576
s_cbranch_scc1 L_poll5
L_poll5_ok:
s_mov_b32 m0,135168
s_add_u32 s42,s50,0
buffer_load_dwordx4 v16,s[28:31],s42 offen sc1 lds
buffer_load_dwordx4 v16,s[28:31],s42 offen offset:1024 sc1 lds
buffer_load_dwordx4 v16,s[28:31],s42 offen offset:2048 sc1 lds
s_waitcnt vmcnt(54)
buffer_load_dwordx4 v16,s[28:31],s42 offen offset:3072 sc1 lds
s_mov_b32 m0,139264
s_add_u32 s42,s50,262144
buffer_load_dwordx4 v16,s[28:31],s42 offen sc1 lds
buffer_load_dwordx4 v16,s[28:31],s42 offen offset:1024 sc1 lds
buffer_load_dwordx4 v16,s[28:31],s42 offen offset:2048 sc1 lds
buffer_load_dwordx4 v16,s[28:31],s42 offen offset:3072 sc1 lds
s_mov_b32 m0,143360
s_add_u32 s42,s50,524288
buffer_load_dwordx4 v16,s[28:31],s42 offen sc1 lds
buffer_load_dwordx4 v16,s[28:31],s42 offen offset:1024 sc1 lds
buffer_load_dwordx4 v16,s[28:31],s42 offen offset:2048 sc1 lds
buffer_load_dwordx4 v16,s[28:31],s42 offen offset:3072 sc1 lds
s_waitcnt vmcnt(0)
s_barrier
s_xor_b32 s50,s35,1
s_lshl_b32 s52,0x10101,s50
s_lshl_b32 s50,s50,12
s_add_u32 s50,s50,s48
s_mov_b32 s45,0
L_poll6:
s_and_b32 s41,s51,s52
s_cmp_eq_u32 s41,s52
s_cbranch_scc1 L_poll6_ok
buffer_load_dword v18,v17,s[28:31],s49 offen sc1
s_waitcnt vmcnt(0)
v_cmp_ne_u32 vcc,0,v18
s_add_u32 s45,s45,1
s_nop 0
s_mov_b32 s51,vcc_lo
s_cmp_lt_u32 s45,1048576
s_cbranch_scc1 L_poll6
L_poll6_ok:
s_mov_b32 m0,147456
s_add_u32 s42,s50,0
buffer_load_dwordx4 v16,s[28:31],s42 offen sc1 lds
buffer_load_dwordx4 v16,s[28:31],s42 offen offset:1024 sc1 lds
buffer_load_dwordx4 v16,s[28:31],s42 offen offset:2048 sc1 lds
buffer_load_dwordx4 v16,s[28:31],s42 offen offset:3072 sc1 lds
s_mov_b32 m0,151552
s_add_u32 s42,s50,262144
buffer_load_dwordx4 v16,s[28:31],s42 offen sc1 lds
buffer_load_dwordx4 v16,s[28:31],s42 offen offset:1024 sc1 lds
buffer_load_dwordx4 v16,s[28:31],s42 offen offset:2048 sc1 lds
buffer_load_dwordx4 v16,s[28:31],s42 offen offset:3072 sc1 lds
s_mov_b32 m0,155648
s_add_u32 s42,s50,524288
buffer_load_dwordx4 v16,s[28:31],s42 offen sc1 lds
buffer_load_dwordx4 v16,s[28:31],s42 offen offset:1024 sc1 lds
buffer_load_dwordx4 v16,s[28:31],s42 offen offset:2048 sc1 lds
buffer_load_dwordx4 v16,s[28:31],s42 offen offset:3072 sc1 lds
s_waitcnt vmcnt(0)
s_barrier
s_endpgm
.p2align 12
L_attn:
s_waitcnt lgkmcnt(0)
s_cmp_eq_u32 s33,0
s_cselect_b32 s24,s64,s74
s_cselect_b32 s25,s65,s75
s_cselect_b32 s16,s70,s80
s_cselect_b32 s17,s71,s81
s_cselect_b32 s8,s66,s76
s_cselect_b32 s9,s67,s77
s_cselect_b32 s12,s68,s78
s_cselect_b32 s13,s69,s79
s_cselect_b32 s20,s72,s82
s_cselect_b32 s21,s73,s83
s_mov_b32 s4,s84
s_mov_b32 s5,s85
s_mov_b32 s96,s86
s_mov_b32 s97,s87
s_mov_b32 s28,s88
s_mov_b32 s29,s89
s_and_b32 s25,s25,0xffff
s_mov_b32 s26,0x180000
s_mov_b32 s27,0x20000
s_and_b32 s17,s17,0xffff
s_mov_b32 s18,0x400000
s_mov_b32 s19,0x20000
s_and_b32 s9,s9,0xffff
s_mov_b32 s10,0x4000000
s_mov_b32 s11,0x20000
s_and_b32 s13,s13,0xffff
s_mov_b32 s14,0x4000000
s_mov_b32 s15,0x20000
s_and_b32 s21,s21,0xffff
s_mov_b32 s22,0x400000
s_mov_b32 s23,0x20000
s_and_b32 s5,s5,0xffff
s_mov_b32 s6,0x300000
s_mov_b32 s7,0x20000
s_and_b32 s97,s97,0xffff
s_mov_b32 s98,0x100
s_mov_b32 s99,0x20000
s_and_b32 s29,s29,0xffff
s_mov_b32 s30,0x1900000
s_mov_b32 s31,0x20000
s_getpc_b64 s[86:87]
L_pc:
s_sub_u32 s86,s86,L_pc-L_start
s_subb_u32 s87,s87,0
s_lshr_b32 s41,s2,3
s_mul_i32 s41,s41,3
s_add_u32 s41,s41,s32
s_lshl_b32 s41,s41,4
v_and_b32 v132,15,v0
v_add_u32 v132,s41,v132
v_lshlrev_b32 v132,7,v132
v_min_u32 v132,L_last-L_start,v132
global_load_dword v255,v132,s[86:87]
s_lshl_b32 s52,s33,4
s_add_u32 s52,s52,s34
s_mul_i32 s41,s52,3
s_add_u32 s41,s41,s32
s_lshl_b32 s44,s41,18
s_lshl_b32 s48,s41,10
s_add_u32 s48,s48,25165824
s_lshl_b32 s52,s52,2
s_lshl_b32 s42,s35,7
v_and_b32 v132,7,v0
v_lshl_add_u32 v25,v132,2,s42
v_lshlrev_b32 v2,26,v0
s_lshl_b32 s54,s32,5
s_add_u32 s54,s54,s34
s_cmp_eq_u32 s32,0
s_cbranch_scc0 L_noreset
v_mov_b32 v133,0
buffer_store_dword v133,v25,s[28:31],s48 offen sc1
buffer_store_dword v133,v25,s[28:31],s48 offen offset:1024 sc1
buffer_store_dword v133,v25,s[28:31],s48 offen offset:2048 sc1
L_noreset:
s_lshl_b32 s42,s35,2
s_add_u32 s56,s48,s42
s_xor_b32 s49,s35,7
s_lshl_b32 s42,s35,12
s_add_u32 s53,s44,s42
v_mov_b32 v160,0
v_mov_b32 v161,0
v_mov_b32 v162,0
v_mov_b32 v163,0
v_mov_b32 v164,0
v_mov_b32 v165,0
v_mov_b32 v166,0
v_mov_b32 v167,0
v_and_b32 v128,15,v0
v_lshrrev_b32 v129,4,v0
v_bfe_u32 v130,v0,2,2
v_and_b32 v131,3,v0
v_mfma_f32_32x32x16_bf16 a[0:15],v[160:163],v[160:163],0
v_lshrrev_b32 v132,1,v128
v_xor_b32 v132,v132,v129
v_lshlrev_b32 v132,4,v132
v_lshl_add_u32 v132,v128,7,v132
v_mfma_f32_32x32x16_bf16 a[16:31],v[160:163],v[160:163],0
s_lshl_b32 s41,s32,12
s_add_u32 s41,s41,114688
v_add_u32 v248,s41,v132
v_xor_b32 v249,64,v248
v_mfma_f32_32x32x16_bf16 a[32:47],v[160:163],v[160:163],0
v_lshlrev_b32 v132,4,v131
v_lshl_add_u32 v132,v130,6,v132
v_lshl_add_u32 v133,v129,3,v130
v_lshl_add_u32 v132,v133,8,v132
v_mfma_f32_32x32x16_bf16 a[48:63],v[160:163],v[160:163],0
v_add_u32 v132,49152,v132
v_xor_b32 v250,0,v132
v_xor_b32 v251,64,v132
v_xor_b32 v252,128,v132
v_mfma_f32_32x32x16_bf16 a[64:79],v[160:163],v[160:163],0
v_xor_b32 v253,192,v132
v_xor_b32 v132,v128,v129
v_lshlrev_b32 v132,4,v132
v_lshl_add_u32 v132,v128,8,v132
v_mfma_f32_32x32x16_bf16 a[80:95],v[160:163],v[160:163],0
v_xor_b32 v8,0,v132
v_xor_b32 v9,64,v132
v_xor_b32 v10,128,v132
v_xor_b32 v11,192,v132
v_mfma_f32_32x32x16_bf16 a[96:111],v[160:163],v[160:163],0
v_lshl_add_u32 v133,v129,2,v130
v_and_b32 v134,7,v133
v_lshlrev_b32 v132,3,v131
v_lshl_add_u32 v132,v134,5,v132
v_mfma_f32_32x32x16_bf16 a[112:127],v[160:163],v[160:163],0
v_lshl_add_u32 v132,v133,8,v132
v_add_u32 v132,32768,v132
v_xor_b32 v12,0,v132
v_xor_b32 v13,32,v132
v_mfma_f32_32x32x16_bf16 a[128:143],v[160:163],v[160:163],0
v_xor_b32 v14,64,v132
v_xor_b32 v15,96,v132
v_xor_b32 v16,128,v132
v_xor_b32 v17,160,v132
v_mfma_f32_32x32x16_bf16 a[144:159],v[160:163],v[160:163],0
v_xor_b32 v18,192,v132
v_xor_b32 v19,224,v132
v_lshlrev_b32 v21,4,v0
s_lshl_b32 s41,s32,13
v_mfma_f32_32x32x16_bf16 a[160:175],v[160:163],v[160:163],0
s_add_u32 s41,s41,131072
v_add_u32 v20,s41,v21
v_mov_b32 v28,0x3f803f80
v_mov_b32 v29,0x3f803f80
v_mfma_f32_32x32x16_bf16 a[176:191],v[160:163],v[160:163],0
v_mov_b32 v30,0x3f803f80
v_mov_b32 v31,0x3f803f80
v_and_b32 v132,1,v129
v_lshlrev_b32 v132,5,v132
v_mfma_f32_32x32x16_bf16 a[192:207],v[160:163],v[160:163],0
v_lshrrev_b32 v133,1,v129
v_lshl_add_u32 v132,v133,4,v132
v_lshl_add_u32 v3,v128,11,v132
s_mul_i32 s50,s34,96
v_mfma_f32_32x32x16_bf16 a[208:223],v[160:163],v[160:163],0
s_lshl_b32 s41,s32,5
s_add_u32 s50,s50,s41
s_lshl_b32 s50,s50,11
s_lshl_b32 s41,s33,10
v_mfma_f32_32x32x16_bf16 a[224:239],v[160:163],v[160:163],0
s_add_u32 s50,s50,s41
s_xor_b32 s41,s37,7
s_lshl_b32 s41,s41,7
s_add_u32 s50,s50,s41
v_mfma_f32_32x32x16_bf16 a[240:255],v[160:163],v[160:163],0
s_add_u32 s51,s50,32768
s_mov_b64 exec,0
s_cmp_eq_u32 s32,1
s_cbranch_scc1 L_chain1
s_cmp_eq_u32 s32,2
s_cbranch_scc1 L_chain2
s_branch L_chain0
L_chain_done:
s_mov_b64 exec,-1
s_barrier
ds_read_b128 v[208:211],v248
ds_read_b128 v[224:227],v248 offset:2048
ds_read_b128 v[216:219],v249
ds_read_b128 v[232:235],v249 offset:2048
ds_read_b64_tr_b16 v[32:33],v250
ds_read_b64_tr_b16 v[34:35],v250 offset:1024
ds_read_b64_tr_b16 v[36:37],v250 offset:8
ds_read_b64_tr_b16 v[38:39],v250 offset:1032
ds_read_b64_tr_b16 v[40:41],v251
ds_read_b64_tr_b16 v[42:43],v251 offset:1024
ds_read_b64_tr_b16 v[44:45],v251 offset:8
ds_read_b64_tr_b16 v[46:47],v251 offset:1032
s_waitcnt lgkmcnt(4)
v_mfma_f32_16x16x32_bf16 v[64:67],v[32:35],v[208:211],0
ds_read_b64_tr_b16 v[48:49],v252
ds_read_b64_tr_b16 v[50:51],v252 offset:1024
v_mfma_f32_16x16x32_bf16 v[72:75],v[32:35],v[224:227],0
v_mfma_f32_16x16x32_bf16 v[76:79],v[36:39],v[224:227],0
ds_read_b64_tr_b16 v[52:53],v252 offset:8
ds_read_b64_tr_b16 v[54:55],v252 offset:1032
v_mfma_f32_16x16x32_bf16 v[68:71],v[36:39],v[208:211],0
s_waitcnt lgkmcnt(4)
v_mfma_f32_16x16x32_bf16 v[80:83],v[40:43],v[208:211],0
ds_read_b64_tr_b16 v[56:57],v253
ds_read_b64_tr_b16 v[58:59],v253 offset:1024
v_mfma_f32_16x16x32_bf16 v[88:91],v[40:43],v[224:227],0
v_mfma_f32_16x16x32_bf16 v[92:95],v[44:47],v[224:227],0
ds_read_b64_tr_b16 v[60:61],v253 offset:8
ds_read_b64_tr_b16 v[62:63],v253 offset:1032
v_mfma_f32_16x16x32_bf16 v[84:87],v[44:47],v[208:211],0
s_waitcnt lgkmcnt(4)
v_mfma_f32_16x16x32_bf16 v[96:99],v[48:51],v[208:211],0
ds_read_b64_tr_b16 v[32:33],v250 offset:8192
ds_read_b64_tr_b16 v[34:35],v250 offset:9216
v_mfma_f32_16x16x32_bf16 v[104:107],v[48:51],v[224:227],0
v_mfma_f32_16x16x32_bf16 v[108:111],v[52:55],v[224:227],0
ds_read_b64_tr_b16 v[36:37],v250 offset:8200
ds_read_b64_tr_b16 v[38:39],v250 offset:9224
v_mfma_f32_16x16x32_bf16 v[100:103],v[52:55],v[208:211],0
s_waitcnt lgkmcnt(4)
v_mfma_f32_16x16x32_bf16 v[112:115],v[56:59],v[208:211],0
ds_read_b64_tr_b16 v[40:41],v251 offset:8192
ds_read_b64_tr_b16 v[42:43],v251 offset:9216
v_mfma_f32_16x16x32_bf16 v[120:123],v[56:59],v[224:227],0
v_mfma_f32_16x16x32_bf16 v[124:127],v[60:63],v[224:227],0
ds_read_b64_tr_b16 v[44:45],v251 offset:8200
ds_read_b64_tr_b16 v[46:47],v251 offset:9224
v_mfma_f32_16x16x32_bf16 v[116:119],v[60:63],v[208:211],0
s_waitcnt lgkmcnt(4)
v_mfma_f32_16x16x32_bf16 v[64:67],v[32:35],v[216:219],v[64:67]
ds_read_b64_tr_b16 v[48:49],v252 offset:8192
ds_read_b64_tr_b16 v[50:51],v252 offset:9216
v_mfma_f32_16x16x32_bf16 v[72:75],v[32:35],v[232:235],v[72:75]
v_mfma_f32_16x16x32_bf16 v[76:79],v[36:39],v[232:235],v[76:79]
ds_read_b64_tr_b16 v[52:53],v252 offset:8200
ds_read_b64_tr_b16 v[54:55],v252 offset:9224
v_mfma_f32_16x16x32_bf16 v[68:71],v[36:39],v[216:219],v[68:71]
s_waitcnt lgkmcnt(4)
v_mfma_f32_16x16x32_bf16 v[80:83],v[40:43],v[216:219],v[80:83]
ds_read_b64_tr_b16 v[56:57],v253 offset:8192
ds_read_b64_tr_b16 v[58:59],v253 offset:9216
v_mfma_f32_16x16x32_bf16 v[88:91],v[40:43],v[232:235],v[88:91]
v_mfma_f32_16x16x32_bf16 v[92:95],v[44:47],v[232:235],v[92:95]
ds_read_b64_tr_b16 v[60:61],v253 offset:8200
ds_read_b64_tr_b16 v[62:63],v253 offset:9224
v_mfma_f32_16x16x32_bf16 v[84:87],v[44:47],v[216:219],v[84:87]
s_waitcnt lgkmcnt(4)
v_mfma_f32_16x16x32_bf16 v[96:99],v[48:51],v[216:219],v[96:99]
v_mfma_f32_16x16x32_bf16 v[104:107],v[48:51],v[232:235],v[104:107]
v_mfma_f32_16x16x32_bf16 v[108:111],v[52:55],v[232:235],v[108:111]
v_mfma_f32_16x16x32_bf16 v[100:103],v[52:55],v[216:219],v[100:103]
s_waitcnt lgkmcnt(0)
v_mfma_f32_16x16x32_bf16 v[112:115],v[56:59],v[216:219],v[112:115]
v_mfma_f32_16x16x32_bf16 v[120:123],v[56:59],v[232:235],v[120:123]
v_mfma_f32_16x16x32_bf16 v[124:127],v[60:63],v[232:235],v[124:127]
v_mfma_f32_16x16x32_bf16 v[116:119],v[60:63],v[216:219],v[116:119]
s_barrier
ds_read_b128 v[208:211],v248 offset:12288
ds_read_b128 v[224:227],v248 offset:14336
ds_read_b128 v[216:219],v249 offset:12288
ds_read_b128 v[232:235],v249 offset:14336
ds_read_b64_tr_b16 v[32:33],v250 offset:16384
ds_read_b64_tr_b16 v[34:35],v250 offset:17408
ds_read_b64_tr_b16 v[36:37],v250 offset:16392
ds_read_b64_tr_b16 v[38:39],v250 offset:17416
ds_read_b64_tr_b16 v[40:41],v251 offset:16384
ds_read_b64_tr_b16 v[42:43],v251 offset:17408
ds_read_b64_tr_b16 v[44:45],v251 offset:16392
ds_read_b64_tr_b16 v[46:47],v251 offset:17416
s_waitcnt lgkmcnt(4)
v_mfma_f32_16x16x32_bf16 v[64:67],v[32:35],v[208:211],v[64:67]
ds_read_b64_tr_b16 v[48:49],v252 offset:16384
ds_read_b64_tr_b16 v[50:51],v252 offset:17408
v_mfma_f32_16x16x32_bf16 v[72:75],v[32:35],v[224:227],v[72:75]
v_mfma_f32_16x16x32_bf16 v[76:79],v[36:39],v[224:227],v[76:79]
ds_read_b64_tr_b16 v[52:53],v252 offset:16392
ds_read_b64_tr_b16 v[54:55],v252 offset:17416
v_mfma_f32_16x16x32_bf16 v[68:71],v[36:39],v[208:211],v[68:71]
s_waitcnt lgkmcnt(4)
v_mfma_f32_16x16x32_bf16 v[80:83],v[40:43],v[208:211],v[80:83]
ds_read_b64_tr_b16 v[56:57],v253 offset:16384
ds_read_b64_tr_b16 v[58:59],v253 offset:17408
v_mfma_f32_16x16x32_bf16 v[88:91],v[40:43],v[224:227],v[88:91]
v_mfma_f32_16x16x32_bf16 v[92:95],v[44:47],v[224:227],v[92:95]
ds_read_b64_tr_b16 v[60:61],v253 offset:16392
ds_read_b64_tr_b16 v[62:63],v253 offset:17416
v_mfma_f32_16x16x32_bf16 v[84:87],v[44:47],v[208:211],v[84:87]
s_waitcnt lgkmcnt(4)
v_mfma_f32_16x16x32_bf16 v[96:99],v[48:51],v[208:211],v[96:99]
ds_read_b64_tr_b16 v[32:33],v250 offset:24576
ds_read_b64_tr_b16 v[34:35],v250 offset:25600
v_mfma_f32_16x16x32_bf16 v[104:107],v[48:51],v[224:227],v[104:107]
v_mfma_f32_16x16x32_bf16 v[108:111],v[52:55],v[224:227],v[108:111]
ds_read_b64_tr_b16 v[36:37],v250 offset:24584
ds_read_b64_tr_b16 v[38:39],v250 offset:25608
v_mfma_f32_16x16x32_bf16 v[100:103],v[52:55],v[208:211],v[100:103]
s_waitcnt lgkmcnt(4)
v_mfma_f32_16x16x32_bf16 v[112:115],v[56:59],v[208:211],v[112:115]
ds_read_b64_tr_b16 v[40:41],v251 offset:24576
ds_read_b64_tr_b16 v[42:43],v251 offset:25600
v_mfma_f32_16x16x32_bf16 v[120:123],v[56:59],v[224:227],v[120:123]
v_mfma_f32_16x16x32_bf16 v[124:127],v[60:63],v[224:227],v[124:127]
ds_read_b64_tr_b16 v[44:45],v251 offset:24584
ds_read_b64_tr_b16 v[46:47],v251 offset:25608
v_mfma_f32_16x16x32_bf16 v[116:119],v[60:63],v[208:211],v[116:119]
s_waitcnt lgkmcnt(4)
v_mfma_f32_16x16x32_bf16 v[64:67],v[32:35],v[216:219],v[64:67]
ds_read_b64_tr_b16 v[48:49],v252 offset:24576
ds_read_b64_tr_b16 v[50:51],v252 offset:25600
v_mfma_f32_16x16x32_bf16 v[72:75],v[32:35],v[232:235],v[72:75]
v_mfma_f32_16x16x32_bf16 v[76:79],v[36:39],v[232:235],v[76:79]
ds_read_b64_tr_b16 v[52:53],v252 offset:24584
ds_read_b64_tr_b16 v[54:55],v252 offset:25608
v_mfma_f32_16x16x32_bf16 v[68:71],v[36:39],v[216:219],v[68:71]
s_waitcnt lgkmcnt(4)
v_mfma_f32_16x16x32_bf16 v[80:83],v[40:43],v[216:219],v[80:83]
ds_read_b64_tr_b16 v[56:57],v253 offset:24576
ds_read_b64_tr_b16 v[58:59],v253 offset:25600
v_mfma_f32_16x16x32_bf16 v[88:91],v[40:43],v[232:235],v[88:91]
v_mfma_f32_16x16x32_bf16 v[92:95],v[44:47],v[232:235],v[92:95]
ds_read_b64_tr_b16 v[60:61],v253 offset:24584
ds_read_b64_tr_b16 v[62:63],v253 offset:25608
v_mfma_f32_16x16x32_bf16 v[84:87],v[44:47],v[216:219],v[84:87]
s_waitcnt lgkmcnt(4)
v_mfma_f32_16x16x32_bf16 v[96:99],v[48:51],v[216:219],v[96:99]
v_mfma_f32_16x16x32_bf16 v[104:107],v[48:51],v[232:235],v[104:107]
v_mfma_f32_16x16x32_bf16 v[108:111],v[52:55],v[232:235],v[108:111]
v_mfma_f32_16x16x32_bf16 v[100:103],v[52:55],v[216:219],v[100:103]
s_waitcnt lgkmcnt(0)
v_mfma_f32_16x16x32_bf16 v[112:115],v[56:59],v[216:219],v[112:115]
v_mfma_f32_16x16x32_bf16 v[120:123],v[56:59],v[232:235],v[120:123]
v_mfma_f32_16x16x32_bf16 v[124:127],v[60:63],v[232:235],v[124:127]
v_mfma_f32_16x16x32_bf16 v[116:119],v[60:63],v[216:219],v[116:119]
s_barrier
ds_read_b128 v[208:211],v248 offset:24576
ds_read_b128 v[224:227],v248 offset:26624
ds_read_b128 v[216:219],v249 offset:24576
ds_read_b128 v[232:235],v249 offset:26624
ds_read_b64_tr_b16 v[32:33],v250 offset:32768
ds_read_b64_tr_b16 v[34:35],v250 offset:33792
ds_read_b64_tr_b16 v[36:37],v250 offset:32776
ds_read_b64_tr_b16 v[38:39],v250 offset:33800
ds_read_b64_tr_b16 v[40:41],v251 offset:32768
ds_read_b64_tr_b16 v[42:43],v251 offset:33792
ds_read_b64_tr_b16 v[44:45],v251 offset:32776
ds_read_b64_tr_b16 v[46:47],v251 offset:33800
s_waitcnt lgkmcnt(4)
v_mfma_f32_16x16x32_bf16 v[64:67],v[32:35],v[208:211],v[64:67]
ds_read_b64_tr_b16 v[48:49],v252 offset:32768
ds_read_b64_tr_b16 v[50:51],v252 offset:33792
v_mfma_f32_16x16x32_bf16 v[72:75],v[32:35],v[224:227],v[72:75]
v_mfma_f32_16x16x32_bf16 v[76:79],v[36:39],v[224:227],v[76:79]
ds_read_b64_tr_b16 v[52:53],v252 offset:32776
ds_read_b64_tr_b16 v[54:55],v252 offset:33800
v_mfma_f32_16x16x32_bf16 v[68:71],v[36:39],v[208:211],v[68:71]
s_waitcnt lgkmcnt(4)
v_mfma_f32_16x16x32_bf16 v[80:83],v[40:43],v[208:211],v[80:83]
ds_read_b64_tr_b16 v[56:57],v253 offset:32768
ds_read_b64_tr_b16 v[58:59],v253 offset:33792
v_mfma_f32_16x16x32_bf16 v[88:91],v[40:43],v[224:227],v[88:91]
v_mfma_f32_16x16x32_bf16 v[92:95],v[44:47],v[224:227],v[92:95]
ds_read_b64_tr_b16 v[60:61],v253 offset:32776
ds_read_b64_tr_b16 v[62:63],v253 offset:33800
v_mfma_f32_16x16x32_bf16 v[84:87],v[44:47],v[208:211],v[84:87]
s_waitcnt lgkmcnt(4)
v_mfma_f32_16x16x32_bf16 v[96:99],v[48:51],v[208:211],v[96:99]
ds_read_b64_tr_b16 v[32:33],v250 offset:40960
ds_read_b64_tr_b16 v[34:35],v250 offset:41984
v_mfma_f32_16x16x32_bf16 v[104:107],v[48:51],v[224:227],v[104:107]
v_mfma_f32_16x16x32_bf16 v[108:111],v[52:55],v[224:227],v[108:111]
ds_read_b64_tr_b16 v[36:37],v250 offset:40968
ds_read_b64_tr_b16 v[38:39],v250 offset:41992
v_mfma_f32_16x16x32_bf16 v[100:103],v[52:55],v[208:211],v[100:103]
s_waitcnt lgkmcnt(4)
v_mfma_f32_16x16x32_bf16 v[112:115],v[56:59],v[208:211],v[112:115]
ds_read_b64_tr_b16 v[40:41],v251 offset:40960
ds_read_b64_tr_b16 v[42:43],v251 offset:41984
v_mfma_f32_16x16x32_bf16 v[120:123],v[56:59],v[224:227],v[120:123]
v_mfma_f32_16x16x32_bf16 v[124:127],v[60:63],v[224:227],v[124:127]
ds_read_b64_tr_b16 v[44:45],v251 offset:40968
ds_read_b64_tr_b16 v[46:47],v251 offset:41992
v_mfma_f32_16x16x32_bf16 v[116:119],v[60:63],v[208:211],v[116:119]
s_waitcnt lgkmcnt(4)
v_mfma_f32_16x16x32_bf16 v[64:67],v[32:35],v[216:219],v[64:67]
ds_read_b64_tr_b16 v[48:49],v252 offset:40960
ds_read_b64_tr_b16 v[50:51],v252 offset:41984
v_mfma_f32_16x16x32_bf16 v[72:75],v[32:35],v[232:235],v[72:75]
v_mfma_f32_16x16x32_bf16 v[76:79],v[36:39],v[232:235],v[76:79]
ds_read_b64_tr_b16 v[52:53],v252 offset:40968
ds_read_b64_tr_b16 v[54:55],v252 offset:41992
v_mfma_f32_16x16x32_bf16 v[68:71],v[36:39],v[216:219],v[68:71]
s_waitcnt lgkmcnt(4)
v_mfma_f32_16x16x32_bf16 v[80:83],v[40:43],v[216:219],v[80:83]
ds_read_b64_tr_b16 v[56:57],v253 offset:40960
ds_read_b64_tr_b16 v[58:59],v253 offset:41984
v_mfma_f32_16x16x32_bf16 v[88:91],v[40:43],v[232:235],v[88:91]
v_mfma_f32_16x16x32_bf16 v[92:95],v[44:47],v[232:235],v[92:95]
ds_read_b64_tr_b16 v[60:61],v253 offset:40968
ds_read_b64_tr_b16 v[62:63],v253 offset:41992
v_mfma_f32_16x16x32_bf16 v[84:87],v[44:47],v[216:219],v[84:87]
s_waitcnt lgkmcnt(4)
v_mfma_f32_16x16x32_bf16 v[96:99],v[48:51],v[216:219],v[96:99]
v_mfma_f32_16x16x32_bf16 v[104:107],v[48:51],v[232:235],v[104:107]
v_mfma_f32_16x16x32_bf16 v[108:111],v[52:55],v[232:235],v[108:111]
v_mfma_f32_16x16x32_bf16 v[100:103],v[52:55],v[216:219],v[100:103]
s_waitcnt lgkmcnt(0)
v_mfma_f32_16x16x32_bf16 v[112:115],v[56:59],v[216:219],v[112:115]
v_mfma_f32_16x16x32_bf16 v[120:123],v[56:59],v[232:235],v[120:123]
v_mfma_f32_16x16x32_bf16 v[124:127],v[60:63],v[232:235],v[124:127]
v_mfma_f32_16x16x32_bf16 v[116:119],v[60:63],v[216:219],v[116:119]
s_barrier
ds_read_b128 v[208:211],v248 offset:36864
ds_read_b128 v[224:227],v248 offset:38912
ds_read_b128 v[216:219],v249 offset:36864
ds_read_b128 v[232:235],v249 offset:38912
ds_read_b64_tr_b16 v[32:33],v250
ds_read_b64_tr_b16 v[34:35],v250 offset:1024
ds_read_b64_tr_b16 v[36:37],v250 offset:8
ds_read_b64_tr_b16 v[38:39],v250 offset:1032
ds_read_b64_tr_b16 v[40:41],v251
ds_read_b64_tr_b16 v[42:43],v251 offset:1024
ds_read_b64_tr_b16 v[44:45],v251 offset:8
ds_read_b64_tr_b16 v[46:47],v251 offset:1032
s_waitcnt lgkmcnt(4)
v_mfma_f32_16x16x32_bf16 v[64:67],v[32:35],v[208:211],v[64:67]
ds_read_b64_tr_b16 v[48:49],v252
ds_read_b64_tr_b16 v[50:51],v252 offset:1024
v_mfma_f32_16x16x32_bf16 v[72:75],v[32:35],v[224:227],v[72:75]
v_mfma_f32_16x16x32_bf16 v[76:79],v[36:39],v[224:227],v[76:79]
ds_read_b64_tr_b16 v[52:53],v252 offset:8
ds_read_b64_tr_b16 v[54:55],v252 offset:1032
v_mfma_f32_16x16x32_bf16 v[68:71],v[36:39],v[208:211],v[68:71]
s_waitcnt lgkmcnt(4)
v_mfma_f32_16x16x32_bf16 v[80:83],v[40:43],v[208:211],v[80:83]
ds_read_b64_tr_b16 v[56:57],v253
ds_read_b64_tr_b16 v[58:59],v253 offset:1024
v_mfma_f32_16x16x32_bf16 v[88:91],v[40:43],v[224:227],v[88:91]
v_mfma_f32_16x16x32_bf16 v[92:95],v[44:47],v[224:227],v[92:95]
ds_read_b64_tr_b16 v[60:61],v253 offset:8
ds_read_b64_tr_b16 v[62:63],v253 offset:1032
v_mfma_f32_16x16x32_bf16 v[84:87],v[44:47],v[208:211],v[84:87]
s_waitcnt lgkmcnt(4)
v_mfma_f32_16x16x32_bf16 v[96:99],v[48:51],v[208:211],v[96:99]
ds_read_b64_tr_b16 v[32:33],v250 offset:8192
ds_read_b64_tr_b16 v[34:35],v250 offset:9216
v_mfma_f32_16x16x32_bf16 v[104:107],v[48:51],v[224:227],v[104:107]
v_mfma_f32_16x16x32_bf16 v[108:111],v[52:55],v[224:227],v[108:111]
ds_read_b64_tr_b16 v[36:37],v250 offset:8200
ds_read_b64_tr_b16 v[38:39],v250 offset:9224
v_mfma_f32_16x16x32_bf16 v[100:103],v[52:55],v[208:211],v[100:103]
s_waitcnt lgkmcnt(4)
v_mfma_f32_16x16x32_bf16 v[112:115],v[56:59],v[208:211],v[112:115]
ds_read_b64_tr_b16 v[40:41],v251 offset:8192
ds_read_b64_tr_b16 v[42:43],v251 offset:9216
v_mfma_f32_16x16x32_bf16 v[120:123],v[56:59],v[224:227],v[120:123]
v_mfma_f32_16x16x32_bf16 v[124:127],v[60:63],v[224:227],v[124:127]
ds_read_b64_tr_b16 v[44:45],v251 offset:8200
ds_read_b64_tr_b16 v[46:47],v251 offset:9224
v_mfma_f32_16x16x32_bf16 v[116:119],v[60:63],v[208:211],v[116:119]
s_waitcnt lgkmcnt(4)
v_mfma_f32_16x16x32_bf16 v[64:67],v[32:35],v[216:219],v[64:67]
ds_read_b64_tr_b16 v[48:49],v252 offset:8192
ds_read_b64_tr_b16 v[50:51],v252 offset:9216
v_mfma_f32_16x16x32_bf16 v[72:75],v[32:35],v[232:235],v[72:75]
v_mfma_f32_16x16x32_bf16 v[76:79],v[36:39],v[232:235],v[76:79]
ds_read_b64_tr_b16 v[52:53],v252 offset:8200
ds_read_b64_tr_b16 v[54:55],v252 offset:9224
v_mfma_f32_16x16x32_bf16 v[68:71],v[36:39],v[216:219],v[68:71]
s_waitcnt lgkmcnt(4)
v_mfma_f32_16x16x32_bf16 v[80:83],v[40:43],v[216:219],v[80:83]
ds_read_b64_tr_b16 v[56:57],v253 offset:8192
ds_read_b64_tr_b16 v[58:59],v253 offset:9216
v_mfma_f32_16x16x32_bf16 v[88:91],v[40:43],v[232:235],v[88:91]
v_mfma_f32_16x16x32_bf16 v[92:95],v[44:47],v[232:235],v[92:95]
ds_read_b64_tr_b16 v[60:61],v253 offset:8200
ds_read_b64_tr_b16 v[62:63],v253 offset:9224
v_mfma_f32_16x16x32_bf16 v[84:87],v[44:47],v[216:219],v[84:87]
s_waitcnt lgkmcnt(4)
v_mfma_f32_16x16x32_bf16 v[96:99],v[48:51],v[216:219],v[96:99]
v_mfma_f32_16x16x32_bf16 v[104:107],v[48:51],v[232:235],v[104:107]
v_mfma_f32_16x16x32_bf16 v[108:111],v[52:55],v[232:235],v[108:111]
v_mfma_f32_16x16x32_bf16 v[100:103],v[52:55],v[216:219],v[100:103]
s_waitcnt lgkmcnt(0)
v_mfma_f32_16x16x32_bf16 v[112:115],v[56:59],v[216:219],v[112:115]
v_mfma_f32_16x16x32_bf16 v[120:123],v[56:59],v[232:235],v[120:123]
v_mfma_f32_16x16x32_bf16 v[124:127],v[60:63],v[232:235],v[124:127]
v_mfma_f32_16x16x32_bf16 v[116:119],v[60:63],v[216:219],v[116:119]
s_barrier
ds_read_b128 v[208:211],v248
ds_read_b128 v[224:227],v248 offset:2048
ds_read_b128 v[216:219],v249
ds_read_b128 v[232:235],v249 offset:2048
ds_read_b64_tr_b16 v[32:33],v250 offset:16384
ds_read_b64_tr_b16 v[34:35],v250 offset:17408
ds_read_b64_tr_b16 v[36:37],v250 offset:16392
ds_read_b64_tr_b16 v[38:39],v250 offset:17416
ds_read_b64_tr_b16 v[40:41],v251 offset:16384
ds_read_b64_tr_b16 v[42:43],v251 offset:17408
ds_read_b64_tr_b16 v[44:45],v251 offset:16392
ds_read_b64_tr_b16 v[46:47],v251 offset:17416
s_waitcnt lgkmcnt(4)
v_mfma_f32_16x16x32_bf16 v[64:67],v[32:35],v[208:211],v[64:67]
ds_read_b64_tr_b16 v[48:49],v252 offset:16384
ds_read_b64_tr_b16 v[50:51],v252 offset:17408
v_mfma_f32_16x16x32_bf16 v[72:75],v[32:35],v[224:227],v[72:75]
v_mfma_f32_16x16x32_bf16 v[76:79],v[36:39],v[224:227],v[76:79]
ds_read_b64_tr_b16 v[52:53],v252 offset:16392
ds_read_b64_tr_b16 v[54:55],v252 offset:17416
v_mfma_f32_16x16x32_bf16 v[68:71],v[36:39],v[208:211],v[68:71]
s_waitcnt lgkmcnt(4)
v_mfma_f32_16x16x32_bf16 v[80:83],v[40:43],v[208:211],v[80:83]
ds_read_b64_tr_b16 v[56:57],v253 offset:16384
ds_read_b64_tr_b16 v[58:59],v253 offset:17408
v_mfma_f32_16x16x32_bf16 v[88:91],v[40:43],v[224:227],v[88:91]
v_mfma_f32_16x16x32_bf16 v[92:95],v[44:47],v[224:227],v[92:95]
ds_read_b64_tr_b16 v[60:61],v253 offset:16392
ds_read_b64_tr_b16 v[62:63],v253 offset:17416
v_mfma_f32_16x16x32_bf16 v[84:87],v[44:47],v[208:211],v[84:87]
s_waitcnt lgkmcnt(4)
v_mfma_f32_16x16x32_bf16 v[96:99],v[48:51],v[208:211],v[96:99]
ds_read_b64_tr_b16 v[32:33],v250 offset:24576
ds_read_b64_tr_b16 v[34:35],v250 offset:25600
v_mfma_f32_16x16x32_bf16 v[104:107],v[48:51],v[224:227],v[104:107]
v_mfma_f32_16x16x32_bf16 v[108:111],v[52:55],v[224:227],v[108:111]
ds_read_b64_tr_b16 v[36:37],v250 offset:24584
ds_read_b64_tr_b16 v[38:39],v250 offset:25608
v_mfma_f32_16x16x32_bf16 v[100:103],v[52:55],v[208:211],v[100:103]
s_waitcnt lgkmcnt(4)
v_mfma_f32_16x16x32_bf16 v[112:115],v[56:59],v[208:211],v[112:115]
ds_read_b64_tr_b16 v[40:41],v251 offset:24576
ds_read_b64_tr_b16 v[42:43],v251 offset:25600
v_mfma_f32_16x16x32_bf16 v[120:123],v[56:59],v[224:227],v[120:123]
v_mfma_f32_16x16x32_bf16 v[124:127],v[60:63],v[224:227],v[124:127]
ds_read_b64_tr_b16 v[44:45],v251 offset:24584
ds_read_b64_tr_b16 v[46:47],v251 offset:25608
v_mfma_f32_16x16x32_bf16 v[116:119],v[60:63],v[208:211],v[116:119]
s_waitcnt lgkmcnt(4)
v_mfma_f32_16x16x32_bf16 v[64:67],v[32:35],v[216:219],v[64:67]
ds_read_b64_tr_b16 v[48:49],v252 offset:24576
ds_read_b64_tr_b16 v[50:51],v252 offset:25600
v_mfma_f32_16x16x32_bf16 v[72:75],v[32:35],v[232:235],v[72:75]
v_mfma_f32_16x16x32_bf16 v[76:79],v[36:39],v[232:235],v[76:79]
ds_read_b64_tr_b16 v[52:53],v252 offset:24584
ds_read_b64_tr_b16 v[54:55],v252 offset:25608
v_mfma_f32_16x16x32_bf16 v[68:71],v[36:39],v[216:219],v[68:71]
s_waitcnt lgkmcnt(4)
v_mfma_f32_16x16x32_bf16 v[80:83],v[40:43],v[216:219],v[80:83]
ds_read_b64_tr_b16 v[56:57],v253 offset:24576
ds_read_b64_tr_b16 v[58:59],v253 offset:25600
v_mfma_f32_16x16x32_bf16 v[88:91],v[40:43],v[232:235],v[88:91]
v_mfma_f32_16x16x32_bf16 v[92:95],v[44:47],v[232:235],v[92:95]
ds_read_b64_tr_b16 v[60:61],v253 offset:24584
ds_read_b64_tr_b16 v[62:63],v253 offset:25608
v_mfma_f32_16x16x32_bf16 v[84:87],v[44:47],v[216:219],v[84:87]
s_waitcnt lgkmcnt(4)
v_mfma_f32_16x16x32_bf16 v[96:99],v[48:51],v[216:219],v[96:99]
v_mfma_f32_16x16x32_bf16 v[104:107],v[48:51],v[232:235],v[104:107]
v_mfma_f32_16x16x32_bf16 v[108:111],v[52:55],v[232:235],v[108:111]
v_mfma_f32_16x16x32_bf16 v[100:103],v[52:55],v[216:219],v[100:103]
s_waitcnt lgkmcnt(0)
v_mfma_f32_16x16x32_bf16 v[112:115],v[56:59],v[216:219],v[112:115]
v_mfma_f32_16x16x32_bf16 v[120:123],v[56:59],v[232:235],v[120:123]
v_mfma_f32_16x16x32_bf16 v[124:127],v[60:63],v[232:235],v[124:127]
v_mfma_f32_16x16x32_bf16 v[116:119],v[60:63],v[216:219],v[116:119]
s_barrier
ds_read_b128 v[208:211],v248 offset:12288
ds_read_b128 v[224:227],v248 offset:14336
ds_read_b128 v[216:219],v249 offset:12288
ds_read_b128 v[232:235],v249 offset:14336
ds_read_b64_tr_b16 v[32:33],v250 offset:32768
ds_read_b64_tr_b16 v[34:35],v250 offset:33792
ds_read_b64_tr_b16 v[36:37],v250 offset:32776
ds_read_b64_tr_b16 v[38:39],v250 offset:33800
ds_read_b64_tr_b16 v[40:41],v251 offset:32768
ds_read_b64_tr_b16 v[42:43],v251 offset:33792
ds_read_b64_tr_b16 v[44:45],v251 offset:32776
ds_read_b64_tr_b16 v[46:47],v251 offset:33800
s_waitcnt lgkmcnt(4)
v_mfma_f32_16x16x32_bf16 v[64:67],v[32:35],v[208:211],v[64:67]
ds_read_b64_tr_b16 v[48:49],v252 offset:32768
ds_read_b64_tr_b16 v[50:51],v252 offset:33792
v_mfma_f32_16x16x32_bf16 v[72:75],v[32:35],v[224:227],v[72:75]
v_mfma_f32_16x16x32_bf16 v[76:79],v[36:39],v[224:227],v[76:79]
ds_read_b64_tr_b16 v[52:53],v252 offset:32776
ds_read_b64_tr_b16 v[54:55],v252 offset:33800
v_mfma_f32_16x16x32_bf16 v[68:71],v[36:39],v[208:211],v[68:71]
s_waitcnt lgkmcnt(4)
v_mfma_f32_16x16x32_bf16 v[80:83],v[40:43],v[208:211],v[80:83]
ds_read_b64_tr_b16 v[56:57],v253 offset:32768
L_chain0:
L_tp_a1:
s_cbranch_execz L_tp_q2
ds_read_b64_tr_b16 v[58:59],v253 offset:33792
v_mfma_f32_16x16x32_bf16 v[88:91],v[40:43],v[224:227],v[88:91]
v_mfma_f32_16x16x32_bf16 v[92:95],v[44:47],v[224:227],v[92:95]
ds_read_b64_tr_b16 v[60:61],v253 offset:32776
ds_read_b64_tr_b16 v[62:63],v253 offset:33800
v_mfma_f32_16x16x32_bf16 v[84:87],v[44:47],v[208:211],v[84:87]
s_waitcnt lgkmcnt(4)
v_mfma_f32_16x16x32_bf16 v[96:99],v[48:51],v[208:211],v[96:99]
ds_read_b64_tr_b16 v[32:33],v250 offset:40960
ds_read_b64_tr_b16 v[34:35],v250 offset:41984
v_mfma_f32_16x16x32_bf16 v[104:107],v[48:51],v[224:227],v[104:107]
v_mfma_f32_16x16x32_bf16 v[108:111],v[52:55],v[224:227],v[108:111]
ds_read_b64_tr_b16 v[36:37],v250 offset:40968
ds_read_b64_tr_b16 v[38:39],v250 offset:41992
v_mfma_f32_16x16x32_bf16 v[100:103],v[52:55],v[208:211],v[100:103]
s_waitcnt lgkmcnt(4)
v_mfma_f32_16x16x32_bf16 v[112:115],v[56:59],v[208:211],v[112:115]
ds_read_b64_tr_b16 v[40:41],v251 offset:40960
ds_read_b64_tr_b16 v[42:43],v251 offset:41984
v_mfma_f32_16x16x32_bf16 v[120:123],v[56:59],v[224:227],v[120:123]
v_mfma_f32_16x16x32_bf16 v[124:127],v[60:63],v[224:227],v[124:127]
ds_read_b64_tr_b16 v[44:45],v251 offset:40968
ds_read_b64_tr_b16 v[46:47],v251 offset:41992
v_mfma_f32_16x16x32_bf16 v[116:119],v[60:63],v[208:211],v[116:119]
s_waitcnt lgkmcnt(4)
v_mfma_f32_16x16x32_bf16 v[64:67],v[32:35],v[216:219],v[64:67]
ds_read_b64_tr_b16 v[48:49],v252 offset:40960
ds_read_b64_tr_b16 v[50:51],v252 offset:41984
v_mfma_f32_16x16x32_bf16 v[72:75],v[32:35],v[232:235],v[72:75]
v_mfma_f32_16x16x32_bf16 v[76:79],v[36:39],v[232:235],v[76:79]
ds_read_b64_tr_b16 v[52:53],v252 offset:40968
ds_read_b64_tr_b16 v[54:55],v252 offset:41992
v_mfma_f32_16x16x32_bf16 v[68:71],v[36:39],v[216:219],v[68:71]
s_waitcnt lgkmcnt(4)
v_mfma_f32_16x16x32_bf16 v[80:83],v[40:43],v[216:219],v[80:83]
ds_read_b64_tr_b16 v[56:57],v253 offset:40960
ds_read_b64_tr_b16 v[58:59],v253 offset:41984
v_mfma_f32_16x16x32_bf16 v[88:91],v[40:43],v[232:235],v[88:91]
v_mfma_f32_16x16x32_bf16 v[92:95],v[44:47],v[232:235],v[92:95]
ds_read_b64_tr_b16 v[60:61],v253 offset:40968
ds_read_b64_tr_b16 v[62:63],v253 offset:41992
v_mfma_f32_16x16x32_bf16 v[84:87],v[44:47],v[216:219],v[84:87]
s_waitcnt lgkmcnt(4)
v_mfma_f32_16x16x32_bf16 v[96:99],v[48:51],v[216:219],v[96:99]
v_mfma_f32_16x16x32_bf16 v[104:107],v[48:51],v[232:235],v[104:107]
v_mfma_f32_16x16x32_bf16 v[108:111],v[52:55],v[232:235],v[108:111]
v_mfma_f32_16x16x32_bf16 v[100:103],v[52:55],v[216:219],v[100:103]
s_waitcnt lgkmcnt(0)
v_mfma_f32_16x16x32_bf16 v[112:115],v[56:59],v[216:219],v[112:115]
v_mfma_f32_16x16x32_bf16 v[120:123],v[56:59],v[232:235],v[120:123]
v_mfma_f32_16x16x32_bf16 v[124:127],v[60:63],v[232:235],v[124:127]
v_mfma_f32_16x16x32_bf16 v[116:119],v[60:63],v[216:219],v[116:119]
s_barrier
ds_read_b128 v[208:211],v248 offset:24576
ds_read_b128 v[224:227],v248 offset:26624
ds_read_b128 v[216:219],v249 offset:24576
ds_read_b128 v[232:235],v249 offset:26624
ds_read_b64_tr_b16 v[32:33],v250
ds_read_b64_tr_b16 v[34:35],v250 offset:1024
ds_read_b64_tr_b16 v[36:37],v250 offset:8
ds_read_b64_tr_b16 v[38:39],v250 offset:1032
ds_read_b64_tr_b16 v[40:41],v251
ds_read_b64_tr_b16 v[42:43],v251 offset:1024
ds_read_b64_tr_b16 v[44:45],v251 offset:8
ds_read_b64_tr_b16 v[46:47],v251 offset:1032
s_waitcnt lgkmcnt(4)
v_mfma_f32_16x16x32_bf16 v[64:67],v[32:35],v[208:211],v[64:67]
ds_read_b64_tr_b16 v[48:49],v252
ds_read_b64_tr_b16 v[50:51],v252 offset:1024
v_mfma_f32_16x16x32_bf16 v[72:75],v[32:35],v[224:227],v[72:75]
v_mfma_f32_16x16x32_bf16 v[76:79],v[36:39],v[224:227],v[76:79]
ds_read_b64_tr_b16 v[52:53],v252 offset:8
ds_read_b64_tr_b16 v[54:55],v252 offset:1032
v_mfma_f32_16x16x32_bf16 v[68:71],v[36:39],v[208:211],v[68:71]
s_waitcnt lgkmcnt(4)
v_mfma_f32_16x16x32_bf16 v[80:83],v[40:43],v[208:211],v[80:83]
ds_read_b64_tr_b16 v[56:57],v253
ds_read_b64_tr_b16 v[58:59],v253 offset:1024
v_mfma_f32_16x16x32_bf16 v[88:91],v[40:43],v[224:227],v[88:91]
v_mfma_f32_16x16x32_bf16 v[92:95],v[44:47],v[224:227],v[92:95]
ds_read_b64_tr_b16 v[60:61],v253 offset:8
ds_read_b64_tr_b16 v[62:63],v253 offset:1032
v_mfma_f32_16x16x32_bf16 v[84:87],v[44:47],v[208:211],v[84:87]
s_waitcnt lgkmcnt(4)
v_mfma_f32_16x16x32_bf16 v[96:99],v[48:51],v[208:211],v[96:99]
ds_read_b64_tr_b16 v[32:33],v250 offset:8192
ds_read_b64_tr_b16 v[34:35],v250 offset:9216
v_mfma_f32_16x16x32_bf16 v[104:107],v[48:51],v[224:227],v[104:107]
v_mfma_f32_16x16x32_bf16 v[108:111],v[52:55],v[224:227],v[108:111]
ds_read_b64_tr_b16 v[36:37],v250 offset:8200
ds_read_b64_tr_b16 v[38:39],v250 offset:9224
v_mfma_f32_16x16x32_bf16 v[100:103],v[52:55],v[208:211],v[100:103]
s_waitcnt lgkmcnt(4)
v_mfma_f32_16x16x32_bf16 v[112:115],v[56:59],v[208:211],v[112:115]
ds_read_b64_tr_b16 v[40:41],v251 offset:8192
ds_read_b64_tr_b16 v[42:43],v251 offset:9216
v_mfma_f32_16x16x32_bf16 v[120:123],v[56:59],v[224:227],v[120:123]
v_mfma_f32_16x16x32_bf16 v[124:127],v[60:63],v[224:227],v[124:127]
ds_read_b64_tr_b16 v[44:45],v251 offset:8200
ds_read_b64_tr_b16 v[46:47],v251 offset:9224
v_mfma_f32_16x16x32_bf16 v[116:119],v[60:63],v[208:211],v[116:119]
s_waitcnt lgkmcnt(4)
v_mfma_f32_16x16x32_bf16 v[64:67],v[32:35],v[216:219],v[64:67]
ds_read_b64_tr_b16 v[48:49],v252 offset:8192
ds_read_b64_tr_b16 v[50:51],v252 offset:9216
v_mfma_f32_16x16x32_bf16 v[72:75],v[32:35],v[232:235],v[72:75]
v_mfma_f32_16x16x32_bf16 v[76:79],v[36:39],v[232:235],v[76:79]
ds_read_b64_tr_b16 v[52:53],v252 offset:8200
ds_read_b64_tr_b16 v[54:55],v252 offset:9224
v_mfma_f32_16x16x32_bf16 v[68:71],v[36:39],v[216:219],v[68:71]
s_waitcnt lgkmcnt(4)
v_mfma_f32_16x16x32_bf16 v[80:83],v[40:43],v[216:219],v[80:83]
ds_read_b64_tr_b16 v[56:57],v253 offset:8192
ds_read_b64_tr_b16 v[58:59],v253 offset:9216
v_mfma_f32_16x16x32_bf16 v[88:91],v[40:43],v[232:235],v[88:91]
v_mfma_f32_16x16x32_bf16 v[92:95],v[44:47],v[232:235],v[92:95]
ds_read_b64_tr_b16 v[60:61],v253 offset:8200
ds_read_b64_tr_b16 v[62:63],v253 offset:9224
v_mfma_f32_16x16x32_bf16 v[84:87],v[44:47],v[216:219],v[84:87]
s_waitcnt lgkmcnt(4)
v_mfma_f32_16x16x32_bf16 v[96:99],v[48:51],v[216:219],v[96:99]
v_mfma_f32_16x16x32_bf16 v[104:107],v[48:51],v[232:235],v[104:107]
v_mfma_f32_16x16x32_bf16 v[108:111],v[52:55],v[232:235],v[108:111]
v_mfma_f32_16x16x32_bf16 v[100:103],v[52:55],v[216:219],v[100:103]
s_waitcnt lgkmcnt(0)
v_mfma_f32_16x16x32_bf16 v[112:115],v[56:59],v[216:219],v[112:115]
v_mfma_f32_16x16x32_bf16 v[120:123],v[56:59],v[232:235],v[120:123]
v_mfma_f32_16x16x32_bf16 v[124:127],v[60:63],v[232:235],v[124:127]
v_mfma_f32_16x16x32_bf16 v[116:119],v[60:63],v[216:219],v[116:119]
s_barrier
ds_read_b128 v[208:211],v248 offset:36864
ds_read_b128 v[224:227],v248 offset:38912
ds_read_b128 v[216:219],v249 offset:36864
ds_read_b128 v[232:235],v249 offset:38912
ds_read_b64_tr_b16 v[32:33],v250 offset:16384
ds_read_b64_tr_b16 v[34:35],v250 offset:17408
ds_read_b64_tr_b16 v[36:37],v250 offset:16392
ds_read_b64_tr_b16 v[38:39],v250 offset:17416
ds_read_b64_tr_b16 v[40:41],v251 offset:16384
ds_read_b64_tr_b16 v[42:43],v251 offset:17408
ds_read_b64_tr_b16 v[44:45],v251 offset:16392
ds_read_b64_tr_b16 v[46:47],v251 offset:17416
s_waitcnt lgkmcnt(4)
v_mfma_f32_16x16x32_bf16 v[64:67],v[32:35],v[208:211],v[64:67]
ds_read_b64_tr_b16 v[48:49],v252 offset:16384
ds_read_b64_tr_b16 v[50:51],v252 offset:17408
v_mfma_f32_16x16x32_bf16 v[72:75],v[32:35],v[224:227],v[72:75]
v_mfma_f32_16x16x32_bf16 v[76:79],v[36:39],v[224:227],v[76:79]
ds_read_b64_tr_b16 v[52:53],v252 offset:16392
ds_read_b64_tr_b16 v[54:55],v252 offset:17416
v_mfma_f32_16x16x32_bf16 v[68:71],v[36:39],v[208:211],v[68:71]
s_waitcnt lgkmcnt(4)
v_mfma_f32_16x16x32_bf16 v[80:83],v[40:43],v[208:211],v[80:83]
ds_read_b64_tr_b16 v[56:57],v253 offset:16384
ds_read_b64_tr_b16 v[58:59],v253 offset:17408
v_mfma_f32_16x16x32_bf16 v[88:91],v[40:43],v[224:227],v[88:91]
v_mfma_f32_16x16x32_bf16 v[92:95],v[44:47],v[224:227],v[92:95]
ds_read_b64_tr_b16 v[60:61],v253 offset:16392
ds_read_b64_tr_b16 v[62:63],v253 offset:17416
v_mfma_f32_16x16x32_bf16 v[84:87],v[44:47],v[208:211],v[84:87]
s_waitcnt lgkmcnt(4)
v_mfma_f32_16x16x32_bf16 v[96:99],v[48:51],v[208:211],v[96:99]
ds_read_b64_tr_b16 v[32:33],v250 offset:24576
ds_read_b64_tr_b16 v[34:35],v250 offset:25600
v_mfma_f32_16x16x32_bf16 v[104:107],v[48:51],v[224:227],v[104:107]
v_mfma_f32_16x16x32_bf16 v[108:111],v[52:55],v[224:227],v[108:111]
ds_read_b64_tr_b16 v[36:37],v250 offset:24584
ds_read_b64_tr_b16 v[38:39],v250 offset:25608
v_mfma_f32_16x16x32_bf16 v[100:103],v[52:55],v[208:211],v[100:103]
s_waitcnt lgkmcnt(4)
v_mfma_f32_16x16x32_bf16 v[112:115],v[56:59],v[208:211],v[112:115]
ds_read_b64_tr_b16 v[40:41],v251 offset:24576
ds_read_b64_tr_b16 v[42:43],v251 offset:25600
v_mfma_f32_16x16x32_bf16 v[120:123],v[56:59],v[224:227],v[120:123]
v_mfma_f32_16x16x32_bf16 v[124:127],v[60:63],v[224:227],v[124:127]
ds_read_b64_tr_b16 v[44:45],v251 offset:24584
ds_read_b64_tr_b16 v[46:47],v251 offset:25608
v_mfma_f32_16x16x32_bf16 v[116:119],v[60:63],v[208:211],v[116:119]
s_waitcnt lgkmcnt(4)
v_mfma_f32_16x16x32_bf16 v[64:67],v[32:35],v[216:219],v[64:67]
ds_read_b64_tr_b16 v[48:49],v252 offset:24576
ds_read_b64_tr_b16 v[50:51],v252 offset:25600
v_mfma_f32_16x16x32_bf16 v[72:75],v[32:35],v[232:235],v[72:75]
v_mfma_f32_16x16x32_bf16 v[76:79],v[36:39],v[232:235],v[76:79]
ds_read_b64_tr_b16 v[52:53],v252 offset:24584
ds_read_b64_tr_b16 v[54:55],v252 offset:25608
v_mfma_f32_16x16x32_bf16 v[68:71],v[36:39],v[216:219],v[68:71]
s_waitcnt lgkmcnt(4)
v_mfma_f32_16x16x32_bf16 v[80:83],v[40:43],v[216:219],v[80:83]
ds_read_b64_tr_b16 v[56:57],v253 offset:24576
ds_read_b64_tr_b16 v[58:59],v253 offset:25600
v_mfma_f32_16x16x32_bf16 v[88:91],v[40:43],v[232:235],v[88:91]
v_mul_f32 v64,s39,v64
v_mul_f32 v65,s39,v65
v_mul_f32 v66,s39,v66
v_mul_f32 v67,s39,v67
v_mul_f32 v68,s39,v68
v_mul_f32 v69,s39,v69
v_mfma_f32_16x16x32_bf16 v[92:95],v[44:47],v[232:235],v[92:95]
ds_read_b64_tr_b16 v[60:61],v253 offset:24584
ds_read_b64_tr_b16 v[62:63],v253 offset:25608
v_mul_f32 v70,s39,v70
v_mfma_f32_16x16x32_bf16 v[84:87],v[44:47],v[216:219],v[84:87]
v_mul_f32 v71,s39,v71
v_cvt_pk_bf16_f32 v176,v64,v65
v_cvt_pk_bf16_f32 v177,v66,v67
v_cvt_pk_bf16_f32 v178,v68,v69
v_cvt_pk_bf16_f32 v179,v70,v71
v_mul_f32 v72,s39,v72
s_waitcnt lgkmcnt(4)
v_mfma_f32_16x16x32_bf16 v[96:99],v[48:51],v[216:219],v[96:99]
v_mul_f32 v73,s39,v73
v_mul_f32 v74,s39,v74
v_mul_f32 v75,s39,v75
v_mul_f32 v76,s39,v76
v_mul_f32 v77,s39,v77
v_mfma_f32_16x16x32_bf16 v[104:107],v[48:51],v[232:235],v[104:107]
v_mul_f32 v78,s39,v78
v_mul_f32 v79,s39,v79
v_cvt_pk_bf16_f32 v192,v72,v73
v_cvt_pk_bf16_f32 v193,v74,v75
v_cvt_pk_bf16_f32 v194,v76,v77
v_cvt_pk_bf16_f32 v195,v78,v79
v_mfma_f32_16x16x32_bf16 v[108:111],v[52:55],v[232:235],v[108:111]
v_mul_f32 v80,s39,v80
v_mul_f32 v81,s39,v81
v_mul_f32 v82,s39,v82
v_mul_f32 v83,s39,v83
v_mfma_f32_16x16x32_bf16 v[100:103],v[52:55],v[216:219],v[100:103]
v_mul_f32 v84,s39,v84
v_mul_f32 v85,s39,v85
v_mul_f32 v86,s39,v86
v_mul_f32 v87,s39,v87
s_waitcnt lgkmcnt(0)
v_mfma_f32_16x16x32_bf16 v[112:115],v[56:59],v[216:219],v[112:115]
v_cvt_pk_bf16_f32 v180,v80,v81
v_cvt_pk_bf16_f32 v181,v82,v83
v_cvt_pk_bf16_f32 v182,v84,v85
v_cvt_pk_bf16_f32 v183,v86,v87
v_mfma_f32_16x16x32_bf16 v[120:123],v[56:59],v[232:235],v[120:123]
v_mul_f32 v88,s39,v88
v_mul_f32 v89,s39,v89
v_mul_f32 v90,s39,v90
v_mul_f32 v91,s39,v91
v_mfma_f32_16x16x32_bf16 v[124:127],v[60:63],v[232:235],v[124:127]
v_mul_f32 v92,s39,v92
v_mul_f32 v93,s39,v93
v_mul_f32 v94,s39,v94
v_mul_f32 v95,s39,v95
v_mfma_f32_16x16x32_bf16 v[116:119],v[60:63],v[216:219],v[116:119]
v_cvt_pk_bf16_f32 v196,v88,v89
v_cvt_pk_bf16_f32 v197,v90,v91
v_cvt_pk_bf16_f32 v198,v92,v93
v_cvt_pk_bf16_f32 v199,v94,v95
s_barrier
ds_read_b128 v[32:35],v8
ds_read_b128 v[36:39],v8 offset:4096
ds_read_b128 v[40:43],v9
ds_read_b128 v[44:47],v9 offset:4096
v_mul_f32 v96,s39,v96
v_mul_f32 v97,s39,v97
v_mul_f32 v98,s39,v98
v_mul_f32 v99,s39,v99
v_mul_f32 v100,s39,v100
v_mul_f32 v101,s39,v101
v_mul_f32 v102,s39,v102
v_mul_f32 v103,s39,v103
v_cvt_pk_bf16_f32 v184,v96,v97
v_cvt_pk_bf16_f32 v185,v98,v99
v_cvt_pk_bf16_f32 v186,v100,v101
v_cvt_pk_bf16_f32 v187,v102,v103
v_mul_f32 v104,s39,v104
v_mul_f32 v105,s39,v105
v_mul_f32 v106,s39,v106
v_mul_f32 v107,s39,v107
v_mul_f32 v108,s39,v108
v_mul_f32 v109,s39,v109
v_mul_f32 v110,s39,v110
v_mul_f32 v111,s39,v111
v_cvt_pk_bf16_f32 v200,v104,v105
v_cvt_pk_bf16_f32 v201,v106,v107
v_cvt_pk_bf16_f32 v202,v108,v109
v_cvt_pk_bf16_f32 v203,v110,v111
s_waitcnt lgkmcnt(2)
v_mfma_f32_16x16x32_bf16 v[128:131],v[32:35],v[176:179],0
ds_read_b128 v[48:51],v10
v_mul_f32 v112,s39,v112
v_mul_f32 v113,s39,v113
v_mfma_f32_16x16x32_bf16 v[136:139],v[32:35],v[192:195],0
v_mul_f32 v114,s39,v114
v_mul_f32 v115,s39,v115
v_mfma_f32_16x16x32_bf16 v[140:143],v[36:39],v[192:195],0
ds_read_b128 v[52:55],v10 offset:4096
v_mul_f32 v116,s39,v116
v_mul_f32 v117,s39,v117
v_mfma_f32_16x16x32_bf16 v[132:135],v[36:39],v[176:179],0
v_mul_f32 v118,s39,v118
v_mul_f32 v119,s39,v119
s_waitcnt lgkmcnt(2)
v_mfma_f32_16x16x32_bf16 v[128:131],v[40:43],v[180:183],v[128:131]
ds_read_b128 v[56:59],v11
v_cvt_pk_bf16_f32 v188,v112,v113
v_cvt_pk_bf16_f32 v189,v114,v115
v_mfma_f32_16x16x32_bf16 v[136:139],v[40:43],v[196:199],v[136:139]
v_cvt_pk_bf16_f32 v190,v116,v117
v_cvt_pk_bf16_f32 v191,v118,v119
v_mfma_f32_16x16x32_bf16 v[140:143],v[44:47],v[196:199],v[140:143]
ds_read_b128 v[60:63],v11 offset:4096
v_mul_f32 v120,s39,v120
v_mul_f32 v121,s39,v121
v_mfma_f32_16x16x32_bf16 v[132:135],v[44:47],v[180:183],v[132:135]
v_mul_f32 v122,s39,v122
v_mul_f32 v123,s39,v123
s_waitcnt lgkmcnt(2)
v_mfma_f32_16x16x32_bf16 v[128:131],v[48:51],v[184:187],v[128:131]
v_mul_f32 v124,s39,v124
v_mul_f32 v125,s39,v125
v_mul_f32 v126,s39,v126
v_mfma_f32_16x16x32_bf16 v[136:139],v[48:51],v[200:203],v[136:139]
v_mul_f32 v127,s39,v127
v_cvt_pk_bf16_f32 v204,v120,v121
v_mfma_f32_16x16x32_bf16 v[140:143],v[52:55],v[200:203],v[140:143]
v_cvt_pk_bf16_f32 v205,v122,v123
v_cvt_pk_bf16_f32 v206,v124,v125
v_cvt_pk_bf16_f32 v207,v126,v127
v_mfma_f32_16x16x32_bf16 v[132:135],v[52:55],v[184:187],v[132:135]
s_waitcnt lgkmcnt(0)
v_mfma_f32_16x16x32_bf16 v[128:131],v[56:59],v[188:191],v[128:131]
v_mfma_f32_16x16x32_bf16 v[136:139],v[56:59],v[204:207],v[136:139]
v_mfma_f32_16x16x32_bf16 v[140:143],v[60:63],v[204:207],v[140:143]
v_mfma_f32_16x16x32_bf16 v[132:135],v[60:63],v[188:191],v[132:135]
s_barrier
ds_read_b128 v[32:35],v8 offset:8192
ds_read_b128 v[36:39],v8 offset:12288
ds_read_b128 v[40:43],v9 offset:8192
ds_read_b128 v[44:47],v9 offset:12288
ds_read_b128 v[48:51],v10 offset:8192
ds_read_b128 v[52:55],v10 offset:12288
v_max3_f32 v22,v128,v129,v130
v_max3_f32 v24,v136,v137,v138
v_max3_f32 v22,v22,v131,v132
v_max3_f32 v24,v24,v139,v140
v_max3_f32 v22,v22,v133,v134
v_max3_f32 v24,v24,v141,v142
v_max_f32 v22,v22,v135
v_max_f32 v24,v24,v143
v_mov_b32 v160,v22
v_mov_b32 v164,v24
s_nop 0
v_permlane16_swap_b32 v160,v22
v_permlane16_swap_b32 v164,v24
v_max_f32 v22,v22,v160
v_max_f32 v24,v24,v164
v_mov_b32 v160,v22
v_mov_b32 v164,v24
s_nop 0
v_permlane32_swap_b32 v160,v22
v_permlane32_swap_b32 v164,v24
v_max_f32 v22,v22,v160
v_max_f32 v24,v24,v164
v_sub_f32 v160,0,v22
v_sub_f32 v164,0,v24
v_sub_f32 v161,0,v22
v_sub_f32 v165,0,v24
v_sub_f32 v162,0,v22
v_sub_f32 v166,0,v24
v_sub_f32 v163,0,v22
v_sub_f32 v167,0,v24
s_waitcnt lgkmcnt(2)
v_mfma_f32_16x16x32_bf16 v[144:147],v[32:35],v[176:179],v[160:163]
ds_read_b128 v[56:59],v11 offset:8192
v_sub_f32 v128,v128,v22
v_sub_f32 v129,v129,v22
v_mfma_f32_16x16x32_bf16 v[152:155],v[32:35],v[192:195],v[164:167]
v_sub_f32 v130,v130,v22
v_sub_f32 v131,v131,v22
v_sub_f32 v132,v132,v22
v_mfma_f32_16x16x32_bf16 v[156:159],v[36:39],v[192:195],v[164:167]
ds_read_b128 v[60:63],v11 offset:12288
v_sub_f32 v133,v133,v22
v_sub_f32 v134,v134,v22
v_mfma_f32_16x16x32_bf16 v[148:151],v[36:39],v[176:179],v[160:163]
v_sub_f32 v135,v135,v22
v_sub_f32 v136,v136,v24
v_sub_f32 v137,v137,v24
v_mfma_f32_16x16x32_bf16 v[144:147],v[40:43],v[180:183],v[144:147]
v_sub_f32 v138,v138,v24
v_sub_f32 v139,v139,v24
v_sub_f32 v140,v140,v24
v_sub_f32 v141,v141,v24
v_mfma_f32_16x16x32_bf16 v[152:155],v[40:43],v[196:199],v[152:155]
v_sub_f32 v142,v142,v24
v_sub_f32 v143,v143,v24
v_mfma_f32_16x16x32_bf16 v[156:159],v[44:47],v[196:199],v[156:159]
v_exp_f32 v128,v128
v_exp_f32 v129,v129
v_mfma_f32_16x16x32_bf16 v[148:151],v[44:47],v[180:183],v[148:151]
v_exp_f32 v130,v130
v_cvt_pk_bf16_f32 v240,v128,v129
s_waitcnt lgkmcnt(0)
v_mfma_f32_16x16x32_bf16 v[144:147],v[48:51],v[184:187],v[144:147]
v_exp_f32 v131,v131
v_exp_f32 v132,v132
v_mfma_f32_16x16x32_bf16 v[152:155],v[48:51],v[200:203],v[152:155]
v_cvt_pk_bf16_f32 v241,v130,v131
v_exp_f32 v133,v133
v_mfma_f32_16x16x32_bf16 v[156:159],v[52:55],v[200:203],v[156:159]
v_exp_f32 v134,v134
v_cvt_pk_bf16_f32 v242,v132,v133
v_mfma_f32_16x16x32_bf16 v[148:151],v[52:55],v[184:187],v[148:151]
v_exp_f32 v135,v135
v_exp_f32 v136,v136
v_mfma_f32_16x16x32_bf16 v[144:147],v[56:59],v[188:191],v[144:147]
v_cvt_pk_bf16_f32 v243,v134,v135
v_exp_f32 v137,v137
v_mfma_f32_16x16x32_bf16 v[152:155],v[56:59],v[204:207],v[152:155]
v_exp_f32 v138,v138
v_mfma_f32_16x16x32_bf16 v[156:159],v[60:63],v[204:207],v[156:159]
v_cvt_pk_bf16_f32 v244,v136,v137
v_exp_f32 v139,v139
v_mfma_f32_16x16x32_bf16 v[148:151],v[60:63],v[188:191],v[148:151]
v_exp_f32 v140,v140
v_cvt_pk_bf16_f32 v245,v138,v139
s_lshl_b32 s64,s35,19
s_lshl_b32 s41,s32,14
s_add_u32 s64,s64,s41
s_lshr_b32 s41,s37,1
s_lshl_b32 s41,s41,8
s_lshl_b32 s65,s36,15
s_or_b32 s65,s65,s41
s_lshl_b32 s59,s32,12
s_mov_b32 s66,2
s_and_b32 s41,s37,1
s_lshl_b32 s41,s41,3
v_lshrrev_b32 v23,4,v0
v_lshlrev_b32 v24,1,v23
v_and_b32 v248,15,v0
v_xor_b32 v248,v248,v24
v_xor_b32 v248,s41,v248
v_lshlrev_b32 v248,4,v248
v_lshl_add_u32 v248,v23,10,v248
v_xor_b32 v249,128,v248
v_add_u32 v250,6144,v248
v_add_u32 v249,3072,v249
v_add_u32 v251,6144,v249
s_sub_u32 s54,s54,1
s_cbranch_scc1 L_count1
L_counted1:
s_barrier
ds_read_b64_tr_b16 v[32:33],v12
ds_read_b64_tr_b16 v[34:35],v12 offset:4096
ds_read_b64_tr_b16 v[36:37],v13
ds_read_b64_tr_b16 v[38:39],v13 offset:4096
ds_read_b64_tr_b16 v[40:41],v14
ds_read_b64_tr_b16 v[42:43],v14 offset:4096
ds_read_b64_tr_b16 v[44:45],v15
ds_read_b64_tr_b16 v[46:47],v15 offset:4096
ds_read_b64_tr_b16 v[48:49],v16
ds_read_b64_tr_b16 v[50:51],v16 offset:4096
ds_read_b64_tr_b16 v[52:53],v17
ds_read_b64_tr_b16 v[54:55],v17 offset:4096
v_exp_f32 v141,v141
v_exp_f32 v142,v142
v_cvt_pk_bf16_f32 v246,v140,v141
v_exp_f32 v143,v143
s_nop 0
v_cvt_pk_bf16_f32 v247,v142,v143
v_mfma_f32_16x16x32_bf16 v[168:171],v[28:31],v[240:243],0
s_nop 0
v_mfma_f32_16x16x32_bf16 v[172:175],v[28:31],v[244:247],0
s_waitcnt lgkmcnt(4)
v_mfma_f32_16x16x32_bf16 v[72:75],v[32:35],v[244:247],0
ds_read_b64_tr_b16 v[56:57],v18
ds_read_b64_tr_b16 v[58:59],v18 offset:4096
v_mfma_f32_16x16x32_bf16 v[64:67],v[32:35],v[240:243],0
v_mfma_f32_16x16x32_bf16 v[68:71],v[36:39],v[240:243],0
ds_read_b64_tr_b16 v[60:61],v19
ds_read_b64_tr_b16 v[62:63],v19 offset:4096
v_mfma_f32_16x16x32_bf16 v[76:79],v[36:39],v[244:247],0
v_max3_f32 v22,v144,v145,v146
v_mfma_f32_16x16x32_bf16 v[88:91],v[40:43],v[244:247],0
ds_read_b128 v[32:35],v8 offset:16384
v_max3_f32 v22,v22,v147,v148
v_mfma_f32_16x16x32_bf16 v[80:83],v[40:43],v[240:243],0
v_max3_f32 v22,v22,v149,v150
v_mfma_f32_16x16x32_bf16 v[84:87],v[44:47],v[240:243],0
ds_read_b128 v[36:39],v8 offset:20480
v_mfma_f32_16x16x32_bf16 v[92:95],v[44:47],v[244:247],0
v_max3_f32 v22,v22,v151,v152
s_waitcnt lgkmcnt(2)
v_mfma_f32_16x16x32_bf16 v[104:107],v[48:51],v[244:247],0
ds_read_b128 v[40:43],v9 offset:16384
v_max3_f32 v22,v22,v153,v154
v_mfma_f32_16x16x32_bf16 v[96:99],v[48:51],v[240:243],0
v_max3_f32 v22,v22,v155,v156
v_mfma_f32_16x16x32_bf16 v[100:103],v[52:55],v[240:243],0
ds_read_b128 v[44:47],v9 offset:20480
v_mfma_f32_16x16x32_bf16 v[108:111],v[52:55],v[244:247],0
v_max3_f32 v22,v22,v157,v158
v_mfma_f32_16x16x32_bf16 v[120:123],v[56:59],v[244:247],0
ds_read_b128 v[48:51],v10 offset:16384
v_max_f32 v22,v22,v159
v_mfma_f32_16x16x32_bf16 v[112:115],v[56:59],v[240:243],0
v_cmp_lt_f32 vcc,s43,v22
v_mfma_f32_16x16x32_bf16 v[116:119],v[60:63],v[240:243],0
ds_read_b128 v[52:55],v10 offset:20480
v_mfma_f32_16x16x32_bf16 v[124:127],v[60:63],v[244:247],0
s_cbranch_vccnz L_rare0
L_back0:
s_waitcnt lgkmcnt(2)
v_mfma_f32_16x16x32_bf16 v[128:131],v[32:35],v[176:179],v[160:163]
ds_read_b128 v[56:59],v11 offset:16384
v_exp_f32 v144,v144
s_cmp_lt_u32 s32,s66
s_cbranch_scc0 L_nowo14
s_add_u32 m0,s59,73728
s_xor_b32 s42,s65,0
s_add_u32 s42,s42,s64
buffer_load_dwordx4 v248,s[20:23],s42 offen lds
buffer_load_dwordx4 v249,s[20:23],s42 offen offset:1024 lds
buffer_load_dwordx4 v250,s[20:23],s42 offen offset:2048 lds
buffer_load_dwordx4 v251,s[20:23],s42 offen offset:3072 lds
L_nowo14:
v_mfma_f32_16x16x32_bf16 v[136:139],v[32:35],v[192:195],v[164:167]
v_exp_f32 v145,v145
v_mfma_f32_16x16x32_bf16 v[140:143],v[36:39],v[192:195],v[164:167]
ds_read_b128 v[60:63],v11 offset:20480
v_exp_f32 v146,v146
v_mfma_f32_16x16x32_bf16 v[132:135],v[36:39],v[176:179],v[160:163]
v_cvt_pk_bf16_f32 v240,v144,v145
v_mfma_f32_16x16x32_bf16 v[128:131],v[40:43],v[180:183],v[128:131]
v_exp_f32 v147,v147
v_mfma_f32_16x16x32_bf16 v[136:139],v[40:43],v[196:199],v[136:139]
v_exp_f32 v148,v148
v_cvt_pk_bf16_f32 v241,v146,v147
v_mfma_f32_16x16x32_bf16 v[140:143],v[44:47],v[196:199],v[140:143]
v_exp_f32 v149,v149
v_mfma_f32_16x16x32_bf16 v[132:135],v[44:47],v[180:183],v[132:135]
v_exp_f32 v150,v150
v_cvt_pk_bf16_f32 v242,v148,v149
s_waitcnt lgkmcnt(0)
v_mfma_f32_16x16x32_bf16 v[128:131],v[48:51],v[184:187],v[128:131]
v_exp_f32 v151,v151
v_mfma_f32_16x16x32_bf16 v[136:139],v[48:51],v[200:203],v[136:139]
v_exp_f32 v152,v152
v_mfma_f32_16x16x32_bf16 v[140:143],v[52:55],v[200:203],v[140:143]
v_cvt_pk_bf16_f32 v243,v150,v151
v_exp_f32 v153,v153
v_mfma_f32_16x16x32_bf16 v[132:135],v[52:55],v[184:187],v[132:135]
v_exp_f32 v154,v154
v_mfma_f32_16x16x32_bf16 v[128:131],v[56:59],v[188:191],v[128:131]
v_cvt_pk_bf16_f32 v244,v152,v153
v_exp_f32 v155,v155
v_mfma_f32_16x16x32_bf16 v[136:139],v[56:59],v[204:207],v[136:139]
v_exp_f32 v156,v156
v_mfma_f32_16x16x32_bf16 v[140:143],v[60:63],v[204:207],v[140:143]
v_cvt_pk_bf16_f32 v245,v154,v155
v_mfma_f32_16x16x32_bf16 v[132:135],v[60:63],v[188:191],v[132:135]
v_exp_f32 v157,v157
s_sub_u32 s54,s54,1
s_cbranch_scc1 L_count2
L_counted2:
L_aloop0:
s_barrier
ds_read_b64_tr_b16 v[32:33],v12 offset:8192
ds_read_b64_tr_b16 v[34:35],v12 offset:12288
ds_read_b64_tr_b16 v[36:37],v13 offset:8192
ds_read_b64_tr_b16 v[38:39],v13 offset:12288
ds_read_b64_tr_b16 v[40:41],v14 offset:8192
ds_read_b64_tr_b16 v[42:43],v14 offset:12288
ds_read_b64_tr_b16 v[44:45],v15 offset:8192
ds_read_b64_tr_b16 v[46:47],v15 offset:12288
ds_read_b64_tr_b16 v[48:49],v16 offset:8192
ds_read_b64_tr_b16 v[50:51],v16 offset:12288
ds_read_b64_tr_b16 v[52:53],v17 offset:8192
ds_read_b64_tr_b16 v[54:55],v17 offset:12288
v_exp_f32 v158,v158
v_cvt_pk_bf16_f32 v246,v156,v157
v_exp_f32 v159,v159
s_nop 0
v_cvt_pk_bf16_f32 v247,v158,v159
v_mfma_f32_16x16x32_bf16 v[168:171],v[28:31],v[240:243],v[168:171]
s_nop 0
v_mfma_f32_16x16x32_bf16 v[172:175],v[28:31],v[244:247],v[172:175]
s_waitcnt lgkmcnt(4)
v_mfma_f32_16x16x32_bf16 v[72:75],v[32:35],v[244:247],v[72:75]
ds_read_b64_tr_b16 v[56:57],v18 offset:8192
ds_read_b64_tr_b16 v[58:59],v18 offset:12288
v_mfma_f32_16x16x32_bf16 v[64:67],v[32:35],v[240:243],v[64:67]
v_mfma_f32_16x16x32_bf16 v[68:71],v[36:39],v[240:243],v[68:71]
ds_read_b64_tr_b16 v[60:61],v19 offset:8192
ds_read_b64_tr_b16 v[62:63],v19 offset:12288
v_mfma_f32_16x16x32_bf16 v[76:79],v[36:39],v[244:247],v[76:79]
v_max3_f32 v22,v128,v129,v130
v_mfma_f32_16x16x32_bf16 v[88:91],v[40:43],v[244:247],v[88:91]
ds_read_b128 v[32:35],v8 offset:24576
v_max3_f32 v22,v22,v131,v132
v_mfma_f32_16x16x32_bf16 v[80:83],v[40:43],v[240:243],v[80:83]
v_max3_f32 v22,v22,v133,v134
v_mfma_f32_16x16x32_bf16 v[84:87],v[44:47],v[240:243],v[84:87]
ds_read_b128 v[36:39],v8 offset:28672
v_mfma_f32_16x16x32_bf16 v[92:95],v[44:47],v[244:247],v[92:95]
v_max3_f32 v22,v22,v135,v136
s_waitcnt lgkmcnt(2)
v_mfma_f32_16x16x32_bf16 v[104:107],v[48:51],v[244:247],v[104:107]
ds_read_b128 v[40:43],v9 offset:24576
v_max3_f32 v22,v22,v137,v138
v_mfma_f32_16x16x32_bf16 v[96:99],v[48:51],v[240:243],v[96:99]
v_max3_f32 v22,v22,v139,v140
v_mfma_f32_16x16x32_bf16 v[100:103],v[52:55],v[240:243],v[100:103]
ds_read_b128 v[44:47],v9 offset:28672
v_mfma_f32_16x16x32_bf16 v[108:111],v[52:55],v[244:247],v[108:111]
v_max3_f32 v22,v22,v141,v142
v_mfma_f32_16x16x32_bf16 v[120:123],v[56:59],v[244:247],v[120:123]
ds_read_b128 v[48:51],v10 offset:24576
v_max_f32 v22,v22,v143
v_mfma_f32_16x16x32_bf16 v[112:115],v[56:59],v[240:243],v[112:115]
v_cmp_lt_f32 vcc,s43,v22
v_mfma_f32_16x16x32_bf16 v[116:119],v[60:63],v[240:243],v[116:119]
ds_read_b128 v[52:55],v10 offset:28672
v_mfma_f32_16x16x32_bf16 v[124:127],v[60:63],v[244:247],v[124:127]
L_chain2:
L_tp_a2:
s_cbranch_execz L_tp_q4
s_cbranch_vccnz L_rare1
L_back1:
s_waitcnt lgkmcnt(2)
v_mfma_f32_16x16x32_bf16 v[144:147],v[32:35],v[176:179],v[160:163]
ds_read_b128 v[56:59],v11 offset:24576
v_exp_f32 v128,v128
v_mfma_f32_16x16x32_bf16 v[152:155],v[32:35],v[192:195],v[164:167]
v_exp_f32 v129,v129
v_mfma_f32_16x16x32_bf16 v[156:159],v[36:39],v[192:195],v[164:167]
ds_read_b128 v[60:63],v11 offset:28672
v_exp_f32 v130,v130
v_mfma_f32_16x16x32_bf16 v[148:151],v[36:39],v[176:179],v[160:163]
v_cvt_pk_bf16_f32 v240,v128,v129
v_mfma_f32_16x16x32_bf16 v[144:147],v[40:43],v[180:183],v[144:147]
v_exp_f32 v131,v131
v_mfma_f32_16x16x32_bf16 v[152:155],v[40:43],v[196:199],v[152:155]
v_exp_f32 v132,v132
v_cvt_pk_bf16_f32 v241,v130,v131
v_mfma_f32_16x16x32_bf16 v[156:159],v[44:47],v[196:199],v[156:159]
v_exp_f32 v133,v133
v_mfma_f32_16x16x32_bf16 v[148:151],v[44:47],v[180:183],v[148:151]
v_exp_f32 v134,v134
v_cvt_pk_bf16_f32 v242,v132,v133
s_waitcnt lgkmcnt(0)
v_mfma_f32_16x16x32_bf16 v[144:147],v[48:51],v[184:187],v[144:147]
v_exp_f32 v135,v135
v_mfma_f32_16x16x32_bf16 v[152:155],v[48:51],v[200:203],v[152:155]
v_exp_f32 v136,v136
v_mfma_f32_16x16x32_bf16 v[156:159],v[52:55],v[200:203],v[156:159]
v_cvt_pk_bf16_f32 v243,v134,v135
v_exp_f32 v137,v137
v_mfma_f32_16x16x32_bf16 v[148:151],v[52:55],v[184:187],v[148:151]
v_exp_f32 v138,v138
v_mfma_f32_16x16x32_bf16 v[144:147],v[56:59],v[188:191],v[144:147]
v_cvt_pk_bf16_f32 v244,v136,v137
v_exp_f32 v139,v139
v_mfma_f32_16x16x32_bf16 v[152:155],v[56:59],v[204:207],v[152:155]
v_exp_f32 v140,v140
v_mfma_f32_16x16x32_bf16 v[156:159],v[60:63],v[204:207],v[156:159]
v_cvt_pk_bf16_f32 v245,v138,v139
v_mfma_f32_16x16x32_bf16 v[148:151],v[60:63],v[188:191],v[148:151]
v_exp_f32 v141,v141
s_sub_u32 s54,s54,1
s_cbranch_scc1 L_count3
L_counted3:
s_barrier
ds_read_b64_tr_b16 v[32:33],v12 offset:16384
ds_read_b64_tr_b16 v[34:35],v12 offset:20480
ds_read_b64_tr_b16 v[36:37],v13 offset:16384
ds_read_b64_tr_b16 v[38:39],v13 offset:20480
ds_read_b64_tr_b16 v[40:41],v14 offset:16384
ds_read_b64_tr_b16 v[42:43],v14 offset:20480
ds_read_b64_tr_b16 v[44:45],v15 offset:16384
ds_read_b64_tr_b16 v[46:47],v15 offset:20480
ds_read_b64_tr_b16 v[48:49],v16 offset:16384
ds_read_b64_tr_b16 v[50:51],v16 offset:20480
ds_read_b64_tr_b16 v[52:53],v17 offset:16384
ds_read_b64_tr_b16 v[54:55],v17 offset:20480
v_exp_f32 v142,v142
v_cvt_pk_bf16_f32 v246,v140,v141
v_exp_f32 v143,v143
s_nop 0
v_cvt_pk_bf16_f32 v247,v142,v143
v_mfma_f32_16x16x32_bf16 v[168:171],v[28:31],v[240:243],v[168:171]
s_nop 0
v_mfma_f32_16x16x32_bf16 v[172:175],v[28:31],v[244:247],v[172:175]
s_waitcnt lgkmcnt(4)
v_mfma_f32_16x16x32_bf16 v[72:75],v[32:35],v[244:247],v[72:75]
ds_read_b64_tr_b16 v[56:57],v18 offset:16384
ds_read_b64_tr_b16 v[58:59],v18 offset:20480
v_mfma_f32_16x16x32_bf16 v[64:67],v[32:35],v[240:243],v[64:67]
v_mfma_f32_16x16x32_bf16 v[68:71],v[36:39],v[240:243],v[68:71]
ds_read_b64_tr_b16 v[60:61],v19 offset:16384
ds_read_b64_tr_b16 v[62:63],v19 offset:20480
v_mfma_f32_16x16x32_bf16 v[76:79],v[36:39],v[244:247],v[76:79]
v_max3_f32 v22,v144,v145,v146
v_mfma_f32_16x16x32_bf16 v[88:91],v[40:43],v[244:247],v[88:91]
ds_read_b128 v[32:35],v8
v_max3_f32 v22,v22,v147,v148
v_mfma_f32_16x16x32_bf16 v[80:83],v[40:43],v[240:243],v[80:83]
v_max3_f32 v22,v22,v149,v150
v_mfma_f32_16x16x32_bf16 v[84:87],v[44:47],v[240:243],v[84:87]
ds_read_b128 v[36:39],v8 offset:4096
v_mfma_f32_16x16x32_bf16 v[92:95],v[44:47],v[244:247],v[92:95]
v_max3_f32 v22,v22,v151,v152
s_waitcnt lgkmcnt(2)
v_mfma_f32_16x16x32_bf16 v[104:107],v[48:51],v[244:247],v[104:107]
ds_read_b128 v[40:43],v9
v_max3_f32 v22,v22,v153,v154
v_mfma_f32_16x16x32_bf16 v[96:99],v[48:51],v[240:243],v[96:99]
v_max3_f32 v22,v22,v155,v156
v_mfma_f32_16x16x32_bf16 v[100:103],v[52:55],v[240:243],v[100:103]
ds_read_b128 v[44:47],v9 offset:4096
v_mfma_f32_16x16x32_bf16 v[108:111],v[52:55],v[244:247],v[108:111]
v_max3_f32 v22,v22,v157,v158
v_mfma_f32_16x16x32_bf16 v[120:123],v[56:59],v[244:247],v[120:123]
ds_read_b128 v[48:51],v10
v_max_f32 v22,v22,v159
v_mfma_f32_16x16x32_bf16 v[112:115],v[56:59],v[240:243],v[112:115]
v_cmp_lt_f32 vcc,s43,v22
v_mfma_f32_16x16x32_bf16 v[116:119],v[60:63],v[240:243],v[116:119]
ds_read_b128 v[52:55],v10 offset:4096
v_mfma_f32_16x16x32_bf16 v[124:127],v[60:63],v[244:247],v[124:127]
s_cbranch_vccnz L_rare2
L_back2:
s_waitcnt lgkmcnt(2)
v_mfma_f32_16x16x32_bf16 v[128:131],v[32:35],v[176:179],v[160:163]
ds_read_b128 v[56:59],v11
v_exp_f32 v144,v144
v_mfma_f32_16x16x32_bf16 v[136:139],v[32:35],v[192:195],v[164:167]
v_exp_f32 v145,v145
v_mfma_f32_16x16x32_bf16 v[140:143],v[36:39],v[192:195],v[164:167]
ds_read_b128 v[60:63],v11 offset:4096
v_exp_f32 v146,v146
v_mfma_f32_16x16x32_bf16 v[132:135],v[36:39],v[176:179],v[160:163]
v_cvt_pk_bf16_f32 v240,v144,v145
v_mfma_f32_16x16x32_bf16 v[128:131],v[40:43],v[180:183],v[128:131]
v_exp_f32 v147,v147
v_mfma_f32_16x16x32_bf16 v[136:139],v[40:43],v[196:199],v[136:139]
v_exp_f32 v148,v148
v_cvt_pk_bf16_f32 v241,v146,v147
v_mfma_f32_16x16x32_bf16 v[140:143],v[44:47],v[196:199],v[140:143]
v_exp_f32 v149,v149
v_mfma_f32_16x16x32_bf16 v[132:135],v[44:47],v[180:183],v[132:135]
v_exp_f32 v150,v150
v_cvt_pk_bf16_f32 v242,v148,v149
s_waitcnt lgkmcnt(0)
v_mfma_f32_16x16x32_bf16 v[128:131],v[48:51],v[184:187],v[128:131]
v_exp_f32 v151,v151
v_mfma_f32_16x16x32_bf16 v[136:139],v[48:51],v[200:203],v[136:139]
v_exp_f32 v152,v152
v_mfma_f32_16x16x32_bf16 v[140:143],v[52:55],v[200:203],v[140:143]
v_cvt_pk_bf16_f32 v243,v150,v151
v_exp_f32 v153,v153
v_mfma_f32_16x16x32_bf16 v[132:135],v[52:55],v[184:187],v[132:135]
v_exp_f32 v154,v154
v_mfma_f32_16x16x32_bf16 v[128:131],v[56:59],v[188:191],v[128:131]
v_cvt_pk_bf16_f32 v244,v152,v153
v_exp_f32 v155,v155
v_mfma_f32_16x16x32_bf16 v[136:139],v[56:59],v[204:207],v[136:139]
v_exp_f32 v156,v156
v_mfma_f32_16x16x32_bf16 v[140:143],v[60:63],v[204:207],v[140:143]
v_cvt_pk_bf16_f32 v245,v154,v155
v_mfma_f32_16x16x32_bf16 v[132:135],v[60:63],v[188:191],v[132:135]
v_exp_f32 v157,v157
s_sub_u32 s54,s54,1
s_cbranch_scc1 L_count4
L_counted4:
s_barrier
ds_read_b64_tr_b16 v[32:33],v12 offset:24576
ds_read_b64_tr_b16 v[34:35],v12 offset:28672
ds_read_b64_tr_b16 v[36:37],v13 offset:24576
ds_read_b64_tr_b16 v[38:39],v13 offset:28672
ds_read_b64_tr_b16 v[40:41],v14 offset:24576
ds_read_b64_tr_b16 v[42:43],v14 offset:28672
ds_read_b64_tr_b16 v[44:45],v15 offset:24576
ds_read_b64_tr_b16 v[46:47],v15 offset:28672
ds_read_b64_tr_b16 v[48:49],v16 offset:24576
ds_read_b64_tr_b16 v[50:51],v16 offset:28672
ds_read_b64_tr_b16 v[52:53],v17 offset:24576
ds_read_b64_tr_b16 v[54:55],v17 offset:28672
v_exp_f32 v158,v158
v_cvt_pk_bf16_f32 v246,v156,v157
v_exp_f32 v159,v159
s_nop 0
v_cvt_pk_bf16_f32 v247,v158,v159
v_mfma_f32_16x16x32_bf16 v[168:171],v[28:31],v[240:243],v[168:171]
s_nop 0
v_mfma_f32_16x16x32_bf16 v[172:175],v[28:31],v[244:247],v[172:175]
s_waitcnt lgkmcnt(4)
v_mfma_f32_16x16x32_bf16 v[72:75],v[32:35],v[244:247],v[72:75]
ds_read_b64_tr_b16 v[56:57],v18 offset:24576
ds_read_b64_tr_b16 v[58:59],v18 offset:28672
v_mfma_f32_16x16x32_bf16 v[64:67],v[32:35],v[240:243],v[64:67]
v_mfma_f32_16x16x32_bf16 v[68:71],v[36:39],v[240:243],v[68:71]
ds_read_b64_tr_b16 v[60:61],v19 offset:24576
ds_read_b64_tr_b16 v[62:63],v19 offset:28672
v_mfma_f32_16x16x32_bf16 v[76:79],v[36:39],v[244:247],v[76:79]
v_max3_f32 v22,v128,v129,v130
v_mfma_f32_16x16x32_bf16 v[88:91],v[40:43],v[244:247],v[88:91]
ds_read_b128 v[32:35],v8 offset:8192
v_max3_f32 v22,v22,v131,v132
v_mfma_f32_16x16x32_bf16 v[80:83],v[40:43],v[240:243],v[80:83]
v_max3_f32 v22,v22,v133,v134
v_mfma_f32_16x16x32_bf16 v[84:87],v[44:47],v[240:243],v[84:87]
ds_read_b128 v[36:39],v8 offset:12288
v_mfma_f32_16x16x32_bf16 v[92:95],v[44:47],v[244:247],v[92:95]
v_max3_f32 v22,v22,v135,v136
s_waitcnt lgkmcnt(2)
v_mfma_f32_16x16x32_bf16 v[104:107],v[48:51],v[244:247],v[104:107]
ds_read_b128 v[40:43],v9 offset:8192
v_max3_f32 v22,v22,v137,v138
v_mfma_f32_16x16x32_bf16 v[96:99],v[48:51],v[240:243],v[96:99]
v_max3_f32 v22,v22,v139,v140
v_mfma_f32_16x16x32_bf16 v[100:103],v[52:55],v[240:243],v[100:103]
ds_read_b128 v[44:47],v9 offset:12288
v_mfma_f32_16x16x32_bf16 v[108:111],v[52:55],v[244:247],v[108:111]
v_max3_f32 v22,v22,v141,v142
v_mfma_f32_16x16x32_bf16 v[120:123],v[56:59],v[244:247],v[120:123]
ds_read_b128 v[48:51],v10 offset:8192
v_max_f32 v22,v22,v143
v_mfma_f32_16x16x32_bf16 v[112:115],v[56:59],v[240:243],v[112:115]
v_cmp_lt_f32 vcc,s43,v22
v_mfma_f32_16x16x32_bf16 v[116:119],v[60:63],v[240:243],v[116:119]
ds_read_b128 v[52:55],v10 offset:12288
v_mfma_f32_16x16x32_bf16 v[124:127],v[60:63],v[244:247],v[124:127]
s_cbranch_vccnz L_rare3
L_back3:
s_waitcnt lgkmcnt(2)
v_mfma_f32_16x16x32_bf16 v[144:147],v[32:35],v[176:179],v[160:163]
ds_read_b128 v[56:59],v11 offset:8192
v_exp_f32 v128,v128
v_mfma_f32_16x16x32_bf16 v[152:155],v[32:35],v[192:195],v[164:167]
v_exp_f32 v129,v129
v_mfma_f32_16x16x32_bf16 v[156:159],v[36:39],v[192:195],v[164:167]
ds_read_b128 v[60:63],v11 offset:12288
v_exp_f32 v130,v130
v_mfma_f32_16x16x32_bf16 v[148:151],v[36:39],v[176:179],v[160:163]
v_cvt_pk_bf16_f32 v240,v128,v129
v_mfma_f32_16x16x32_bf16 v[144:147],v[40:43],v[180:183],v[144:147]
v_exp_f32 v131,v131
v_mfma_f32_16x16x32_bf16 v[152:155],v[40:43],v[196:199],v[152:155]
v_exp_f32 v132,v132
v_cvt_pk_bf16_f32 v241,v130,v131
v_mfma_f32_16x16x32_bf16 v[156:159],v[44:47],v[196:199],v[156:159]
v_exp_f32 v133,v133
v_mfma_f32_16x16x32_bf16 v[148:151],v[44:47],v[180:183],v[148:151]
v_exp_f32 v134,v134
v_cvt_pk_bf16_f32 v242,v132,v133
s_waitcnt lgkmcnt(0)
v_mfma_f32_16x16x32_bf16 v[144:147],v[48:51],v[184:187],v[144:147]
v_exp_f32 v135,v135
v_mfma_f32_16x16x32_bf16 v[152:155],v[48:51],v[200:203],v[152:155]
v_exp_f32 v136,v136
v_mfma_f32_16x16x32_bf16 v[156:159],v[52:55],v[200:203],v[156:159]
v_cvt_pk_bf16_f32 v243,v134,v135
v_exp_f32 v137,v137
v_mfma_f32_16x16x32_bf16 v[148:151],v[52:55],v[184:187],v[148:151]
v_exp_f32 v138,v138
v_mfma_f32_16x16x32_bf16 v[144:147],v[56:59],v[188:191],v[144:147]
v_cvt_pk_bf16_f32 v244,v136,v137
v_exp_f32 v139,v139
v_mfma_f32_16x16x32_bf16 v[152:155],v[56:59],v[204:207],v[152:155]
v_exp_f32 v140,v140
v_mfma_f32_16x16x32_bf16 v[156:159],v[60:63],v[204:207],v[156:159]
v_cvt_pk_bf16_f32 v245,v138,v139
v_mfma_f32_16x16x32_bf16 v[148:151],v[60:63],v[188:191],v[148:151]
v_exp_f32 v141,v141
s_sub_u32 s54,s54,1
s_cbranch_scc1 L_count5
L_counted5:
s_barrier
ds_read_b64_tr_b16 v[32:33],v12
ds_read_b64_tr_b16 v[34:35],v12 offset:4096
ds_read_b64_tr_b16 v[36:37],v13
ds_read_b64_tr_b16 v[38:39],v13 offset:4096
ds_read_b64_tr_b16 v[40:41],v14
ds_read_b64_tr_b16 v[42:43],v14 offset:4096
ds_read_b64_tr_b16 v[44:45],v15
ds_read_b64_tr_b16 v[46:47],v15 offset:4096
ds_read_b64_tr_b16 v[48:49],v16
ds_read_b64_tr_b16 v[50:51],v16 offset:4096
ds_read_b64_tr_b16 v[52:53],v17
ds_read_b64_tr_b16 v[54:55],v17 offset:4096
v_exp_f32 v142,v142
v_cvt_pk_bf16_f32 v246,v140,v141
v_exp_f32 v143,v143
s_nop 0
v_cvt_pk_bf16_f32 v247,v142,v143
v_mfma_f32_16x16x32_bf16 v[168:171],v[28:31],v[240:243],v[168:171]
s_nop 0
v_mfma_f32_16x16x32_bf16 v[172:175],v[28:31],v[244:247],v[172:175]
s_waitcnt lgkmcnt(4)
v_mfma_f32_16x16x32_bf16 v[72:75],v[32:35],v[244:247],v[72:75]
ds_read_b64_tr_b16 v[56:57],v18
ds_read_b64_tr_b16 v[58:59],v18 offset:4096
v_mfma_f32_16x16x32_bf16 v[64:67],v[32:35],v[240:243],v[64:67]
v_mfma_f32_16x16x32_bf16 v[68:71],v[36:39],v[240:243],v[68:71]
ds_read_b64_tr_b16 v[60:61],v19
ds_read_b64_tr_b16 v[62:63],v19 offset:4096
v_mfma_f32_16x16x32_bf16 v[76:79],v[36:39],v[244:247],v[76:79]
v_max3_f32 v22,v144,v145,v146
v_mfma_f32_16x16x32_bf16 v[88:91],v[40:43],v[244:247],v[88:91]
ds_read_b128 v[32:35],v8 offset:16384
v_max3_f32 v22,v22,v147,v148
v_mfma_f32_16x16x32_bf16 v[80:83],v[40:43],v[240:243],v[80:83]
v_max3_f32 v22,v22,v149,v150
v_mfma_f32_16x16x32_bf16 v[84:87],v[44:47],v[240:243],v[84:87]
ds_read_b128 v[36:39],v8 offset:20480
v_mfma_f32_16x16x32_bf16 v[92:95],v[44:47],v[244:247],v[92:95]
v_max3_f32 v22,v22,v151,v152
s_waitcnt lgkmcnt(2)
v_mfma_f32_16x16x32_bf16 v[104:107],v[48:51],v[244:247],v[104:107]
ds_read_b128 v[40:43],v9 offset:16384
v_max3_f32 v22,v22,v153,v154
v_mfma_f32_16x16x32_bf16 v[96:99],v[48:51],v[240:243],v[96:99]
v_max3_f32 v22,v22,v155,v156
v_mfma_f32_16x16x32_bf16 v[100:103],v[52:55],v[240:243],v[100:103]
ds_read_b128 v[44:47],v9 offset:20480
v_mfma_f32_16x16x32_bf16 v[108:111],v[52:55],v[244:247],v[108:111]
v_max3_f32 v22,v22,v157,v158
v_mfma_f32_16x16x32_bf16 v[120:123],v[56:59],v[244:247],v[120:123]
ds_read_b128 v[48:51],v10 offset:16384
v_max_f32 v22,v22,v159
v_mfma_f32_16x16x32_bf16 v[112:115],v[56:59],v[240:243],v[112:115]
v_cmp_lt_f32 vcc,s43,v22
v_mfma_f32_16x16x32_bf16 v[116:119],v[60:63],v[240:243],v[116:119]
ds_read_b128 v[52:55],v10 offset:20480
v_mfma_f32_16x16x32_bf16 v[124:127],v[60:63],v[244:247],v[124:127]
s_cbranch_vccnz L_rare4
L_back4:
s_waitcnt lgkmcnt(2)
v_mfma_f32_16x16x32_bf16 v[128:131],v[32:35],v[176:179],v[160:163]
ds_read_b128 v[56:59],v11 offset:16384
v_exp_f32 v144,v144
v_mfma_f32_16x16x32_bf16 v[136:139],v[32:35],v[192:195],v[164:167]
v_exp_f32 v145,v145
v_mfma_f32_16x16x32_bf16 v[140:143],v[36:39],v[192:195],v[164:167]
ds_read_b128 v[60:63],v11 offset:20480
v_exp_f32 v146,v146
v_mfma_f32_16x16x32_bf16 v[132:135],v[36:39],v[176:179],v[160:163]
v_cvt_pk_bf16_f32 v240,v144,v145
v_mfma_f32_16x16x32_bf16 v[128:131],v[40:43],v[180:183],v[128:131]
v_exp_f32 v147,v147
v_mfma_f32_16x16x32_bf16 v[136:139],v[40:43],v[196:199],v[136:139]
v_exp_f32 v148,v148
v_cvt_pk_bf16_f32 v241,v146,v147
v_mfma_f32_16x16x32_bf16 v[140:143],v[44:47],v[196:199],v[140:143]
v_exp_f32 v149,v149
v_mfma_f32_16x16x32_bf16 v[132:135],v[44:47],v[180:183],v[132:135]
v_exp_f32 v150,v150
v_cvt_pk_bf16_f32 v242,v148,v149
s_waitcnt lgkmcnt(0)
v_mfma_f32_16x16x32_bf16 v[128:131],v[48:51],v[184:187],v[128:131]
v_exp_f32 v151,v151
v_mfma_f32_16x16x32_bf16 v[136:139],v[48:51],v[200:203],v[136:139]
v_exp_f32 v152,v152
v_mfma_f32_16x16x32_bf16 v[140:143],v[52:55],v[200:203],v[140:143]
v_cvt_pk_bf16_f32 v243,v150,v151
v_exp_f32 v153,v153
v_mfma_f32_16x16x32_bf16 v[132:135],v[52:55],v[184:187],v[132:135]
v_exp_f32 v154,v154
v_mfma_f32_16x16x32_bf16 v[128:131],v[56:59],v[188:191],v[128:131]
v_cvt_pk_bf16_f32 v244,v152,v153
v_exp_f32 v155,v155
v_mfma_f32_16x16x32_bf16 v[136:139],v[56:59],v[204:207],v[136:139]
v_exp_f32 v156,v156
v_mfma_f32_16x16x32_bf16 v[140:143],v[60:63],v[204:207],v[140:143]
v_cvt_pk_bf16_f32 v245,v154,v155
v_mfma_f32_16x16x32_bf16 v[132:135],v[60:63],v[188:191],v[132:135]
v_exp_f32 v157,v157
s_sub_u32 s54,s54,1
s_cbranch_scc1 L_count6
L_counted6:
s_add_u32 s100,s100,1
s_cmp_eq_u32 s100,3
s_cbranch_scc0 L_aloop0
s_barrier
ds_read_b64_tr_b16 v[32:33],v12 offset:8192
ds_read_b64_tr_b16 v[34:35],v12 offset:12288
ds_read_b64_tr_b16 v[36:37],v13 offset:8192
ds_read_b64_tr_b16 v[38:39],v13 offset:12288
ds_read_b64_tr_b16 v[40:41],v14 offset:8192
ds_read_b64_tr_b16 v[42:43],v14 offset:12288
ds_read_b64_tr_b16 v[44:45],v15 offset:8192
ds_read_b64_tr_b16 v[46:47],v15 offset:12288
ds_read_b64_tr_b16 v[48:49],v16 offset:8192
ds_read_b64_tr_b16 v[50:51],v16 offset:12288
ds_read_b64_tr_b16 v[52:53],v17 offset:8192
ds_read_b64_tr_b16 v[54:55],v17 offset:12288
v_exp_f32 v158,v158
v_cvt_pk_bf16_f32 v246,v156,v157
v_exp_f32 v159,v159
s_nop 0
v_cvt_pk_bf16_f32 v247,v158,v159
v_mfma_f32_16x16x32_bf16 v[168:171],v[28:31],v[240:243],v[168:171]
s_nop 0
v_mfma_f32_16x16x32_bf16 v[172:175],v[28:31],v[244:247],v[172:175]
s_waitcnt lgkmcnt(4)
v_mfma_f32_16x16x32_bf16 v[72:75],v[32:35],v[244:247],v[72:75]
ds_read_b64_tr_b16 v[56:57],v18 offset:8192
ds_read_b64_tr_b16 v[58:59],v18 offset:12288
v_mfma_f32_16x16x32_bf16 v[64:67],v[32:35],v[240:243],v[64:67]
v_mfma_f32_16x16x32_bf16 v[68:71],v[36:39],v[240:243],v[68:71]
ds_read_b64_tr_b16 v[60:61],v19 offset:8192
ds_read_b64_tr_b16 v[62:63],v19 offset:12288
v_mfma_f32_16x16x32_bf16 v[76:79],v[36:39],v[244:247],v[76:79]
v_max3_f32 v22,v128,v129,v130
v_mfma_f32_16x16x32_bf16 v[88:91],v[40:43],v[244:247],v[88:91]
ds_read_b128 v[32:35],v8 offset:24576
v_max3_f32 v22,v22,v131,v132
v_mfma_f32_16x16x32_bf16 v[80:83],v[40:43],v[240:243],v[80:83]
v_max3_f32 v22,v22,v133,v134
v_mfma_f32_16x16x32_bf16 v[84:87],v[44:47],v[240:243],v[84:87]
ds_read_b128 v[36:39],v8 offset:28672
v_mfma_f32_16x16x32_bf16 v[92:95],v[44:47],v[244:247],v[92:95]
v_max3_f32 v22,v22,v135,v136
s_waitcnt lgkmcnt(2)
v_mfma_f32_16x16x32_bf16 v[104:107],v[48:51],v[244:247],v[104:107]
ds_read_b128 v[40:43],v9 offset:24576
v_max3_f32 v22,v22,v137,v138
v_mfma_f32_16x16x32_bf16 v[96:99],v[48:51],v[240:243],v[96:99]
v_max3_f32 v22,v22,v139,v140
v_mfma_f32_16x16x32_bf16 v[100:103],v[52:55],v[240:243],v[100:103]
ds_read_b128 v[44:47],v9 offset:28672
v_mfma_f32_16x16x32_bf16 v[108:111],v[52:55],v[244:247],v[108:111]
v_max3_f32 v22,v22,v141,v142
v_mfma_f32_16x16x32_bf16 v[120:123],v[56:59],v[244:247],v[120:123]
ds_read_b128 v[48:51],v10 offset:24576
v_max_f32 v22,v22,v143
v_mfma_f32_16x16x32_bf16 v[112:115],v[56:59],v[240:243],v[112:115]
v_cmp_lt_f32 vcc,s43,v22
v_mfma_f32_16x16x32_bf16 v[116:119],v[60:63],v[240:243],v[116:119]
ds_read_b128 v[52:55],v10 offset:28672
v_mfma_f32_16x16x32_bf16 v[124:127],v[60:63],v[244:247],v[124:127]
s_cbranch_vccnz L_rare13
L_back13:
s_waitcnt lgkmcnt(2)
v_mfma_f32_16x16x32_bf16 v[144:147],v[32:35],v[176:179],v[160:163]
ds_read_b128 v[56:59],v11 offset:24576
v_exp_f32 v128,v128
v_mfma_f32_16x16x32_bf16 v[152:155],v[32:35],v[192:195],v[164:167]
v_exp_f32 v129,v129
v_mfma_f32_16x16x32_bf16 v[156:159],v[36:39],v[192:195],v[164:167]
ds_read_b128 v[60:63],v11 offset:28672
v_exp_f32 v130,v130
v_mfma_f32_16x16x32_bf16 v[148:151],v[36:39],v[176:179],v[160:163]
v_cvt_pk_bf16_f32 v240,v128,v129
v_mfma_f32_16x16x32_bf16 v[144:147],v[40:43],v[180:183],v[144:147]
v_exp_f32 v131,v131
v_mfma_f32_16x16x32_bf16 v[152:155],v[40:43],v[196:199],v[152:155]
v_exp_f32 v132,v132
v_cvt_pk_bf16_f32 v241,v130,v131
v_mfma_f32_16x16x32_bf16 v[156:159],v[44:47],v[196:199],v[156:159]
v_exp_f32 v133,v133
v_mfma_f32_16x16x32_bf16 v[148:151],v[44:47],v[180:183],v[148:151]
v_exp_f32 v134,v134
v_cvt_pk_bf16_f32 v242,v132,v133
s_waitcnt lgkmcnt(0)
v_mfma_f32_16x16x32_bf16 v[144:147],v[48:51],v[184:187],v[144:147]
v_exp_f32 v135,v135
v_mfma_f32_16x16x32_bf16 v[152:155],v[48:51],v[200:203],v[152:155]
v_exp_f32 v136,v136
v_mfma_f32_16x16x32_bf16 v[156:159],v[52:55],v[200:203],v[156:159]
v_cvt_pk_bf16_f32 v243,v134,v135
v_exp_f32 v137,v137
v_mfma_f32_16x16x32_bf16 v[148:151],v[52:55],v[184:187],v[148:151]
v_exp_f32 v138,v138
v_mfma_f32_16x16x32_bf16 v[144:147],v[56:59],v[188:191],v[144:147]
v_cvt_pk_bf16_f32 v244,v136,v137
v_exp_f32 v139,v139
v_mfma_f32_16x16x32_bf16 v[152:155],v[56:59],v[204:207],v[152:155]
v_exp_f32 v140,v140
v_mfma_f32_16x16x32_bf16 v[156:159],v[60:63],v[204:207],v[156:159]
v_cvt_pk_bf16_f32 v245,v138,v139
v_mfma_f32_16x16x32_bf16 v[148:151],v[60:63],v[188:191],v[148:151]
v_exp_f32 v141,v141
s_xor_b32 s41,s49,0
s_lshl_b32 s42,s41,15
s_add_u32 s67,s42,s53
s_lshl_b32 s42,s41,7
s_add_u32 s74,s42,s56
s_xor_b32 s41,s49,1
s_lshl_b32 s42,s41,15
s_add_u32 s68,s42,s53
s_lshl_b32 s42,s41,7
s_add_u32 s75,s42,s56
s_xor_b32 s41,s49,2
s_lshl_b32 s42,s41,15
s_add_u32 s69,s42,s53
s_lshl_b32 s42,s41,7
s_add_u32 s76,s42,s56
s_xor_b32 s41,s49,3
s_lshl_b32 s42,s41,15
s_add_u32 s70,s42,s53
s_lshl_b32 s42,s41,7
s_add_u32 s77,s42,s56
s_xor_b32 s41,s49,4
s_lshl_b32 s42,s41,15
s_add_u32 s71,s42,s53
s_lshl_b32 s42,s41,7
s_add_u32 s78,s42,s56
s_xor_b32 s41,s49,5
s_lshl_b32 s42,s41,15
s_add_u32 s72,s42,s53
s_lshl_b32 s42,s41,7
s_add_u32 s79,s42,s56
s_xor_b32 s41,s49,6
s_lshl_b32 s42,s41,15
s_add_u32 s73,s42,s53
s_lshl_b32 s42,s41,7
s_add_u32 s80,s42,s56
s_sub_u32 s54,s54,1
s_cbranch_scc1 L_count15
L_counted15:
s_barrier
ds_read_b64_tr_b16 v[32:33],v12 offset:16384
ds_read_b64_tr_b16 v[34:35],v12 offset:20480
ds_read_b64_tr_b16 v[36:37],v13 offset:16384
ds_read_b64_tr_b16 v[38:39],v13 offset:20480
ds_read_b64_tr_b16 v[40:41],v14 offset:16384
ds_read_b64_tr_b16 v[42:43],v14 offset:20480
ds_read_b64_tr_b16 v[44:45],v15 offset:16384
ds_read_b64_tr_b16 v[46:47],v15 offset:20480
ds_read_b64_tr_b16 v[48:49],v16 offset:16384
ds_read_b64_tr_b16 v[50:51],v16 offset:20480
ds_read_b64_tr_b16 v[52:53],v17 offset:16384
ds_read_b64_tr_b16 v[54:55],v17 offset:20480
v_exp_f32 v142,v142
v_cvt_pk_bf16_f32 v246,v140,v141
v_exp_f32 v143,v143
s_nop 0
v_cvt_pk_bf16_f32 v247,v142,v143
v_mfma_f32_16x16x32_bf16 v[168:171],v[28:31],v[240:243],v[168:171]
ds_read_b128 v[176:179],v20
v_mfma_f32_16x16x32_bf16 v[172:175],v[28:31],v[244:247],v[172:175]
s_waitcnt lgkmcnt(5)
v_mfma_f32_16x16x32_bf16 v[72:75],v[32:35],v[244:247],v[72:75]
ds_read_b64_tr_b16 v[56:57],v18 offset:16384
ds_read_b64_tr_b16 v[58:59],v18 offset:20480
v_mfma_f32_16x16x32_bf16 v[64:67],v[32:35],v[240:243],v[64:67]
ds_read_b128 v[192:195],v20 offset:4096
v_mfma_f32_16x16x32_bf16 v[68:71],v[36:39],v[240:243],v[68:71]
ds_read_b64_tr_b16 v[60:61],v19 offset:16384
ds_read_b64_tr_b16 v[62:63],v19 offset:20480
v_mfma_f32_16x16x32_bf16 v[76:79],v[36:39],v[244:247],v[76:79]
ds_read_b128 v[180:183],v20 offset:1024
v_max3_f32 v22,v144,v145,v146
v_mfma_f32_16x16x32_bf16 v[88:91],v[40:43],v[244:247],v[88:91]
ds_read_b128 v[32:35],v8
v_max3_f32 v22,v22,v147,v148
v_mfma_f32_16x16x32_bf16 v[80:83],v[40:43],v[240:243],v[80:83]
ds_read_b128 v[196:199],v20 offset:5120
v_max3_f32 v22,v22,v149,v150
v_mfma_f32_16x16x32_bf16 v[84:87],v[44:47],v[240:243],v[84:87]
ds_read_b128 v[36:39],v8 offset:4096
v_mfma_f32_16x16x32_bf16 v[92:95],v[44:47],v[244:247],v[92:95]
ds_read_b128 v[184:187],v20 offset:2048
v_max3_f32 v22,v22,v151,v152
s_waitcnt lgkmcnt(5)
v_mfma_f32_16x16x32_bf16 v[104:107],v[48:51],v[244:247],v[104:107]
ds_read_b128 v[40:43],v9
v_max3_f32 v22,v22,v153,v154
v_mfma_f32_16x16x32_bf16 v[96:99],v[48:51],v[240:243],v[96:99]
ds_read_b128 v[200:203],v20 offset:6144
v_max3_f32 v22,v22,v155,v156
v_mfma_f32_16x16x32_bf16 v[100:103],v[52:55],v[240:243],v[100:103]
ds_read_b128 v[44:47],v9 offset:4096
v_mfma_f32_16x16x32_bf16 v[108:111],v[52:55],v[244:247],v[108:111]
ds_read_b128 v[188:191],v20 offset:3072
v_max3_f32 v22,v22,v157,v158
v_mfma_f32_16x16x32_bf16 v[120:123],v[56:59],v[244:247],v[120:123]
ds_read_b128 v[48:51],v10
v_max_f32 v22,v22,v159
v_mfma_f32_16x16x32_bf16 v[112:115],v[56:59],v[240:243],v[112:115]
ds_read_b128 v[204:207],v20 offset:7168
v_cmp_lt_f32 vcc,s43,v22
v_mfma_f32_16x16x32_bf16 v[116:119],v[60:63],v[240:243],v[116:119]
ds_read_b128 v[52:55],v10 offset:4096
v_mfma_f32_16x16x32_bf16 v[124:127],v[60:63],v[244:247],v[124:127]
s_cbranch_vccnz L_rare14
L_back14:
s_waitcnt lgkmcnt(4)
v_mfma_f32_16x16x32_bf16 v[128:131],v[32:35],v[176:179],0
ds_read_b128 v[56:59],v11
v_exp_f32 v144,v144
s_cmp_lt_u32 s32,s66
s_cbranch_scc0 L_nowo15
s_add_u32 m0,s59,81920
s_xor_b32 s42,s65,32768
s_add_u32 s42,s42,s64
buffer_load_dwordx4 v248,s[20:23],s42 offen lds
buffer_load_dwordx4 v249,s[20:23],s42 offen offset:1024 lds
buffer_load_dwordx4 v250,s[20:23],s42 offen offset:2048 lds
buffer_load_dwordx4 v251,s[20:23],s42 offen offset:3072 lds
L_nowo15:
v_mfma_f32_16x16x32_bf16 v[136:139],v[32:35],v[192:195],0
v_exp_f32 v145,v145
v_mfma_f32_16x16x32_bf16 v[140:143],v[36:39],v[192:195],0
ds_read_b128 v[60:63],v11 offset:4096
v_exp_f32 v146,v146
v_mfma_f32_16x16x32_bf16 v[132:135],v[36:39],v[176:179],0
v_cvt_pk_bf16_f32 v240,v144,v145
v_mfma_f32_16x16x32_bf16 v[128:131],v[40:43],v[180:183],v[128:131]
v_exp_f32 v147,v147
v_mfma_f32_16x16x32_bf16 v[136:139],v[40:43],v[196:199],v[136:139]
v_exp_f32 v148,v148
v_cvt_pk_bf16_f32 v241,v146,v147
v_mfma_f32_16x16x32_bf16 v[140:143],v[44:47],v[196:199],v[140:143]
v_exp_f32 v149,v149
v_mfma_f32_16x16x32_bf16 v[132:135],v[44:47],v[180:183],v[132:135]
v_exp_f32 v150,v150
v_cvt_pk_bf16_f32 v242,v148,v149
s_waitcnt lgkmcnt(0)
v_mfma_f32_16x16x32_bf16 v[128:131],v[48:51],v[184:187],v[128:131]
v_exp_f32 v151,v151
v_mfma_f32_16x16x32_bf16 v[136:139],v[48:51],v[200:203],v[136:139]
v_exp_f32 v152,v152
v_mfma_f32_16x16x32_bf16 v[140:143],v[52:55],v[200:203],v[140:143]
v_cvt_pk_bf16_f32 v243,v150,v151
v_exp_f32 v153,v153
v_mfma_f32_16x16x32_bf16 v[132:135],v[52:55],v[184:187],v[132:135]
v_exp_f32 v154,v154
v_mfma_f32_16x16x32_bf16 v[128:131],v[56:59],v[188:191],v[128:131]
v_cvt_pk_bf16_f32 v244,v152,v153
v_exp_f32 v155,v155
v_mfma_f32_16x16x32_bf16 v[136:139],v[56:59],v[204:207],v[136:139]
v_exp_f32 v156,v156
v_mfma_f32_16x16x32_bf16 v[140:143],v[60:63],v[204:207],v[140:143]
v_cvt_pk_bf16_f32 v245,v154,v155
v_mfma_f32_16x16x32_bf16 v[132:135],v[60:63],v[188:191],v[132:135]
v_exp_f32 v157,v157
s_waitcnt vmcnt(4)
s_sub_u32 s54,s54,1
s_cbranch_scc1 L_count16
L_counted16:
s_barrier
ds_read_b64_tr_b16 v[32:33],v12 offset:24576
ds_read_b64_tr_b16 v[34:35],v12 offset:28672
ds_read_b64_tr_b16 v[36:37],v13 offset:24576
ds_read_b64_tr_b16 v[38:39],v13 offset:28672
ds_read_b64_tr_b16 v[40:41],v14 offset:24576
ds_read_b64_tr_b16 v[42:43],v14 offset:28672
ds_read_b64_tr_b16 v[44:45],v15 offset:24576
ds_read_b64_tr_b16 v[46:47],v15 offset:28672
L_tp_a3:
s_cbranch_execz L_tp_a6
ds_read_b64_tr_b16 v[48:49],v16 offset:24576
ds_read_b64_tr_b16 v[50:51],v16 offset:28672
ds_read_b64_tr_b16 v[52:53],v17 offset:24576
ds_read_b64_tr_b16 v[54:55],v17 offset:28672
v_exp_f32 v158,v158
v_cvt_pk_bf16_f32 v246,v156,v157
v_exp_f32 v159,v159
s_nop 0
v_cvt_pk_bf16_f32 v247,v158,v159
v_mfma_f32_16x16x32_bf16 v[168:171],v[28:31],v[240:243],v[168:171]
s_nop 0
v_mfma_f32_16x16x32_bf16 v[172:175],v[28:31],v[244:247],v[172:175]
s_waitcnt lgkmcnt(4)
v_mfma_f32_16x16x32_bf16 v[72:75],v[32:35],v[244:247],v[72:75]
ds_read_b64_tr_b16 v[56:57],v18 offset:24576
ds_read_b64_tr_b16 v[58:59],v18 offset:28672
v_max3_f32 v22,v128,v129,v130
v_mfma_f32_16x16x32_bf16 v[64:67],v[32:35],v[240:243],v[64:67]
v_max3_f32 v24,v136,v137,v138
v_max3_f32 v22,v22,v131,v132
v_max3_f32 v24,v24,v139,v140
v_max3_f32 v22,v22,v133,v134
v_mfma_f32_16x16x32_bf16 v[68:71],v[36:39],v[240:243],v[68:71]
ds_read_b64_tr_b16 v[60:61],v19 offset:24576
ds_read_b64_tr_b16 v[62:63],v19 offset:28672
v_max3_f32 v24,v24,v141,v142
v_mfma_f32_16x16x32_bf16 v[76:79],v[36:39],v[244:247],v[76:79]
v_max_f32 v22,v22,v135
v_max_f32 v24,v24,v143
v_mov_b32 v160,v22
v_mov_b32 v164,v24
v_mfma_f32_16x16x32_bf16 v[88:91],v[40:43],v[244:247],v[88:91]
ds_read_b128 v[32:35],v8 offset:8192
v_permlane16_swap_b32 v160,v22
v_permlane16_swap_b32 v164,v24
v_mfma_f32_16x16x32_bf16 v[80:83],v[40:43],v[240:243],v[80:83]
v_max_f32 v22,v22,v160
v_max_f32 v24,v24,v164
v_mov_b32 v160,v22
v_mov_b32 v164,v24
v_mfma_f32_16x16x32_bf16 v[84:87],v[44:47],v[240:243],v[84:87]
ds_read_b128 v[36:39],v8 offset:12288
v_permlane32_swap_b32 v160,v22
v_permlane32_swap_b32 v164,v24
v_max_f32 v22,v22,v160
v_mfma_f32_16x16x32_bf16 v[92:95],v[44:47],v[244:247],v[92:95]
v_max_f32 v24,v24,v164
v_sub_f32 v160,0,v22
v_sub_f32 v164,0,v24
v_sub_f32 v161,0,v22
s_waitcnt lgkmcnt(2)
v_mfma_f32_16x16x32_bf16 v[104:107],v[48:51],v[244:247],v[104:107]
ds_read_b128 v[40:43],v9 offset:8192
v_sub_f32 v165,0,v24
v_sub_f32 v162,0,v22
v_mfma_f32_16x16x32_bf16 v[96:99],v[48:51],v[240:243],v[96:99]
v_sub_f32 v166,0,v24
v_sub_f32 v163,0,v22
v_sub_f32 v167,0,v24
v_mfma_f32_16x16x32_bf16 v[100:103],v[52:55],v[240:243],v[100:103]
ds_read_b128 v[44:47],v9 offset:12288
v_rcp_f32 v26,v168
v_rcp_f32 v27,v172
v_mfma_f32_16x16x32_bf16 v[108:111],v[52:55],v[244:247],v[108:111]
v_sub_f32 v128,v128,v22
v_sub_f32 v129,v129,v22
v_sub_f32 v130,v130,v22
v_mfma_f32_16x16x32_bf16 v[120:123],v[56:59],v[244:247],v[120:123]
ds_read_b128 v[48:51],v10 offset:8192
v_sub_f32 v131,v131,v22
v_sub_f32 v132,v132,v22
v_sub_f32 v133,v133,v22
v_mfma_f32_16x16x32_bf16 v[112:115],v[56:59],v[240:243],v[112:115]
v_sub_f32 v134,v134,v22
v_sub_f32 v135,v135,v22
v_sub_f32 v136,v136,v24
v_sub_f32 v137,v137,v24
v_mfma_f32_16x16x32_bf16 v[116:119],v[60:63],v[240:243],v[116:119]
ds_read_b128 v[52:55],v10 offset:12288
v_sub_f32 v138,v138,v24
v_sub_f32 v139,v139,v24
v_mfma_f32_16x16x32_bf16 v[124:127],v[60:63],v[244:247],v[124:127]
v_sub_f32 v140,v140,v24
v_sub_f32 v141,v141,v24
v_sub_f32 v142,v142,v24
v_sub_f32 v143,v143,v24
s_waitcnt lgkmcnt(2)
v_mfma_f32_16x16x32_bf16 v[144:147],v[32:35],v[176:179],v[160:163]
ds_read_b128 v[56:59],v11 offset:8192
v_mul_f32 v64,v64,v26
v_mul_f32 v65,v65,v26
v_mul_f32 v66,v66,v26
s_cmp_lt_u32 s32,s66
s_cbranch_scc0 L_nowo16
s_add_u32 m0,s59,90112
s_xor_b32 s42,s65,65536
s_add_u32 s42,s42,s64
buffer_load_dwordx4 v248,s[20:23],s42 offen lds
buffer_load_dwordx4 v249,s[20:23],s42 offen offset:1024 lds
buffer_load_dwordx4 v250,s[20:23],s42 offen offset:2048 lds
buffer_load_dwordx4 v251,s[20:23],s42 offen offset:3072 lds
L_nowo16:
v_mfma_f32_16x16x32_bf16 v[152:155],v[32:35],v[192:195],v[164:167]
v_mul_f32 v67,v67,v26
v_mul_f32 v68,v68,v26
v_mul_f32 v69,v69,v26
v_mul_f32 v70,v70,v26
v_mfma_f32_16x16x32_bf16 v[156:159],v[36:39],v[192:195],v[164:167]
ds_read_b128 v[60:63],v11 offset:12288
v_mul_f32 v71,v71,v26
v_cvt_pk_bf16_f32 v208,v64,v65
v_mfma_f32_16x16x32_bf16 v[148:151],v[36:39],v[176:179],v[160:163]
v_cvt_pk_bf16_f32 v209,v66,v67
v_cvt_pk_bf16_f32 v210,v68,v69
v_cvt_pk_bf16_f32 v211,v70,v71
v_mul_f32 v72,v72,v27
v_mul_f32 v73,v73,v27
v_mfma_f32_16x16x32_bf16 v[144:147],v[40:43],v[180:183],v[144:147]
ds_read_b64_tr_b16 v[32:33],v12 offset:40960
ds_read_b64_tr_b16 v[34:35],v12 offset:45056
v_mul_f32 v74,v74,v27
v_mfma_f32_16x16x32_bf16 v[152:155],v[40:43],v[196:199],v[152:155]
v_mul_f32 v75,v75,v27
v_mul_f32 v76,v76,v27
v_mul_f32 v77,v77,v27
v_mul_f32 v78,v78,v27
v_mfma_f32_16x16x32_bf16 v[156:159],v[44:47],v[196:199],v[156:159]
ds_read_b64_tr_b16 v[36:37],v13 offset:40960
ds_read_b64_tr_b16 v[38:39],v13 offset:45056
v_mul_f32 v79,v79,v27
v_mfma_f32_16x16x32_bf16 v[148:151],v[44:47],v[180:183],v[148:151]
v_cvt_pk_bf16_f32 v212,v72,v73
v_cvt_pk_bf16_f32 v213,v74,v75
v_cvt_pk_bf16_f32 v214,v76,v77
v_cvt_pk_bf16_f32 v215,v78,v79
s_waitcnt lgkmcnt(4)
v_mfma_f32_16x16x32_bf16 v[144:147],v[48:51],v[184:187],v[144:147]
ds_read_b64_tr_b16 v[40:41],v14 offset:40960
ds_read_b64_tr_b16 v[42:43],v14 offset:45056
v_exp_f32 v128,v128
v_mfma_f32_16x16x32_bf16 v[152:155],v[48:51],v[200:203],v[152:155]
v_exp_f32 v129,v129
v_exp_f32 v130,v130
v_mfma_f32_16x16x32_bf16 v[156:159],v[52:55],v[200:203],v[156:159]
ds_read_b64_tr_b16 v[44:45],v15 offset:40960
ds_read_b64_tr_b16 v[46:47],v15 offset:45056
v_mfma_f32_16x16x32_bf16 v[148:151],v[52:55],v[184:187],v[148:151]
v_cvt_pk_bf16_f32 v240,v128,v129
v_exp_f32 v131,v131
v_exp_f32 v132,v132
v_mfma_f32_16x16x32_bf16 v[144:147],v[56:59],v[188:191],v[144:147]
ds_read_b64_tr_b16 v[48:49],v16 offset:40960
ds_read_b64_tr_b16 v[50:51],v16 offset:45056
v_cvt_pk_bf16_f32 v241,v130,v131
v_mfma_f32_16x16x32_bf16 v[152:155],v[56:59],v[204:207],v[152:155]
v_exp_f32 v133,v133
v_exp_f32 v134,v134
v_mfma_f32_16x16x32_bf16 v[156:159],v[60:63],v[204:207],v[156:159]
ds_read_b64_tr_b16 v[52:53],v17 offset:40960
ds_read_b64_tr_b16 v[54:55],v17 offset:45056
v_cvt_pk_bf16_f32 v242,v132,v133
v_mfma_f32_16x16x32_bf16 v[148:151],v[60:63],v[188:191],v[148:151]
v_exp_f32 v135,v135
v_exp_f32 v136,v136
s_waitcnt vmcnt(4)
L_aloop1:
s_barrier
s_waitcnt lgkmcnt(4)
v_mfma_f32_16x16x32_bf16 a[0:3],v[32:35],v[208:211],a[0:3]
ds_read_b64_tr_b16 v[56:57],v18 offset:40960
ds_read_b64_tr_b16 v[58:59],v18 offset:45056
v_mul_f32 v80,v80,v26
v_cvt_pk_bf16_f32 v243,v134,v135
v_mfma_f32_16x16x32_bf16 a[8:11],v[32:35],v[212:215],a[8:11]
v_mul_f32 v81,v81,v26
v_exp_f32 v137,v137
v_mul_f32 v82,v82,v26
v_exp_f32 v138,v138
v_mul_f32 v83,v83,v26
v_cvt_pk_bf16_f32 v244,v136,v137
v_mul_f32 v84,v84,v26
v_mfma_f32_16x16x32_bf16 a[12:15],v[36:39],v[212:215],a[12:15]
ds_read_b64_tr_b16 v[60:61],v19 offset:40960
ds_read_b64_tr_b16 v[62:63],v19 offset:45056
v_exp_f32 v139,v139
v_mul_f32 v85,v85,v26
v_mfma_f32_16x16x32_bf16 a[4:7],v[36:39],v[208:211],a[4:7]
v_exp_f32 v140,v140
v_mul_f32 v86,v86,v26
v_cvt_pk_bf16_f32 v245,v138,v139
v_mul_f32 v87,v87,v26
v_exp_f32 v141,v141
v_cvt_pk_bf16_f32 v216,v80,v81
v_mfma_f32_16x16x32_bf16 a[16:19],v[40:43],v[208:211],a[16:19]
ds_read_b64_tr_b16 v[32:33],v12
ds_read_b64_tr_b16 v[34:35],v12 offset:4096
v_exp_f32 v142,v142
v_cvt_pk_bf16_f32 v217,v82,v83
v_mfma_f32_16x16x32_bf16 a[24:27],v[40:43],v[212:215],a[24:27]
v_cvt_pk_bf16_f32 v246,v140,v141
v_cvt_pk_bf16_f32 v218,v84,v85
v_exp_f32 v143,v143
v_cvt_pk_bf16_f32 v219,v86,v87
v_cvt_pk_bf16_f32 v247,v142,v143
v_mul_f32 v88,v88,v27
v_mul_f32 v89,v89,v27
v_mul_f32 v90,v90,v27
v_mfma_f32_16x16x32_bf16 a[28:31],v[44:47],v[212:215],a[28:31]
ds_read_b64_tr_b16 v[36:37],v13
ds_read_b64_tr_b16 v[38:39],v13 offset:4096
v_mul_f32 v91,v91,v27
v_mul_f32 v92,v92,v27
v_mfma_f32_16x16x32_bf16 a[20:23],v[44:47],v[208:211],a[20:23]
v_mul_f32 v93,v93,v27
v_mul_f32 v94,v94,v27
v_mul_f32 v95,v95,v27
v_cvt_pk_bf16_f32 v220,v88,v89
v_cvt_pk_bf16_f32 v221,v90,v91
v_cvt_pk_bf16_f32 v222,v92,v93
v_cvt_pk_bf16_f32 v223,v94,v95
v_mul_f32 v96,v96,v26
v_mul_f32 v97,v97,v26
v_mul_f32 v98,v98,v26
s_waitcnt lgkmcnt(4)
v_mfma_f32_16x16x32_bf16 a[32:35],v[48:51],v[208:211],a[32:35]
ds_read_b64_tr_b16 v[40:41],v14
ds_read_b64_tr_b16 v[42:43],v14 offset:4096
v_mul_f32 v99,v99,v26
v_mul_f32 v100,v100,v26
v_mfma_f32_16x16x32_bf16 a[40:43],v[48:51],v[212:215],a[40:43]
v_mul_f32 v101,v101,v26
v_mul_f32 v102,v102,v26
v_mul_f32 v103,v103,v26
v_cvt_pk_bf16_f32 v224,v96,v97
v_cvt_pk_bf16_f32 v225,v98,v99
v_cvt_pk_bf16_f32 v226,v100,v101
v_cvt_pk_bf16_f32 v227,v102,v103
v_mul_f32 v104,v104,v27
v_mul_f32 v105,v105,v27
v_mfma_f32_16x16x32_bf16 a[44:47],v[52:55],v[212:215],a[44:47]
ds_read_b64_tr_b16 v[44:45],v15
ds_read_b64_tr_b16 v[46:47],v15 offset:4096
v_mul_f32 v106,v106,v27
v_mul_f32 v107,v107,v27
v_mfma_f32_16x16x32_bf16 a[36:39],v[52:55],v[208:211],a[36:39]
v_mul_f32 v108,v108,v27
v_mul_f32 v109,v109,v27
v_mul_f32 v110,v110,v27
v_mul_f32 v111,v111,v27
v_cvt_pk_bf16_f32 v228,v104,v105
v_cvt_pk_bf16_f32 v229,v106,v107
v_cvt_pk_bf16_f32 v230,v108,v109
v_cvt_pk_bf16_f32 v231,v110,v111
v_mul_f32 v112,v112,v26
v_mfma_f32_16x16x32_bf16 a[48:51],v[56:59],v[208:211],a[48:51]
ds_read_b64_tr_b16 v[48:49],v16
ds_read_b64_tr_b16 v[50:51],v16 offset:4096
v_mul_f32 v113,v113,v26
v_mul_f32 v114,v114,v26
v_mul_f32 v115,v115,v26
v_mfma_f32_16x16x32_bf16 a[56:59],v[56:59],v[212:215],a[56:59]
v_mul_f32 v116,v116,v26
v_mul_f32 v117,v117,v26
v_mul_f32 v118,v118,v26
v_mul_f32 v119,v119,v26
v_cvt_pk_bf16_f32 v232,v112,v113
v_cvt_pk_bf16_f32 v233,v114,v115
v_cvt_pk_bf16_f32 v234,v116,v117
v_cvt_pk_bf16_f32 v235,v118,v119
v_mul_f32 v120,v120,v27
v_mfma_f32_16x16x32_bf16 a[60:63],v[60:63],v[212:215],a[60:63]
ds_read_b64_tr_b16 v[52:53],v17
ds_read_b64_tr_b16 v[54:55],v17 offset:4096
v_mul_f32 v121,v121,v27
v_mul_f32 v122,v122,v27
v_mfma_f32_16x16x32_bf16 a[52:55],v[60:63],v[208:211],a[52:55]
v_mul_f32 v123,v123,v27
v_mul_f32 v124,v124,v27
v_mul_f32 v125,v125,v27
v_mul_f32 v126,v126,v27
v_mul_f32 v127,v127,v27
v_cvt_pk_bf16_f32 v236,v120,v121
v_cvt_pk_bf16_f32 v237,v122,v123
v_cvt_pk_bf16_f32 v238,v124,v125
v_cvt_pk_bf16_f32 v239,v126,v127
v_mfma_f32_16x16x32_bf16 v[168:171],v[28:31],v[240:243],0
v_mfma_f32_16x16x32_bf16 v[172:175],v[28:31],v[244:247],0
s_waitcnt lgkmcnt(4)
v_mfma_f32_16x16x32_bf16 v[72:75],v[32:35],v[244:247],0
ds_read_b64_tr_b16 v[56:57],v18
ds_read_b64_tr_b16 v[58:59],v18 offset:4096
v_mfma_f32_16x16x32_bf16 v[64:67],v[32:35],v[240:243],0
v_mfma_f32_16x16x32_bf16 v[68:71],v[36:39],v[240:243],0
ds_read_b64_tr_b16 v[60:61],v19
ds_read_b64_tr_b16 v[62:63],v19 offset:4096
v_mfma_f32_16x16x32_bf16 v[76:79],v[36:39],v[244:247],0
v_max3_f32 v22,v144,v145,v146
v_mfma_f32_16x16x32_bf16 v[88:91],v[40:43],v[244:247],0
ds_read_b128 v[32:35],v8 offset:16384
v_max3_f32 v22,v22,v147,v148
v_mfma_f32_16x16x32_bf16 v[80:83],v[40:43],v[240:243],0
v_max3_f32 v22,v22,v149,v150
v_mfma_f32_16x16x32_bf16 v[84:87],v[44:47],v[240:243],0
ds_read_b128 v[36:39],v8 offset:20480
v_mfma_f32_16x16x32_bf16 v[92:95],v[44:47],v[244:247],0
v_max3_f32 v22,v22,v151,v152
s_waitcnt lgkmcnt(2)
v_mfma_f32_16x16x32_bf16 v[104:107],v[48:51],v[244:247],0
ds_read_b128 v[40:43],v9 offset:16384
v_max3_f32 v22,v22,v153,v154
v_mfma_f32_16x16x32_bf16 v[96:99],v[48:51],v[240:243],0
v_max3_f32 v22,v22,v155,v156
v_mfma_f32_16x16x32_bf16 v[100:103],v[52:55],v[240:243],0
ds_read_b128 v[44:47],v9 offset:20480
v_mfma_f32_16x16x32_bf16 v[108:111],v[52:55],v[244:247],0
v_max3_f32 v22,v22,v157,v158
v_mfma_f32_16x16x32_bf16 v[120:123],v[56:59],v[244:247],0
ds_read_b128 v[48:51],v10 offset:16384
v_max_f32 v22,v22,v159
v_mfma_f32_16x16x32_bf16 v[112:115],v[56:59],v[240:243],0
v_cmp_lt_f32 vcc,s43,v22
v_mfma_f32_16x16x32_bf16 v[116:119],v[60:63],v[240:243],0
ds_read_b128 v[52:55],v10 offset:20480
v_mfma_f32_16x16x32_bf16 v[124:127],v[60:63],v[244:247],0
s_cbranch_vccnz L_rare15
L_back15:
s_waitcnt lgkmcnt(2)
v_mfma_f32_16x16x32_bf16 v[128:131],v[32:35],v[176:179],v[160:163]
ds_read_b128 v[56:59],v11 offset:16384
v_exp_f32 v144,v144
s_cmp_lt_u32 s32,s66
s_cbranch_scc0 L_nowo17
s_add_u32 m0,s59,65536
s_xor_b32 s42,s65,98304
s_add_u32 s42,s42,s64
buffer_load_dwordx4 v248,s[20:23],s42 offen lds
buffer_load_dwordx4 v249,s[20:23],s42 offen offset:1024 lds
buffer_load_dwordx4 v250,s[20:23],s42 offen offset:2048 lds
buffer_load_dwordx4 v251,s[20:23],s42 offen offset:3072 lds
L_nowo17:
v_mfma_f32_16x16x32_bf16 v[136:139],v[32:35],v[192:195],v[164:167]
v_exp_f32 v145,v145
v_mfma_f32_16x16x32_bf16 v[140:143],v[36:39],v[192:195],v[164:167]
ds_read_b128 v[60:63],v11 offset:20480
v_mfma_f32_16x16x32_bf16 v[132:135],v[36:39],v[176:179],v[160:163]
v_exp_f32 v146,v146
v_mfma_f32_16x16x32_bf16 v[128:131],v[40:43],v[180:183],v[128:131]
ds_read_b64_tr_b16 v[32:33],v12 offset:49152
ds_read_b64_tr_b16 v[34:35],v12 offset:53248
v_cvt_pk_bf16_f32 v240,v144,v145
v_mfma_f32_16x16x32_bf16 v[136:139],v[40:43],v[196:199],v[136:139]
v_exp_f32 v147,v147
v_mfma_f32_16x16x32_bf16 v[140:143],v[44:47],v[196:199],v[140:143]
ds_read_b64_tr_b16 v[36:37],v13 offset:49152
ds_read_b64_tr_b16 v[38:39],v13 offset:53248
v_mfma_f32_16x16x32_bf16 v[132:135],v[44:47],v[180:183],v[132:135]
v_exp_f32 v148,v148
s_waitcnt lgkmcnt(4)
v_mfma_f32_16x16x32_bf16 v[128:131],v[48:51],v[184:187],v[128:131]
ds_read_b64_tr_b16 v[40:41],v14 offset:49152
ds_read_b64_tr_b16 v[42:43],v14 offset:53248
v_cvt_pk_bf16_f32 v241,v146,v147
v_mfma_f32_16x16x32_bf16 v[136:139],v[48:51],v[200:203],v[136:139]
v_exp_f32 v149,v149
v_mfma_f32_16x16x32_bf16 v[140:143],v[52:55],v[200:203],v[140:143]
ds_read_b64_tr_b16 v[44:45],v15 offset:49152
ds_read_b64_tr_b16 v[46:47],v15 offset:53248
v_mfma_f32_16x16x32_bf16 v[132:135],v[52:55],v[184:187],v[132:135]
v_exp_f32 v150,v150
v_mfma_f32_16x16x32_bf16 v[128:131],v[56:59],v[188:191],v[128:131]
ds_read_b64_tr_b16 v[48:49],v16 offset:49152
ds_read_b64_tr_b16 v[50:51],v16 offset:53248
v_mfma_f32_16x16x32_bf16 v[136:139],v[56:59],v[204:207],v[136:139]
v_cvt_pk_bf16_f32 v242,v148,v149
v_exp_f32 v151,v151
v_mfma_f32_16x16x32_bf16 v[140:143],v[60:63],v[204:207],v[140:143]
ds_read_b64_tr_b16 v[52:53],v17 offset:49152
ds_read_b64_tr_b16 v[54:55],v17 offset:53248
v_mfma_f32_16x16x32_bf16 v[132:135],v[60:63],v[188:191],v[132:135]
v_exp_f32 v152,v152
s_waitcnt vmcnt(4)
s_barrier
s_waitcnt lgkmcnt(4)
v_mfma_f32_16x16x32_bf16 a[0:3],v[32:35],v[216:219],a[0:3]
ds_read_b64_tr_b16 v[56:57],v18 offset:49152
ds_read_b64_tr_b16 v[58:59],v18 offset:53248
v_mfma_f32_16x16x32_bf16 a[8:11],v[32:35],v[220:223],a[8:11]
v_cvt_pk_bf16_f32 v243,v150,v151
v_exp_f32 v153,v153
v_mfma_f32_16x16x32_bf16 a[12:15],v[36:39],v[220:223],a[12:15]
ds_read_b64_tr_b16 v[60:61],v19 offset:49152
ds_read_b64_tr_b16 v[62:63],v19 offset:53248
v_mfma_f32_16x16x32_bf16 a[4:7],v[36:39],v[216:219],a[4:7]
v_exp_f32 v154,v154
v_mfma_f32_16x16x32_bf16 a[16:19],v[40:43],v[216:219],a[16:19]
ds_read_b64_tr_b16 v[32:33],v12 offset:8192
ds_read_b64_tr_b16 v[34:35],v12 offset:12288
v_mfma_f32_16x16x32_bf16 a[24:27],v[40:43],v[220:223],a[24:27]
v_cvt_pk_bf16_f32 v244,v152,v153
v_mfma_f32_16x16x32_bf16 a[28:31],v[44:47],v[220:223],a[28:31]
ds_read_b64_tr_b16 v[36:37],v13 offset:8192
ds_read_b64_tr_b16 v[38:39],v13 offset:12288
v_exp_f32 v155,v155
v_mfma_f32_16x16x32_bf16 a[20:23],v[44:47],v[216:219],a[20:23]
v_exp_f32 v156,v156
s_waitcnt lgkmcnt(4)
v_mfma_f32_16x16x32_bf16 a[32:35],v[48:51],v[216:219],a[32:35]
ds_read_b64_tr_b16 v[40:41],v14 offset:8192
ds_read_b64_tr_b16 v[42:43],v14 offset:12288
v_mfma_f32_16x16x32_bf16 a[40:43],v[48:51],v[220:223],a[40:43]
v_cvt_pk_bf16_f32 v245,v154,v155
v_mfma_f32_16x16x32_bf16 a[44:47],v[52:55],v[220:223],a[44:47]
ds_read_b64_tr_b16 v[44:45],v15 offset:8192
ds_read_b64_tr_b16 v[46:47],v15 offset:12288
v_exp_f32 v157,v157
v_mfma_f32_16x16x32_bf16 a[36:39],v[52:55],v[216:219],a[36:39]
v_exp_f32 v158,v158
v_mfma_f32_16x16x32_bf16 a[48:51],v[56:59],v[216:219],a[48:51]
ds_read_b64_tr_b16 v[48:49],v16 offset:8192
ds_read_b64_tr_b16 v[50:51],v16 offset:12288
v_mfma_f32_16x16x32_bf16 a[56:59],v[56:59],v[220:223],a[56:59]
v_cvt_pk_bf16_f32 v246,v156,v157
v_mfma_f32_16x16x32_bf16 a[60:63],v[60:63],v[220:223],a[60:63]
ds_read_b64_tr_b16 v[52:53],v17 offset:8192
ds_read_b64_tr_b16 v[54:55],v17 offset:12288
v_exp_f32 v159,v159
v_mfma_f32_16x16x32_bf16 a[52:55],v[60:63],v[216:219],a[52:55]
v_cvt_pk_bf16_f32 v247,v158,v159
v_mfma_f32_16x16x32_bf16 v[168:171],v[28:31],v[240:243],v[168:171]
s_nop 0
v_mfma_f32_16x16x32_bf16 v[172:175],v[28:31],v[244:247],v[172:175]
s_waitcnt lgkmcnt(4)
v_mfma_f32_16x16x32_bf16 v[72:75],v[32:35],v[244:247],v[72:75]
ds_read_b64_tr_b16 v[56:57],v18 offset:8192
ds_read_b64_tr_b16 v[58:59],v18 offset:12288
v_mfma_f32_16x16x32_bf16 v[64:67],v[32:35],v[240:243],v[64:67]
v_mfma_f32_16x16x32_bf16 v[68:71],v[36:39],v[240:243],v[68:71]
ds_read_b64_tr_b16 v[60:61],v19 offset:8192
ds_read_b64_tr_b16 v[62:63],v19 offset:12288
v_mfma_f32_16x16x32_bf16 v[76:79],v[36:39],v[244:247],v[76:79]
v_max3_f32 v22,v128,v129,v130
v_mfma_f32_16x16x32_bf16 v[88:91],v[40:43],v[244:247],v[88:91]
ds_read_b128 v[32:35],v8 offset:24576
v_max3_f32 v22,v22,v131,v132
v_mfma_f32_16x16x32_bf16 v[80:83],v[40:43],v[240:243],v[80:83]
v_max3_f32 v22,v22,v133,v134
v_mfma_f32_16x16x32_bf16 v[84:87],v[44:47],v[240:243],v[84:87]
ds_read_b128 v[36:39],v8 offset:28672
v_mfma_f32_16x16x32_bf16 v[92:95],v[44:47],v[244:247],v[92:95]
v_max3_f32 v22,v22,v135,v136
s_waitcnt lgkmcnt(2)
v_mfma_f32_16x16x32_bf16 v[104:107],v[48:51],v[244:247],v[104:107]
ds_read_b128 v[40:43],v9 offset:24576
v_max3_f32 v22,v22,v137,v138
v_mfma_f32_16x16x32_bf16 v[96:99],v[48:51],v[240:243],v[96:99]
v_max3_f32 v22,v22,v139,v140
v_mfma_f32_16x16x32_bf16 v[100:103],v[52:55],v[240:243],v[100:103]
ds_read_b128 v[44:47],v9 offset:28672
v_mfma_f32_16x16x32_bf16 v[108:111],v[52:55],v[244:247],v[108:111]
v_max3_f32 v22,v22,v141,v142
v_mfma_f32_16x16x32_bf16 v[120:123],v[56:59],v[244:247],v[120:123]
ds_read_b128 v[48:51],v10 offset:24576
v_max_f32 v22,v22,v143
v_mfma_f32_16x16x32_bf16 v[112:115],v[56:59],v[240:243],v[112:115]
v_cmp_lt_f32 vcc,s43,v22
v_mfma_f32_16x16x32_bf16 v[116:119],v[60:63],v[240:243],v[116:119]
ds_read_b128 v[52:55],v10 offset:28672
v_mfma_f32_16x16x32_bf16 v[124:127],v[60:63],v[244:247],v[124:127]
s_cbranch_vccnz L_rare16
L_back16:
s_waitcnt lgkmcnt(2)
v_mfma_f32_16x16x32_bf16 v[144:147],v[32:35],v[176:179],v[160:163]
ds_read_b128 v[56:59],v11 offset:24576
v_exp_f32 v128,v128
s_cmp_lt_u32 s32,s66
s_cbranch_scc0 L_nowo18
s_add_u32 m0,s59,73728
s_xor_b32 s42,s65,256
s_add_u32 s42,s42,s64
buffer_load_dwordx4 v248,s[20:23],s42 offen lds
buffer_load_dwordx4 v249,s[20:23],s42 offen offset:1024 lds
buffer_load_dwordx4 v250,s[20:23],s42 offen offset:2048 lds
buffer_load_dwordx4 v251,s[20:23],s42 offen offset:3072 lds
L_nowo18:
v_mfma_f32_16x16x32_bf16 v[152:155],v[32:35],v[192:195],v[164:167]
v_exp_f32 v129,v129
v_mfma_f32_16x16x32_bf16 v[156:159],v[36:39],v[192:195],v[164:167]
ds_read_b128 v[60:63],v11 offset:28672
v_mfma_f32_16x16x32_bf16 v[148:151],v[36:39],v[176:179],v[160:163]
v_exp_f32 v130,v130
v_mfma_f32_16x16x32_bf16 v[144:147],v[40:43],v[180:183],v[144:147]
ds_read_b64_tr_b16 v[32:33],v12 offset:57344
ds_read_b64_tr_b16 v[34:35],v12 offset:61440
v_cvt_pk_bf16_f32 v240,v128,v129
v_mfma_f32_16x16x32_bf16 v[152:155],v[40:43],v[196:199],v[152:155]
v_exp_f32 v131,v131
v_mfma_f32_16x16x32_bf16 v[156:159],v[44:47],v[196:199],v[156:159]
ds_read_b64_tr_b16 v[36:37],v13 offset:57344
ds_read_b64_tr_b16 v[38:39],v13 offset:61440
v_mfma_f32_16x16x32_bf16 v[148:151],v[44:47],v[180:183],v[148:151]
v_exp_f32 v132,v132
s_waitcnt lgkmcnt(4)
v_mfma_f32_16x16x32_bf16 v[144:147],v[48:51],v[184:187],v[144:147]
ds_read_b64_tr_b16 v[40:41],v14 offset:57344
ds_read_b64_tr_b16 v[42:43],v14 offset:61440
v_cvt_pk_bf16_f32 v241,v130,v131
v_mfma_f32_16x16x32_bf16 v[152:155],v[48:51],v[200:203],v[152:155]
v_exp_f32 v133,v133
v_mfma_f32_16x16x32_bf16 v[156:159],v[52:55],v[200:203],v[156:159]
ds_read_b64_tr_b16 v[44:45],v15 offset:57344
ds_read_b64_tr_b16 v[46:47],v15 offset:61440
v_mfma_f32_16x16x32_bf16 v[148:151],v[52:55],v[184:187],v[148:151]
v_exp_f32 v134,v134
v_mfma_f32_16x16x32_bf16 v[144:147],v[56:59],v[188:191],v[144:147]
ds_read_b64_tr_b16 v[48:49],v16 offset:57344
ds_read_b64_tr_b16 v[50:51],v16 offset:61440
v_mfma_f32_16x16x32_bf16 v[152:155],v[56:59],v[204:207],v[152:155]
v_cvt_pk_bf16_f32 v242,v132,v133
v_exp_f32 v135,v135
v_mfma_f32_16x16x32_bf16 v[156:159],v[60:63],v[204:207],v[156:159]
ds_read_b64_tr_b16 v[52:53],v17 offset:57344
ds_read_b64_tr_b16 v[54:55],v17 offset:61440
v_mfma_f32_16x16x32_bf16 v[148:151],v[60:63],v[188:191],v[148:151]
v_exp_f32 v136,v136
s_waitcnt vmcnt(4)
s_barrier
s_waitcnt lgkmcnt(4)
v_mfma_f32_16x16x32_bf16 a[0:3],v[32:35],v[224:227],a[0:3]
ds_read_b64_tr_b16 v[56:57],v18 offset:57344
ds_read_b64_tr_b16 v[58:59],v18 offset:61440
v_mfma_f32_16x16x32_bf16 a[8:11],v[32:35],v[228:231],a[8:11]
v_cvt_pk_bf16_f32 v243,v134,v135
v_exp_f32 v137,v137
v_mfma_f32_16x16x32_bf16 a[12:15],v[36:39],v[228:231],a[12:15]
ds_read_b64_tr_b16 v[60:61],v19 offset:57344
ds_read_b64_tr_b16 v[62:63],v19 offset:61440
v_mfma_f32_16x16x32_bf16 a[4:7],v[36:39],v[224:227],a[4:7]
v_exp_f32 v138,v138
v_mfma_f32_16x16x32_bf16 a[16:19],v[40:43],v[224:227],a[16:19]
ds_read_b64_tr_b16 v[32:33],v12 offset:16384
ds_read_b64_tr_b16 v[34:35],v12 offset:20480
v_mfma_f32_16x16x32_bf16 a[24:27],v[40:43],v[228:231],a[24:27]
v_cvt_pk_bf16_f32 v244,v136,v137
v_mfma_f32_16x16x32_bf16 a[28:31],v[44:47],v[228:231],a[28:31]
ds_read_b64_tr_b16 v[36:37],v13 offset:16384
ds_read_b64_tr_b16 v[38:39],v13 offset:20480
v_exp_f32 v139,v139
v_mfma_f32_16x16x32_bf16 a[20:23],v[44:47],v[224:227],a[20:23]
v_exp_f32 v140,v140
s_waitcnt lgkmcnt(4)
v_mfma_f32_16x16x32_bf16 a[32:35],v[48:51],v[224:227],a[32:35]
ds_read_b64_tr_b16 v[40:41],v14 offset:16384
ds_read_b64_tr_b16 v[42:43],v14 offset:20480
v_mfma_f32_16x16x32_bf16 a[40:43],v[48:51],v[228:231],a[40:43]
v_cvt_pk_bf16_f32 v245,v138,v139
v_mfma_f32_16x16x32_bf16 a[44:47],v[52:55],v[228:231],a[44:47]
ds_read_b64_tr_b16 v[44:45],v15 offset:16384
ds_read_b64_tr_b16 v[46:47],v15 offset:20480
v_exp_f32 v141,v141
v_mfma_f32_16x16x32_bf16 a[36:39],v[52:55],v[224:227],a[36:39]
v_exp_f32 v142,v142
v_mfma_f32_16x16x32_bf16 a[48:51],v[56:59],v[224:227],a[48:51]
ds_read_b64_tr_b16 v[48:49],v16 offset:16384
ds_read_b64_tr_b16 v[50:51],v16 offset:20480
v_mfma_f32_16x16x32_bf16 a[56:59],v[56:59],v[228:231],a[56:59]
v_cvt_pk_bf16_f32 v246,v140,v141
v_mfma_f32_16x16x32_bf16 a[60:63],v[60:63],v[228:231],a[60:63]
ds_read_b64_tr_b16 v[52:53],v17 offset:16384
ds_read_b64_tr_b16 v[54:55],v17 offset:20480
v_exp_f32 v143,v143
v_mfma_f32_16x16x32_bf16 a[52:55],v[60:63],v[224:227],a[52:55]
v_cvt_pk_bf16_f32 v247,v142,v143
v_mfma_f32_16x16x32_bf16 v[168:171],v[28:31],v[240:243],v[168:171]
s_nop 0
v_mfma_f32_16x16x32_bf16 v[172:175],v[28:31],v[244:247],v[172:175]
s_waitcnt lgkmcnt(4)
v_mfma_f32_16x16x32_bf16 v[72:75],v[32:35],v[244:247],v[72:75]
ds_read_b64_tr_b16 v[56:57],v18 offset:16384
ds_read_b64_tr_b16 v[58:59],v18 offset:20480
v_mfma_f32_16x16x32_bf16 v[64:67],v[32:35],v[240:243],v[64:67]
v_mfma_f32_16x16x32_bf16 v[68:71],v[36:39],v[240:243],v[68:71]
ds_read_b64_tr_b16 v[60:61],v19 offset:16384
ds_read_b64_tr_b16 v[62:63],v19 offset:20480
v_mfma_f32_16x16x32_bf16 v[76:79],v[36:39],v[244:247],v[76:79]
v_max3_f32 v22,v144,v145,v146
v_mfma_f32_16x16x32_bf16 v[88:91],v[40:43],v[244:247],v[88:91]
ds_read_b128 v[32:35],v8
v_max3_f32 v22,v22,v147,v148
v_mfma_f32_16x16x32_bf16 v[80:83],v[40:43],v[240:243],v[80:83]
v_max3_f32 v22,v22,v149,v150
v_mfma_f32_16x16x32_bf16 v[84:87],v[44:47],v[240:243],v[84:87]
ds_read_b128 v[36:39],v8 offset:4096
v_mfma_f32_16x16x32_bf16 v[92:95],v[44:47],v[244:247],v[92:95]
v_max3_f32 v22,v22,v151,v152
s_waitcnt lgkmcnt(2)
v_mfma_f32_16x16x32_bf16 v[104:107],v[48:51],v[244:247],v[104:107]
ds_read_b128 v[40:43],v9
v_max3_f32 v22,v22,v153,v154
v_mfma_f32_16x16x32_bf16 v[96:99],v[48:51],v[240:243],v[96:99]
v_max3_f32 v22,v22,v155,v156
v_mfma_f32_16x16x32_bf16 v[100:103],v[52:55],v[240:243],v[100:103]
ds_read_b128 v[44:47],v9 offset:4096
v_mfma_f32_16x16x32_bf16 v[108:111],v[52:55],v[244:247],v[108:111]
v_max3_f32 v22,v22,v157,v158
v_mfma_f32_16x16x32_bf16 v[120:123],v[56:59],v[244:247],v[120:123]
ds_read_b128 v[48:51],v10
v_max_f32 v22,v22,v159
v_mfma_f32_16x16x32_bf16 v[112:115],v[56:59],v[240:243],v[112:115]
v_cmp_lt_f32 vcc,s43,v22
v_mfma_f32_16x16x32_bf16 v[116:119],v[60:63],v[240:243],v[116:119]
ds_read_b128 v[52:55],v10 offset:4096
v_mfma_f32_16x16x32_bf16 v[124:127],v[60:63],v[244:247],v[124:127]
s_cbranch_vccnz L_rare17
L_back17:
s_waitcnt lgkmcnt(2)
v_mfma_f32_16x16x32_bf16 v[128:131],v[32:35],v[176:179],v[160:163]
ds_read_b128 v[56:59],v11
v_exp_f32 v144,v144
s_cmp_lt_u32 s32,s66
s_cbranch_scc0 L_nowo19
s_add_u32 m0,s59,81920
s_xor_b32 s42,s65,33024
L_tp_a4:
s_cbranch_execz L_tp_a7
s_add_u32 s42,s42,s64
buffer_load_dwordx4 v248,s[20:23],s42 offen lds
buffer_load_dwordx4 v249,s[20:23],s42 offen offset:1024 lds
buffer_load_dwordx4 v250,s[20:23],s42 offen offset:2048 lds
buffer_load_dwordx4 v251,s[20:23],s42 offen offset:3072 lds
L_nowo19:
v_mfma_f32_16x16x32_bf16 v[136:139],v[32:35],v[192:195],v[164:167]
v_exp_f32 v145,v145
v_mfma_f32_16x16x32_bf16 v[140:143],v[36:39],v[192:195],v[164:167]
ds_read_b128 v[60:63],v11 offset:4096
v_mfma_f32_16x16x32_bf16 v[132:135],v[36:39],v[176:179],v[160:163]
v_exp_f32 v146,v146
v_mfma_f32_16x16x32_bf16 v[128:131],v[40:43],v[180:183],v[128:131]
ds_read_b64_tr_b16 v[32:33],v12 offset:32768
ds_read_b64_tr_b16 v[34:35],v12 offset:36864
v_cvt_pk_bf16_f32 v240,v144,v145
v_mfma_f32_16x16x32_bf16 v[136:139],v[40:43],v[196:199],v[136:139]
v_exp_f32 v147,v147
v_mfma_f32_16x16x32_bf16 v[140:143],v[44:47],v[196:199],v[140:143]
ds_read_b64_tr_b16 v[36:37],v13 offset:32768
ds_read_b64_tr_b16 v[38:39],v13 offset:36864
v_mfma_f32_16x16x32_bf16 v[132:135],v[44:47],v[180:183],v[132:135]
v_exp_f32 v148,v148
s_waitcnt lgkmcnt(4)
v_mfma_f32_16x16x32_bf16 v[128:131],v[48:51],v[184:187],v[128:131]
ds_read_b64_tr_b16 v[40:41],v14 offset:32768
ds_read_b64_tr_b16 v[42:43],v14 offset:36864
v_cvt_pk_bf16_f32 v241,v146,v147
v_mfma_f32_16x16x32_bf16 v[136:139],v[48:51],v[200:203],v[136:139]
v_exp_f32 v149,v149
v_mfma_f32_16x16x32_bf16 v[140:143],v[52:55],v[200:203],v[140:143]
ds_read_b64_tr_b16 v[44:45],v15 offset:32768
ds_read_b64_tr_b16 v[46:47],v15 offset:36864
v_mfma_f32_16x16x32_bf16 v[132:135],v[52:55],v[184:187],v[132:135]
v_exp_f32 v150,v150
v_mfma_f32_16x16x32_bf16 v[128:131],v[56:59],v[188:191],v[128:131]
ds_read_b64_tr_b16 v[48:49],v16 offset:32768
ds_read_b64_tr_b16 v[50:51],v16 offset:36864
v_mfma_f32_16x16x32_bf16 v[136:139],v[56:59],v[204:207],v[136:139]
v_cvt_pk_bf16_f32 v242,v148,v149
v_exp_f32 v151,v151
v_mfma_f32_16x16x32_bf16 v[140:143],v[60:63],v[204:207],v[140:143]
ds_read_b64_tr_b16 v[52:53],v17 offset:32768
ds_read_b64_tr_b16 v[54:55],v17 offset:36864
v_mfma_f32_16x16x32_bf16 v[132:135],v[60:63],v[188:191],v[132:135]
v_exp_f32 v152,v152
s_waitcnt vmcnt(4)
s_barrier
s_waitcnt lgkmcnt(4)
v_mfma_f32_16x16x32_bf16 a[0:3],v[32:35],v[232:235],a[0:3]
ds_read_b64_tr_b16 v[56:57],v18 offset:32768
ds_read_b64_tr_b16 v[58:59],v18 offset:36864
v_mfma_f32_16x16x32_bf16 a[8:11],v[32:35],v[236:239],a[8:11]
v_cvt_pk_bf16_f32 v243,v150,v151
v_exp_f32 v153,v153
v_mfma_f32_16x16x32_bf16 a[12:15],v[36:39],v[236:239],a[12:15]
ds_read_b64_tr_b16 v[60:61],v19 offset:32768
ds_read_b64_tr_b16 v[62:63],v19 offset:36864
v_mfma_f32_16x16x32_bf16 a[4:7],v[36:39],v[232:235],a[4:7]
v_exp_f32 v154,v154
v_mfma_f32_16x16x32_bf16 a[16:19],v[40:43],v[232:235],a[16:19]
ds_read_b64_tr_b16 v[32:33],v12 offset:24576
ds_read_b64_tr_b16 v[34:35],v12 offset:28672
v_mfma_f32_16x16x32_bf16 a[24:27],v[40:43],v[236:239],a[24:27]
v_cvt_pk_bf16_f32 v244,v152,v153
v_mfma_f32_16x16x32_bf16 a[28:31],v[44:47],v[236:239],a[28:31]
ds_read_b64_tr_b16 v[36:37],v13 offset:24576
ds_read_b64_tr_b16 v[38:39],v13 offset:28672
v_exp_f32 v155,v155
v_mfma_f32_16x16x32_bf16 a[20:23],v[44:47],v[232:235],a[20:23]
v_exp_f32 v156,v156
s_waitcnt lgkmcnt(4)
v_mfma_f32_16x16x32_bf16 a[32:35],v[48:51],v[232:235],a[32:35]
ds_read_b64_tr_b16 v[40:41],v14 offset:24576
ds_read_b64_tr_b16 v[42:43],v14 offset:28672
v_mfma_f32_16x16x32_bf16 a[40:43],v[48:51],v[236:239],a[40:43]
v_cvt_pk_bf16_f32 v245,v154,v155
v_mfma_f32_16x16x32_bf16 a[44:47],v[52:55],v[236:239],a[44:47]
ds_read_b64_tr_b16 v[44:45],v15 offset:24576
ds_read_b64_tr_b16 v[46:47],v15 offset:28672
v_exp_f32 v157,v157
v_mfma_f32_16x16x32_bf16 a[36:39],v[52:55],v[232:235],a[36:39]
v_exp_f32 v158,v158
v_mfma_f32_16x16x32_bf16 a[48:51],v[56:59],v[232:235],a[48:51]
ds_read_b64_tr_b16 v[48:49],v16 offset:24576
ds_read_b64_tr_b16 v[50:51],v16 offset:28672
v_mfma_f32_16x16x32_bf16 a[56:59],v[56:59],v[236:239],a[56:59]
v_cvt_pk_bf16_f32 v246,v156,v157
v_mfma_f32_16x16x32_bf16 a[60:63],v[60:63],v[236:239],a[60:63]
ds_read_b64_tr_b16 v[52:53],v17 offset:24576
ds_read_b64_tr_b16 v[54:55],v17 offset:28672
v_exp_f32 v159,v159
v_mfma_f32_16x16x32_bf16 a[52:55],v[60:63],v[232:235],a[52:55]
v_cvt_pk_bf16_f32 v247,v158,v159
v_mfma_f32_16x16x32_bf16 v[168:171],v[28:31],v[240:243],v[168:171]
s_nop 0
v_mfma_f32_16x16x32_bf16 v[172:175],v[28:31],v[244:247],v[172:175]
s_waitcnt lgkmcnt(4)
v_mfma_f32_16x16x32_bf16 v[72:75],v[32:35],v[244:247],v[72:75]
ds_read_b64_tr_b16 v[56:57],v18 offset:24576
ds_read_b64_tr_b16 v[58:59],v18 offset:28672
v_mfma_f32_16x16x32_bf16 v[64:67],v[32:35],v[240:243],v[64:67]
v_mfma_f32_16x16x32_bf16 v[68:71],v[36:39],v[240:243],v[68:71]
ds_read_b64_tr_b16 v[60:61],v19 offset:24576
ds_read_b64_tr_b16 v[62:63],v19 offset:28672
v_mfma_f32_16x16x32_bf16 v[76:79],v[36:39],v[244:247],v[76:79]
v_max3_f32 v22,v128,v129,v130
v_mfma_f32_16x16x32_bf16 v[88:91],v[40:43],v[244:247],v[88:91]
ds_read_b128 v[32:35],v8 offset:8192
v_max3_f32 v22,v22,v131,v132
v_mfma_f32_16x16x32_bf16 v[80:83],v[40:43],v[240:243],v[80:83]
v_max3_f32 v22,v22,v133,v134
v_mfma_f32_16x16x32_bf16 v[84:87],v[44:47],v[240:243],v[84:87]
ds_read_b128 v[36:39],v8 offset:12288
v_mfma_f32_16x16x32_bf16 v[92:95],v[44:47],v[244:247],v[92:95]
v_max3_f32 v22,v22,v135,v136
s_waitcnt lgkmcnt(2)
v_mfma_f32_16x16x32_bf16 v[104:107],v[48:51],v[244:247],v[104:107]
ds_read_b128 v[40:43],v9 offset:8192
v_max3_f32 v22,v22,v137,v138
v_mfma_f32_16x16x32_bf16 v[96:99],v[48:51],v[240:243],v[96:99]
v_max3_f32 v22,v22,v139,v140
v_mfma_f32_16x16x32_bf16 v[100:103],v[52:55],v[240:243],v[100:103]
ds_read_b128 v[44:47],v9 offset:12288
v_mfma_f32_16x16x32_bf16 v[108:111],v[52:55],v[244:247],v[108:111]
v_max3_f32 v22,v22,v141,v142
v_mfma_f32_16x16x32_bf16 v[120:123],v[56:59],v[244:247],v[120:123]
ds_read_b128 v[48:51],v10 offset:8192
v_max_f32 v22,v22,v143
v_mfma_f32_16x16x32_bf16 v[112:115],v[56:59],v[240:243],v[112:115]
v_cmp_lt_f32 vcc,s43,v22
v_mfma_f32_16x16x32_bf16 v[116:119],v[60:63],v[240:243],v[116:119]
ds_read_b128 v[52:55],v10 offset:12288
v_mfma_f32_16x16x32_bf16 v[124:127],v[60:63],v[244:247],v[124:127]
s_cbranch_vccnz L_rare18
L_back18:
s_waitcnt lgkmcnt(2)
v_mfma_f32_16x16x32_bf16 v[144:147],v[32:35],v[176:179],v[160:163]
ds_read_b128 v[56:59],v11 offset:8192
v_exp_f32 v128,v128
s_cmp_lt_u32 s32,s66
s_cbranch_scc0 L_nowo20
s_add_u32 m0,s59,90112
s_xor_b32 s42,s65,65792
s_add_u32 s42,s42,s64
buffer_load_dwordx4 v248,s[20:23],s42 offen lds
buffer_load_dwordx4 v249,s[20:23],s42 offen offset:1024 lds
buffer_load_dwordx4 v250,s[20:23],s42 offen offset:2048 lds
buffer_load_dwordx4 v251,s[20:23],s42 offen offset:3072 lds
L_nowo20:
v_mfma_f32_16x16x32_bf16 v[152:155],v[32:35],v[192:195],v[164:167]
v_exp_f32 v129,v129
v_mfma_f32_16x16x32_bf16 v[156:159],v[36:39],v[192:195],v[164:167]
ds_read_b128 v[60:63],v11 offset:12288
v_mfma_f32_16x16x32_bf16 v[148:151],v[36:39],v[176:179],v[160:163]
v_exp_f32 v130,v130
v_mfma_f32_16x16x32_bf16 v[144:147],v[40:43],v[180:183],v[144:147]
ds_read_b64_tr_b16 v[32:33],v12 offset:40960
ds_read_b64_tr_b16 v[34:35],v12 offset:45056
v_cvt_pk_bf16_f32 v240,v128,v129
v_mfma_f32_16x16x32_bf16 v[152:155],v[40:43],v[196:199],v[152:155]
v_exp_f32 v131,v131
v_mfma_f32_16x16x32_bf16 v[156:159],v[44:47],v[196:199],v[156:159]
ds_read_b64_tr_b16 v[36:37],v13 offset:40960
ds_read_b64_tr_b16 v[38:39],v13 offset:45056
v_mfma_f32_16x16x32_bf16 v[148:151],v[44:47],v[180:183],v[148:151]
v_exp_f32 v132,v132
s_waitcnt lgkmcnt(4)
v_mfma_f32_16x16x32_bf16 v[144:147],v[48:51],v[184:187],v[144:147]
ds_read_b64_tr_b16 v[40:41],v14 offset:40960
ds_read_b64_tr_b16 v[42:43],v14 offset:45056
v_cvt_pk_bf16_f32 v241,v130,v131
v_mfma_f32_16x16x32_bf16 v[152:155],v[48:51],v[200:203],v[152:155]
v_exp_f32 v133,v133
v_mfma_f32_16x16x32_bf16 v[156:159],v[52:55],v[200:203],v[156:159]
ds_read_b64_tr_b16 v[44:45],v15 offset:40960
ds_read_b64_tr_b16 v[46:47],v15 offset:45056
v_mfma_f32_16x16x32_bf16 v[148:151],v[52:55],v[184:187],v[148:151]
v_exp_f32 v134,v134
v_mfma_f32_16x16x32_bf16 v[144:147],v[56:59],v[188:191],v[144:147]
ds_read_b64_tr_b16 v[48:49],v16 offset:40960
ds_read_b64_tr_b16 v[50:51],v16 offset:45056
v_mfma_f32_16x16x32_bf16 v[152:155],v[56:59],v[204:207],v[152:155]
v_cvt_pk_bf16_f32 v242,v132,v133
v_exp_f32 v135,v135
v_mfma_f32_16x16x32_bf16 v[156:159],v[60:63],v[204:207],v[156:159]
ds_read_b64_tr_b16 v[52:53],v17 offset:40960
ds_read_b64_tr_b16 v[54:55],v17 offset:45056
v_mfma_f32_16x16x32_bf16 v[148:151],v[60:63],v[188:191],v[148:151]
v_exp_f32 v136,v136
s_waitcnt vmcnt(4)
s_barrier
s_waitcnt lgkmcnt(4)
v_mfma_f32_16x16x32_bf16 a[64:67],v[32:35],v[208:211],a[64:67]
ds_read_b64_tr_b16 v[56:57],v18 offset:40960
ds_read_b64_tr_b16 v[58:59],v18 offset:45056
v_mfma_f32_16x16x32_bf16 a[72:75],v[32:35],v[212:215],a[72:75]
v_cvt_pk_bf16_f32 v243,v134,v135
v_exp_f32 v137,v137
v_mfma_f32_16x16x32_bf16 a[76:79],v[36:39],v[212:215],a[76:79]
ds_read_b64_tr_b16 v[60:61],v19 offset:40960
ds_read_b64_tr_b16 v[62:63],v19 offset:45056
v_mfma_f32_16x16x32_bf16 a[68:71],v[36:39],v[208:211],a[68:71]
v_exp_f32 v138,v138
v_mfma_f32_16x16x32_bf16 a[80:83],v[40:43],v[208:211],a[80:83]
ds_read_b64_tr_b16 v[32:33],v12
ds_read_b64_tr_b16 v[34:35],v12 offset:4096
v_mfma_f32_16x16x32_bf16 a[88:91],v[40:43],v[212:215],a[88:91]
v_cvt_pk_bf16_f32 v244,v136,v137
v_mfma_f32_16x16x32_bf16 a[92:95],v[44:47],v[212:215],a[92:95]
ds_read_b64_tr_b16 v[36:37],v13
ds_read_b64_tr_b16 v[38:39],v13 offset:4096
v_exp_f32 v139,v139
v_mfma_f32_16x16x32_bf16 a[84:87],v[44:47],v[208:211],a[84:87]
v_exp_f32 v140,v140
s_waitcnt lgkmcnt(4)
v_mfma_f32_16x16x32_bf16 a[96:99],v[48:51],v[208:211],a[96:99]
ds_read_b64_tr_b16 v[40:41],v14
ds_read_b64_tr_b16 v[42:43],v14 offset:4096
v_mfma_f32_16x16x32_bf16 a[104:107],v[48:51],v[212:215],a[104:107]
v_cvt_pk_bf16_f32 v245,v138,v139
v_mfma_f32_16x16x32_bf16 a[108:111],v[52:55],v[212:215],a[108:111]
ds_read_b64_tr_b16 v[44:45],v15
ds_read_b64_tr_b16 v[46:47],v15 offset:4096
v_exp_f32 v141,v141
v_mfma_f32_16x16x32_bf16 a[100:103],v[52:55],v[208:211],a[100:103]
v_exp_f32 v142,v142
v_mfma_f32_16x16x32_bf16 a[112:115],v[56:59],v[208:211],a[112:115]
ds_read_b64_tr_b16 v[48:49],v16
ds_read_b64_tr_b16 v[50:51],v16 offset:4096
v_mfma_f32_16x16x32_bf16 a[120:123],v[56:59],v[212:215],a[120:123]
v_cvt_pk_bf16_f32 v246,v140,v141
v_mfma_f32_16x16x32_bf16 a[124:127],v[60:63],v[212:215],a[124:127]
ds_read_b64_tr_b16 v[52:53],v17
ds_read_b64_tr_b16 v[54:55],v17 offset:4096
v_exp_f32 v143,v143
v_mfma_f32_16x16x32_bf16 a[116:119],v[60:63],v[208:211],a[116:119]
v_cvt_pk_bf16_f32 v247,v142,v143
v_mfma_f32_16x16x32_bf16 v[168:171],v[28:31],v[240:243],v[168:171]
s_nop 0
v_mfma_f32_16x16x32_bf16 v[172:175],v[28:31],v[244:247],v[172:175]
s_waitcnt lgkmcnt(4)
v_mfma_f32_16x16x32_bf16 v[72:75],v[32:35],v[244:247],v[72:75]
ds_read_b64_tr_b16 v[56:57],v18
ds_read_b64_tr_b16 v[58:59],v18 offset:4096
v_mfma_f32_16x16x32_bf16 v[64:67],v[32:35],v[240:243],v[64:67]
v_mfma_f32_16x16x32_bf16 v[68:71],v[36:39],v[240:243],v[68:71]
ds_read_b64_tr_b16 v[60:61],v19
ds_read_b64_tr_b16 v[62:63],v19 offset:4096
v_mfma_f32_16x16x32_bf16 v[76:79],v[36:39],v[244:247],v[76:79]
v_max3_f32 v22,v144,v145,v146
v_mfma_f32_16x16x32_bf16 v[88:91],v[40:43],v[244:247],v[88:91]
ds_read_b128 v[32:35],v8 offset:16384
v_max3_f32 v22,v22,v147,v148
v_mfma_f32_16x16x32_bf16 v[80:83],v[40:43],v[240:243],v[80:83]
v_max3_f32 v22,v22,v149,v150
v_mfma_f32_16x16x32_bf16 v[84:87],v[44:47],v[240:243],v[84:87]
ds_read_b128 v[36:39],v8 offset:20480
v_mfma_f32_16x16x32_bf16 v[92:95],v[44:47],v[244:247],v[92:95]
v_max3_f32 v22,v22,v151,v152
s_waitcnt lgkmcnt(2)
v_mfma_f32_16x16x32_bf16 v[104:107],v[48:51],v[244:247],v[104:107]
ds_read_b128 v[40:43],v9 offset:16384
v_max3_f32 v22,v22,v153,v154
v_mfma_f32_16x16x32_bf16 v[96:99],v[48:51],v[240:243],v[96:99]
v_max3_f32 v22,v22,v155,v156
v_mfma_f32_16x16x32_bf16 v[100:103],v[52:55],v[240:243],v[100:103]
ds_read_b128 v[44:47],v9 offset:20480
v_mfma_f32_16x16x32_bf16 v[108:111],v[52:55],v[244:247],v[108:111]
v_max3_f32 v22,v22,v157,v158
v_mfma_f32_16x16x32_bf16 v[120:123],v[56:59],v[244:247],v[120:123]
ds_read_b128 v[48:51],v10 offset:16384
v_max_f32 v22,v22,v159
v_mfma_f32_16x16x32_bf16 v[112:115],v[56:59],v[240:243],v[112:115]
v_cmp_lt_f32 vcc,s43,v22
v_mfma_f32_16x16x32_bf16 v[116:119],v[60:63],v[240:243],v[116:119]
ds_read_b128 v[52:55],v10 offset:20480
v_mfma_f32_16x16x32_bf16 v[124:127],v[60:63],v[244:247],v[124:127]
s_cbranch_vccnz L_rare19
L_back19:
s_waitcnt lgkmcnt(2)
v_mfma_f32_16x16x32_bf16 v[128:131],v[32:35],v[176:179],v[160:163]
ds_read_b128 v[56:59],v11 offset:16384
v_exp_f32 v144,v144
s_cmp_lt_u32 s32,s66
s_cbranch_scc0 L_nowo21
s_add_u32 m0,s59,65536
s_xor_b32 s42,s65,98560
s_add_u32 s42,s42,s64
buffer_load_dwordx4 v248,s[20:23],s42 offen lds
buffer_load_dwordx4 v249,s[20:23],s42 offen offset:1024 lds
buffer_load_dwordx4 v250,s[20:23],s42 offen offset:2048 lds
buffer_load_dwordx4 v251,s[20:23],s42 offen offset:3072 lds
L_nowo21:
v_mfma_f32_16x16x32_bf16 v[136:139],v[32:35],v[192:195],v[164:167]
v_exp_f32 v145,v145
v_mfma_f32_16x16x32_bf16 v[140:143],v[36:39],v[192:195],v[164:167]
ds_read_b128 v[60:63],v11 offset:20480
v_mfma_f32_16x16x32_bf16 v[132:135],v[36:39],v[176:179],v[160:163]
v_exp_f32 v146,v146
v_mfma_f32_16x16x32_bf16 v[128:131],v[40:43],v[180:183],v[128:131]
ds_read_b64_tr_b16 v[32:33],v12 offset:49152
ds_read_b64_tr_b16 v[34:35],v12 offset:53248
v_cvt_pk_bf16_f32 v240,v144,v145
v_mfma_f32_16x16x32_bf16 v[136:139],v[40:43],v[196:199],v[136:139]
v_exp_f32 v147,v147
v_mfma_f32_16x16x32_bf16 v[140:143],v[44:47],v[196:199],v[140:143]
ds_read_b64_tr_b16 v[36:37],v13 offset:49152
ds_read_b64_tr_b16 v[38:39],v13 offset:53248
v_mfma_f32_16x16x32_bf16 v[132:135],v[44:47],v[180:183],v[132:135]
v_exp_f32 v148,v148
s_waitcnt lgkmcnt(4)
v_mfma_f32_16x16x32_bf16 v[128:131],v[48:51],v[184:187],v[128:131]
ds_read_b64_tr_b16 v[40:41],v14 offset:49152
ds_read_b64_tr_b16 v[42:43],v14 offset:53248
v_cvt_pk_bf16_f32 v241,v146,v147
v_mfma_f32_16x16x32_bf16 v[136:139],v[48:51],v[200:203],v[136:139]
v_exp_f32 v149,v149
v_mfma_f32_16x16x32_bf16 v[140:143],v[52:55],v[200:203],v[140:143]
ds_read_b64_tr_b16 v[44:45],v15 offset:49152
ds_read_b64_tr_b16 v[46:47],v15 offset:53248
v_mfma_f32_16x16x32_bf16 v[132:135],v[52:55],v[184:187],v[132:135]
v_exp_f32 v150,v150
v_mfma_f32_16x16x32_bf16 v[128:131],v[56:59],v[188:191],v[128:131]
ds_read_b64_tr_b16 v[48:49],v16 offset:49152
ds_read_b64_tr_b16 v[50:51],v16 offset:53248
v_mfma_f32_16x16x32_bf16 v[136:139],v[56:59],v[204:207],v[136:139]
v_cvt_pk_bf16_f32 v242,v148,v149
v_exp_f32 v151,v151
v_mfma_f32_16x16x32_bf16 v[140:143],v[60:63],v[204:207],v[140:143]
ds_read_b64_tr_b16 v[52:53],v17 offset:49152
ds_read_b64_tr_b16 v[54:55],v17 offset:53248
v_mfma_f32_16x16x32_bf16 v[132:135],v[60:63],v[188:191],v[132:135]
v_exp_f32 v152,v152
s_waitcnt vmcnt(4)
s_barrier
s_waitcnt lgkmcnt(4)
v_mfma_f32_16x16x32_bf16 a[64:67],v[32:35],v[216:219],a[64:67]
ds_read_b64_tr_b16 v[56:57],v18 offset:49152
ds_read_b64_tr_b16 v[58:59],v18 offset:53248
v_mfma_f32_16x16x32_bf16 a[72:75],v[32:35],v[220:223],a[72:75]
v_cvt_pk_bf16_f32 v243,v150,v151
v_exp_f32 v153,v153
v_mfma_f32_16x16x32_bf16 a[76:79],v[36:39],v[220:223],a[76:79]
ds_read_b64_tr_b16 v[60:61],v19 offset:49152
ds_read_b64_tr_b16 v[62:63],v19 offset:53248
v_mfma_f32_16x16x32_bf16 a[68:71],v[36:39],v[216:219],a[68:71]
v_exp_f32 v154,v154
v_mfma_f32_16x16x32_bf16 a[80:83],v[40:43],v[216:219],a[80:83]
ds_read_b64_tr_b16 v[32:33],v12 offset:8192
ds_read_b64_tr_b16 v[34:35],v12 offset:12288
v_mfma_f32_16x16x32_bf16 a[88:91],v[40:43],v[220:223],a[88:91]
v_cvt_pk_bf16_f32 v244,v152,v153
v_mfma_f32_16x16x32_bf16 a[92:95],v[44:47],v[220:223],a[92:95]
ds_read_b64_tr_b16 v[36:37],v13 offset:8192
ds_read_b64_tr_b16 v[38:39],v13 offset:12288
v_exp_f32 v155,v155
v_mfma_f32_16x16x32_bf16 a[84:87],v[44:47],v[216:219],a[84:87]
v_exp_f32 v156,v156
s_waitcnt lgkmcnt(4)
v_mfma_f32_16x16x32_bf16 a[96:99],v[48:51],v[216:219],a[96:99]
ds_read_b64_tr_b16 v[40:41],v14 offset:8192
ds_read_b64_tr_b16 v[42:43],v14 offset:12288
v_mfma_f32_16x16x32_bf16 a[104:107],v[48:51],v[220:223],a[104:107]
v_cvt_pk_bf16_f32 v245,v154,v155
v_mfma_f32_16x16x32_bf16 a[108:111],v[52:55],v[220:223],a[108:111]
ds_read_b64_tr_b16 v[44:45],v15 offset:8192
ds_read_b64_tr_b16 v[46:47],v15 offset:12288
v_exp_f32 v157,v157
v_mfma_f32_16x16x32_bf16 a[100:103],v[52:55],v[216:219],a[100:103]
v_exp_f32 v158,v158
v_mfma_f32_16x16x32_bf16 a[112:115],v[56:59],v[216:219],a[112:115]
ds_read_b64_tr_b16 v[48:49],v16 offset:8192
ds_read_b64_tr_b16 v[50:51],v16 offset:12288
v_mfma_f32_16x16x32_bf16 a[120:123],v[56:59],v[220:223],a[120:123]
v_cvt_pk_bf16_f32 v246,v156,v157
v_mfma_f32_16x16x32_bf16 a[124:127],v[60:63],v[220:223],a[124:127]
ds_read_b64_tr_b16 v[52:53],v17 offset:8192
ds_read_b64_tr_b16 v[54:55],v17 offset:12288
v_exp_f32 v159,v159
v_mfma_f32_16x16x32_bf16 a[116:119],v[60:63],v[216:219],a[116:119]
v_cvt_pk_bf16_f32 v247,v158,v159
v_mfma_f32_16x16x32_bf16 v[168:171],v[28:31],v[240:243],v[168:171]
s_nop 0
v_mfma_f32_16x16x32_bf16 v[172:175],v[28:31],v[244:247],v[172:175]
s_waitcnt lgkmcnt(4)
v_mfma_f32_16x16x32_bf16 v[72:75],v[32:35],v[244:247],v[72:75]
ds_read_b64_tr_b16 v[56:57],v18 offset:8192
ds_read_b64_tr_b16 v[58:59],v18 offset:12288
v_mfma_f32_16x16x32_bf16 v[64:67],v[32:35],v[240:243],v[64:67]
v_mfma_f32_16x16x32_bf16 v[68:71],v[36:39],v[240:243],v[68:71]
ds_read_b64_tr_b16 v[60:61],v19 offset:8192
ds_read_b64_tr_b16 v[62:63],v19 offset:12288
v_mfma_f32_16x16x32_bf16 v[76:79],v[36:39],v[244:247],v[76:79]
v_max3_f32 v22,v128,v129,v130
v_mfma_f32_16x16x32_bf16 v[88:91],v[40:43],v[244:247],v[88:91]
ds_read_b128 v[32:35],v8 offset:24576
v_max3_f32 v22,v22,v131,v132
v_mfma_f32_16x16x32_bf16 v[80:83],v[40:43],v[240:243],v[80:83]
v_max3_f32 v22,v22,v133,v134
v_mfma_f32_16x16x32_bf16 v[84:87],v[44:47],v[240:243],v[84:87]
ds_read_b128 v[36:39],v8 offset:28672
v_mfma_f32_16x16x32_bf16 v[92:95],v[44:47],v[244:247],v[92:95]
v_max3_f32 v22,v22,v135,v136
s_waitcnt lgkmcnt(2)
v_mfma_f32_16x16x32_bf16 v[104:107],v[48:51],v[244:247],v[104:107]
ds_read_b128 v[40:43],v9 offset:24576
v_max3_f32 v22,v22,v137,v138
v_mfma_f32_16x16x32_bf16 v[96:99],v[48:51],v[240:243],v[96:99]
v_max3_f32 v22,v22,v139,v140
v_mfma_f32_16x16x32_bf16 v[100:103],v[52:55],v[240:243],v[100:103]
ds_read_b128 v[44:47],v9 offset:28672
v_mfma_f32_16x16x32_bf16 v[108:111],v[52:55],v[244:247],v[108:111]
v_max3_f32 v22,v22,v141,v142
v_mfma_f32_16x16x32_bf16 v[120:123],v[56:59],v[244:247],v[120:123]
ds_read_b128 v[48:51],v10 offset:24576
v_max_f32 v22,v22,v143
v_mfma_f32_16x16x32_bf16 v[112:115],v[56:59],v[240:243],v[112:115]
v_cmp_lt_f32 vcc,s43,v22
v_mfma_f32_16x16x32_bf16 v[116:119],v[60:63],v[240:243],v[116:119]
ds_read_b128 v[52:55],v10 offset:28672
v_mfma_f32_16x16x32_bf16 v[124:127],v[60:63],v[244:247],v[124:127]
s_cbranch_vccnz L_rare20
L_back20:
s_waitcnt lgkmcnt(2)
v_mfma_f32_16x16x32_bf16 v[144:147],v[32:35],v[176:179],v[160:163]
ds_read_b128 v[56:59],v11 offset:24576
v_exp_f32 v128,v128
s_cmp_lt_u32 s32,s66
s_cbranch_scc0 L_nowo22
s_add_u32 m0,s59,73728
s_xor_b32 s42,s65,512
s_add_u32 s42,s42,s64
buffer_load_dwordx4 v248,s[20:23],s42 offen lds
buffer_load_dwordx4 v249,s[20:23],s42 offen offset:1024 lds
buffer_load_dwordx4 v250,s[20:23],s42 offen offset:2048 lds
buffer_load_dwordx4 v251,s[20:23],s42 offen offset:3072 lds
L_nowo22:
v_mfma_f32_16x16x32_bf16 v[152:155],v[32:35],v[192:195],v[164:167]
v_exp_f32 v129,v129
v_mfma_f32_16x16x32_bf16 v[156:159],v[36:39],v[192:195],v[164:167]
ds_read_b128 v[60:63],v11 offset:28672
v_mfma_f32_16x16x32_bf16 v[148:151],v[36:39],v[176:179],v[160:163]
v_exp_f32 v130,v130
v_mfma_f32_16x16x32_bf16 v[144:147],v[40:43],v[180:183],v[144:147]
ds_read_b64_tr_b16 v[32:33],v12 offset:57344
ds_read_b64_tr_b16 v[34:35],v12 offset:61440
v_cvt_pk_bf16_f32 v240,v128,v129
v_mfma_f32_16x16x32_bf16 v[152:155],v[40:43],v[196:199],v[152:155]
v_exp_f32 v131,v131
v_mfma_f32_16x16x32_bf16 v[156:159],v[44:47],v[196:199],v[156:159]
ds_read_b64_tr_b16 v[36:37],v13 offset:57344
ds_read_b64_tr_b16 v[38:39],v13 offset:61440
v_mfma_f32_16x16x32_bf16 v[148:151],v[44:47],v[180:183],v[148:151]
v_exp_f32 v132,v132
s_waitcnt lgkmcnt(4)
v_mfma_f32_16x16x32_bf16 v[144:147],v[48:51],v[184:187],v[144:147]
ds_read_b64_tr_b16 v[40:41],v14 offset:57344
ds_read_b64_tr_b16 v[42:43],v14 offset:61440
v_cvt_pk_bf16_f32 v241,v130,v131
v_mfma_f32_16x16x32_bf16 v[152:155],v[48:51],v[200:203],v[152:155]
v_exp_f32 v133,v133
v_mfma_f32_16x16x32_bf16 v[156:159],v[52:55],v[200:203],v[156:159]
ds_read_b64_tr_b16 v[44:45],v15 offset:57344
ds_read_b64_tr_b16 v[46:47],v15 offset:61440
v_mfma_f32_16x16x32_bf16 v[148:151],v[52:55],v[184:187],v[148:151]
v_exp_f32 v134,v134
v_mfma_f32_16x16x32_bf16 v[144:147],v[56:59],v[188:191],v[144:147]
ds_read_b64_tr_b16 v[48:49],v16 offset:57344
ds_read_b64_tr_b16 v[50:51],v16 offset:61440
v_mfma_f32_16x16x32_bf16 v[152:155],v[56:59],v[204:207],v[152:155]
v_cvt_pk_bf16_f32 v242,v132,v133
v_exp_f32 v135,v135
v_mfma_f32_16x16x32_bf16 v[156:159],v[60:63],v[204:207],v[156:159]
ds_read_b64_tr_b16 v[52:53],v17 offset:57344
ds_read_b64_tr_b16 v[54:55],v17 offset:61440
v_mfma_f32_16x16x32_bf16 v[148:151],v[60:63],v[188:191],v[148:151]
v_exp_f32 v136,v136
s_waitcnt vmcnt(4)
s_barrier
s_waitcnt lgkmcnt(4)
v_mfma_f32_16x16x32_bf16 a[64:67],v[32:35],v[224:227],a[64:67]
ds_read_b64_tr_b16 v[56:57],v18 offset:57344
ds_read_b64_tr_b16 v[58:59],v18 offset:61440
v_mfma_f32_16x16x32_bf16 a[72:75],v[32:35],v[228:231],a[72:75]
v_cvt_pk_bf16_f32 v243,v134,v135
v_exp_f32 v137,v137
v_mfma_f32_16x16x32_bf16 a[76:79],v[36:39],v[228:231],a[76:79]
ds_read_b64_tr_b16 v[60:61],v19 offset:57344
ds_read_b64_tr_b16 v[62:63],v19 offset:61440
v_mfma_f32_16x16x32_bf16 a[68:71],v[36:39],v[224:227],a[68:71]
v_exp_f32 v138,v138
v_mfma_f32_16x16x32_bf16 a[80:83],v[40:43],v[224:227],a[80:83]
ds_read_b64_tr_b16 v[32:33],v12 offset:16384
ds_read_b64_tr_b16 v[34:35],v12 offset:20480
v_mfma_f32_16x16x32_bf16 a[88:91],v[40:43],v[228:231],a[88:91]
v_cvt_pk_bf16_f32 v244,v136,v137
v_mfma_f32_16x16x32_bf16 a[92:95],v[44:47],v[228:231],a[92:95]
ds_read_b64_tr_b16 v[36:37],v13 offset:16384
ds_read_b64_tr_b16 v[38:39],v13 offset:20480
v_exp_f32 v139,v139
v_mfma_f32_16x16x32_bf16 a[84:87],v[44:47],v[224:227],a[84:87]
v_exp_f32 v140,v140
s_waitcnt lgkmcnt(4)
v_mfma_f32_16x16x32_bf16 a[96:99],v[48:51],v[224:227],a[96:99]
ds_read_b64_tr_b16 v[40:41],v14 offset:16384
ds_read_b64_tr_b16 v[42:43],v14 offset:20480
v_mfma_f32_16x16x32_bf16 a[104:107],v[48:51],v[228:231],a[104:107]
v_cvt_pk_bf16_f32 v245,v138,v139
v_mfma_f32_16x16x32_bf16 a[108:111],v[52:55],v[228:231],a[108:111]
ds_read_b64_tr_b16 v[44:45],v15 offset:16384
ds_read_b64_tr_b16 v[46:47],v15 offset:20480
v_exp_f32 v141,v141
v_mfma_f32_16x16x32_bf16 a[100:103],v[52:55],v[224:227],a[100:103]
v_exp_f32 v142,v142
v_mfma_f32_16x16x32_bf16 a[112:115],v[56:59],v[224:227],a[112:115]
ds_read_b64_tr_b16 v[48:49],v16 offset:16384
ds_read_b64_tr_b16 v[50:51],v16 offset:20480
v_mfma_f32_16x16x32_bf16 a[120:123],v[56:59],v[228:231],a[120:123]
v_cvt_pk_bf16_f32 v246,v140,v141
v_mfma_f32_16x16x32_bf16 a[124:127],v[60:63],v[228:231],a[124:127]
ds_read_b64_tr_b16 v[52:53],v17 offset:16384
ds_read_b64_tr_b16 v[54:55],v17 offset:20480
v_exp_f32 v143,v143
v_mfma_f32_16x16x32_bf16 a[116:119],v[60:63],v[224:227],a[116:119]
v_cvt_pk_bf16_f32 v247,v142,v143
v_mfma_f32_16x16x32_bf16 v[168:171],v[28:31],v[240:243],v[168:171]
s_nop 0
v_mfma_f32_16x16x32_bf16 v[172:175],v[28:31],v[244:247],v[172:175]
s_waitcnt lgkmcnt(4)
v_mfma_f32_16x16x32_bf16 v[72:75],v[32:35],v[244:247],v[72:75]
ds_read_b64_tr_b16 v[56:57],v18 offset:16384
ds_read_b64_tr_b16 v[58:59],v18 offset:20480
v_mfma_f32_16x16x32_bf16 v[64:67],v[32:35],v[240:243],v[64:67]
v_mfma_f32_16x16x32_bf16 v[68:71],v[36:39],v[240:243],v[68:71]
ds_read_b64_tr_b16 v[60:61],v19 offset:16384
ds_read_b64_tr_b16 v[62:63],v19 offset:20480
v_mfma_f32_16x16x32_bf16 v[76:79],v[36:39],v[244:247],v[76:79]
v_max3_f32 v22,v144,v145,v146
v_mfma_f32_16x16x32_bf16 v[88:91],v[40:43],v[244:247],v[88:91]
ds_read_b128 v[32:35],v8
v_max3_f32 v22,v22,v147,v148
v_mfma_f32_16x16x32_bf16 v[80:83],v[40:43],v[240:243],v[80:83]
v_max3_f32 v22,v22,v149,v150
v_mfma_f32_16x16x32_bf16 v[84:87],v[44:47],v[240:243],v[84:87]
ds_read_b128 v[36:39],v8 offset:4096
v_mfma_f32_16x16x32_bf16 v[92:95],v[44:47],v[244:247],v[92:95]
v_max3_f32 v22,v22,v151,v152
s_waitcnt lgkmcnt(2)
v_mfma_f32_16x16x32_bf16 v[104:107],v[48:51],v[244:247],v[104:107]
ds_read_b128 v[40:43],v9
v_max3_f32 v22,v22,v153,v154
v_mfma_f32_16x16x32_bf16 v[96:99],v[48:51],v[240:243],v[96:99]
v_max3_f32 v22,v22,v155,v156
v_mfma_f32_16x16x32_bf16 v[100:103],v[52:55],v[240:243],v[100:103]
ds_read_b128 v[44:47],v9 offset:4096
v_mfma_f32_16x16x32_bf16 v[108:111],v[52:55],v[244:247],v[108:111]
v_max3_f32 v22,v22,v157,v158
v_mfma_f32_16x16x32_bf16 v[120:123],v[56:59],v[244:247],v[120:123]
ds_read_b128 v[48:51],v10
v_max_f32 v22,v22,v159
v_mfma_f32_16x16x32_bf16 v[112:115],v[56:59],v[240:243],v[112:115]
v_cmp_lt_f32 vcc,s43,v22
v_mfma_f32_16x16x32_bf16 v[116:119],v[60:63],v[240:243],v[116:119]
ds_read_b128 v[52:55],v10 offset:4096
v_mfma_f32_16x16x32_bf16 v[124:127],v[60:63],v[244:247],v[124:127]
s_cbranch_vccnz L_rare21
L_back21:
s_waitcnt lgkmcnt(2)
v_mfma_f32_16x16x32_bf16 v[128:131],v[32:35],v[176:179],v[160:163]
ds_read_b128 v[56:59],v11
v_exp_f32 v144,v144
s_cmp_lt_u32 s32,s66
s_cbranch_scc0 L_nowo23
s_add_u32 m0,s59,81920
s_xor_b32 s42,s65,33280
s_add_u32 s42,s42,s64
buffer_load_dwordx4 v248,s[20:23],s42 offen lds
buffer_load_dwordx4 v249,s[20:23],s42 offen offset:1024 lds
buffer_load_dwordx4 v250,s[20:23],s42 offen offset:2048 lds
buffer_load_dwordx4 v251,s[20:23],s42 offen offset:3072 lds
L_nowo23:
v_mfma_f32_16x16x32_bf16 v[136:139],v[32:35],v[192:195],v[164:167]
L_tp_a5:
s_cbranch_execz L_tp_q6
v_exp_f32 v145,v145
v_mfma_f32_16x16x32_bf16 v[140:143],v[36:39],v[192:195],v[164:167]
ds_read_b128 v[60:63],v11 offset:4096
v_mfma_f32_16x16x32_bf16 v[132:135],v[36:39],v[176:179],v[160:163]
v_exp_f32 v146,v146
v_mfma_f32_16x16x32_bf16 v[128:131],v[40:43],v[180:183],v[128:131]
ds_read_b64_tr_b16 v[32:33],v12 offset:32768
ds_read_b64_tr_b16 v[34:35],v12 offset:36864
v_cvt_pk_bf16_f32 v240,v144,v145
v_mfma_f32_16x16x32_bf16 v[136:139],v[40:43],v[196:199],v[136:139]
v_exp_f32 v147,v147
v_mfma_f32_16x16x32_bf16 v[140:143],v[44:47],v[196:199],v[140:143]
ds_read_b64_tr_b16 v[36:37],v13 offset:32768
ds_read_b64_tr_b16 v[38:39],v13 offset:36864
v_mfma_f32_16x16x32_bf16 v[132:135],v[44:47],v[180:183],v[132:135]
v_exp_f32 v148,v148
s_waitcnt lgkmcnt(4)
v_mfma_f32_16x16x32_bf16 v[128:131],v[48:51],v[184:187],v[128:131]
ds_read_b64_tr_b16 v[40:41],v14 offset:32768
ds_read_b64_tr_b16 v[42:43],v14 offset:36864
v_cvt_pk_bf16_f32 v241,v146,v147
v_mfma_f32_16x16x32_bf16 v[136:139],v[48:51],v[200:203],v[136:139]
v_exp_f32 v149,v149
v_mfma_f32_16x16x32_bf16 v[140:143],v[52:55],v[200:203],v[140:143]
ds_read_b64_tr_b16 v[44:45],v15 offset:32768
ds_read_b64_tr_b16 v[46:47],v15 offset:36864
v_mfma_f32_16x16x32_bf16 v[132:135],v[52:55],v[184:187],v[132:135]
v_exp_f32 v150,v150
v_mfma_f32_16x16x32_bf16 v[128:131],v[56:59],v[188:191],v[128:131]
ds_read_b64_tr_b16 v[48:49],v16 offset:32768
ds_read_b64_tr_b16 v[50:51],v16 offset:36864
v_mfma_f32_16x16x32_bf16 v[136:139],v[56:59],v[204:207],v[136:139]
v_cvt_pk_bf16_f32 v242,v148,v149
v_exp_f32 v151,v151
v_mfma_f32_16x16x32_bf16 v[140:143],v[60:63],v[204:207],v[140:143]
ds_read_b64_tr_b16 v[52:53],v17 offset:32768
ds_read_b64_tr_b16 v[54:55],v17 offset:36864
v_mfma_f32_16x16x32_bf16 v[132:135],v[60:63],v[188:191],v[132:135]
v_exp_f32 v152,v152
s_waitcnt vmcnt(4)
s_barrier
s_waitcnt lgkmcnt(4)
v_mfma_f32_16x16x32_bf16 a[64:67],v[32:35],v[232:235],a[64:67]
ds_read_b64_tr_b16 v[56:57],v18 offset:32768
ds_read_b64_tr_b16 v[58:59],v18 offset:36864
v_mfma_f32_16x16x32_bf16 a[72:75],v[32:35],v[236:239],a[72:75]
v_cvt_pk_bf16_f32 v243,v150,v151
v_exp_f32 v153,v153
v_mfma_f32_16x16x32_bf16 a[76:79],v[36:39],v[236:239],a[76:79]
ds_read_b64_tr_b16 v[60:61],v19 offset:32768
ds_read_b64_tr_b16 v[62:63],v19 offset:36864
v_mfma_f32_16x16x32_bf16 a[68:71],v[36:39],v[232:235],a[68:71]
v_exp_f32 v154,v154
v_mfma_f32_16x16x32_bf16 a[80:83],v[40:43],v[232:235],a[80:83]
ds_read_b64_tr_b16 v[32:33],v12 offset:24576
ds_read_b64_tr_b16 v[34:35],v12 offset:28672
v_mfma_f32_16x16x32_bf16 a[88:91],v[40:43],v[236:239],a[88:91]
v_cvt_pk_bf16_f32 v244,v152,v153
v_mfma_f32_16x16x32_bf16 a[92:95],v[44:47],v[236:239],a[92:95]
ds_read_b64_tr_b16 v[36:37],v13 offset:24576
ds_read_b64_tr_b16 v[38:39],v13 offset:28672
v_exp_f32 v155,v155
v_mfma_f32_16x16x32_bf16 a[84:87],v[44:47],v[232:235],a[84:87]
v_exp_f32 v156,v156
s_waitcnt lgkmcnt(4)
v_mfma_f32_16x16x32_bf16 a[96:99],v[48:51],v[232:235],a[96:99]
ds_read_b64_tr_b16 v[40:41],v14 offset:24576
ds_read_b64_tr_b16 v[42:43],v14 offset:28672
v_mfma_f32_16x16x32_bf16 a[104:107],v[48:51],v[236:239],a[104:107]
v_cvt_pk_bf16_f32 v245,v154,v155
v_mfma_f32_16x16x32_bf16 a[108:111],v[52:55],v[236:239],a[108:111]
ds_read_b64_tr_b16 v[44:45],v15 offset:24576
ds_read_b64_tr_b16 v[46:47],v15 offset:28672
v_exp_f32 v157,v157
v_mfma_f32_16x16x32_bf16 a[100:103],v[52:55],v[232:235],a[100:103]
v_exp_f32 v158,v158
v_mfma_f32_16x16x32_bf16 a[112:115],v[56:59],v[232:235],a[112:115]
ds_read_b64_tr_b16 v[48:49],v16 offset:24576
ds_read_b64_tr_b16 v[50:51],v16 offset:28672
v_mfma_f32_16x16x32_bf16 a[120:123],v[56:59],v[236:239],a[120:123]
v_cvt_pk_bf16_f32 v246,v156,v157
v_mfma_f32_16x16x32_bf16 a[124:127],v[60:63],v[236:239],a[124:127]
ds_read_b64_tr_b16 v[52:53],v17 offset:24576
ds_read_b64_tr_b16 v[54:55],v17 offset:28672
v_exp_f32 v159,v159
v_mfma_f32_16x16x32_bf16 a[116:119],v[60:63],v[232:235],a[116:119]
v_cvt_pk_bf16_f32 v247,v158,v159
v_mfma_f32_16x16x32_bf16 v[168:171],v[28:31],v[240:243],v[168:171]
s_nop 0
v_mfma_f32_16x16x32_bf16 v[172:175],v[28:31],v[244:247],v[172:175]
s_waitcnt lgkmcnt(4)
v_mfma_f32_16x16x32_bf16 v[72:75],v[32:35],v[244:247],v[72:75]
ds_read_b64_tr_b16 v[56:57],v18 offset:24576
ds_read_b64_tr_b16 v[58:59],v18 offset:28672
v_mfma_f32_16x16x32_bf16 v[64:67],v[32:35],v[240:243],v[64:67]
v_mfma_f32_16x16x32_bf16 v[68:71],v[36:39],v[240:243],v[68:71]
ds_read_b64_tr_b16 v[60:61],v19 offset:24576
ds_read_b64_tr_b16 v[62:63],v19 offset:28672
v_mfma_f32_16x16x32_bf16 v[76:79],v[36:39],v[244:247],v[76:79]
v_max3_f32 v22,v128,v129,v130
v_mfma_f32_16x16x32_bf16 v[88:91],v[40:43],v[244:247],v[88:91]
ds_read_b128 v[32:35],v8 offset:8192
v_max3_f32 v22,v22,v131,v132
v_mfma_f32_16x16x32_bf16 v[80:83],v[40:43],v[240:243],v[80:83]
v_max3_f32 v22,v22,v133,v134
v_mfma_f32_16x16x32_bf16 v[84:87],v[44:47],v[240:243],v[84:87]
ds_read_b128 v[36:39],v8 offset:12288
v_mfma_f32_16x16x32_bf16 v[92:95],v[44:47],v[244:247],v[92:95]
v_max3_f32 v22,v22,v135,v136
s_waitcnt lgkmcnt(2)
v_mfma_f32_16x16x32_bf16 v[104:107],v[48:51],v[244:247],v[104:107]
ds_read_b128 v[40:43],v9 offset:8192
v_max3_f32 v22,v22,v137,v138
v_mfma_f32_16x16x32_bf16 v[96:99],v[48:51],v[240:243],v[96:99]
v_max3_f32 v22,v22,v139,v140
v_mfma_f32_16x16x32_bf16 v[100:103],v[52:55],v[240:243],v[100:103]
ds_read_b128 v[44:47],v9 offset:12288
v_mfma_f32_16x16x32_bf16 v[108:111],v[52:55],v[244:247],v[108:111]
v_max3_f32 v22,v22,v141,v142
v_mfma_f32_16x16x32_bf16 v[120:123],v[56:59],v[244:247],v[120:123]
ds_read_b128 v[48:51],v10 offset:8192
v_max_f32 v22,v22,v143
v_mfma_f32_16x16x32_bf16 v[112:115],v[56:59],v[240:243],v[112:115]
v_cmp_lt_f32 vcc,s43,v22
v_mfma_f32_16x16x32_bf16 v[116:119],v[60:63],v[240:243],v[116:119]
ds_read_b128 v[52:55],v10 offset:12288
v_mfma_f32_16x16x32_bf16 v[124:127],v[60:63],v[244:247],v[124:127]
s_cbranch_vccnz L_rare22
L_back22:
s_waitcnt lgkmcnt(2)
v_mfma_f32_16x16x32_bf16 v[144:147],v[32:35],v[176:179],v[160:163]
ds_read_b128 v[56:59],v11 offset:8192
v_exp_f32 v128,v128
s_cmp_lt_u32 s32,s66
s_cbranch_scc0 L_nowo24
s_add_u32 m0,s59,90112
s_xor_b32 s42,s65,66048
s_add_u32 s42,s42,s64
buffer_load_dwordx4 v248,s[20:23],s42 offen lds
buffer_load_dwordx4 v249,s[20:23],s42 offen offset:1024 lds
buffer_load_dwordx4 v250,s[20:23],s42 offen offset:2048 lds
buffer_load_dwordx4 v251,s[20:23],s42 offen offset:3072 lds
L_nowo24:
v_mfma_f32_16x16x32_bf16 v[152:155],v[32:35],v[192:195],v[164:167]
v_exp_f32 v129,v129
v_mfma_f32_16x16x32_bf16 v[156:159],v[36:39],v[192:195],v[164:167]
ds_read_b128 v[60:63],v11 offset:12288
v_mfma_f32_16x16x32_bf16 v[148:151],v[36:39],v[176:179],v[160:163]
v_exp_f32 v130,v130
v_mfma_f32_16x16x32_bf16 v[144:147],v[40:43],v[180:183],v[144:147]
ds_read_b64_tr_b16 v[32:33],v12 offset:40960
ds_read_b64_tr_b16 v[34:35],v12 offset:45056
v_cvt_pk_bf16_f32 v240,v128,v129
v_mfma_f32_16x16x32_bf16 v[152:155],v[40:43],v[196:199],v[152:155]
v_exp_f32 v131,v131
v_mfma_f32_16x16x32_bf16 v[156:159],v[44:47],v[196:199],v[156:159]
ds_read_b64_tr_b16 v[36:37],v13 offset:40960
ds_read_b64_tr_b16 v[38:39],v13 offset:45056
v_mfma_f32_16x16x32_bf16 v[148:151],v[44:47],v[180:183],v[148:151]
v_exp_f32 v132,v132
s_waitcnt lgkmcnt(4)
v_mfma_f32_16x16x32_bf16 v[144:147],v[48:51],v[184:187],v[144:147]
ds_read_b64_tr_b16 v[40:41],v14 offset:40960
ds_read_b64_tr_b16 v[42:43],v14 offset:45056
v_cvt_pk_bf16_f32 v241,v130,v131
v_mfma_f32_16x16x32_bf16 v[152:155],v[48:51],v[200:203],v[152:155]
v_exp_f32 v133,v133
v_mfma_f32_16x16x32_bf16 v[156:159],v[52:55],v[200:203],v[156:159]
ds_read_b64_tr_b16 v[44:45],v15 offset:40960
ds_read_b64_tr_b16 v[46:47],v15 offset:45056
v_mfma_f32_16x16x32_bf16 v[148:151],v[52:55],v[184:187],v[148:151]
v_exp_f32 v134,v134
v_mfma_f32_16x16x32_bf16 v[144:147],v[56:59],v[188:191],v[144:147]
ds_read_b64_tr_b16 v[48:49],v16 offset:40960
ds_read_b64_tr_b16 v[50:51],v16 offset:45056
v_mfma_f32_16x16x32_bf16 v[152:155],v[56:59],v[204:207],v[152:155]
v_cvt_pk_bf16_f32 v242,v132,v133
v_exp_f32 v135,v135
v_mfma_f32_16x16x32_bf16 v[156:159],v[60:63],v[204:207],v[156:159]
ds_read_b64_tr_b16 v[52:53],v17 offset:40960
ds_read_b64_tr_b16 v[54:55],v17 offset:45056
v_mfma_f32_16x16x32_bf16 v[148:151],v[60:63],v[188:191],v[148:151]
v_exp_f32 v136,v136
s_waitcnt vmcnt(4)
s_barrier
s_waitcnt lgkmcnt(4)
v_mfma_f32_16x16x32_bf16 a[128:131],v[32:35],v[208:211],a[128:131]
ds_read_b64_tr_b16 v[56:57],v18 offset:40960
ds_read_b64_tr_b16 v[58:59],v18 offset:45056
v_mfma_f32_16x16x32_bf16 a[136:139],v[32:35],v[212:215],a[136:139]
v_cvt_pk_bf16_f32 v243,v134,v135
v_exp_f32 v137,v137
v_mfma_f32_16x16x32_bf16 a[140:143],v[36:39],v[212:215],a[140:143]
ds_read_b64_tr_b16 v[60:61],v19 offset:40960
ds_read_b64_tr_b16 v[62:63],v19 offset:45056
v_mfma_f32_16x16x32_bf16 a[132:135],v[36:39],v[208:211],a[132:135]
v_exp_f32 v138,v138
v_mfma_f32_16x16x32_bf16 a[144:147],v[40:43],v[208:211],a[144:147]
ds_read_b64_tr_b16 v[32:33],v12
ds_read_b64_tr_b16 v[34:35],v12 offset:4096
v_mfma_f32_16x16x32_bf16 a[152:155],v[40:43],v[212:215],a[152:155]
v_cvt_pk_bf16_f32 v244,v136,v137
v_mfma_f32_16x16x32_bf16 a[156:159],v[44:47],v[212:215],a[156:159]
ds_read_b64_tr_b16 v[36:37],v13
ds_read_b64_tr_b16 v[38:39],v13 offset:4096
v_exp_f32 v139,v139
v_mfma_f32_16x16x32_bf16 a[148:151],v[44:47],v[208:211],a[148:151]
v_exp_f32 v140,v140
s_waitcnt lgkmcnt(4)
v_mfma_f32_16x16x32_bf16 a[160:163],v[48:51],v[208:211],a[160:163]
ds_read_b64_tr_b16 v[40:41],v14
ds_read_b64_tr_b16 v[42:43],v14 offset:4096
v_mfma_f32_16x16x32_bf16 a[168:171],v[48:51],v[212:215],a[168:171]
v_cvt_pk_bf16_f32 v245,v138,v139
v_mfma_f32_16x16x32_bf16 a[172:175],v[52:55],v[212:215],a[172:175]
ds_read_b64_tr_b16 v[44:45],v15
ds_read_b64_tr_b16 v[46:47],v15 offset:4096
v_exp_f32 v141,v141
v_mfma_f32_16x16x32_bf16 a[164:167],v[52:55],v[208:211],a[164:167]
v_exp_f32 v142,v142
v_mfma_f32_16x16x32_bf16 a[176:179],v[56:59],v[208:211],a[176:179]
ds_read_b64_tr_b16 v[48:49],v16
ds_read_b64_tr_b16 v[50:51],v16 offset:4096
v_mfma_f32_16x16x32_bf16 a[184:187],v[56:59],v[212:215],a[184:187]
v_cvt_pk_bf16_f32 v246,v140,v141
v_mfma_f32_16x16x32_bf16 a[188:191],v[60:63],v[212:215],a[188:191]
ds_read_b64_tr_b16 v[52:53],v17
ds_read_b64_tr_b16 v[54:55],v17 offset:4096
v_exp_f32 v143,v143
v_mfma_f32_16x16x32_bf16 a[180:183],v[60:63],v[208:211],a[180:183]
v_cvt_pk_bf16_f32 v247,v142,v143
v_mfma_f32_16x16x32_bf16 v[168:171],v[28:31],v[240:243],v[168:171]
s_nop 0
v_mfma_f32_16x16x32_bf16 v[172:175],v[28:31],v[244:247],v[172:175]
s_waitcnt lgkmcnt(4)
v_mfma_f32_16x16x32_bf16 v[72:75],v[32:35],v[244:247],v[72:75]
ds_read_b64_tr_b16 v[56:57],v18
ds_read_b64_tr_b16 v[58:59],v18 offset:4096
v_mfma_f32_16x16x32_bf16 v[64:67],v[32:35],v[240:243],v[64:67]
v_mfma_f32_16x16x32_bf16 v[68:71],v[36:39],v[240:243],v[68:71]
ds_read_b64_tr_b16 v[60:61],v19
ds_read_b64_tr_b16 v[62:63],v19 offset:4096
v_mfma_f32_16x16x32_bf16 v[76:79],v[36:39],v[244:247],v[76:79]
v_max3_f32 v22,v144,v145,v146
v_mfma_f32_16x16x32_bf16 v[88:91],v[40:43],v[244:247],v[88:91]
ds_read_b128 v[32:35],v8 offset:16384
v_max3_f32 v22,v22,v147,v148
v_mfma_f32_16x16x32_bf16 v[80:83],v[40:43],v[240:243],v[80:83]
v_max3_f32 v22,v22,v149,v150
v_mfma_f32_16x16x32_bf16 v[84:87],v[44:47],v[240:243],v[84:87]
ds_read_b128 v[36:39],v8 offset:20480
v_mfma_f32_16x16x32_bf16 v[92:95],v[44:47],v[244:247],v[92:95]
v_max3_f32 v22,v22,v151,v152
s_waitcnt lgkmcnt(2)
v_mfma_f32_16x16x32_bf16 v[104:107],v[48:51],v[244:247],v[104:107]
ds_read_b128 v[40:43],v9 offset:16384
v_max3_f32 v22,v22,v153,v154
v_mfma_f32_16x16x32_bf16 v[96:99],v[48:51],v[240:243],v[96:99]
v_max3_f32 v22,v22,v155,v156
v_mfma_f32_16x16x32_bf16 v[100:103],v[52:55],v[240:243],v[100:103]
ds_read_b128 v[44:47],v9 offset:20480
v_mfma_f32_16x16x32_bf16 v[108:111],v[52:55],v[244:247],v[108:111]
v_max3_f32 v22,v22,v157,v158
v_mfma_f32_16x16x32_bf16 v[120:123],v[56:59],v[244:247],v[120:123]
ds_read_b128 v[48:51],v10 offset:16384
v_max_f32 v22,v22,v159
v_mfma_f32_16x16x32_bf16 v[112:115],v[56:59],v[240:243],v[112:115]
v_cmp_lt_f32 vcc,s43,v22
v_mfma_f32_16x16x32_bf16 v[116:119],v[60:63],v[240:243],v[116:119]
ds_read_b128 v[52:55],v10 offset:20480
v_mfma_f32_16x16x32_bf16 v[124:127],v[60:63],v[244:247],v[124:127]
s_cbranch_vccnz L_rare23
L_back23:
s_waitcnt lgkmcnt(2)
v_mfma_f32_16x16x32_bf16 v[128:131],v[32:35],v[176:179],v[160:163]
ds_read_b128 v[56:59],v11 offset:16384
v_exp_f32 v144,v144
s_cmp_lt_u32 s32,s66
s_cbranch_scc0 L_nowo25
s_add_u32 m0,s59,65536
s_xor_b32 s42,s65,98816
s_add_u32 s42,s42,s64
buffer_load_dwordx4 v248,s[20:23],s42 offen lds
buffer_load_dwordx4 v249,s[20:23],s42 offen offset:1024 lds
buffer_load_dwordx4 v250,s[20:23],s42 offen offset:2048 lds
buffer_load_dwordx4 v251,s[20:23],s42 offen offset:3072 lds
L_nowo25:
v_mfma_f32_16x16x32_bf16 v[136:139],v[32:35],v[192:195],v[164:167]
v_exp_f32 v145,v145
v_mfma_f32_16x16x32_bf16 v[140:143],v[36:39],v[192:195],v[164:167]
ds_read_b128 v[60:63],v11 offset:20480
v_mfma_f32_16x16x32_bf16 v[132:135],v[36:39],v[176:179],v[160:163]
v_exp_f32 v146,v146
v_mfma_f32_16x16x32_bf16 v[128:131],v[40:43],v[180:183],v[128:131]
ds_read_b64_tr_b16 v[32:33],v12 offset:49152
ds_read_b64_tr_b16 v[34:35],v12 offset:53248
v_cvt_pk_bf16_f32 v240,v144,v145
v_mfma_f32_16x16x32_bf16 v[136:139],v[40:43],v[196:199],v[136:139]
v_exp_f32 v147,v147
v_mfma_f32_16x16x32_bf16 v[140:143],v[44:47],v[196:199],v[140:143]
ds_read_b64_tr_b16 v[36:37],v13 offset:49152
ds_read_b64_tr_b16 v[38:39],v13 offset:53248
v_mfma_f32_16x16x32_bf16 v[132:135],v[44:47],v[180:183],v[132:135]
v_exp_f32 v148,v148
s_waitcnt lgkmcnt(4)
v_mfma_f32_16x16x32_bf16 v[128:131],v[48:51],v[184:187],v[128:131]
ds_read_b64_tr_b16 v[40:41],v14 offset:49152
ds_read_b64_tr_b16 v[42:43],v14 offset:53248
v_cvt_pk_bf16_f32 v241,v146,v147
v_mfma_f32_16x16x32_bf16 v[136:139],v[48:51],v[200:203],v[136:139]
v_exp_f32 v149,v149
v_mfma_f32_16x16x32_bf16 v[140:143],v[52:55],v[200:203],v[140:143]
ds_read_b64_tr_b16 v[44:45],v15 offset:49152
ds_read_b64_tr_b16 v[46:47],v15 offset:53248
v_mfma_f32_16x16x32_bf16 v[132:135],v[52:55],v[184:187],v[132:135]
v_exp_f32 v150,v150
v_mfma_f32_16x16x32_bf16 v[128:131],v[56:59],v[188:191],v[128:131]
ds_read_b64_tr_b16 v[48:49],v16 offset:49152
ds_read_b64_tr_b16 v[50:51],v16 offset:53248
v_mfma_f32_16x16x32_bf16 v[136:139],v[56:59],v[204:207],v[136:139]
v_cvt_pk_bf16_f32 v242,v148,v149
v_exp_f32 v151,v151
v_mfma_f32_16x16x32_bf16 v[140:143],v[60:63],v[204:207],v[140:143]
ds_read_b64_tr_b16 v[52:53],v17 offset:49152
ds_read_b64_tr_b16 v[54:55],v17 offset:53248
v_mfma_f32_16x16x32_bf16 v[132:135],v[60:63],v[188:191],v[132:135]
v_exp_f32 v152,v152
s_waitcnt vmcnt(4)
s_barrier
s_waitcnt lgkmcnt(4)
v_mfma_f32_16x16x32_bf16 a[128:131],v[32:35],v[216:219],a[128:131]
ds_read_b64_tr_b16 v[56:57],v18 offset:49152
ds_read_b64_tr_b16 v[58:59],v18 offset:53248
v_mfma_f32_16x16x32_bf16 a[136:139],v[32:35],v[220:223],a[136:139]
v_cvt_pk_bf16_f32 v243,v150,v151
v_exp_f32 v153,v153
v_mfma_f32_16x16x32_bf16 a[140:143],v[36:39],v[220:223],a[140:143]
ds_read_b64_tr_b16 v[60:61],v19 offset:49152
ds_read_b64_tr_b16 v[62:63],v19 offset:53248
v_mfma_f32_16x16x32_bf16 a[132:135],v[36:39],v[216:219],a[132:135]
v_exp_f32 v154,v154
v_mfma_f32_16x16x32_bf16 a[144:147],v[40:43],v[216:219],a[144:147]
ds_read_b64_tr_b16 v[32:33],v12 offset:8192
ds_read_b64_tr_b16 v[34:35],v12 offset:12288
v_mfma_f32_16x16x32_bf16 a[152:155],v[40:43],v[220:223],a[152:155]
v_cvt_pk_bf16_f32 v244,v152,v153
v_mfma_f32_16x16x32_bf16 a[156:159],v[44:47],v[220:223],a[156:159]
ds_read_b64_tr_b16 v[36:37],v13 offset:8192
ds_read_b64_tr_b16 v[38:39],v13 offset:12288
v_exp_f32 v155,v155
v_mfma_f32_16x16x32_bf16 a[148:151],v[44:47],v[216:219],a[148:151]
v_exp_f32 v156,v156
s_waitcnt lgkmcnt(4)
v_mfma_f32_16x16x32_bf16 a[160:163],v[48:51],v[216:219],a[160:163]
ds_read_b64_tr_b16 v[40:41],v14 offset:8192
ds_read_b64_tr_b16 v[42:43],v14 offset:12288
v_mfma_f32_16x16x32_bf16 a[168:171],v[48:51],v[220:223],a[168:171]
v_cvt_pk_bf16_f32 v245,v154,v155
v_mfma_f32_16x16x32_bf16 a[172:175],v[52:55],v[220:223],a[172:175]
ds_read_b64_tr_b16 v[44:45],v15 offset:8192
ds_read_b64_tr_b16 v[46:47],v15 offset:12288
v_exp_f32 v157,v157
v_mfma_f32_16x16x32_bf16 a[164:167],v[52:55],v[216:219],a[164:167]
v_exp_f32 v158,v158
v_mfma_f32_16x16x32_bf16 a[176:179],v[56:59],v[216:219],a[176:179]
ds_read_b64_tr_b16 v[48:49],v16 offset:8192
ds_read_b64_tr_b16 v[50:51],v16 offset:12288
v_mfma_f32_16x16x32_bf16 a[184:187],v[56:59],v[220:223],a[184:187]
v_cvt_pk_bf16_f32 v246,v156,v157
v_mfma_f32_16x16x32_bf16 a[188:191],v[60:63],v[220:223],a[188:191]
ds_read_b64_tr_b16 v[52:53],v17 offset:8192
ds_read_b64_tr_b16 v[54:55],v17 offset:12288
v_exp_f32 v159,v159
v_mfma_f32_16x16x32_bf16 a[180:183],v[60:63],v[216:219],a[180:183]
v_cvt_pk_bf16_f32 v247,v158,v159
v_mfma_f32_16x16x32_bf16 v[168:171],v[28:31],v[240:243],v[168:171]
s_nop 0
v_mfma_f32_16x16x32_bf16 v[172:175],v[28:31],v[244:247],v[172:175]
s_waitcnt lgkmcnt(4)
v_mfma_f32_16x16x32_bf16 v[72:75],v[32:35],v[244:247],v[72:75]
ds_read_b64_tr_b16 v[56:57],v18 offset:8192
ds_read_b64_tr_b16 v[58:59],v18 offset:12288
v_mfma_f32_16x16x32_bf16 v[64:67],v[32:35],v[240:243],v[64:67]
v_mfma_f32_16x16x32_bf16 v[68:71],v[36:39],v[240:243],v[68:71]
ds_read_b64_tr_b16 v[60:61],v19 offset:8192
ds_read_b64_tr_b16 v[62:63],v19 offset:12288
v_mfma_f32_16x16x32_bf16 v[76:79],v[36:39],v[244:247],v[76:79]
v_max3_f32 v22,v128,v129,v130
v_mfma_f32_16x16x32_bf16 v[88:91],v[40:43],v[244:247],v[88:91]
ds_read_b128 v[32:35],v8 offset:24576
v_max3_f32 v22,v22,v131,v132
v_mfma_f32_16x16x32_bf16 v[80:83],v[40:43],v[240:243],v[80:83]
v_max3_f32 v22,v22,v133,v134
v_mfma_f32_16x16x32_bf16 v[84:87],v[44:47],v[240:243],v[84:87]
ds_read_b128 v[36:39],v8 offset:28672
v_mfma_f32_16x16x32_bf16 v[92:95],v[44:47],v[244:247],v[92:95]
v_max3_f32 v22,v22,v135,v136
s_waitcnt lgkmcnt(2)
v_mfma_f32_16x16x32_bf16 v[104:107],v[48:51],v[244:247],v[104:107]
ds_read_b128 v[40:43],v9 offset:24576
v_max3_f32 v22,v22,v137,v138
v_mfma_f32_16x16x32_bf16 v[96:99],v[48:51],v[240:243],v[96:99]
v_max3_f32 v22,v22,v139,v140
v_mfma_f32_16x16x32_bf16 v[100:103],v[52:55],v[240:243],v[100:103]
ds_read_b128 v[44:47],v9 offset:28672
v_mfma_f32_16x16x32_bf16 v[108:111],v[52:55],v[244:247],v[108:111]
v_max3_f32 v22,v22,v141,v142
v_mfma_f32_16x16x32_bf16 v[120:123],v[56:59],v[244:247],v[120:123]
ds_read_b128 v[48:51],v10 offset:24576
v_max_f32 v22,v22,v143
v_mfma_f32_16x16x32_bf16 v[112:115],v[56:59],v[240:243],v[112:115]
v_cmp_lt_f32 vcc,s43,v22
v_mfma_f32_16x16x32_bf16 v[116:119],v[60:63],v[240:243],v[116:119]
ds_read_b128 v[52:55],v10 offset:28672
v_mfma_f32_16x16x32_bf16 v[124:127],v[60:63],v[244:247],v[124:127]
s_cbranch_vccnz L_rare24
L_back24:
s_waitcnt lgkmcnt(2)
v_mfma_f32_16x16x32_bf16 v[144:147],v[32:35],v[176:179],v[160:163]
ds_read_b128 v[56:59],v11 offset:24576
v_exp_f32 v128,v128
s_cmp_lt_u32 s32,s66
s_cbranch_scc0 L_nowo26
s_add_u32 m0,s59,73728
s_xor_b32 s42,s65,768
s_add_u32 s42,s42,s64
buffer_load_dwordx4 v248,s[20:23],s42 offen lds
buffer_load_dwordx4 v249,s[20:23],s42 offen offset:1024 lds
buffer_load_dwordx4 v250,s[20:23],s42 offen offset:2048 lds
buffer_load_dwordx4 v251,s[20:23],s42 offen offset:3072 lds
L_nowo26:
v_mfma_f32_16x16x32_bf16 v[152:155],v[32:35],v[192:195],v[164:167]
v_exp_f32 v129,v129
v_mfma_f32_16x16x32_bf16 v[156:159],v[36:39],v[192:195],v[164:167]
ds_read_b128 v[60:63],v11 offset:28672
v_mfma_f32_16x16x32_bf16 v[148:151],v[36:39],v[176:179],v[160:163]
v_exp_f32 v130,v130
v_mfma_f32_16x16x32_bf16 v[144:147],v[40:43],v[180:183],v[144:147]
ds_read_b64_tr_b16 v[32:33],v12 offset:57344
ds_read_b64_tr_b16 v[34:35],v12 offset:61440
v_cvt_pk_bf16_f32 v240,v128,v129
v_mfma_f32_16x16x32_bf16 v[152:155],v[40:43],v[196:199],v[152:155]
v_exp_f32 v131,v131
v_mfma_f32_16x16x32_bf16 v[156:159],v[44:47],v[196:199],v[156:159]
ds_read_b64_tr_b16 v[36:37],v13 offset:57344
ds_read_b64_tr_b16 v[38:39],v13 offset:61440
v_mfma_f32_16x16x32_bf16 v[148:151],v[44:47],v[180:183],v[148:151]
v_exp_f32 v132,v132
s_waitcnt lgkmcnt(4)
v_mfma_f32_16x16x32_bf16 v[144:147],v[48:51],v[184:187],v[144:147]
ds_read_b64_tr_b16 v[40:41],v14 offset:57344
ds_read_b64_tr_b16 v[42:43],v14 offset:61440
v_cvt_pk_bf16_f32 v241,v130,v131
v_mfma_f32_16x16x32_bf16 v[152:155],v[48:51],v[200:203],v[152:155]
v_exp_f32 v133,v133
v_mfma_f32_16x16x32_bf16 v[156:159],v[52:55],v[200:203],v[156:159]
ds_read_b64_tr_b16 v[44:45],v15 offset:57344
ds_read_b64_tr_b16 v[46:47],v15 offset:61440
v_mfma_f32_16x16x32_bf16 v[148:151],v[52:55],v[184:187],v[148:151]
v_exp_f32 v134,v134
v_mfma_f32_16x16x32_bf16 v[144:147],v[56:59],v[188:191],v[144:147]
ds_read_b64_tr_b16 v[48:49],v16 offset:57344
ds_read_b64_tr_b16 v[50:51],v16 offset:61440
v_mfma_f32_16x16x32_bf16 v[152:155],v[56:59],v[204:207],v[152:155]
v_cvt_pk_bf16_f32 v242,v132,v133
v_exp_f32 v135,v135
v_mfma_f32_16x16x32_bf16 v[156:159],v[60:63],v[204:207],v[156:159]
ds_read_b64_tr_b16 v[52:53],v17 offset:57344
ds_read_b64_tr_b16 v[54:55],v17 offset:61440
v_mfma_f32_16x16x32_bf16 v[148:151],v[60:63],v[188:191],v[148:151]
v_exp_f32 v136,v136
s_waitcnt vmcnt(4)
s_barrier
s_waitcnt lgkmcnt(4)
v_mfma_f32_16x16x32_bf16 a[128:131],v[32:35],v[224:227],a[128:131]
ds_read_b64_tr_b16 v[56:57],v18 offset:57344
ds_read_b64_tr_b16 v[58:59],v18 offset:61440
v_mfma_f32_16x16x32_bf16 a[136:139],v[32:35],v[228:231],a[136:139]
v_cvt_pk_bf16_f32 v243,v134,v135
v_exp_f32 v137,v137
v_mfma_f32_16x16x32_bf16 a[140:143],v[36:39],v[228:231],a[140:143]
ds_read_b64_tr_b16 v[60:61],v19 offset:57344
ds_read_b64_tr_b16 v[62:63],v19 offset:61440
v_mfma_f32_16x16x32_bf16 a[132:135],v[36:39],v[224:227],a[132:135]
v_exp_f32 v138,v138
v_mfma_f32_16x16x32_bf16 a[144:147],v[40:43],v[224:227],a[144:147]
ds_read_b64_tr_b16 v[32:33],v12 offset:16384
ds_read_b64_tr_b16 v[34:35],v12 offset:20480
v_mfma_f32_16x16x32_bf16 a[152:155],v[40:43],v[228:231],a[152:155]
v_cvt_pk_bf16_f32 v244,v136,v137
v_mfma_f32_16x16x32_bf16 a[156:159],v[44:47],v[228:231],a[156:159]
ds_read_b64_tr_b16 v[36:37],v13 offset:16384
ds_read_b64_tr_b16 v[38:39],v13 offset:20480
v_exp_f32 v139,v139
v_mfma_f32_16x16x32_bf16 a[148:151],v[44:47],v[224:227],a[148:151]
v_exp_f32 v140,v140
s_waitcnt lgkmcnt(4)
v_mfma_f32_16x16x32_bf16 a[160:163],v[48:51],v[224:227],a[160:163]
ds_read_b64_tr_b16 v[40:41],v14 offset:16384
ds_read_b64_tr_b16 v[42:43],v14 offset:20480
v_mfma_f32_16x16x32_bf16 a[168:171],v[48:51],v[228:231],a[168:171]
v_cvt_pk_bf16_f32 v245,v138,v139
v_mfma_f32_16x16x32_bf16 a[172:175],v[52:55],v[228:231],a[172:175]
ds_read_b64_tr_b16 v[44:45],v15 offset:16384
ds_read_b64_tr_b16 v[46:47],v15 offset:20480
v_exp_f32 v141,v141
v_mfma_f32_16x16x32_bf16 a[164:167],v[52:55],v[224:227],a[164:167]
v_exp_f32 v142,v142
v_mfma_f32_16x16x32_bf16 a[176:179],v[56:59],v[224:227],a[176:179]
ds_read_b64_tr_b16 v[48:49],v16 offset:16384
ds_read_b64_tr_b16 v[50:51],v16 offset:20480
v_mfma_f32_16x16x32_bf16 a[184:187],v[56:59],v[228:231],a[184:187]
v_cvt_pk_bf16_f32 v246,v140,v141
v_mfma_f32_16x16x32_bf16 a[188:191],v[60:63],v[228:231],a[188:191]
ds_read_b64_tr_b16 v[52:53],v17 offset:16384
ds_read_b64_tr_b16 v[54:55],v17 offset:20480
v_exp_f32 v143,v143
v_mfma_f32_16x16x32_bf16 a[180:183],v[60:63],v[224:227],a[180:183]
v_cvt_pk_bf16_f32 v247,v142,v143
v_mfma_f32_16x16x32_bf16 v[168:171],v[28:31],v[240:243],v[168:171]
s_nop 0
v_mfma_f32_16x16x32_bf16 v[172:175],v[28:31],v[244:247],v[172:175]
s_waitcnt lgkmcnt(4)
v_mfma_f32_16x16x32_bf16 v[72:75],v[32:35],v[244:247],v[72:75]
ds_read_b64_tr_b16 v[56:57],v18 offset:16384
ds_read_b64_tr_b16 v[58:59],v18 offset:20480
v_mfma_f32_16x16x32_bf16 v[64:67],v[32:35],v[240:243],v[64:67]
v_mfma_f32_16x16x32_bf16 v[68:71],v[36:39],v[240:243],v[68:71]
ds_read_b64_tr_b16 v[60:61],v19 offset:16384
ds_read_b64_tr_b16 v[62:63],v19 offset:20480
v_mfma_f32_16x16x32_bf16 v[76:79],v[36:39],v[244:247],v[76:79]
v_max3_f32 v22,v144,v145,v146
v_mfma_f32_16x16x32_bf16 v[88:91],v[40:43],v[244:247],v[88:91]
ds_read_b128 v[32:35],v8
v_max3_f32 v22,v22,v147,v148
v_mfma_f32_16x16x32_bf16 v[80:83],v[40:43],v[240:243],v[80:83]
v_max3_f32 v22,v22,v149,v150
v_mfma_f32_16x16x32_bf16 v[84:87],v[44:47],v[240:243],v[84:87]
ds_read_b128 v[36:39],v8 offset:4096
v_mfma_f32_16x16x32_bf16 v[92:95],v[44:47],v[244:247],v[92:95]
v_max3_f32 v22,v22,v151,v152
s_waitcnt lgkmcnt(2)
v_mfma_f32_16x16x32_bf16 v[104:107],v[48:51],v[244:247],v[104:107]
ds_read_b128 v[40:43],v9
v_max3_f32 v22,v22,v153,v154
v_mfma_f32_16x16x32_bf16 v[96:99],v[48:51],v[240:243],v[96:99]
v_max3_f32 v22,v22,v155,v156
v_mfma_f32_16x16x32_bf16 v[100:103],v[52:55],v[240:243],v[100:103]
ds_read_b128 v[44:47],v9 offset:4096
v_mfma_f32_16x16x32_bf16 v[108:111],v[52:55],v[244:247],v[108:111]
v_max3_f32 v22,v22,v157,v158
v_mfma_f32_16x16x32_bf16 v[120:123],v[56:59],v[244:247],v[120:123]
ds_read_b128 v[48:51],v10
v_max_f32 v22,v22,v159
v_mfma_f32_16x16x32_bf16 v[112:115],v[56:59],v[240:243],v[112:115]
v_cmp_lt_f32 vcc,s43,v22
v_mfma_f32_16x16x32_bf16 v[116:119],v[60:63],v[240:243],v[116:119]
ds_read_b128 v[52:55],v10 offset:4096
v_mfma_f32_16x16x32_bf16 v[124:127],v[60:63],v[244:247],v[124:127]
s_cbranch_vccnz L_rare25
L_back25:
s_waitcnt lgkmcnt(2)
v_mfma_f32_16x16x32_bf16 v[128:131],v[32:35],v[176:179],v[160:163]
ds_read_b128 v[56:59],v11
v_exp_f32 v144,v144
s_cmp_lt_u32 s32,s66
s_cbranch_scc0 L_nowo27
s_add_u32 m0,s59,81920
s_xor_b32 s42,s65,33536
s_add_u32 s42,s42,s64
buffer_load_dwordx4 v248,s[20:23],s42 offen lds
buffer_load_dwordx4 v249,s[20:23],s42 offen offset:1024 lds
buffer_load_dwordx4 v250,s[20:23],s42 offen offset:2048 lds
buffer_load_dwordx4 v251,s[20:23],s42 offen offset:3072 lds
L_nowo27:
v_mfma_f32_16x16x32_bf16 v[136:139],v[32:35],v[192:195],v[164:167]
v_exp_f32 v145,v145
v_mfma_f32_16x16x32_bf16 v[140:143],v[36:39],v[192:195],v[164:167]
ds_read_b128 v[60:63],v11 offset:4096
v_mfma_f32_16x16x32_bf16 v[132:135],v[36:39],v[176:179],v[160:163]
v_exp_f32 v146,v146
v_mfma_f32_16x16x32_bf16 v[128:131],v[40:43],v[180:183],v[128:131]
L_tp_a6:
s_cbranch_execz L_chain_done
ds_read_b64_tr_b16 v[32:33],v12 offset:32768
ds_read_b64_tr_b16 v[34:35],v12 offset:36864
v_cvt_pk_bf16_f32 v240,v144,v145
v_mfma_f32_16x16x32_bf16 v[136:139],v[40:43],v[196:199],v[136:139]
v_exp_f32 v147,v147
v_mfma_f32_16x16x32_bf16 v[140:143],v[44:47],v[196:199],v[140:143]
ds_read_b64_tr_b16 v[36:37],v13 offset:32768
ds_read_b64_tr_b16 v[38:39],v13 offset:36864
v_mfma_f32_16x16x32_bf16 v[132:135],v[44:47],v[180:183],v[132:135]
v_exp_f32 v148,v148
s_waitcnt lgkmcnt(4)
v_mfma_f32_16x16x32_bf16 v[128:131],v[48:51],v[184:187],v[128:131]
ds_read_b64_tr_b16 v[40:41],v14 offset:32768
ds_read_b64_tr_b16 v[42:43],v14 offset:36864
v_cvt_pk_bf16_f32 v241,v146,v147
v_mfma_f32_16x16x32_bf16 v[136:139],v[48:51],v[200:203],v[136:139]
v_exp_f32 v149,v149
v_mfma_f32_16x16x32_bf16 v[140:143],v[52:55],v[200:203],v[140:143]
ds_read_b64_tr_b16 v[44:45],v15 offset:32768
ds_read_b64_tr_b16 v[46:47],v15 offset:36864
v_mfma_f32_16x16x32_bf16 v[132:135],v[52:55],v[184:187],v[132:135]
v_exp_f32 v150,v150
v_mfma_f32_16x16x32_bf16 v[128:131],v[56:59],v[188:191],v[128:131]
ds_read_b64_tr_b16 v[48:49],v16 offset:32768
ds_read_b64_tr_b16 v[50:51],v16 offset:36864
v_mfma_f32_16x16x32_bf16 v[136:139],v[56:59],v[204:207],v[136:139]
v_cvt_pk_bf16_f32 v242,v148,v149
v_exp_f32 v151,v151
v_mfma_f32_16x16x32_bf16 v[140:143],v[60:63],v[204:207],v[140:143]
ds_read_b64_tr_b16 v[52:53],v17 offset:32768
ds_read_b64_tr_b16 v[54:55],v17 offset:36864
v_mfma_f32_16x16x32_bf16 v[132:135],v[60:63],v[188:191],v[132:135]
v_exp_f32 v152,v152
s_waitcnt vmcnt(4)
s_barrier
s_waitcnt lgkmcnt(4)
v_mfma_f32_16x16x32_bf16 a[128:131],v[32:35],v[232:235],a[128:131]
ds_read_b64_tr_b16 v[56:57],v18 offset:32768
ds_read_b64_tr_b16 v[58:59],v18 offset:36864
v_mfma_f32_16x16x32_bf16 a[136:139],v[32:35],v[236:239],a[136:139]
v_cvt_pk_bf16_f32 v243,v150,v151
v_exp_f32 v153,v153
v_mfma_f32_16x16x32_bf16 a[140:143],v[36:39],v[236:239],a[140:143]
ds_read_b64_tr_b16 v[60:61],v19 offset:32768
ds_read_b64_tr_b16 v[62:63],v19 offset:36864
v_mfma_f32_16x16x32_bf16 a[132:135],v[36:39],v[232:235],a[132:135]
v_exp_f32 v154,v154
v_mfma_f32_16x16x32_bf16 a[144:147],v[40:43],v[232:235],a[144:147]
ds_read_b64_tr_b16 v[32:33],v12 offset:24576
ds_read_b64_tr_b16 v[34:35],v12 offset:28672
v_mfma_f32_16x16x32_bf16 a[152:155],v[40:43],v[236:239],a[152:155]
v_cvt_pk_bf16_f32 v244,v152,v153
v_mfma_f32_16x16x32_bf16 a[156:159],v[44:47],v[236:239],a[156:159]
ds_read_b64_tr_b16 v[36:37],v13 offset:24576
ds_read_b64_tr_b16 v[38:39],v13 offset:28672
v_exp_f32 v155,v155
v_mfma_f32_16x16x32_bf16 a[148:151],v[44:47],v[232:235],a[148:151]
v_exp_f32 v156,v156
s_waitcnt lgkmcnt(4)
v_mfma_f32_16x16x32_bf16 a[160:163],v[48:51],v[232:235],a[160:163]
ds_read_b64_tr_b16 v[40:41],v14 offset:24576
ds_read_b64_tr_b16 v[42:43],v14 offset:28672
v_mfma_f32_16x16x32_bf16 a[168:171],v[48:51],v[236:239],a[168:171]
v_cvt_pk_bf16_f32 v245,v154,v155
v_mfma_f32_16x16x32_bf16 a[172:175],v[52:55],v[236:239],a[172:175]
ds_read_b64_tr_b16 v[44:45],v15 offset:24576
ds_read_b64_tr_b16 v[46:47],v15 offset:28672
v_exp_f32 v157,v157
v_mfma_f32_16x16x32_bf16 a[164:167],v[52:55],v[232:235],a[164:167]
v_exp_f32 v158,v158
v_mfma_f32_16x16x32_bf16 a[176:179],v[56:59],v[232:235],a[176:179]
ds_read_b64_tr_b16 v[48:49],v16 offset:24576
ds_read_b64_tr_b16 v[50:51],v16 offset:28672
v_mfma_f32_16x16x32_bf16 a[184:187],v[56:59],v[236:239],a[184:187]
v_cvt_pk_bf16_f32 v246,v156,v157
v_mfma_f32_16x16x32_bf16 a[188:191],v[60:63],v[236:239],a[188:191]
ds_read_b64_tr_b16 v[52:53],v17 offset:24576
ds_read_b64_tr_b16 v[54:55],v17 offset:28672
v_exp_f32 v159,v159
v_mfma_f32_16x16x32_bf16 a[180:183],v[60:63],v[232:235],a[180:183]
v_cvt_pk_bf16_f32 v247,v158,v159
v_mfma_f32_16x16x32_bf16 v[168:171],v[28:31],v[240:243],v[168:171]
s_nop 0
v_mfma_f32_16x16x32_bf16 v[172:175],v[28:31],v[244:247],v[172:175]
s_waitcnt lgkmcnt(4)
v_mfma_f32_16x16x32_bf16 v[72:75],v[32:35],v[244:247],v[72:75]
ds_read_b64_tr_b16 v[56:57],v18 offset:24576
ds_read_b64_tr_b16 v[58:59],v18 offset:28672
v_mfma_f32_16x16x32_bf16 v[64:67],v[32:35],v[240:243],v[64:67]
v_mfma_f32_16x16x32_bf16 v[68:71],v[36:39],v[240:243],v[68:71]
ds_read_b64_tr_b16 v[60:61],v19 offset:24576
ds_read_b64_tr_b16 v[62:63],v19 offset:28672
v_mfma_f32_16x16x32_bf16 v[76:79],v[36:39],v[244:247],v[76:79]
v_max3_f32 v22,v128,v129,v130
v_mfma_f32_16x16x32_bf16 v[88:91],v[40:43],v[244:247],v[88:91]
ds_read_b128 v[32:35],v8 offset:8192
v_max3_f32 v22,v22,v131,v132
v_mfma_f32_16x16x32_bf16 v[80:83],v[40:43],v[240:243],v[80:83]
v_max3_f32 v22,v22,v133,v134
v_mfma_f32_16x16x32_bf16 v[84:87],v[44:47],v[240:243],v[84:87]
ds_read_b128 v[36:39],v8 offset:12288
v_mfma_f32_16x16x32_bf16 v[92:95],v[44:47],v[244:247],v[92:95]
v_max3_f32 v22,v22,v135,v136
s_waitcnt lgkmcnt(2)
v_mfma_f32_16x16x32_bf16 v[104:107],v[48:51],v[244:247],v[104:107]
ds_read_b128 v[40:43],v9 offset:8192
v_max3_f32 v22,v22,v137,v138
v_mfma_f32_16x16x32_bf16 v[96:99],v[48:51],v[240:243],v[96:99]
v_max3_f32 v22,v22,v139,v140
v_mfma_f32_16x16x32_bf16 v[100:103],v[52:55],v[240:243],v[100:103]
ds_read_b128 v[44:47],v9 offset:12288
v_mfma_f32_16x16x32_bf16 v[108:111],v[52:55],v[244:247],v[108:111]
v_max3_f32 v22,v22,v141,v142
v_mfma_f32_16x16x32_bf16 v[120:123],v[56:59],v[244:247],v[120:123]
ds_read_b128 v[48:51],v10 offset:8192
v_max_f32 v22,v22,v143
v_mfma_f32_16x16x32_bf16 v[112:115],v[56:59],v[240:243],v[112:115]
v_cmp_lt_f32 vcc,s43,v22
v_mfma_f32_16x16x32_bf16 v[116:119],v[60:63],v[240:243],v[116:119]
ds_read_b128 v[52:55],v10 offset:12288
v_mfma_f32_16x16x32_bf16 v[124:127],v[60:63],v[244:247],v[124:127]
s_cbranch_vccnz L_rare26
L_back26:
s_waitcnt lgkmcnt(2)
v_mfma_f32_16x16x32_bf16 v[144:147],v[32:35],v[176:179],v[160:163]
ds_read_b128 v[56:59],v11 offset:8192
v_exp_f32 v128,v128
s_cmp_lt_u32 s32,s66
s_cbranch_scc0 L_nowo28
s_add_u32 m0,s59,90112
s_xor_b32 s42,s65,66304
s_add_u32 s42,s42,s64
buffer_load_dwordx4 v248,s[20:23],s42 offen lds
buffer_load_dwordx4 v249,s[20:23],s42 offen offset:1024 lds
buffer_load_dwordx4 v250,s[20:23],s42 offen offset:2048 lds
buffer_load_dwordx4 v251,s[20:23],s42 offen offset:3072 lds
L_nowo28:
v_mfma_f32_16x16x32_bf16 v[152:155],v[32:35],v[192:195],v[164:167]
v_exp_f32 v129,v129
v_mfma_f32_16x16x32_bf16 v[156:159],v[36:39],v[192:195],v[164:167]
ds_read_b128 v[60:63],v11 offset:12288
v_mfma_f32_16x16x32_bf16 v[148:151],v[36:39],v[176:179],v[160:163]
v_exp_f32 v130,v130
v_mfma_f32_16x16x32_bf16 v[144:147],v[40:43],v[180:183],v[144:147]
ds_read_b64_tr_b16 v[32:33],v12 offset:40960
ds_read_b64_tr_b16 v[34:35],v12 offset:45056
v_cvt_pk_bf16_f32 v240,v128,v129
v_mfma_f32_16x16x32_bf16 v[152:155],v[40:43],v[196:199],v[152:155]
v_exp_f32 v131,v131
v_mfma_f32_16x16x32_bf16 v[156:159],v[44:47],v[196:199],v[156:159]
ds_read_b64_tr_b16 v[36:37],v13 offset:40960
ds_read_b64_tr_b16 v[38:39],v13 offset:45056
v_mfma_f32_16x16x32_bf16 v[148:151],v[44:47],v[180:183],v[148:151]
v_exp_f32 v132,v132
s_waitcnt lgkmcnt(4)
v_mfma_f32_16x16x32_bf16 v[144:147],v[48:51],v[184:187],v[144:147]
ds_read_b64_tr_b16 v[40:41],v14 offset:40960
ds_read_b64_tr_b16 v[42:43],v14 offset:45056
v_cvt_pk_bf16_f32 v241,v130,v131
v_mfma_f32_16x16x32_bf16 v[152:155],v[48:51],v[200:203],v[152:155]
v_exp_f32 v133,v133
v_mfma_f32_16x16x32_bf16 v[156:159],v[52:55],v[200:203],v[156:159]
ds_read_b64_tr_b16 v[44:45],v15 offset:40960
ds_read_b64_tr_b16 v[46:47],v15 offset:45056
v_mfma_f32_16x16x32_bf16 v[148:151],v[52:55],v[184:187],v[148:151]
v_exp_f32 v134,v134
v_mfma_f32_16x16x32_bf16 v[144:147],v[56:59],v[188:191],v[144:147]
ds_read_b64_tr_b16 v[48:49],v16 offset:40960
ds_read_b64_tr_b16 v[50:51],v16 offset:45056
v_mfma_f32_16x16x32_bf16 v[152:155],v[56:59],v[204:207],v[152:155]
v_cvt_pk_bf16_f32 v242,v132,v133
v_exp_f32 v135,v135
v_mfma_f32_16x16x32_bf16 v[156:159],v[60:63],v[204:207],v[156:159]
ds_read_b64_tr_b16 v[52:53],v17 offset:40960
ds_read_b64_tr_b16 v[54:55],v17 offset:45056
v_mfma_f32_16x16x32_bf16 v[148:151],v[60:63],v[188:191],v[148:151]
v_exp_f32 v136,v136
s_waitcnt vmcnt(4)
s_barrier
s_waitcnt lgkmcnt(4)
v_mfma_f32_16x16x32_bf16 a[192:195],v[32:35],v[208:211],a[192:195]
ds_read_b64_tr_b16 v[56:57],v18 offset:40960
ds_read_b64_tr_b16 v[58:59],v18 offset:45056
v_mfma_f32_16x16x32_bf16 a[200:203],v[32:35],v[212:215],a[200:203]
v_cvt_pk_bf16_f32 v243,v134,v135
v_exp_f32 v137,v137
v_mfma_f32_16x16x32_bf16 a[204:207],v[36:39],v[212:215],a[204:207]
ds_read_b64_tr_b16 v[60:61],v19 offset:40960
ds_read_b64_tr_b16 v[62:63],v19 offset:45056
v_mfma_f32_16x16x32_bf16 a[196:199],v[36:39],v[208:211],a[196:199]
v_exp_f32 v138,v138
v_mfma_f32_16x16x32_bf16 a[208:211],v[40:43],v[208:211],a[208:211]
ds_read_b64_tr_b16 v[32:33],v12
ds_read_b64_tr_b16 v[34:35],v12 offset:4096
v_mfma_f32_16x16x32_bf16 a[216:219],v[40:43],v[212:215],a[216:219]
v_cvt_pk_bf16_f32 v244,v136,v137
v_mfma_f32_16x16x32_bf16 a[220:223],v[44:47],v[212:215],a[220:223]
ds_read_b64_tr_b16 v[36:37],v13
ds_read_b64_tr_b16 v[38:39],v13 offset:4096
v_exp_f32 v139,v139
v_mfma_f32_16x16x32_bf16 a[212:215],v[44:47],v[208:211],a[212:215]
v_exp_f32 v140,v140
s_waitcnt lgkmcnt(4)
v_mfma_f32_16x16x32_bf16 a[224:227],v[48:51],v[208:211],a[224:227]
ds_read_b64_tr_b16 v[40:41],v14
ds_read_b64_tr_b16 v[42:43],v14 offset:4096
v_mfma_f32_16x16x32_bf16 a[232:235],v[48:51],v[212:215],a[232:235]
v_cvt_pk_bf16_f32 v245,v138,v139
v_mfma_f32_16x16x32_bf16 a[236:239],v[52:55],v[212:215],a[236:239]
ds_read_b64_tr_b16 v[44:45],v15
ds_read_b64_tr_b16 v[46:47],v15 offset:4096
v_exp_f32 v141,v141
v_mfma_f32_16x16x32_bf16 a[228:231],v[52:55],v[208:211],a[228:231]
v_exp_f32 v142,v142
v_mfma_f32_16x16x32_bf16 a[240:243],v[56:59],v[208:211],a[240:243]
ds_read_b64_tr_b16 v[48:49],v16
ds_read_b64_tr_b16 v[50:51],v16 offset:4096
v_mfma_f32_16x16x32_bf16 a[248:251],v[56:59],v[212:215],a[248:251]
v_cvt_pk_bf16_f32 v246,v140,v141
v_mfma_f32_16x16x32_bf16 a[252:255],v[60:63],v[212:215],a[252:255]
ds_read_b64_tr_b16 v[52:53],v17
ds_read_b64_tr_b16 v[54:55],v17 offset:4096
v_exp_f32 v143,v143
v_mfma_f32_16x16x32_bf16 a[244:247],v[60:63],v[208:211],a[244:247]
v_cvt_pk_bf16_f32 v247,v142,v143
v_mfma_f32_16x16x32_bf16 v[168:171],v[28:31],v[240:243],v[168:171]
s_nop 0
v_mfma_f32_16x16x32_bf16 v[172:175],v[28:31],v[244:247],v[172:175]
s_waitcnt lgkmcnt(4)
v_mfma_f32_16x16x32_bf16 v[72:75],v[32:35],v[244:247],v[72:75]
ds_read_b64_tr_b16 v[56:57],v18
ds_read_b64_tr_b16 v[58:59],v18 offset:4096
v_mfma_f32_16x16x32_bf16 v[64:67],v[32:35],v[240:243],v[64:67]
v_mfma_f32_16x16x32_bf16 v[68:71],v[36:39],v[240:243],v[68:71]
ds_read_b64_tr_b16 v[60:61],v19
ds_read_b64_tr_b16 v[62:63],v19 offset:4096
v_mfma_f32_16x16x32_bf16 v[76:79],v[36:39],v[244:247],v[76:79]
v_max3_f32 v22,v144,v145,v146
v_mfma_f32_16x16x32_bf16 v[88:91],v[40:43],v[244:247],v[88:91]
ds_read_b128 v[32:35],v8 offset:16384
v_max3_f32 v22,v22,v147,v148
v_mfma_f32_16x16x32_bf16 v[80:83],v[40:43],v[240:243],v[80:83]
v_max3_f32 v22,v22,v149,v150
v_mfma_f32_16x16x32_bf16 v[84:87],v[44:47],v[240:243],v[84:87]
ds_read_b128 v[36:39],v8 offset:20480
v_mfma_f32_16x16x32_bf16 v[92:95],v[44:47],v[244:247],v[92:95]
v_max3_f32 v22,v22,v151,v152
s_waitcnt lgkmcnt(2)
v_mfma_f32_16x16x32_bf16 v[104:107],v[48:51],v[244:247],v[104:107]
ds_read_b128 v[40:43],v9 offset:16384
v_max3_f32 v22,v22,v153,v154
v_mfma_f32_16x16x32_bf16 v[96:99],v[48:51],v[240:243],v[96:99]
v_max3_f32 v22,v22,v155,v156
v_mfma_f32_16x16x32_bf16 v[100:103],v[52:55],v[240:243],v[100:103]
ds_read_b128 v[44:47],v9 offset:20480
v_mfma_f32_16x16x32_bf16 v[108:111],v[52:55],v[244:247],v[108:111]
v_max3_f32 v22,v22,v157,v158
v_mfma_f32_16x16x32_bf16 v[120:123],v[56:59],v[244:247],v[120:123]
ds_read_b128 v[48:51],v10 offset:16384
v_max_f32 v22,v22,v159
v_mfma_f32_16x16x32_bf16 v[112:115],v[56:59],v[240:243],v[112:115]
v_cmp_lt_f32 vcc,s43,v22
v_mfma_f32_16x16x32_bf16 v[116:119],v[60:63],v[240:243],v[116:119]
ds_read_b128 v[52:55],v10 offset:20480
v_mfma_f32_16x16x32_bf16 v[124:127],v[60:63],v[244:247],v[124:127]
s_cbranch_vccnz L_rare27
L_back27:
s_waitcnt lgkmcnt(2)
v_mfma_f32_16x16x32_bf16 v[128:131],v[32:35],v[176:179],v[160:163]
ds_read_b128 v[56:59],v11 offset:16384
v_exp_f32 v144,v144
s_cmp_lt_u32 s32,s66
s_cbranch_scc0 L_nowo29
s_add_u32 m0,s59,65536
s_xor_b32 s42,s65,99072
s_add_u32 s42,s42,s64
buffer_load_dwordx4 v248,s[20:23],s42 offen lds
buffer_load_dwordx4 v249,s[20:23],s42 offen offset:1024 lds
buffer_load_dwordx4 v250,s[20:23],s42 offen offset:2048 lds
buffer_load_dwordx4 v251,s[20:23],s42 offen offset:3072 lds
s_add_u32 s64,s64,131072
L_nowo29:
v_mfma_f32_16x16x32_bf16 v[136:139],v[32:35],v[192:195],v[164:167]
v_exp_f32 v145,v145
v_mfma_f32_16x16x32_bf16 v[140:143],v[36:39],v[192:195],v[164:167]
ds_read_b128 v[60:63],v11 offset:20480
v_mfma_f32_16x16x32_bf16 v[132:135],v[36:39],v[176:179],v[160:163]
v_exp_f32 v146,v146
v_mfma_f32_16x16x32_bf16 v[128:131],v[40:43],v[180:183],v[128:131]
ds_read_b64_tr_b16 v[32:33],v12 offset:49152
ds_read_b64_tr_b16 v[34:35],v12 offset:53248
v_cvt_pk_bf16_f32 v240,v144,v145
v_mfma_f32_16x16x32_bf16 v[136:139],v[40:43],v[196:199],v[136:139]
v_exp_f32 v147,v147
v_mfma_f32_16x16x32_bf16 v[140:143],v[44:47],v[196:199],v[140:143]
ds_read_b64_tr_b16 v[36:37],v13 offset:49152
ds_read_b64_tr_b16 v[38:39],v13 offset:53248
v_mfma_f32_16x16x32_bf16 v[132:135],v[44:47],v[180:183],v[132:135]
v_exp_f32 v148,v148
s_waitcnt lgkmcnt(4)
v_mfma_f32_16x16x32_bf16 v[128:131],v[48:51],v[184:187],v[128:131]
ds_read_b64_tr_b16 v[40:41],v14 offset:49152
ds_read_b64_tr_b16 v[42:43],v14 offset:53248
v_cvt_pk_bf16_f32 v241,v146,v147
v_mfma_f32_16x16x32_bf16 v[136:139],v[48:51],v[200:203],v[136:139]
v_exp_f32 v149,v149
v_mfma_f32_16x16x32_bf16 v[140:143],v[52:55],v[200:203],v[140:143]
ds_read_b64_tr_b16 v[44:45],v15 offset:49152
ds_read_b64_tr_b16 v[46:47],v15 offset:53248
v_mfma_f32_16x16x32_bf16 v[132:135],v[52:55],v[184:187],v[132:135]
v_exp_f32 v150,v150
v_mfma_f32_16x16x32_bf16 v[128:131],v[56:59],v[188:191],v[128:131]
ds_read_b64_tr_b16 v[48:49],v16 offset:49152
ds_read_b64_tr_b16 v[50:51],v16 offset:53248
v_mfma_f32_16x16x32_bf16 v[136:139],v[56:59],v[204:207],v[136:139]
v_cvt_pk_bf16_f32 v242,v148,v149
v_exp_f32 v151,v151
v_mfma_f32_16x16x32_bf16 v[140:143],v[60:63],v[204:207],v[140:143]
ds_read_b64_tr_b16 v[52:53],v17 offset:49152
ds_read_b64_tr_b16 v[54:55],v17 offset:53248
v_mfma_f32_16x16x32_bf16 v[132:135],v[60:63],v[188:191],v[132:135]
v_exp_f32 v152,v152
s_waitcnt vmcnt(4)
s_barrier
s_waitcnt lgkmcnt(4)
v_mfma_f32_16x16x32_bf16 a[192:195],v[32:35],v[216:219],a[192:195]
ds_read_b64_tr_b16 v[56:57],v18 offset:49152
ds_read_b64_tr_b16 v[58:59],v18 offset:53248
v_mfma_f32_16x16x32_bf16 a[200:203],v[32:35],v[220:223],a[200:203]
v_cvt_pk_bf16_f32 v243,v150,v151
v_exp_f32 v153,v153
v_mfma_f32_16x16x32_bf16 a[204:207],v[36:39],v[220:223],a[204:207]
ds_read_b64_tr_b16 v[60:61],v19 offset:49152
ds_read_b64_tr_b16 v[62:63],v19 offset:53248
v_mfma_f32_16x16x32_bf16 a[196:199],v[36:39],v[216:219],a[196:199]
v_exp_f32 v154,v154
v_mfma_f32_16x16x32_bf16 a[208:211],v[40:43],v[216:219],a[208:211]
ds_read_b64_tr_b16 v[32:33],v12 offset:8192
ds_read_b64_tr_b16 v[34:35],v12 offset:12288
v_mfma_f32_16x16x32_bf16 a[216:219],v[40:43],v[220:223],a[216:219]
v_cvt_pk_bf16_f32 v244,v152,v153
v_mfma_f32_16x16x32_bf16 a[220:223],v[44:47],v[220:223],a[220:223]
ds_read_b64_tr_b16 v[36:37],v13 offset:8192
ds_read_b64_tr_b16 v[38:39],v13 offset:12288
v_exp_f32 v155,v155
v_mfma_f32_16x16x32_bf16 a[212:215],v[44:47],v[216:219],a[212:215]
v_exp_f32 v156,v156
s_waitcnt lgkmcnt(4)
v_mfma_f32_16x16x32_bf16 a[224:227],v[48:51],v[216:219],a[224:227]
ds_read_b64_tr_b16 v[40:41],v14 offset:8192
ds_read_b64_tr_b16 v[42:43],v14 offset:12288
v_mfma_f32_16x16x32_bf16 a[232:235],v[48:51],v[220:223],a[232:235]
v_cvt_pk_bf16_f32 v245,v154,v155
v_mfma_f32_16x16x32_bf16 a[236:239],v[52:55],v[220:223],a[236:239]
ds_read_b64_tr_b16 v[44:45],v15 offset:8192
ds_read_b64_tr_b16 v[46:47],v15 offset:12288
v_exp_f32 v157,v157
v_mfma_f32_16x16x32_bf16 a[228:231],v[52:55],v[216:219],a[228:231]
v_exp_f32 v158,v158
v_mfma_f32_16x16x32_bf16 a[240:243],v[56:59],v[216:219],a[240:243]
ds_read_b64_tr_b16 v[48:49],v16 offset:8192
ds_read_b64_tr_b16 v[50:51],v16 offset:12288
v_mfma_f32_16x16x32_bf16 a[248:251],v[56:59],v[220:223],a[248:251]
v_cvt_pk_bf16_f32 v246,v156,v157
v_mfma_f32_16x16x32_bf16 a[252:255],v[60:63],v[220:223],a[252:255]
ds_read_b64_tr_b16 v[52:53],v17 offset:8192
ds_read_b64_tr_b16 v[54:55],v17 offset:12288
v_exp_f32 v159,v159
v_mfma_f32_16x16x32_bf16 a[244:247],v[60:63],v[216:219],a[244:247]
v_cvt_pk_bf16_f32 v247,v158,v159
v_mfma_f32_16x16x32_bf16 v[168:171],v[28:31],v[240:243],v[168:171]
s_nop 0
v_mfma_f32_16x16x32_bf16 v[172:175],v[28:31],v[244:247],v[172:175]
s_waitcnt lgkmcnt(4)
v_mfma_f32_16x16x32_bf16 v[72:75],v[32:35],v[244:247],v[72:75]
ds_read_b64_tr_b16 v[56:57],v18 offset:8192
ds_read_b64_tr_b16 v[58:59],v18 offset:12288
v_mfma_f32_16x16x32_bf16 v[64:67],v[32:35],v[240:243],v[64:67]
v_mfma_f32_16x16x32_bf16 v[68:71],v[36:39],v[240:243],v[68:71]
ds_read_b64_tr_b16 v[60:61],v19 offset:8192
ds_read_b64_tr_b16 v[62:63],v19 offset:12288
v_mfma_f32_16x16x32_bf16 v[76:79],v[36:39],v[244:247],v[76:79]
v_max3_f32 v22,v128,v129,v130
v_mfma_f32_16x16x32_bf16 v[88:91],v[40:43],v[244:247],v[88:91]
ds_read_b128 v[32:35],v8 offset:24576
v_max3_f32 v22,v22,v131,v132
v_mfma_f32_16x16x32_bf16 v[80:83],v[40:43],v[240:243],v[80:83]
v_max3_f32 v22,v22,v133,v134
v_mfma_f32_16x16x32_bf16 v[84:87],v[44:47],v[240:243],v[84:87]
ds_read_b128 v[36:39],v8 offset:28672
v_mfma_f32_16x16x32_bf16 v[92:95],v[44:47],v[244:247],v[92:95]
v_max3_f32 v22,v22,v135,v136
s_waitcnt lgkmcnt(2)
v_mfma_f32_16x16x32_bf16 v[104:107],v[48:51],v[244:247],v[104:107]
ds_read_b128 v[40:43],v9 offset:24576
v_max3_f32 v22,v22,v137,v138
v_mfma_f32_16x16x32_bf16 v[96:99],v[48:51],v[240:243],v[96:99]
v_max3_f32 v22,v22,v139,v140
v_mfma_f32_16x16x32_bf16 v[100:103],v[52:55],v[240:243],v[100:103]
ds_read_b128 v[44:47],v9 offset:28672
v_mfma_f32_16x16x32_bf16 v[108:111],v[52:55],v[244:247],v[108:111]
v_max3_f32 v22,v22,v141,v142
v_mfma_f32_16x16x32_bf16 v[120:123],v[56:59],v[244:247],v[120:123]
ds_read_b128 v[48:51],v10 offset:24576
v_max_f32 v22,v22,v143
v_mfma_f32_16x16x32_bf16 v[112:115],v[56:59],v[240:243],v[112:115]
v_cmp_lt_f32 vcc,s43,v22
v_mfma_f32_16x16x32_bf16 v[116:119],v[60:63],v[240:243],v[116:119]
ds_read_b128 v[52:55],v10 offset:28672
v_mfma_f32_16x16x32_bf16 v[124:127],v[60:63],v[244:247],v[124:127]
s_cbranch_vccnz L_rare28
L_back28:
s_waitcnt lgkmcnt(2)
v_mfma_f32_16x16x32_bf16 v[144:147],v[32:35],v[176:179],v[160:163]
ds_read_b128 v[56:59],v11 offset:24576
v_exp_f32 v128,v128
s_cmp_lt_u32 s32,s66
s_cbranch_scc0 L_nowo30
s_add_u32 m0,s59,73728
s_xor_b32 s42,s65,0
s_add_u32 s42,s42,s64
buffer_load_dwordx4 v248,s[20:23],s42 offen lds
buffer_load_dwordx4 v249,s[20:23],s42 offen offset:1024 lds
buffer_load_dwordx4 v250,s[20:23],s42 offen offset:2048 lds
buffer_load_dwordx4 v251,s[20:23],s42 offen offset:3072 lds
L_nowo30:
v_mfma_f32_16x16x32_bf16 v[152:155],v[32:35],v[192:195],v[164:167]
v_exp_f32 v129,v129
v_mfma_f32_16x16x32_bf16 v[156:159],v[36:39],v[192:195],v[164:167]
ds_read_b128 v[60:63],v11 offset:28672
v_mfma_f32_16x16x32_bf16 v[148:151],v[36:39],v[176:179],v[160:163]
v_exp_f32 v130,v130
v_mfma_f32_16x16x32_bf16 v[144:147],v[40:43],v[180:183],v[144:147]
ds_read_b64_tr_b16 v[32:33],v12 offset:57344
ds_read_b64_tr_b16 v[34:35],v12 offset:61440
v_cvt_pk_bf16_f32 v240,v128,v129
v_mfma_f32_16x16x32_bf16 v[152:155],v[40:43],v[196:199],v[152:155]
v_exp_f32 v131,v131
v_mfma_f32_16x16x32_bf16 v[156:159],v[44:47],v[196:199],v[156:159]
ds_read_b64_tr_b16 v[36:37],v13 offset:57344
ds_read_b64_tr_b16 v[38:39],v13 offset:61440
v_mfma_f32_16x16x32_bf16 v[148:151],v[44:47],v[180:183],v[148:151]
v_exp_f32 v132,v132
s_waitcnt lgkmcnt(4)
v_mfma_f32_16x16x32_bf16 v[144:147],v[48:51],v[184:187],v[144:147]
ds_read_b64_tr_b16 v[40:41],v14 offset:57344
ds_read_b64_tr_b16 v[42:43],v14 offset:61440
v_cvt_pk_bf16_f32 v241,v130,v131
v_mfma_f32_16x16x32_bf16 v[152:155],v[48:51],v[200:203],v[152:155]
v_exp_f32 v133,v133
v_mfma_f32_16x16x32_bf16 v[156:159],v[52:55],v[200:203],v[156:159]
ds_read_b64_tr_b16 v[44:45],v15 offset:57344
ds_read_b64_tr_b16 v[46:47],v15 offset:61440
v_mfma_f32_16x16x32_bf16 v[148:151],v[52:55],v[184:187],v[148:151]
v_exp_f32 v134,v134
v_mfma_f32_16x16x32_bf16 v[144:147],v[56:59],v[188:191],v[144:147]
ds_read_b64_tr_b16 v[48:49],v16 offset:57344
ds_read_b64_tr_b16 v[50:51],v16 offset:61440
v_mfma_f32_16x16x32_bf16 v[152:155],v[56:59],v[204:207],v[152:155]
v_cvt_pk_bf16_f32 v242,v132,v133
v_exp_f32 v135,v135
v_mfma_f32_16x16x32_bf16 v[156:159],v[60:63],v[204:207],v[156:159]
ds_read_b64_tr_b16 v[52:53],v17 offset:57344
ds_read_b64_tr_b16 v[54:55],v17 offset:61440
v_mfma_f32_16x16x32_bf16 v[148:151],v[60:63],v[188:191],v[148:151]
v_exp_f32 v136,v136
s_waitcnt vmcnt(4)
s_add_u32 s100,s100,1
s_cmp_eq_u32 s100,6
s_cbranch_scc1 L_aloop1_end
s_barrier
s_waitcnt lgkmcnt(4)
v_mfma_f32_16x16x32_bf16 a[192:195],v[32:35],v[224:227],a[192:195]
ds_read_b64_tr_b16 v[56:57],v18 offset:57344
ds_read_b64_tr_b16 v[58:59],v18 offset:61440
v_mfma_f32_16x16x32_bf16 a[200:203],v[32:35],v[228:231],a[200:203]
v_cvt_pk_bf16_f32 v243,v134,v135
v_exp_f32 v137,v137
v_mfma_f32_16x16x32_bf16 a[204:207],v[36:39],v[228:231],a[204:207]
ds_read_b64_tr_b16 v[60:61],v19 offset:57344
ds_read_b64_tr_b16 v[62:63],v19 offset:61440
v_mfma_f32_16x16x32_bf16 a[196:199],v[36:39],v[224:227],a[196:199]
v_exp_f32 v138,v138
v_mfma_f32_16x16x32_bf16 a[208:211],v[40:43],v[224:227],a[208:211]
ds_read_b64_tr_b16 v[32:33],v12 offset:16384
ds_read_b64_tr_b16 v[34:35],v12 offset:20480
v_mfma_f32_16x16x32_bf16 a[216:219],v[40:43],v[228:231],a[216:219]
v_cvt_pk_bf16_f32 v244,v136,v137
v_mfma_f32_16x16x32_bf16 a[220:223],v[44:47],v[228:231],a[220:223]
ds_read_b64_tr_b16 v[36:37],v13 offset:16384
ds_read_b64_tr_b16 v[38:39],v13 offset:20480
v_exp_f32 v139,v139
v_mfma_f32_16x16x32_bf16 a[212:215],v[44:47],v[224:227],a[212:215]
v_exp_f32 v140,v140
s_waitcnt lgkmcnt(4)
v_mfma_f32_16x16x32_bf16 a[224:227],v[48:51],v[224:227],a[224:227]
ds_read_b64_tr_b16 v[40:41],v14 offset:16384
ds_read_b64_tr_b16 v[42:43],v14 offset:20480
v_mfma_f32_16x16x32_bf16 a[232:235],v[48:51],v[228:231],a[232:235]
v_cvt_pk_bf16_f32 v245,v138,v139
v_mfma_f32_16x16x32_bf16 a[236:239],v[52:55],v[228:231],a[236:239]
ds_read_b64_tr_b16 v[44:45],v15 offset:16384
ds_read_b64_tr_b16 v[46:47],v15 offset:20480
v_exp_f32 v141,v141
v_mfma_f32_16x16x32_bf16 a[228:231],v[52:55],v[224:227],a[228:231]
v_exp_f32 v142,v142
v_mfma_f32_16x16x32_bf16 a[240:243],v[56:59],v[224:227],a[240:243]
ds_read_b64_tr_b16 v[48:49],v16 offset:16384
ds_read_b64_tr_b16 v[50:51],v16 offset:20480
v_mfma_f32_16x16x32_bf16 a[248:251],v[56:59],v[228:231],a[248:251]
v_cvt_pk_bf16_f32 v246,v140,v141
v_mfma_f32_16x16x32_bf16 a[252:255],v[60:63],v[228:231],a[252:255]
ds_read_b64_tr_b16 v[52:53],v17 offset:16384
ds_read_b64_tr_b16 v[54:55],v17 offset:20480
v_exp_f32 v143,v143
v_mfma_f32_16x16x32_bf16 a[244:247],v[60:63],v[224:227],a[244:247]
v_cvt_pk_bf16_f32 v247,v142,v143
v_mfma_f32_16x16x32_bf16 v[168:171],v[28:31],v[240:243],v[168:171]
ds_read_b128 v[176:179],v20
v_mfma_f32_16x16x32_bf16 v[172:175],v[28:31],v[244:247],v[172:175]
s_waitcnt lgkmcnt(5)
v_mfma_f32_16x16x32_bf16 v[72:75],v[32:35],v[244:247],v[72:75]
ds_read_b64_tr_b16 v[56:57],v18 offset:16384
ds_read_b64_tr_b16 v[58:59],v18 offset:20480
v_mfma_f32_16x16x32_bf16 v[64:67],v[32:35],v[240:243],v[64:67]
ds_read_b128 v[192:195],v20 offset:4096
v_mfma_f32_16x16x32_bf16 v[68:71],v[36:39],v[240:243],v[68:71]
ds_read_b64_tr_b16 v[60:61],v19 offset:16384
ds_read_b64_tr_b16 v[62:63],v19 offset:20480
v_mfma_f32_16x16x32_bf16 v[76:79],v[36:39],v[244:247],v[76:79]
ds_read_b128 v[180:183],v20 offset:1024
v_max3_f32 v22,v144,v145,v146
v_mfma_f32_16x16x32_bf16 v[88:91],v[40:43],v[244:247],v[88:91]
ds_read_b128 v[32:35],v8
v_max3_f32 v22,v22,v147,v148
v_mfma_f32_16x16x32_bf16 v[80:83],v[40:43],v[240:243],v[80:83]
ds_read_b128 v[196:199],v20 offset:5120
v_max3_f32 v22,v22,v149,v150
v_mfma_f32_16x16x32_bf16 v[84:87],v[44:47],v[240:243],v[84:87]
ds_read_b128 v[36:39],v8 offset:4096
v_mfma_f32_16x16x32_bf16 v[92:95],v[44:47],v[244:247],v[92:95]
ds_read_b128 v[184:187],v20 offset:2048
v_max3_f32 v22,v22,v151,v152
s_waitcnt lgkmcnt(5)
v_mfma_f32_16x16x32_bf16 v[104:107],v[48:51],v[244:247],v[104:107]
ds_read_b128 v[40:43],v9
v_max3_f32 v22,v22,v153,v154
v_mfma_f32_16x16x32_bf16 v[96:99],v[48:51],v[240:243],v[96:99]
ds_read_b128 v[200:203],v20 offset:6144
v_max3_f32 v22,v22,v155,v156
v_mfma_f32_16x16x32_bf16 v[100:103],v[52:55],v[240:243],v[100:103]
ds_read_b128 v[44:47],v9 offset:4096
v_mfma_f32_16x16x32_bf16 v[108:111],v[52:55],v[244:247],v[108:111]
ds_read_b128 v[188:191],v20 offset:3072
v_max3_f32 v22,v22,v157,v158
v_mfma_f32_16x16x32_bf16 v[120:123],v[56:59],v[244:247],v[120:123]
ds_read_b128 v[48:51],v10
v_max_f32 v22,v22,v159
v_mfma_f32_16x16x32_bf16 v[112:115],v[56:59],v[240:243],v[112:115]
ds_read_b128 v[204:207],v20 offset:7168
v_cmp_lt_f32 vcc,s43,v22
v_mfma_f32_16x16x32_bf16 v[116:119],v[60:63],v[240:243],v[116:119]
ds_read_b128 v[52:55],v10 offset:4096
v_mfma_f32_16x16x32_bf16 v[124:127],v[60:63],v[244:247],v[124:127]
s_cbranch_vccnz L_rare29
L_back29:
s_waitcnt lgkmcnt(4)
v_mfma_f32_16x16x32_bf16 v[128:131],v[32:35],v[176:179],0
ds_read_b128 v[56:59],v11
v_exp_f32 v144,v144
s_cmp_eq_u32 s100,5
s_cselect_b32 s66,0,2
s_cmp_lt_u32 s32,s66
s_cbranch_scc0 L_nowo31
s_add_u32 m0,s59,81920
s_xor_b32 s42,s65,32768
s_add_u32 s42,s42,s64
buffer_load_dwordx4 v248,s[20:23],s42 offen lds
buffer_load_dwordx4 v249,s[20:23],s42 offen offset:1024 lds
buffer_load_dwordx4 v250,s[20:23],s42 offen offset:2048 lds
buffer_load_dwordx4 v251,s[20:23],s42 offen offset:3072 lds
L_nowo31:
v_mfma_f32_16x16x32_bf16 v[136:139],v[32:35],v[192:195],0
L_tp_a7:
s_cbranch_execz L_chain_done
v_exp_f32 v145,v145
v_mfma_f32_16x16x32_bf16 v[140:143],v[36:39],v[192:195],0
ds_read_b128 v[60:63],v11 offset:4096
v_mfma_f32_16x16x32_bf16 v[132:135],v[36:39],v[176:179],0
v_exp_f32 v146,v146
v_mfma_f32_16x16x32_bf16 v[128:131],v[40:43],v[180:183],v[128:131]
ds_read_b64_tr_b16 v[32:33],v12 offset:32768
ds_read_b64_tr_b16 v[34:35],v12 offset:36864
v_cvt_pk_bf16_f32 v240,v144,v145
v_mfma_f32_16x16x32_bf16 v[136:139],v[40:43],v[196:199],v[136:139]
v_exp_f32 v147,v147
v_mfma_f32_16x16x32_bf16 v[140:143],v[44:47],v[196:199],v[140:143]
ds_read_b64_tr_b16 v[36:37],v13 offset:32768
ds_read_b64_tr_b16 v[38:39],v13 offset:36864
v_mfma_f32_16x16x32_bf16 v[132:135],v[44:47],v[180:183],v[132:135]
v_exp_f32 v148,v148
s_waitcnt lgkmcnt(4)
v_mfma_f32_16x16x32_bf16 v[128:131],v[48:51],v[184:187],v[128:131]
ds_read_b64_tr_b16 v[40:41],v14 offset:32768
ds_read_b64_tr_b16 v[42:43],v14 offset:36864
v_cvt_pk_bf16_f32 v241,v146,v147
v_mfma_f32_16x16x32_bf16 v[136:139],v[48:51],v[200:203],v[136:139]
v_exp_f32 v149,v149
v_mfma_f32_16x16x32_bf16 v[140:143],v[52:55],v[200:203],v[140:143]
ds_read_b64_tr_b16 v[44:45],v15 offset:32768
ds_read_b64_tr_b16 v[46:47],v15 offset:36864
v_mfma_f32_16x16x32_bf16 v[132:135],v[52:55],v[184:187],v[132:135]
v_exp_f32 v150,v150
v_mfma_f32_16x16x32_bf16 v[128:131],v[56:59],v[188:191],v[128:131]
ds_read_b64_tr_b16 v[48:49],v16 offset:32768
ds_read_b64_tr_b16 v[50:51],v16 offset:36864
v_mfma_f32_16x16x32_bf16 v[136:139],v[56:59],v[204:207],v[136:139]
v_cvt_pk_bf16_f32 v242,v148,v149
v_exp_f32 v151,v151
v_mfma_f32_16x16x32_bf16 v[140:143],v[60:63],v[204:207],v[140:143]
ds_read_b64_tr_b16 v[52:53],v17 offset:32768
ds_read_b64_tr_b16 v[54:55],v17 offset:36864
v_mfma_f32_16x16x32_bf16 v[132:135],v[60:63],v[188:191],v[132:135]
v_exp_f32 v152,v152
s_waitcnt vmcnt(4)
s_cmp_eq_u32 s66,0
s_cbranch_scc0 L_keep32
s_waitcnt vmcnt(0)
L_keep32:
s_barrier
s_waitcnt lgkmcnt(4)
v_mfma_f32_16x16x32_bf16 a[192:195],v[32:35],v[232:235],a[192:195]
ds_read_b64_tr_b16 v[56:57],v18 offset:32768
ds_read_b64_tr_b16 v[58:59],v18 offset:36864
v_mfma_f32_16x16x32_bf16 a[200:203],v[32:35],v[236:239],a[200:203]
v_cvt_pk_bf16_f32 v243,v150,v151
v_exp_f32 v153,v153
v_mfma_f32_16x16x32_bf16 a[204:207],v[36:39],v[236:239],a[204:207]
ds_read_b64_tr_b16 v[60:61],v19 offset:32768
ds_read_b64_tr_b16 v[62:63],v19 offset:36864
v_mfma_f32_16x16x32_bf16 a[196:199],v[36:39],v[232:235],a[196:199]
v_exp_f32 v154,v154
v_mfma_f32_16x16x32_bf16 a[208:211],v[40:43],v[232:235],a[208:211]
ds_read_b64_tr_b16 v[32:33],v12 offset:24576
ds_read_b64_tr_b16 v[34:35],v12 offset:28672
v_mfma_f32_16x16x32_bf16 a[216:219],v[40:43],v[236:239],a[216:219]
v_cvt_pk_bf16_f32 v244,v152,v153
v_mfma_f32_16x16x32_bf16 a[220:223],v[44:47],v[236:239],a[220:223]
ds_read_b64_tr_b16 v[36:37],v13 offset:24576
ds_read_b64_tr_b16 v[38:39],v13 offset:28672
v_exp_f32 v155,v155
v_mfma_f32_16x16x32_bf16 a[212:215],v[44:47],v[232:235],a[212:215]
v_exp_f32 v156,v156
s_waitcnt lgkmcnt(4)
v_mfma_f32_16x16x32_bf16 a[224:227],v[48:51],v[232:235],a[224:227]
ds_read_b64_tr_b16 v[40:41],v14 offset:24576
ds_read_b64_tr_b16 v[42:43],v14 offset:28672
v_mfma_f32_16x16x32_bf16 a[232:235],v[48:51],v[236:239],a[232:235]
v_cvt_pk_bf16_f32 v245,v154,v155
v_mfma_f32_16x16x32_bf16 a[236:239],v[52:55],v[236:239],a[236:239]
ds_read_b64_tr_b16 v[44:45],v15 offset:24576
ds_read_b64_tr_b16 v[46:47],v15 offset:28672
v_exp_f32 v157,v157
v_mfma_f32_16x16x32_bf16 a[228:231],v[52:55],v[232:235],a[228:231]
v_exp_f32 v158,v158
v_mfma_f32_16x16x32_bf16 a[240:243],v[56:59],v[232:235],a[240:243]
ds_read_b64_tr_b16 v[48:49],v16 offset:24576
ds_read_b64_tr_b16 v[50:51],v16 offset:28672
v_mfma_f32_16x16x32_bf16 a[248:251],v[56:59],v[236:239],a[248:251]
v_cvt_pk_bf16_f32 v246,v156,v157
v_mfma_f32_16x16x32_bf16 a[252:255],v[60:63],v[236:239],a[252:255]
ds_read_b64_tr_b16 v[52:53],v17 offset:24576
ds_read_b64_tr_b16 v[54:55],v17 offset:28672
v_exp_f32 v159,v159
v_mfma_f32_16x16x32_bf16 a[244:247],v[60:63],v[232:235],a[244:247]
v_cvt_pk_bf16_f32 v247,v158,v159
v_mfma_f32_16x16x32_bf16 v[168:171],v[28:31],v[240:243],v[168:171]
s_nop 0
v_mfma_f32_16x16x32_bf16 v[172:175],v[28:31],v[244:247],v[172:175]
s_waitcnt lgkmcnt(4)
v_mfma_f32_16x16x32_bf16 v[72:75],v[32:35],v[244:247],v[72:75]
ds_read_b64_tr_b16 v[56:57],v18 offset:24576
ds_read_b64_tr_b16 v[58:59],v18 offset:28672
v_max3_f32 v22,v128,v129,v130
v_mfma_f32_16x16x32_bf16 v[64:67],v[32:35],v[240:243],v[64:67]
v_max3_f32 v24,v136,v137,v138
v_max3_f32 v22,v22,v131,v132
v_max3_f32 v24,v24,v139,v140
v_max3_f32 v22,v22,v133,v134
v_mfma_f32_16x16x32_bf16 v[68:71],v[36:39],v[240:243],v[68:71]
ds_read_b64_tr_b16 v[60:61],v19 offset:24576
ds_read_b64_tr_b16 v[62:63],v19 offset:28672
v_max3_f32 v24,v24,v141,v142
v_mfma_f32_16x16x32_bf16 v[76:79],v[36:39],v[244:247],v[76:79]
v_max_f32 v22,v22,v135
v_max_f32 v24,v24,v143
v_mov_b32 v160,v22
v_mov_b32 v164,v24
v_mfma_f32_16x16x32_bf16 v[88:91],v[40:43],v[244:247],v[88:91]
ds_read_b128 v[32:35],v8 offset:8192
v_permlane16_swap_b32 v160,v22
v_permlane16_swap_b32 v164,v24
v_mfma_f32_16x16x32_bf16 v[80:83],v[40:43],v[240:243],v[80:83]
v_max_f32 v22,v22,v160
v_max_f32 v24,v24,v164
v_mov_b32 v160,v22
v_mov_b32 v164,v24
v_mfma_f32_16x16x32_bf16 v[84:87],v[44:47],v[240:243],v[84:87]
ds_read_b128 v[36:39],v8 offset:12288
v_permlane32_swap_b32 v160,v22
v_permlane32_swap_b32 v164,v24
v_max_f32 v22,v22,v160
v_mfma_f32_16x16x32_bf16 v[92:95],v[44:47],v[244:247],v[92:95]
v_max_f32 v24,v24,v164
v_sub_f32 v160,0,v22
v_sub_f32 v164,0,v24
v_sub_f32 v161,0,v22
s_waitcnt lgkmcnt(2)
v_mfma_f32_16x16x32_bf16 v[104:107],v[48:51],v[244:247],v[104:107]
ds_read_b128 v[40:43],v9 offset:8192
v_sub_f32 v165,0,v24
v_sub_f32 v162,0,v22
v_mfma_f32_16x16x32_bf16 v[96:99],v[48:51],v[240:243],v[96:99]
v_sub_f32 v166,0,v24
v_sub_f32 v163,0,v22
v_sub_f32 v167,0,v24
v_mfma_f32_16x16x32_bf16 v[100:103],v[52:55],v[240:243],v[100:103]
ds_read_b128 v[44:47],v9 offset:12288
v_rcp_f32 v26,v168
v_rcp_f32 v27,v172
v_mfma_f32_16x16x32_bf16 v[108:111],v[52:55],v[244:247],v[108:111]
v_sub_f32 v128,v128,v22
v_sub_f32 v129,v129,v22
v_sub_f32 v130,v130,v22
v_mfma_f32_16x16x32_bf16 v[120:123],v[56:59],v[244:247],v[120:123]
ds_read_b128 v[48:51],v10 offset:8192
v_sub_f32 v131,v131,v22
v_sub_f32 v132,v132,v22
v_sub_f32 v133,v133,v22
v_mfma_f32_16x16x32_bf16 v[112:115],v[56:59],v[240:243],v[112:115]
v_sub_f32 v134,v134,v22
v_sub_f32 v135,v135,v22
v_sub_f32 v136,v136,v24
v_sub_f32 v137,v137,v24
v_mfma_f32_16x16x32_bf16 v[116:119],v[60:63],v[240:243],v[116:119]
ds_read_b128 v[52:55],v10 offset:12288
v_sub_f32 v138,v138,v24
v_sub_f32 v139,v139,v24
v_mfma_f32_16x16x32_bf16 v[124:127],v[60:63],v[244:247],v[124:127]
v_sub_f32 v140,v140,v24
v_sub_f32 v141,v141,v24
v_sub_f32 v142,v142,v24
v_sub_f32 v143,v143,v24
s_waitcnt lgkmcnt(2)
v_mfma_f32_16x16x32_bf16 v[144:147],v[32:35],v[176:179],v[160:163]
ds_read_b128 v[56:59],v11 offset:8192
v_mul_f32 v64,v64,v26
v_mul_f32 v65,v65,v26
v_mul_f32 v66,v66,v26
s_cmp_lt_u32 s32,s66
s_cbranch_scc0 L_nowo32
s_add_u32 m0,s59,90112
s_xor_b32 s42,s65,65536
s_add_u32 s42,s42,s64
buffer_load_dwordx4 v248,s[20:23],s42 offen lds
buffer_load_dwordx4 v249,s[20:23],s42 offen offset:1024 lds
buffer_load_dwordx4 v250,s[20:23],s42 offen offset:2048 lds
buffer_load_dwordx4 v251,s[20:23],s42 offen offset:3072 lds
L_nowo32:
v_mfma_f32_16x16x32_bf16 v[152:155],v[32:35],v[192:195],v[164:167]
v_mul_f32 v67,v67,v26
v_mul_f32 v68,v68,v26
v_mul_f32 v69,v69,v26
v_mul_f32 v70,v70,v26
v_mfma_f32_16x16x32_bf16 v[156:159],v[36:39],v[192:195],v[164:167]
ds_read_b128 v[60:63],v11 offset:12288
v_mul_f32 v71,v71,v26
v_cvt_pk_bf16_f32 v208,v64,v65
v_mfma_f32_16x16x32_bf16 v[148:151],v[36:39],v[176:179],v[160:163]
v_cvt_pk_bf16_f32 v209,v66,v67
v_cvt_pk_bf16_f32 v210,v68,v69
v_cvt_pk_bf16_f32 v211,v70,v71
v_mul_f32 v72,v72,v27
v_mul_f32 v73,v73,v27
v_mfma_f32_16x16x32_bf16 v[144:147],v[40:43],v[180:183],v[144:147]
ds_read_b64_tr_b16 v[32:33],v12 offset:40960
ds_read_b64_tr_b16 v[34:35],v12 offset:45056
v_mul_f32 v74,v74,v27
v_mfma_f32_16x16x32_bf16 v[152:155],v[40:43],v[196:199],v[152:155]
v_mul_f32 v75,v75,v27
v_mul_f32 v76,v76,v27
v_mul_f32 v77,v77,v27
v_mul_f32 v78,v78,v27
v_mfma_f32_16x16x32_bf16 v[156:159],v[44:47],v[196:199],v[156:159]
ds_read_b64_tr_b16 v[36:37],v13 offset:40960
ds_read_b64_tr_b16 v[38:39],v13 offset:45056
v_mul_f32 v79,v79,v27
v_mfma_f32_16x16x32_bf16 v[148:151],v[44:47],v[180:183],v[148:151]
v_cvt_pk_bf16_f32 v212,v72,v73
v_cvt_pk_bf16_f32 v213,v74,v75
v_cvt_pk_bf16_f32 v214,v76,v77
v_cvt_pk_bf16_f32 v215,v78,v79
s_waitcnt lgkmcnt(4)
v_mfma_f32_16x16x32_bf16 v[144:147],v[48:51],v[184:187],v[144:147]
ds_read_b64_tr_b16 v[40:41],v14 offset:40960
ds_read_b64_tr_b16 v[42:43],v14 offset:45056
v_exp_f32 v128,v128
v_mfma_f32_16x16x32_bf16 v[152:155],v[48:51],v[200:203],v[152:155]
v_exp_f32 v129,v129
v_exp_f32 v130,v130
v_mfma_f32_16x16x32_bf16 v[156:159],v[52:55],v[200:203],v[156:159]
ds_read_b64_tr_b16 v[44:45],v15 offset:40960
ds_read_b64_tr_b16 v[46:47],v15 offset:45056
v_mfma_f32_16x16x32_bf16 v[148:151],v[52:55],v[184:187],v[148:151]
v_cvt_pk_bf16_f32 v240,v128,v129
v_exp_f32 v131,v131
v_exp_f32 v132,v132
v_mfma_f32_16x16x32_bf16 v[144:147],v[56:59],v[188:191],v[144:147]
ds_read_b64_tr_b16 v[48:49],v16 offset:40960
ds_read_b64_tr_b16 v[50:51],v16 offset:45056
v_cvt_pk_bf16_f32 v241,v130,v131
v_mfma_f32_16x16x32_bf16 v[152:155],v[56:59],v[204:207],v[152:155]
v_exp_f32 v133,v133
v_exp_f32 v134,v134
v_mfma_f32_16x16x32_bf16 v[156:159],v[60:63],v[204:207],v[156:159]
ds_read_b64_tr_b16 v[52:53],v17 offset:40960
ds_read_b64_tr_b16 v[54:55],v17 offset:45056
v_cvt_pk_bf16_f32 v242,v132,v133
v_mfma_f32_16x16x32_bf16 v[148:151],v[60:63],v[188:191],v[148:151]
v_exp_f32 v135,v135
v_exp_f32 v136,v136
s_waitcnt vmcnt(4)
s_branch L_aloop1
.p2align 12
L_aloop1_end:
L_tp_a8:
s_cbranch_execz L_tr_a8
s_barrier
v_add_u32 v176,65536,v12
v_add_u32 v177,65536,v13
v_add_u32 v178,65536,v14
v_add_u32 v179,65536,v15
v_add_u32 v180,65536,v16
v_add_u32 v181,65536,v17
v_add_u32 v182,65536,v18
v_add_u32 v183,65536,v19
s_waitcnt lgkmcnt(4)
v_mfma_f32_16x16x32_bf16 a[192:195],v[32:35],v[224:227],a[192:195]
ds_read_b64_tr_b16 v[56:57],v18 offset:57344
ds_read_b64_tr_b16 v[58:59],v18 offset:61440
v_mfma_f32_16x16x32_bf16 a[200:203],v[32:35],v[228:231],a[200:203]
v_cvt_pk_bf16_f32 v243,v134,v135
v_exp_f32 v137,v137
v_mfma_f32_16x16x32_bf16 a[204:207],v[36:39],v[228:231],a[204:207]
ds_read_b64_tr_b16 v[60:61],v19 offset:57344
ds_read_b64_tr_b16 v[62:63],v19 offset:61440
v_mfma_f32_16x16x32_bf16 a[196:199],v[36:39],v[224:227],a[196:199]
v_exp_f32 v138,v138
v_mfma_f32_16x16x32_bf16 a[208:211],v[40:43],v[224:227],a[208:211]
ds_read_b64_tr_b16 v[32:33],v176
ds_read_b64_tr_b16 v[34:35],v176 offset:4096
v_mfma_f32_16x16x32_bf16 a[216:219],v[40:43],v[228:231],a[216:219]
v_cvt_pk_bf16_f32 v244,v136,v137
v_mfma_f32_16x16x32_bf16 a[220:223],v[44:47],v[228:231],a[220:223]
ds_read_b64_tr_b16 v[36:37],v177
ds_read_b64_tr_b16 v[38:39],v177 offset:4096
v_exp_f32 v139,v139
v_mfma_f32_16x16x32_bf16 a[212:215],v[44:47],v[224:227],a[212:215]
v_exp_f32 v140,v140
s_waitcnt lgkmcnt(4)
v_mfma_f32_16x16x32_bf16 a[224:227],v[48:51],v[224:227],a[224:227]
ds_read_b64_tr_b16 v[40:41],v178
ds_read_b64_tr_b16 v[42:43],v178 offset:4096
v_mfma_f32_16x16x32_bf16 a[232:235],v[48:51],v[228:231],a[232:235]
v_cvt_pk_bf16_f32 v245,v138,v139
v_mfma_f32_16x16x32_bf16 a[236:239],v[52:55],v[228:231],a[236:239]
ds_read_b64_tr_b16 v[44:45],v179
ds_read_b64_tr_b16 v[46:47],v179 offset:4096
v_exp_f32 v141,v141
v_mfma_f32_16x16x32_bf16 a[228:231],v[52:55],v[224:227],a[228:231]
v_exp_f32 v142,v142
v_mfma_f32_16x16x32_bf16 a[240:243],v[56:59],v[224:227],a[240:243]
ds_read_b64_tr_b16 v[48:49],v180
ds_read_b64_tr_b16 v[50:51],v180 offset:4096
v_mfma_f32_16x16x32_bf16 a[248:251],v[56:59],v[228:231],a[248:251]
v_cvt_pk_bf16_f32 v246,v140,v141
v_mfma_f32_16x16x32_bf16 a[252:255],v[60:63],v[228:231],a[252:255]
ds_read_b64_tr_b16 v[52:53],v181
ds_read_b64_tr_b16 v[54:55],v181 offset:4096
v_exp_f32 v143,v143
v_mfma_f32_16x16x32_bf16 a[244:247],v[60:63],v[224:227],a[244:247]
v_cvt_pk_bf16_f32 v247,v142,v143
v_mfma_f32_16x16x32_bf16 v[168:171],v[28:31],v[240:243],v[168:171]
v_subrev_u32 v184,32768,v12
v_subrev_u32 v185,32768,v13
v_mfma_f32_16x16x32_bf16 v[172:175],v[28:31],v[244:247],v[172:175]
v_subrev_u32 v186,32768,v14
v_subrev_u32 v187,32768,v15
v_subrev_u32 v188,32768,v16
s_waitcnt lgkmcnt(4)
v_mfma_f32_16x16x32_bf16 v[72:75],v[32:35],v[244:247],v[72:75]
ds_read_b64_tr_b16 v[56:57],v182
ds_read_b64_tr_b16 v[58:59],v182 offset:4096
v_subrev_u32 v189,32768,v17
v_mfma_f32_16x16x32_bf16 v[64:67],v[32:35],v[240:243],v[64:67]
v_subrev_u32 v190,32768,v18
v_subrev_u32 v191,32768,v19
v_mfma_f32_16x16x32_bf16 v[68:71],v[36:39],v[240:243],v[68:71]
ds_read_b64_tr_b16 v[60:61],v183
ds_read_b64_tr_b16 v[62:63],v183 offset:4096
v_mfma_f32_16x16x32_bf16 v[76:79],v[36:39],v[244:247],v[76:79]
v_max3_f32 v22,v144,v145,v146
v_max3_f32 v22,v22,v147,v148
v_mfma_f32_16x16x32_bf16 v[88:91],v[40:43],v[244:247],v[88:91]
ds_read_b64_tr_b16 v[32:33],v12 offset:32768
ds_read_b64_tr_b16 v[34:35],v12 offset:36864
v_mfma_f32_16x16x32_bf16 v[80:83],v[40:43],v[240:243],v[80:83]
v_max3_f32 v22,v22,v149,v150
v_mfma_f32_16x16x32_bf16 v[84:87],v[44:47],v[240:243],v[84:87]
ds_read_b64_tr_b16 v[36:37],v13 offset:32768
ds_read_b64_tr_b16 v[38:39],v13 offset:36864
v_mfma_f32_16x16x32_bf16 v[92:95],v[44:47],v[244:247],v[92:95]
v_max3_f32 v22,v22,v151,v152
v_max3_f32 v22,v22,v153,v154
s_waitcnt lgkmcnt(4)
v_mfma_f32_16x16x32_bf16 v[104:107],v[48:51],v[244:247],v[104:107]
ds_read_b64_tr_b16 v[40:41],v14 offset:32768
ds_read_b64_tr_b16 v[42:43],v14 offset:36864
v_mfma_f32_16x16x32_bf16 v[96:99],v[48:51],v[240:243],v[96:99]
v_max3_f32 v22,v22,v155,v156
v_mfma_f32_16x16x32_bf16 v[100:103],v[52:55],v[240:243],v[100:103]
ds_read_b64_tr_b16 v[44:45],v15 offset:32768
ds_read_b64_tr_b16 v[46:47],v15 offset:36864
v_mfma_f32_16x16x32_bf16 v[108:111],v[52:55],v[244:247],v[108:111]
v_max3_f32 v22,v22,v157,v158
v_max_f32 v22,v22,v159
v_mfma_f32_16x16x32_bf16 v[120:123],v[56:59],v[244:247],v[120:123]
ds_read_b64_tr_b16 v[48:49],v16 offset:32768
ds_read_b64_tr_b16 v[50:51],v16 offset:36864
v_mfma_f32_16x16x32_bf16 v[112:115],v[56:59],v[240:243],v[112:115]
v_cmp_lt_f32 vcc,s43,v22
v_mfma_f32_16x16x32_bf16 v[116:119],v[60:63],v[240:243],v[116:119]
ds_read_b64_tr_b16 v[52:53],v17 offset:32768
ds_read_b64_tr_b16 v[54:55],v17 offset:36864
v_mfma_f32_16x16x32_bf16 v[124:127],v[60:63],v[244:247],v[124:127]
s_cbranch_vccnz L_rare59
L_back59:
s_waitcnt vmcnt(0)
s_barrier
v_exp_f32 v144,v144
v_exp_f32 v145,v145
v_exp_f32 v146,v146
v_cvt_pk_bf16_f32 v240,v144,v145
s_waitcnt lgkmcnt(4)
v_mfma_f32_16x16x32_bf16 a[192:195],v[32:35],v[232:235],a[192:195]
ds_read_b64_tr_b16 v[56:57],v18 offset:32768
ds_read_b64_tr_b16 v[58:59],v18 offset:36864
v_exp_f32 v147,v147
v_mfma_f32_16x16x32_bf16 a[200:203],v[32:35],v[236:239],a[200:203]
v_exp_f32 v148,v148
v_mfma_f32_16x16x32_bf16 a[204:207],v[36:39],v[236:239],a[204:207]
ds_read_b64_tr_b16 v[60:61],v19 offset:32768
ds_read_b64_tr_b16 v[62:63],v19 offset:36864
v_cvt_pk_bf16_f32 v241,v146,v147
v_mfma_f32_16x16x32_bf16 a[196:199],v[36:39],v[232:235],a[196:199]
v_exp_f32 v149,v149
v_exp_f32 v150,v150
v_mfma_f32_16x16x32_bf16 a[208:211],v[40:43],v[232:235],a[208:211]
ds_read_b64_tr_b16 v[32:33],v176 offset:57344
ds_read_b64_tr_b16 v[34:35],v176 offset:61440
v_mfma_f32_16x16x32_bf16 a[216:219],v[40:43],v[236:239],a[216:219]
v_cvt_pk_bf16_f32 v242,v148,v149
v_exp_f32 v151,v151
v_mfma_f32_16x16x32_bf16 a[220:223],v[44:47],v[236:239],a[220:223]
ds_read_b64_tr_b16 v[36:37],v177 offset:57344
ds_read_b64_tr_b16 v[38:39],v177 offset:61440
v_exp_f32 v152,v152
v_mfma_f32_16x16x32_bf16 a[212:215],v[44:47],v[232:235],a[212:215]
v_cvt_pk_bf16_f32 v243,v150,v151
v_exp_f32 v153,v153
s_waitcnt lgkmcnt(4)
v_mfma_f32_16x16x32_bf16 a[224:227],v[48:51],v[232:235],a[224:227]
ds_read_b64_tr_b16 v[40:41],v178 offset:57344
ds_read_b64_tr_b16 v[42:43],v178 offset:61440
v_mfma_f32_16x16x32_bf16 a[232:235],v[48:51],v[236:239],a[232:235]
v_exp_f32 v154,v154
v_cvt_pk_bf16_f32 v244,v152,v153
v_mfma_f32_16x16x32_bf16 a[236:239],v[52:55],v[236:239],a[236:239]
ds_read_b64_tr_b16 v[44:45],v179 offset:57344
ds_read_b64_tr_b16 v[46:47],v179 offset:61440
v_exp_f32 v155,v155
v_mfma_f32_16x16x32_bf16 a[228:231],v[52:55],v[232:235],a[228:231]
v_exp_f32 v156,v156
v_cvt_pk_bf16_f32 v245,v154,v155
v_mfma_f32_16x16x32_bf16 a[240:243],v[56:59],v[232:235],a[240:243]
ds_read_b64_tr_b16 v[48:49],v180 offset:57344
ds_read_b64_tr_b16 v[50:51],v180 offset:61440
v_mfma_f32_16x16x32_bf16 a[248:251],v[56:59],v[236:239],a[248:251]
v_exp_f32 v157,v157
v_exp_f32 v158,v158
v_mfma_f32_16x16x32_bf16 a[252:255],v[60:63],v[236:239],a[252:255]
ds_read_b64_tr_b16 v[52:53],v181 offset:57344
ds_read_b64_tr_b16 v[54:55],v181 offset:61440
v_cvt_pk_bf16_f32 v246,v156,v157
v_mfma_f32_16x16x32_bf16 a[244:247],v[60:63],v[232:235],a[244:247]
v_exp_f32 v159,v159
s_nop 0
v_cvt_pk_bf16_f32 v247,v158,v159
v_mfma_f32_16x16x32_bf16 v[168:171],v[28:31],v[240:243],v[168:171]
s_nop 0
v_mfma_f32_16x16x32_bf16 v[172:175],v[28:31],v[244:247],v[172:175]
s_waitcnt lgkmcnt(4)
v_mfma_f32_16x16x32_bf16 v[72:75],v[32:35],v[244:247],v[72:75]
ds_read_b64_tr_b16 v[56:57],v182 offset:57344
ds_read_b64_tr_b16 v[58:59],v182 offset:61440
v_mfma_f32_16x16x32_bf16 v[64:67],v[32:35],v[240:243],v[64:67]
s_nop 0
v_rcp_f32 v26,v168
s_nop 0
v_rcp_f32 v27,v172
v_mfma_f32_16x16x32_bf16 v[68:71],v[36:39],v[240:243],v[68:71]
ds_read_b64_tr_b16 v[60:61],v183 offset:57344
ds_read_b64_tr_b16 v[62:63],v183 offset:61440
v_mfma_f32_16x16x32_bf16 v[76:79],v[36:39],v[244:247],v[76:79]
v_mfma_f32_16x16x32_bf16 v[88:91],v[40:43],v[244:247],v[88:91]
v_mfma_f32_16x16x32_bf16 v[80:83],v[40:43],v[240:243],v[80:83]
v_mul_f32 v64,v64,v26
v_mul_f32 v65,v65,v26
v_mfma_f32_16x16x32_bf16 v[84:87],v[44:47],v[240:243],v[84:87]
v_mul_f32 v66,v66,v26
v_mul_f32 v67,v67,v26
v_mfma_f32_16x16x32_bf16 v[92:95],v[44:47],v[244:247],v[92:95]
v_mul_f32 v68,v68,v26
v_mul_f32 v69,v69,v26
v_mul_f32 v70,v70,v26
s_waitcnt lgkmcnt(0)
v_mfma_f32_16x16x32_bf16 v[104:107],v[48:51],v[244:247],v[104:107]
v_mul_f32 v71,v71,v26
v_cvt_pk_bf16_f32 v208,v64,v65
v_mfma_f32_16x16x32_bf16 v[96:99],v[48:51],v[240:243],v[96:99]
v_cvt_pk_bf16_f32 v209,v66,v67
v_cvt_pk_bf16_f32 v210,v68,v69
v_mfma_f32_16x16x32_bf16 v[100:103],v[52:55],v[240:243],v[100:103]
v_cvt_pk_bf16_f32 v211,v70,v71
v_mul_f32 v72,v72,v27
v_mfma_f32_16x16x32_bf16 v[108:111],v[52:55],v[244:247],v[108:111]
v_mul_f32 v73,v73,v27
v_mul_f32 v74,v74,v27
v_mfma_f32_16x16x32_bf16 v[120:123],v[56:59],v[244:247],v[120:123]
v_mul_f32 v75,v75,v27
v_mul_f32 v76,v76,v27
v_mfma_f32_16x16x32_bf16 v[112:115],v[56:59],v[240:243],v[112:115]
v_mul_f32 v77,v77,v27
v_mul_f32 v78,v78,v27
v_mul_f32 v79,v79,v27
v_mfma_f32_16x16x32_bf16 v[116:119],v[60:63],v[240:243],v[116:119]
v_cvt_pk_bf16_f32 v212,v72,v73
v_cvt_pk_bf16_f32 v213,v74,v75
v_mfma_f32_16x16x32_bf16 v[124:127],v[60:63],v[244:247],v[124:127]
v_cvt_pk_bf16_f32 v214,v76,v77
v_cvt_pk_bf16_f32 v215,v78,v79
s_barrier
ds_read_b64_tr_b16 v[32:33],v12 offset:40960
ds_read_b64_tr_b16 v[34:35],v12 offset:45056
ds_read_b64_tr_b16 v[36:37],v13 offset:40960
ds_read_b64_tr_b16 v[38:39],v13 offset:45056
ds_read_b64_tr_b16 v[40:41],v176 offset:8192
ds_read_b64_tr_b16 v[42:43],v176 offset:12288
ds_read_b64_tr_b16 v[44:45],v177 offset:8192
ds_read_b64_tr_b16 v[46:47],v177 offset:12288
ds_read_b64_tr_b16 v[48:49],v176 offset:16384
ds_read_b64_tr_b16 v[50:51],v176 offset:20480
ds_read_b64_tr_b16 v[52:53],v177 offset:16384
ds_read_b64_tr_b16 v[54:55],v177 offset:20480
s_waitcnt lgkmcnt(4)
v_mfma_f32_16x16x32_bf16 a[0:3],v[32:35],v[208:211],a[0:3]
ds_read_b64_tr_b16 v[56:57],v176 offset:24576
ds_read_b64_tr_b16 v[58:59],v176 offset:28672
v_mul_f32 v80,v80,v26
v_mul_f32 v81,v81,v26
v_mfma_f32_16x16x32_bf16 a[8:11],v[32:35],v[212:215],a[8:11]
v_mul_f32 v82,v82,v26
v_mul_f32 v83,v83,v26
v_mul_f32 v84,v84,v26
v_mul_f32 v85,v85,v26
v_mul_f32 v86,v86,v26
v_mul_f32 v87,v87,v26
v_cvt_pk_bf16_f32 v216,v80,v81
v_cvt_pk_bf16_f32 v217,v82,v83
v_cvt_pk_bf16_f32 v218,v84,v85
v_cvt_pk_bf16_f32 v219,v86,v87
v_mfma_f32_16x16x32_bf16 a[12:15],v[36:39],v[212:215],a[12:15]
ds_read_b64_tr_b16 v[60:61],v177 offset:24576
ds_read_b64_tr_b16 v[62:63],v177 offset:28672
v_mul_f32 v88,v88,v27
v_mul_f32 v89,v89,v27
v_mfma_f32_16x16x32_bf16 a[4:7],v[36:39],v[208:211],a[4:7]
v_mul_f32 v90,v90,v27
v_mul_f32 v91,v91,v27
v_mul_f32 v92,v92,v27
v_mul_f32 v93,v93,v27
v_mul_f32 v94,v94,v27
v_mul_f32 v95,v95,v27
v_cvt_pk_bf16_f32 v220,v88,v89
v_cvt_pk_bf16_f32 v221,v90,v91
v_cvt_pk_bf16_f32 v222,v92,v93
v_cvt_pk_bf16_f32 v223,v94,v95
v_mfma_f32_16x16x32_bf16 a[0:3],v[40:43],v[216:219],a[0:3]
ds_read_b64_tr_b16 v[32:33],v14 offset:40960
ds_read_b64_tr_b16 v[34:35],v14 offset:45056
v_mul_f32 v96,v96,v26
v_mul_f32 v97,v97,v26
v_mfma_f32_16x16x32_bf16 a[8:11],v[40:43],v[220:223],a[8:11]
v_mul_f32 v98,v98,v26
v_mul_f32 v99,v99,v26
v_mul_f32 v100,v100,v26
v_mul_f32 v101,v101,v26
v_mul_f32 v102,v102,v26
v_mul_f32 v103,v103,v26
v_cvt_pk_bf16_f32 v224,v96,v97
v_cvt_pk_bf16_f32 v225,v98,v99
v_cvt_pk_bf16_f32 v226,v100,v101
v_cvt_pk_bf16_f32 v227,v102,v103
v_mfma_f32_16x16x32_bf16 a[12:15],v[44:47],v[220:223],a[12:15]
ds_read_b64_tr_b16 v[36:37],v178 offset:8192
ds_read_b64_tr_b16 v[38:39],v178 offset:12288
v_mul_f32 v104,v104,v27
v_mul_f32 v105,v105,v27
v_mfma_f32_16x16x32_bf16 a[4:7],v[44:47],v[216:219],a[4:7]
v_mul_f32 v106,v106,v27
v_mul_f32 v107,v107,v27
v_mul_f32 v108,v108,v27
v_mul_f32 v109,v109,v27
v_mul_f32 v110,v110,v27
v_mul_f32 v111,v111,v27
v_cvt_pk_bf16_f32 v228,v104,v105
v_cvt_pk_bf16_f32 v229,v106,v107
v_cvt_pk_bf16_f32 v230,v108,v109
v_cvt_pk_bf16_f32 v231,v110,v111
s_waitcnt lgkmcnt(4)
v_mfma_f32_16x16x32_bf16 a[0:3],v[48:51],v[224:227],a[0:3]
ds_read_b64_tr_b16 v[40:41],v178 offset:16384
ds_read_b64_tr_b16 v[42:43],v178 offset:20480
v_mul_f32 v112,v112,v26
v_mul_f32 v113,v113,v26
v_mfma_f32_16x16x32_bf16 a[8:11],v[48:51],v[228:231],a[8:11]
v_mul_f32 v114,v114,v26
v_mul_f32 v115,v115,v26
v_mul_f32 v116,v116,v26
v_mul_f32 v117,v117,v26
v_mul_f32 v118,v118,v26
v_mul_f32 v119,v119,v26
v_cvt_pk_bf16_f32 v232,v112,v113
v_cvt_pk_bf16_f32 v233,v114,v115
v_cvt_pk_bf16_f32 v234,v116,v117
v_cvt_pk_bf16_f32 v235,v118,v119
v_mfma_f32_16x16x32_bf16 a[12:15],v[52:55],v[228:231],a[12:15]
ds_read_b64_tr_b16 v[44:45],v178 offset:24576
ds_read_b64_tr_b16 v[46:47],v178 offset:28672
v_mul_f32 v120,v120,v27
v_mul_f32 v121,v121,v27
v_mfma_f32_16x16x32_bf16 a[4:7],v[52:55],v[224:227],a[4:7]
v_mul_f32 v122,v122,v27
v_mul_f32 v123,v123,v27
v_mul_f32 v124,v124,v27
v_mul_f32 v125,v125,v27
v_mul_f32 v126,v126,v27
v_mul_f32 v127,v127,v27
v_cvt_pk_bf16_f32 v236,v120,v121
v_cvt_pk_bf16_f32 v237,v122,v123
v_cvt_pk_bf16_f32 v238,v124,v125
v_cvt_pk_bf16_f32 v239,v126,v127
v_mfma_f32_16x16x32_bf16 a[0:3],v[56:59],v[232:235],a[0:3]
ds_read_b64_tr_b16 v[48:49],v15 offset:40960
ds_read_b64_tr_b16 v[50:51],v15 offset:45056
v_mfma_f32_16x16x32_bf16 a[8:11],v[56:59],v[236:239],a[8:11]
v_mfma_f32_16x16x32_bf16 a[12:15],v[60:63],v[236:239],a[12:15]
ds_read_b64_tr_b16 v[52:53],v179 offset:8192
ds_read_b64_tr_b16 v[54:55],v179 offset:12288
v_mfma_f32_16x16x32_bf16 a[4:7],v[60:63],v[232:235],a[4:7]
s_waitcnt lgkmcnt(4)
v_mfma_f32_16x16x32_bf16 a[16:19],v[32:35],v[208:211],a[16:19]
ds_read_b64_tr_b16 v[56:57],v179 offset:16384
ds_read_b64_tr_b16 v[58:59],v179 offset:20480
v_mfma_f32_16x16x32_bf16 a[24:27],v[32:35],v[212:215],a[24:27]
v_mfma_f32_16x16x32_bf16 a[24:27],v[36:39],v[220:223],a[24:27]
ds_read_b64_tr_b16 v[60:61],v179 offset:24576
ds_read_b64_tr_b16 v[62:63],v179 offset:28672
v_mfma_f32_16x16x32_bf16 a[16:19],v[36:39],v[216:219],a[16:19]
v_accvgpr_read_b32 v128,a0
v_accvgpr_read_b32 v129,a1
v_accvgpr_read_b32 v130,a2
v_accvgpr_read_b32 v131,a3
v_mfma_f32_16x16x32_bf16 a[16:19],v[40:43],v[224:227],a[16:19]
ds_read_b64_tr_b16 v[32:33],v16 offset:40960
ds_read_b64_tr_b16 v[34:35],v16 offset:45056
v_accvgpr_read_b32 v132,a4
v_mfma_f32_16x16x32_bf16 a[24:27],v[40:43],v[228:231],a[24:27]
v_accvgpr_read_b32 v133,a5
v_accvgpr_read_b32 v134,a6
v_accvgpr_read_b32 v135,a7
v_cvt_pk_bf16_f32 v128,v128,v129
v_cvt_pk_bf16_f32 v129,v130,v131
v_mfma_f32_16x16x32_bf16 a[24:27],v[44:47],v[236:239],a[24:27]
ds_read_b64_tr_b16 v[36:37],v180 offset:8192
ds_read_b64_tr_b16 v[38:39],v180 offset:12288
v_cvt_pk_bf16_f32 v130,v132,v133
v_mfma_f32_16x16x32_bf16 a[16:19],v[44:47],v[232:235],a[16:19]
v_cvt_pk_bf16_f32 v131,v134,v135
buffer_store_dwordx4 v[128:131],v21,s[28:31],s67 offen sc1
s_waitcnt lgkmcnt(4)
v_mfma_f32_16x16x32_bf16 a[20:23],v[48:51],v[208:211],a[20:23]
ds_read_b64_tr_b16 v[40:41],v180 offset:16384
ds_read_b64_tr_b16 v[42:43],v180 offset:20480
v_mfma_f32_16x16x32_bf16 a[28:31],v[48:51],v[212:215],a[28:31]
v_accvgpr_read_b32 v136,a8
v_accvgpr_read_b32 v137,a9
v_accvgpr_read_b32 v138,a10
v_accvgpr_read_b32 v139,a11
v_mfma_f32_16x16x32_bf16 a[28:31],v[52:55],v[220:223],a[28:31]
ds_read_b64_tr_b16 v[44:45],v180 offset:24576
ds_read_b64_tr_b16 v[46:47],v180 offset:28672
v_accvgpr_read_b32 v140,a12
v_mfma_f32_16x16x32_bf16 a[20:23],v[52:55],v[216:219],a[20:23]
v_accvgpr_read_b32 v141,a13
v_accvgpr_read_b32 v142,a14
v_accvgpr_read_b32 v143,a15
v_cvt_pk_bf16_f32 v136,v136,v137
v_cvt_pk_bf16_f32 v137,v138,v139
v_mfma_f32_16x16x32_bf16 a[20:23],v[56:59],v[224:227],a[20:23]
ds_read_b64_tr_b16 v[48:49],v17 offset:40960
ds_read_b64_tr_b16 v[50:51],v17 offset:45056
v_cvt_pk_bf16_f32 v138,v140,v141
v_mfma_f32_16x16x32_bf16 a[28:31],v[56:59],v[228:231],a[28:31]
v_cvt_pk_bf16_f32 v139,v142,v143
buffer_store_dwordx4 v[136:139],v21,s[28:31],s67 offen offset:1024 sc1
v_mfma_f32_16x16x32_bf16 a[28:31],v[60:63],v[236:239],a[28:31]
ds_read_b64_tr_b16 v[52:53],v181 offset:8192
ds_read_b64_tr_b16 v[54:55],v181 offset:12288
v_mfma_f32_16x16x32_bf16 a[20:23],v[60:63],v[232:235],a[20:23]
s_waitcnt lgkmcnt(4)
v_mfma_f32_16x16x32_bf16 a[32:35],v[32:35],v[208:211],a[32:35]
ds_read_b64_tr_b16 v[56:57],v181 offset:16384
ds_read_b64_tr_b16 v[58:59],v181 offset:20480
v_mfma_f32_16x16x32_bf16 a[40:43],v[32:35],v[212:215],a[40:43]
v_mfma_f32_16x16x32_bf16 a[40:43],v[36:39],v[220:223],a[40:43]
ds_read_b64_tr_b16 v[60:61],v181 offset:24576
ds_read_b64_tr_b16 v[62:63],v181 offset:28672
v_mfma_f32_16x16x32_bf16 a[32:35],v[36:39],v[216:219],a[32:35]
v_accvgpr_read_b32 v144,a16
v_accvgpr_read_b32 v145,a17
v_accvgpr_read_b32 v146,a18
v_accvgpr_read_b32 v147,a19
v_mfma_f32_16x16x32_bf16 a[32:35],v[40:43],v[224:227],a[32:35]
ds_read_b64_tr_b16 v[32:33],v18 offset:40960
ds_read_b64_tr_b16 v[34:35],v18 offset:45056
v_accvgpr_read_b32 v148,a20
v_mfma_f32_16x16x32_bf16 a[40:43],v[40:43],v[228:231],a[40:43]
v_accvgpr_read_b32 v149,a21
v_accvgpr_read_b32 v150,a22
v_accvgpr_read_b32 v151,a23
v_cvt_pk_bf16_f32 v144,v144,v145
v_cvt_pk_bf16_f32 v145,v146,v147
v_mfma_f32_16x16x32_bf16 a[40:43],v[44:47],v[236:239],a[40:43]
ds_read_b64_tr_b16 v[36:37],v182 offset:8192
ds_read_b64_tr_b16 v[38:39],v182 offset:12288
v_cvt_pk_bf16_f32 v146,v148,v149
v_mfma_f32_16x16x32_bf16 a[32:35],v[44:47],v[232:235],a[32:35]
v_cvt_pk_bf16_f32 v147,v150,v151
buffer_store_dwordx4 v[144:147],v21,s[28:31],s67 offen offset:2048 sc1
s_waitcnt lgkmcnt(4)
v_mfma_f32_16x16x32_bf16 a[36:39],v[48:51],v[208:211],a[36:39]
ds_read_b64_tr_b16 v[40:41],v182 offset:16384
ds_read_b64_tr_b16 v[42:43],v182 offset:20480
v_mfma_f32_16x16x32_bf16 a[44:47],v[48:51],v[212:215],a[44:47]
v_accvgpr_read_b32 v152,a24
v_accvgpr_read_b32 v153,a25
v_accvgpr_read_b32 v154,a26
v_accvgpr_read_b32 v155,a27
v_mfma_f32_16x16x32_bf16 a[44:47],v[52:55],v[220:223],a[44:47]
ds_read_b64_tr_b16 v[44:45],v182 offset:24576
ds_read_b64_tr_b16 v[46:47],v182 offset:28672
v_accvgpr_read_b32 v156,a28
v_mfma_f32_16x16x32_bf16 a[36:39],v[52:55],v[216:219],a[36:39]
v_accvgpr_read_b32 v157,a29
v_accvgpr_read_b32 v158,a30
v_accvgpr_read_b32 v159,a31
v_cvt_pk_bf16_f32 v152,v152,v153
v_cvt_pk_bf16_f32 v153,v154,v155
v_mfma_f32_16x16x32_bf16 a[36:39],v[56:59],v[224:227],a[36:39]
ds_read_b64_tr_b16 v[48:49],v19 offset:40960
ds_read_b64_tr_b16 v[50:51],v19 offset:45056
v_cvt_pk_bf16_f32 v154,v156,v157
v_mfma_f32_16x16x32_bf16 a[44:47],v[56:59],v[228:231],a[44:47]
v_cvt_pk_bf16_f32 v155,v158,v159
buffer_store_dwordx4 v[152:155],v21,s[28:31],s67 offen offset:3072 sc1
v_mfma_f32_16x16x32_bf16 a[44:47],v[60:63],v[236:239],a[44:47]
ds_read_b64_tr_b16 v[52:53],v183 offset:8192
ds_read_b64_tr_b16 v[54:55],v183 offset:12288
v_mfma_f32_16x16x32_bf16 a[36:39],v[60:63],v[232:235],a[36:39]
s_waitcnt lgkmcnt(4)
v_mfma_f32_16x16x32_bf16 a[48:51],v[32:35],v[208:211],a[48:51]
ds_read_b64_tr_b16 v[56:57],v183 offset:16384
ds_read_b64_tr_b16 v[58:59],v183 offset:20480
v_mfma_f32_16x16x32_bf16 a[56:59],v[32:35],v[212:215],a[56:59]
v_mfma_f32_16x16x32_bf16 a[56:59],v[36:39],v[220:223],a[56:59]
ds_read_b64_tr_b16 v[60:61],v183 offset:24576
ds_read_b64_tr_b16 v[62:63],v183 offset:28672
v_mfma_f32_16x16x32_bf16 a[48:51],v[36:39],v[216:219],a[48:51]
v_accvgpr_read_b32 v128,a32
v_accvgpr_read_b32 v129,a33
v_accvgpr_read_b32 v130,a34
v_accvgpr_read_b32 v131,a35
v_mfma_f32_16x16x32_bf16 a[48:51],v[40:43],v[224:227],a[48:51]
ds_read_b64_tr_b16 v[32:33],v176 offset:32768
ds_read_b64_tr_b16 v[34:35],v176 offset:36864
v_accvgpr_read_b32 v132,a36
v_mfma_f32_16x16x32_bf16 a[56:59],v[40:43],v[228:231],a[56:59]
v_accvgpr_read_b32 v133,a37
v_accvgpr_read_b32 v134,a38
v_accvgpr_read_b32 v135,a39
v_cvt_pk_bf16_f32 v128,v128,v129
v_cvt_pk_bf16_f32 v129,v130,v131
v_mfma_f32_16x16x32_bf16 a[56:59],v[44:47],v[236:239],a[56:59]
ds_read_b64_tr_b16 v[36:37],v176 offset:40960
ds_read_b64_tr_b16 v[38:39],v176 offset:45056
v_cvt_pk_bf16_f32 v130,v132,v133
v_mfma_f32_16x16x32_bf16 a[48:51],v[44:47],v[232:235],a[48:51]
v_cvt_pk_bf16_f32 v131,v134,v135
buffer_store_dwordx4 v[128:131],v21,s[28:31],s68 offen sc1
s_waitcnt lgkmcnt(4)
v_mfma_f32_16x16x32_bf16 a[52:55],v[48:51],v[208:211],a[52:55]
ds_read_b64_tr_b16 v[40:41],v176 offset:49152
ds_read_b64_tr_b16 v[42:43],v176 offset:53248
v_mfma_f32_16x16x32_bf16 a[60:63],v[48:51],v[212:215],a[60:63]
v_accvgpr_read_b32 v136,a40
v_accvgpr_read_b32 v137,a41
v_accvgpr_read_b32 v138,a42
v_accvgpr_read_b32 v139,a43
v_mfma_f32_16x16x32_bf16 a[60:63],v[52:55],v[220:223],a[60:63]
ds_read_b64_tr_b16 v[44:45],v12 offset:16384
ds_read_b64_tr_b16 v[46:47],v12 offset:20480
v_accvgpr_read_b32 v140,a44
v_mfma_f32_16x16x32_bf16 a[52:55],v[52:55],v[216:219],a[52:55]
v_accvgpr_read_b32 v141,a45
v_accvgpr_read_b32 v142,a46
v_accvgpr_read_b32 v143,a47
v_cvt_pk_bf16_f32 v136,v136,v137
v_cvt_pk_bf16_f32 v137,v138,v139
v_mfma_f32_16x16x32_bf16 a[52:55],v[56:59],v[224:227],a[52:55]
ds_read_b64_tr_b16 v[48:49],v177 offset:32768
ds_read_b64_tr_b16 v[50:51],v177 offset:36864
v_cvt_pk_bf16_f32 v138,v140,v141
v_mfma_f32_16x16x32_bf16 a[60:63],v[56:59],v[228:231],a[60:63]
v_cvt_pk_bf16_f32 v139,v142,v143
buffer_store_dwordx4 v[136:139],v21,s[28:31],s68 offen offset:1024 sc1
v_mfma_f32_16x16x32_bf16 a[60:63],v[60:63],v[236:239],a[60:63]
ds_read_b64_tr_b16 v[52:53],v177 offset:40960
ds_read_b64_tr_b16 v[54:55],v177 offset:45056
v_mfma_f32_16x16x32_bf16 a[52:55],v[60:63],v[232:235],a[52:55]
s_waitcnt lgkmcnt(4)
v_mfma_f32_16x16x32_bf16 a[64:67],v[32:35],v[208:211],a[64:67]
ds_read_b64_tr_b16 v[56:57],v177 offset:49152
ds_read_b64_tr_b16 v[58:59],v177 offset:53248
v_mfma_f32_16x16x32_bf16 a[72:75],v[32:35],v[212:215],a[72:75]
v_mfma_f32_16x16x32_bf16 a[72:75],v[36:39],v[220:223],a[72:75]
ds_read_b64_tr_b16 v[60:61],v13 offset:16384
ds_read_b64_tr_b16 v[62:63],v13 offset:20480
v_mfma_f32_16x16x32_bf16 a[64:67],v[36:39],v[216:219],a[64:67]
v_accvgpr_read_b32 v144,a48
v_accvgpr_read_b32 v145,a49
v_accvgpr_read_b32 v146,a50
v_accvgpr_read_b32 v147,a51
v_mfma_f32_16x16x32_bf16 a[64:67],v[40:43],v[224:227],a[64:67]
ds_read_b64_tr_b16 v[32:33],v178 offset:32768
ds_read_b64_tr_b16 v[34:35],v178 offset:36864
v_accvgpr_read_b32 v148,a52
v_mfma_f32_16x16x32_bf16 a[72:75],v[40:43],v[228:231],a[72:75]
v_accvgpr_read_b32 v149,a53
v_accvgpr_read_b32 v150,a54
v_accvgpr_read_b32 v151,a55
v_cvt_pk_bf16_f32 v144,v144,v145
v_cvt_pk_bf16_f32 v145,v146,v147
v_mfma_f32_16x16x32_bf16 a[72:75],v[44:47],v[236:239],a[72:75]
ds_read_b64_tr_b16 v[36:37],v178 offset:40960
ds_read_b64_tr_b16 v[38:39],v178 offset:45056
v_cvt_pk_bf16_f32 v146,v148,v149
v_mfma_f32_16x16x32_bf16 a[64:67],v[44:47],v[232:235],a[64:67]
v_cvt_pk_bf16_f32 v147,v150,v151
buffer_store_dwordx4 v[144:147],v21,s[28:31],s68 offen offset:2048 sc1
s_waitcnt lgkmcnt(4)
v_mfma_f32_16x16x32_bf16 a[68:71],v[48:51],v[208:211],a[68:71]
ds_read_b64_tr_b16 v[40:41],v178 offset:49152
ds_read_b64_tr_b16 v[42:43],v178 offset:53248
v_mfma_f32_16x16x32_bf16 a[76:79],v[48:51],v[212:215],a[76:79]
v_accvgpr_read_b32 v152,a56
v_accvgpr_read_b32 v153,a57
v_accvgpr_read_b32 v154,a58
v_accvgpr_read_b32 v155,a59
v_mfma_f32_16x16x32_bf16 a[76:79],v[52:55],v[220:223],a[76:79]
ds_read_b64_tr_b16 v[44:45],v14 offset:16384
ds_read_b64_tr_b16 v[46:47],v14 offset:20480
v_accvgpr_read_b32 v156,a60
v_mfma_f32_16x16x32_bf16 a[68:71],v[52:55],v[216:219],a[68:71]
v_accvgpr_read_b32 v157,a61
v_accvgpr_read_b32 v158,a62
v_accvgpr_read_b32 v159,a63
v_cvt_pk_bf16_f32 v152,v152,v153
v_cvt_pk_bf16_f32 v153,v154,v155
L_tp_a9:
s_cbranch_execz L_tr_a9
v_mfma_f32_16x16x32_bf16 a[68:71],v[56:59],v[224:227],a[68:71]
ds_read_b64_tr_b16 v[48:49],v179 offset:32768
ds_read_b64_tr_b16 v[50:51],v179 offset:36864
v_cvt_pk_bf16_f32 v154,v156,v157
v_mfma_f32_16x16x32_bf16 a[76:79],v[56:59],v[228:231],a[76:79]
v_cvt_pk_bf16_f32 v155,v158,v159
buffer_store_dwordx4 v[152:155],v21,s[28:31],s68 offen offset:3072 sc1
v_mfma_f32_16x16x32_bf16 a[76:79],v[60:63],v[236:239],a[76:79]
ds_read_b64_tr_b16 v[52:53],v179 offset:40960
ds_read_b64_tr_b16 v[54:55],v179 offset:45056
v_mfma_f32_16x16x32_bf16 a[68:71],v[60:63],v[232:235],a[68:71]
s_waitcnt lgkmcnt(4)
v_mfma_f32_16x16x32_bf16 a[80:83],v[32:35],v[208:211],a[80:83]
ds_read_b64_tr_b16 v[56:57],v179 offset:49152
ds_read_b64_tr_b16 v[58:59],v179 offset:53248
v_mfma_f32_16x16x32_bf16 a[88:91],v[32:35],v[212:215],a[88:91]
v_mfma_f32_16x16x32_bf16 a[88:91],v[36:39],v[220:223],a[88:91]
ds_read_b64_tr_b16 v[60:61],v15 offset:16384
ds_read_b64_tr_b16 v[62:63],v15 offset:20480
v_mfma_f32_16x16x32_bf16 a[80:83],v[36:39],v[216:219],a[80:83]
v_accvgpr_read_b32 v128,a64
v_accvgpr_read_b32 v129,a65
v_accvgpr_read_b32 v130,a66
v_accvgpr_read_b32 v131,a67
v_mfma_f32_16x16x32_bf16 a[80:83],v[40:43],v[224:227],a[80:83]
ds_read_b64_tr_b16 v[32:33],v180 offset:32768
ds_read_b64_tr_b16 v[34:35],v180 offset:36864
v_accvgpr_read_b32 v132,a68
v_mfma_f32_16x16x32_bf16 a[88:91],v[40:43],v[228:231],a[88:91]
v_accvgpr_read_b32 v133,a69
v_accvgpr_read_b32 v134,a70
v_accvgpr_read_b32 v135,a71
v_cvt_pk_bf16_f32 v128,v128,v129
v_cvt_pk_bf16_f32 v129,v130,v131
v_mfma_f32_16x16x32_bf16 a[88:91],v[44:47],v[236:239],a[88:91]
ds_read_b64_tr_b16 v[36:37],v180 offset:40960
ds_read_b64_tr_b16 v[38:39],v180 offset:45056
v_cvt_pk_bf16_f32 v130,v132,v133
v_mfma_f32_16x16x32_bf16 a[80:83],v[44:47],v[232:235],a[80:83]
v_cvt_pk_bf16_f32 v131,v134,v135
buffer_store_dwordx4 v[128:131],v21,s[28:31],s69 offen sc1
s_waitcnt lgkmcnt(4)
v_mfma_f32_16x16x32_bf16 a[84:87],v[48:51],v[208:211],a[84:87]
ds_read_b64_tr_b16 v[40:41],v180 offset:49152
ds_read_b64_tr_b16 v[42:43],v180 offset:53248
v_mfma_f32_16x16x32_bf16 a[92:95],v[48:51],v[212:215],a[92:95]
v_accvgpr_read_b32 v136,a72
v_accvgpr_read_b32 v137,a73
v_accvgpr_read_b32 v138,a74
v_accvgpr_read_b32 v139,a75
v_mfma_f32_16x16x32_bf16 a[92:95],v[52:55],v[220:223],a[92:95]
ds_read_b64_tr_b16 v[44:45],v16 offset:16384
ds_read_b64_tr_b16 v[46:47],v16 offset:20480
v_accvgpr_read_b32 v140,a76
v_mfma_f32_16x16x32_bf16 a[84:87],v[52:55],v[216:219],a[84:87]
v_accvgpr_read_b32 v141,a77
v_accvgpr_read_b32 v142,a78
v_accvgpr_read_b32 v143,a79
v_cvt_pk_bf16_f32 v136,v136,v137
v_cvt_pk_bf16_f32 v137,v138,v139
v_mfma_f32_16x16x32_bf16 a[84:87],v[56:59],v[224:227],a[84:87]
ds_read_b64_tr_b16 v[48:49],v181 offset:32768
ds_read_b64_tr_b16 v[50:51],v181 offset:36864
v_cvt_pk_bf16_f32 v138,v140,v141
v_mfma_f32_16x16x32_bf16 a[92:95],v[56:59],v[228:231],a[92:95]
v_cvt_pk_bf16_f32 v139,v142,v143
buffer_store_dwordx4 v[136:139],v21,s[28:31],s69 offen offset:1024 sc1
v_mfma_f32_16x16x32_bf16 a[92:95],v[60:63],v[236:239],a[92:95]
ds_read_b64_tr_b16 v[52:53],v181 offset:40960
ds_read_b64_tr_b16 v[54:55],v181 offset:45056
v_mfma_f32_16x16x32_bf16 a[84:87],v[60:63],v[232:235],a[84:87]
s_waitcnt lgkmcnt(4)
v_mfma_f32_16x16x32_bf16 a[96:99],v[32:35],v[208:211],a[96:99]
ds_read_b64_tr_b16 v[56:57],v181 offset:49152
ds_read_b64_tr_b16 v[58:59],v181 offset:53248
v_mfma_f32_16x16x32_bf16 a[104:107],v[32:35],v[212:215],a[104:107]
v_mfma_f32_16x16x32_bf16 a[104:107],v[36:39],v[220:223],a[104:107]
ds_read_b64_tr_b16 v[60:61],v17 offset:16384
ds_read_b64_tr_b16 v[62:63],v17 offset:20480
v_mfma_f32_16x16x32_bf16 a[96:99],v[36:39],v[216:219],a[96:99]
v_accvgpr_read_b32 v144,a80
v_accvgpr_read_b32 v145,a81
v_accvgpr_read_b32 v146,a82
v_accvgpr_read_b32 v147,a83
v_mfma_f32_16x16x32_bf16 a[96:99],v[40:43],v[224:227],a[96:99]
ds_read_b64_tr_b16 v[32:33],v182 offset:32768
ds_read_b64_tr_b16 v[34:35],v182 offset:36864
v_accvgpr_read_b32 v148,a84
v_mfma_f32_16x16x32_bf16 a[104:107],v[40:43],v[228:231],a[104:107]
v_accvgpr_read_b32 v149,a85
v_accvgpr_read_b32 v150,a86
v_accvgpr_read_b32 v151,a87
v_cvt_pk_bf16_f32 v144,v144,v145
v_cvt_pk_bf16_f32 v145,v146,v147
v_mfma_f32_16x16x32_bf16 a[104:107],v[44:47],v[236:239],a[104:107]
ds_read_b64_tr_b16 v[36:37],v182 offset:40960
ds_read_b64_tr_b16 v[38:39],v182 offset:45056
v_cvt_pk_bf16_f32 v146,v148,v149
v_mfma_f32_16x16x32_bf16 a[96:99],v[44:47],v[232:235],a[96:99]
v_cvt_pk_bf16_f32 v147,v150,v151
buffer_store_dwordx4 v[144:147],v21,s[28:31],s69 offen offset:2048 sc1
s_waitcnt lgkmcnt(4)
v_mfma_f32_16x16x32_bf16 a[100:103],v[48:51],v[208:211],a[100:103]
ds_read_b64_tr_b16 v[40:41],v182 offset:49152
ds_read_b64_tr_b16 v[42:43],v182 offset:53248
v_mfma_f32_16x16x32_bf16 a[108:111],v[48:51],v[212:215],a[108:111]
v_accvgpr_read_b32 v152,a88
v_accvgpr_read_b32 v153,a89
v_accvgpr_read_b32 v154,a90
v_accvgpr_read_b32 v155,a91
v_mfma_f32_16x16x32_bf16 a[108:111],v[52:55],v[220:223],a[108:111]
ds_read_b64_tr_b16 v[44:45],v18 offset:16384
ds_read_b64_tr_b16 v[46:47],v18 offset:20480
v_accvgpr_read_b32 v156,a92
v_mfma_f32_16x16x32_bf16 a[100:103],v[52:55],v[216:219],a[100:103]
v_accvgpr_read_b32 v157,a93
v_accvgpr_read_b32 v158,a94
v_accvgpr_read_b32 v159,a95
v_cvt_pk_bf16_f32 v152,v152,v153
v_cvt_pk_bf16_f32 v153,v154,v155
v_mfma_f32_16x16x32_bf16 a[100:103],v[56:59],v[224:227],a[100:103]
ds_read_b64_tr_b16 v[48:49],v183 offset:32768
ds_read_b64_tr_b16 v[50:51],v183 offset:36864
v_cvt_pk_bf16_f32 v154,v156,v157
v_mfma_f32_16x16x32_bf16 a[108:111],v[56:59],v[228:231],a[108:111]
v_cvt_pk_bf16_f32 v155,v158,v159
buffer_store_dwordx4 v[152:155],v21,s[28:31],s69 offen offset:3072 sc1
v_mfma_f32_16x16x32_bf16 a[108:111],v[60:63],v[236:239],a[108:111]
ds_read_b64_tr_b16 v[52:53],v183 offset:40960
ds_read_b64_tr_b16 v[54:55],v183 offset:45056
v_mfma_f32_16x16x32_bf16 a[100:103],v[60:63],v[232:235],a[100:103]
s_waitcnt lgkmcnt(4)
v_mfma_f32_16x16x32_bf16 a[112:115],v[32:35],v[208:211],a[112:115]
ds_read_b64_tr_b16 v[56:57],v183 offset:49152
ds_read_b64_tr_b16 v[58:59],v183 offset:53248
v_mfma_f32_16x16x32_bf16 a[120:123],v[32:35],v[212:215],a[120:123]
v_mfma_f32_16x16x32_bf16 a[120:123],v[36:39],v[220:223],a[120:123]
ds_read_b64_tr_b16 v[60:61],v19 offset:16384
ds_read_b64_tr_b16 v[62:63],v19 offset:20480
v_mfma_f32_16x16x32_bf16 a[112:115],v[36:39],v[216:219],a[112:115]
v_accvgpr_read_b32 v128,a96
v_accvgpr_read_b32 v129,a97
v_accvgpr_read_b32 v130,a98
v_mfma_f32_16x16x32_bf16 a[112:115],v[40:43],v[224:227],a[112:115]
v_accvgpr_read_b32 v131,a99
v_accvgpr_read_b32 v132,a100
v_mfma_f32_16x16x32_bf16 a[120:123],v[40:43],v[228:231],a[120:123]
v_accvgpr_read_b32 v133,a101
v_accvgpr_read_b32 v134,a102
v_accvgpr_read_b32 v135,a103
v_mfma_f32_16x16x32_bf16 a[120:123],v[44:47],v[236:239],a[120:123]
v_cvt_pk_bf16_f32 v128,v128,v129
v_cvt_pk_bf16_f32 v129,v130,v131
v_cvt_pk_bf16_f32 v130,v132,v133
v_mfma_f32_16x16x32_bf16 a[112:115],v[44:47],v[232:235],a[112:115]
v_cvt_pk_bf16_f32 v131,v134,v135
s_waitcnt lgkmcnt(0)
v_mfma_f32_16x16x32_bf16 a[116:119],v[48:51],v[208:211],a[116:119]
buffer_store_dwordx4 v[128:131],v21,s[28:31],s70 offen sc1
v_mfma_f32_16x16x32_bf16 a[124:127],v[48:51],v[212:215],a[124:127]
v_accvgpr_read_b32 v136,a104
v_accvgpr_read_b32 v137,a105
v_accvgpr_read_b32 v138,a106
v_mfma_f32_16x16x32_bf16 a[124:127],v[52:55],v[220:223],a[124:127]
v_accvgpr_read_b32 v139,a107
v_accvgpr_read_b32 v140,a108
v_mfma_f32_16x16x32_bf16 a[116:119],v[52:55],v[216:219],a[116:119]
v_accvgpr_read_b32 v141,a109
v_accvgpr_read_b32 v142,a110
v_accvgpr_read_b32 v143,a111
v_mfma_f32_16x16x32_bf16 a[116:119],v[56:59],v[224:227],a[116:119]
v_cvt_pk_bf16_f32 v136,v136,v137
v_cvt_pk_bf16_f32 v137,v138,v139
v_cvt_pk_bf16_f32 v138,v140,v141
v_mfma_f32_16x16x32_bf16 a[124:127],v[56:59],v[228:231],a[124:127]
v_cvt_pk_bf16_f32 v139,v142,v143
v_mfma_f32_16x16x32_bf16 a[124:127],v[60:63],v[236:239],a[124:127]
buffer_store_dwordx4 v[136:139],v21,s[28:31],s70 offen offset:1024 sc1
v_mfma_f32_16x16x32_bf16 a[116:119],v[60:63],v[232:235],a[116:119]
s_barrier
ds_read_b64_tr_b16 v[32:33],v184
ds_read_b64_tr_b16 v[34:35],v184 offset:4096
ds_read_b64_tr_b16 v[36:37],v184 offset:8192
ds_read_b64_tr_b16 v[38:39],v184 offset:12288
ds_read_b64_tr_b16 v[40:41],v184 offset:16384
ds_read_b64_tr_b16 v[42:43],v184 offset:20480
ds_read_b64_tr_b16 v[44:45],v184 offset:24576
ds_read_b64_tr_b16 v[46:47],v184 offset:28672
ds_read_b64_tr_b16 v[48:49],v185
ds_read_b64_tr_b16 v[50:51],v185 offset:4096
ds_read_b64_tr_b16 v[52:53],v185 offset:8192
ds_read_b64_tr_b16 v[54:55],v185 offset:12288
s_waitcnt lgkmcnt(4)
v_mfma_f32_16x16x32_bf16 a[128:131],v[32:35],v[208:211],a[128:131]
ds_read_b64_tr_b16 v[56:57],v185 offset:16384
ds_read_b64_tr_b16 v[58:59],v185 offset:20480
v_mfma_f32_16x16x32_bf16 a[136:139],v[32:35],v[212:215],a[136:139]
v_mfma_f32_16x16x32_bf16 a[136:139],v[36:39],v[220:223],a[136:139]
ds_read_b64_tr_b16 v[60:61],v185 offset:24576
ds_read_b64_tr_b16 v[62:63],v185 offset:28672
v_mfma_f32_16x16x32_bf16 a[128:131],v[36:39],v[216:219],a[128:131]
v_accvgpr_read_b32 v144,a112
v_accvgpr_read_b32 v145,a113
v_accvgpr_read_b32 v146,a114
v_accvgpr_read_b32 v147,a115
v_accvgpr_read_b32 v148,a116
v_mfma_f32_16x16x32_bf16 a[128:131],v[40:43],v[224:227],a[128:131]
ds_read_b64_tr_b16 v[32:33],v186
ds_read_b64_tr_b16 v[34:35],v186 offset:4096
v_accvgpr_read_b32 v149,a117
v_mfma_f32_16x16x32_bf16 a[136:139],v[40:43],v[228:231],a[136:139]
v_accvgpr_read_b32 v150,a118
v_accvgpr_read_b32 v151,a119
v_cvt_pk_bf16_f32 v144,v144,v145
v_cvt_pk_bf16_f32 v145,v146,v147
v_cvt_pk_bf16_f32 v146,v148,v149
v_mfma_f32_16x16x32_bf16 a[136:139],v[44:47],v[236:239],a[136:139]
ds_read_b64_tr_b16 v[36:37],v186 offset:8192
ds_read_b64_tr_b16 v[38:39],v186 offset:12288
v_cvt_pk_bf16_f32 v147,v150,v151
v_mfma_f32_16x16x32_bf16 a[128:131],v[44:47],v[232:235],a[128:131]
buffer_store_dwordx4 v[144:147],v21,s[28:31],s70 offen offset:2048 sc1
v_accvgpr_read_b32 v152,a120
s_waitcnt lgkmcnt(4)
v_mfma_f32_16x16x32_bf16 a[132:135],v[48:51],v[208:211],a[132:135]
ds_read_b64_tr_b16 v[40:41],v186 offset:16384
ds_read_b64_tr_b16 v[42:43],v186 offset:20480
v_accvgpr_read_b32 v153,a121
v_accvgpr_read_b32 v154,a122
v_mfma_f32_16x16x32_bf16 a[140:143],v[48:51],v[212:215],a[140:143]
v_accvgpr_read_b32 v155,a123
v_accvgpr_read_b32 v156,a124
v_accvgpr_read_b32 v157,a125
v_accvgpr_read_b32 v158,a126
v_mfma_f32_16x16x32_bf16 a[140:143],v[52:55],v[220:223],a[140:143]
ds_read_b64_tr_b16 v[44:45],v186 offset:24576
ds_read_b64_tr_b16 v[46:47],v186 offset:28672
v_accvgpr_read_b32 v159,a127
v_cvt_pk_bf16_f32 v152,v152,v153
v_mfma_f32_16x16x32_bf16 a[132:135],v[52:55],v[216:219],a[132:135]
v_cvt_pk_bf16_f32 v153,v154,v155
v_cvt_pk_bf16_f32 v154,v156,v157
v_cvt_pk_bf16_f32 v155,v158,v159
v_mfma_f32_16x16x32_bf16 a[132:135],v[56:59],v[224:227],a[132:135]
ds_read_b64_tr_b16 v[48:49],v187
ds_read_b64_tr_b16 v[50:51],v187 offset:4096
buffer_store_dwordx4 v[152:155],v21,s[28:31],s70 offen offset:3072 sc1
v_mfma_f32_16x16x32_bf16 a[140:143],v[56:59],v[228:231],a[140:143]
s_waitcnt vmcnt(12)
buffer_store_dword v28,v2,s[28:31],s74 offen sc1
v_mfma_f32_16x16x32_bf16 a[140:143],v[60:63],v[236:239],a[140:143]
ds_read_b64_tr_b16 v[52:53],v187 offset:8192
ds_read_b64_tr_b16 v[54:55],v187 offset:12288
v_mfma_f32_16x16x32_bf16 a[132:135],v[60:63],v[232:235],a[132:135]
s_waitcnt lgkmcnt(4)
v_mfma_f32_16x16x32_bf16 a[144:147],v[32:35],v[208:211],a[144:147]
ds_read_b64_tr_b16 v[56:57],v187 offset:16384
ds_read_b64_tr_b16 v[58:59],v187 offset:20480
v_mfma_f32_16x16x32_bf16 a[152:155],v[32:35],v[212:215],a[152:155]
v_mfma_f32_16x16x32_bf16 a[152:155],v[36:39],v[220:223],a[152:155]
ds_read_b64_tr_b16 v[60:61],v187 offset:24576
ds_read_b64_tr_b16 v[62:63],v187 offset:28672
v_mfma_f32_16x16x32_bf16 a[144:147],v[36:39],v[216:219],a[144:147]
v_accvgpr_read_b32 v128,a128
v_accvgpr_read_b32 v129,a129
v_accvgpr_read_b32 v130,a130
v_accvgpr_read_b32 v131,a131
v_mfma_f32_16x16x32_bf16 a[144:147],v[40:43],v[224:227],a[144:147]
ds_read_b64_tr_b16 v[32:33],v188
ds_read_b64_tr_b16 v[34:35],v188 offset:4096
v_accvgpr_read_b32 v132,a132
v_mfma_f32_16x16x32_bf16 a[152:155],v[40:43],v[228:231],a[152:155]
v_accvgpr_read_b32 v133,a133
v_accvgpr_read_b32 v134,a134
v_accvgpr_read_b32 v135,a135
v_cvt_pk_bf16_f32 v128,v128,v129
v_cvt_pk_bf16_f32 v129,v130,v131
v_mfma_f32_16x16x32_bf16 a[152:155],v[44:47],v[236:239],a[152:155]
ds_read_b64_tr_b16 v[36:37],v188 offset:8192
ds_read_b64_tr_b16 v[38:39],v188 offset:12288
v_cvt_pk_bf16_f32 v130,v132,v133
v_mfma_f32_16x16x32_bf16 a[144:147],v[44:47],v[232:235],a[144:147]
v_cvt_pk_bf16_f32 v131,v134,v135
buffer_store_dwordx4 v[128:131],v21,s[28:31],s71 offen sc1
s_waitcnt lgkmcnt(4)
v_mfma_f32_16x16x32_bf16 a[148:151],v[48:51],v[208:211],a[148:151]
ds_read_b64_tr_b16 v[40:41],v188 offset:16384
ds_read_b64_tr_b16 v[42:43],v188 offset:20480
v_mfma_f32_16x16x32_bf16 a[156:159],v[48:51],v[212:215],a[156:159]
v_accvgpr_read_b32 v136,a136
v_accvgpr_read_b32 v137,a137
v_accvgpr_read_b32 v138,a138
v_accvgpr_read_b32 v139,a139
v_mfma_f32_16x16x32_bf16 a[156:159],v[52:55],v[220:223],a[156:159]
ds_read_b64_tr_b16 v[44:45],v188 offset:24576
ds_read_b64_tr_b16 v[46:47],v188 offset:28672
v_accvgpr_read_b32 v140,a140
v_mfma_f32_16x16x32_bf16 a[148:151],v[52:55],v[216:219],a[148:151]
v_accvgpr_read_b32 v141,a141
v_accvgpr_read_b32 v142,a142
v_accvgpr_read_b32 v143,a143
v_cvt_pk_bf16_f32 v136,v136,v137
v_cvt_pk_bf16_f32 v137,v138,v139
v_mfma_f32_16x16x32_bf16 a[148:151],v[56:59],v[224:227],a[148:151]
ds_read_b64_tr_b16 v[48:49],v189
ds_read_b64_tr_b16 v[50:51],v189 offset:4096
v_cvt_pk_bf16_f32 v138,v140,v141
v_mfma_f32_16x16x32_bf16 a[156:159],v[56:59],v[228:231],a[156:159]
v_cvt_pk_bf16_f32 v139,v142,v143
buffer_store_dwordx4 v[136:139],v21,s[28:31],s71 offen offset:1024 sc1
v_mfma_f32_16x16x32_bf16 a[156:159],v[60:63],v[236:239],a[156:159]
ds_read_b64_tr_b16 v[52:53],v189 offset:8192
ds_read_b64_tr_b16 v[54:55],v189 offset:12288
v_mfma_f32_16x16x32_bf16 a[148:151],v[60:63],v[232:235],a[148:151]
s_waitcnt lgkmcnt(4)
v_mfma_f32_16x16x32_bf16 a[160:163],v[32:35],v[208:211],a[160:163]
ds_read_b64_tr_b16 v[56:57],v189 offset:16384
ds_read_b64_tr_b16 v[58:59],v189 offset:20480
v_mfma_f32_16x16x32_bf16 a[168:171],v[32:35],v[212:215],a[168:171]
v_mfma_f32_16x16x32_bf16 a[168:171],v[36:39],v[220:223],a[168:171]
ds_read_b64_tr_b16 v[60:61],v189 offset:24576
ds_read_b64_tr_b16 v[62:63],v189 offset:28672
v_mfma_f32_16x16x32_bf16 a[160:163],v[36:39],v[216:219],a[160:163]
v_accvgpr_read_b32 v144,a144
v_accvgpr_read_b32 v145,a145
v_accvgpr_read_b32 v146,a146
v_accvgpr_read_b32 v147,a147
v_accvgpr_read_b32 v148,a148
v_mfma_f32_16x16x32_bf16 a[160:163],v[40:43],v[224:227],a[160:163]
ds_read_b64_tr_b16 v[32:33],v190
ds_read_b64_tr_b16 v[34:35],v190 offset:4096
v_accvgpr_read_b32 v149,a149
v_mfma_f32_16x16x32_bf16 a[168:171],v[40:43],v[228:231],a[168:171]
v_accvgpr_read_b32 v150,a150
v_accvgpr_read_b32 v151,a151
v_cvt_pk_bf16_f32 v144,v144,v145
v_cvt_pk_bf16_f32 v145,v146,v147
v_cvt_pk_bf16_f32 v146,v148,v149
v_mfma_f32_16x16x32_bf16 a[168:171],v[44:47],v[236:239],a[168:171]
ds_read_b64_tr_b16 v[36:37],v190 offset:8192
ds_read_b64_tr_b16 v[38:39],v190 offset:12288
v_cvt_pk_bf16_f32 v147,v150,v151
v_mfma_f32_16x16x32_bf16 a[160:163],v[44:47],v[232:235],a[160:163]
buffer_store_dwordx4 v[144:147],v21,s[28:31],s71 offen offset:2048 sc1
v_accvgpr_read_b32 v152,a152
s_waitcnt lgkmcnt(4)
v_mfma_f32_16x16x32_bf16 a[164:167],v[48:51],v[208:211],a[164:167]
ds_read_b64_tr_b16 v[40:41],v190 offset:16384
ds_read_b64_tr_b16 v[42:43],v190 offset:20480
v_accvgpr_read_b32 v153,a153
v_accvgpr_read_b32 v154,a154
v_mfma_f32_16x16x32_bf16 a[172:175],v[48:51],v[212:215],a[172:175]
v_accvgpr_read_b32 v155,a155
v_accvgpr_read_b32 v156,a156
v_accvgpr_read_b32 v157,a157
v_accvgpr_read_b32 v158,a158
v_mfma_f32_16x16x32_bf16 a[172:175],v[52:55],v[220:223],a[172:175]
ds_read_b64_tr_b16 v[44:45],v190 offset:24576
ds_read_b64_tr_b16 v[46:47],v190 offset:28672
v_accvgpr_read_b32 v159,a159
v_cvt_pk_bf16_f32 v152,v152,v153
v_mfma_f32_16x16x32_bf16 a[164:167],v[52:55],v[216:219],a[164:167]
v_cvt_pk_bf16_f32 v153,v154,v155
v_cvt_pk_bf16_f32 v154,v156,v157
v_cvt_pk_bf16_f32 v155,v158,v159
v_mfma_f32_16x16x32_bf16 a[164:167],v[56:59],v[224:227],a[164:167]
ds_read_b64_tr_b16 v[48:49],v191
ds_read_b64_tr_b16 v[50:51],v191 offset:4096
buffer_store_dwordx4 v[152:155],v21,s[28:31],s71 offen offset:3072 sc1
v_mfma_f32_16x16x32_bf16 a[172:175],v[56:59],v[228:231],a[172:175]
s_waitcnt vmcnt(13)
buffer_store_dword v28,v2,s[28:31],s75 offen sc1
v_mfma_f32_16x16x32_bf16 a[172:175],v[60:63],v[236:239],a[172:175]
ds_read_b64_tr_b16 v[52:53],v191 offset:8192
ds_read_b64_tr_b16 v[54:55],v191 offset:12288
v_mfma_f32_16x16x32_bf16 a[164:167],v[60:63],v[232:235],a[164:167]
s_waitcnt lgkmcnt(4)
v_mfma_f32_16x16x32_bf16 a[176:179],v[32:35],v[208:211],a[176:179]
ds_read_b64_tr_b16 v[56:57],v191 offset:16384
ds_read_b64_tr_b16 v[58:59],v191 offset:20480
v_mfma_f32_16x16x32_bf16 a[184:187],v[32:35],v[212:215],a[184:187]
v_mfma_f32_16x16x32_bf16 a[184:187],v[36:39],v[220:223],a[184:187]
ds_read_b64_tr_b16 v[60:61],v191 offset:24576
ds_read_b64_tr_b16 v[62:63],v191 offset:28672
v_mfma_f32_16x16x32_bf16 a[176:179],v[36:39],v[216:219],a[176:179]
v_accvgpr_read_b32 v128,a160
v_accvgpr_read_b32 v129,a161
v_accvgpr_read_b32 v130,a162
v_accvgpr_read_b32 v131,a163
v_mfma_f32_16x16x32_bf16 a[176:179],v[40:43],v[224:227],a[176:179]
ds_read_b64_tr_b16 v[32:33],v12
ds_read_b64_tr_b16 v[34:35],v12 offset:4096
v_accvgpr_read_b32 v132,a164
v_mfma_f32_16x16x32_bf16 a[184:187],v[40:43],v[228:231],a[184:187]
v_accvgpr_read_b32 v133,a165
v_accvgpr_read_b32 v134,a166
v_accvgpr_read_b32 v135,a167
v_cvt_pk_bf16_f32 v128,v128,v129
v_cvt_pk_bf16_f32 v129,v130,v131
v_mfma_f32_16x16x32_bf16 a[184:187],v[44:47],v[236:239],a[184:187]
ds_read_b64_tr_b16 v[36:37],v12 offset:8192
ds_read_b64_tr_b16 v[38:39],v12 offset:12288
v_cvt_pk_bf16_f32 v130,v132,v133
v_mfma_f32_16x16x32_bf16 a[176:179],v[44:47],v[232:235],a[176:179]
v_cvt_pk_bf16_f32 v131,v134,v135
buffer_store_dwordx4 v[128:131],v21,s[28:31],s72 offen sc1
s_waitcnt lgkmcnt(4)
v_mfma_f32_16x16x32_bf16 a[180:183],v[48:51],v[208:211],a[180:183]
ds_read_b64_tr_b16 v[40:41],v12 offset:57344
ds_read_b64_tr_b16 v[42:43],v12 offset:61440
v_mfma_f32_16x16x32_bf16 a[188:191],v[48:51],v[212:215],a[188:191]
v_accvgpr_read_b32 v136,a168
v_accvgpr_read_b32 v137,a169
v_accvgpr_read_b32 v138,a170
v_accvgpr_read_b32 v139,a171
v_mfma_f32_16x16x32_bf16 a[188:191],v[52:55],v[220:223],a[188:191]
ds_read_b64_tr_b16 v[44:45],v12 offset:49152
ds_read_b64_tr_b16 v[46:47],v12 offset:53248
v_accvgpr_read_b32 v140,a172
v_mfma_f32_16x16x32_bf16 a[180:183],v[52:55],v[216:219],a[180:183]
v_accvgpr_read_b32 v141,a173
v_accvgpr_read_b32 v142,a174
v_accvgpr_read_b32 v143,a175
v_cvt_pk_bf16_f32 v136,v136,v137
v_cvt_pk_bf16_f32 v137,v138,v139
v_mfma_f32_16x16x32_bf16 a[180:183],v[56:59],v[224:227],a[180:183]
ds_read_b64_tr_b16 v[48:49],v13
ds_read_b64_tr_b16 v[50:51],v13 offset:4096
v_cvt_pk_bf16_f32 v138,v140,v141
v_mfma_f32_16x16x32_bf16 a[188:191],v[56:59],v[228:231],a[188:191]
v_cvt_pk_bf16_f32 v139,v142,v143
buffer_store_dwordx4 v[136:139],v21,s[28:31],s72 offen offset:1024 sc1
v_mfma_f32_16x16x32_bf16 a[188:191],v[60:63],v[236:239],a[188:191]
ds_read_b64_tr_b16 v[52:53],v13 offset:8192
ds_read_b64_tr_b16 v[54:55],v13 offset:12288
v_mfma_f32_16x16x32_bf16 a[180:183],v[60:63],v[232:235],a[180:183]
s_waitcnt lgkmcnt(4)
v_mfma_f32_16x16x32_bf16 a[192:195],v[32:35],v[208:211],a[192:195]
ds_read_b64_tr_b16 v[56:57],v13 offset:57344
ds_read_b64_tr_b16 v[58:59],v13 offset:61440
v_mfma_f32_16x16x32_bf16 a[200:203],v[32:35],v[212:215],a[200:203]
v_mfma_f32_16x16x32_bf16 a[200:203],v[36:39],v[220:223],a[200:203]
ds_read_b64_tr_b16 v[60:61],v13 offset:49152
ds_read_b64_tr_b16 v[62:63],v13 offset:53248
v_mfma_f32_16x16x32_bf16 a[192:195],v[36:39],v[216:219],a[192:195]
v_accvgpr_read_b32 v144,a176
v_accvgpr_read_b32 v145,a177
v_accvgpr_read_b32 v146,a178
v_accvgpr_read_b32 v147,a179
v_accvgpr_read_b32 v148,a180
v_mfma_f32_16x16x32_bf16 a[192:195],v[40:43],v[224:227],a[192:195]
ds_read_b64_tr_b16 v[32:33],v14
ds_read_b64_tr_b16 v[34:35],v14 offset:4096
v_accvgpr_read_b32 v149,a181
v_mfma_f32_16x16x32_bf16 a[200:203],v[40:43],v[228:231],a[200:203]
v_accvgpr_read_b32 v150,a182
v_accvgpr_read_b32 v151,a183
v_cvt_pk_bf16_f32 v144,v144,v145
v_cvt_pk_bf16_f32 v145,v146,v147
v_cvt_pk_bf16_f32 v146,v148,v149
v_mfma_f32_16x16x32_bf16 a[200:203],v[44:47],v[236:239],a[200:203]
ds_read_b64_tr_b16 v[36:37],v14 offset:8192
ds_read_b64_tr_b16 v[38:39],v14 offset:12288
v_cvt_pk_bf16_f32 v147,v150,v151
v_mfma_f32_16x16x32_bf16 a[192:195],v[44:47],v[232:235],a[192:195]
buffer_store_dwordx4 v[144:147],v21,s[28:31],s72 offen offset:2048 sc1
v_accvgpr_read_b32 v152,a184
s_waitcnt lgkmcnt(4)
v_mfma_f32_16x16x32_bf16 a[196:199],v[48:51],v[208:211],a[196:199]
ds_read_b64_tr_b16 v[40:41],v14 offset:57344
ds_read_b64_tr_b16 v[42:43],v14 offset:61440
v_accvgpr_read_b32 v153,a185
v_accvgpr_read_b32 v154,a186
v_mfma_f32_16x16x32_bf16 a[204:207],v[48:51],v[212:215],a[204:207]
v_accvgpr_read_b32 v155,a187
v_accvgpr_read_b32 v156,a188
v_accvgpr_read_b32 v157,a189
v_accvgpr_read_b32 v158,a190
v_mfma_f32_16x16x32_bf16 a[204:207],v[52:55],v[220:223],a[204:207]
ds_read_b64_tr_b16 v[44:45],v14 offset:49152
ds_read_b64_tr_b16 v[46:47],v14 offset:53248
v_accvgpr_read_b32 v159,a191
v_cvt_pk_bf16_f32 v152,v152,v153
v_mfma_f32_16x16x32_bf16 a[196:199],v[52:55],v[216:219],a[196:199]
v_cvt_pk_bf16_f32 v153,v154,v155
v_cvt_pk_bf16_f32 v154,v156,v157
v_cvt_pk_bf16_f32 v155,v158,v159
v_mfma_f32_16x16x32_bf16 a[196:199],v[56:59],v[224:227],a[196:199]
ds_read_b64_tr_b16 v[48:49],v15
ds_read_b64_tr_b16 v[50:51],v15 offset:4096
buffer_store_dwordx4 v[152:155],v21,s[28:31],s72 offen offset:3072 sc1
v_mfma_f32_16x16x32_bf16 a[204:207],v[56:59],v[228:231],a[204:207]
s_waitcnt vmcnt(14)
buffer_store_dword v28,v2,s[28:31],s76 offen sc1
v_mfma_f32_16x16x32_bf16 a[204:207],v[60:63],v[236:239],a[204:207]
ds_read_b64_tr_b16 v[52:53],v15 offset:8192
ds_read_b64_tr_b16 v[54:55],v15 offset:12288
v_mfma_f32_16x16x32_bf16 a[196:199],v[60:63],v[232:235],a[196:199]
s_waitcnt lgkmcnt(4)
s_barrier
v_mfma_f32_16x16x32_bf16 a[208:211],v[32:35],v[208:211],a[208:211]
ds_read_b64_tr_b16 v[56:57],v15 offset:57344
ds_read_b64_tr_b16 v[58:59],v15 offset:61440
v_mfma_f32_16x16x32_bf16 a[216:219],v[32:35],v[212:215],a[216:219]
v_mfma_f32_16x16x32_bf16 a[216:219],v[36:39],v[220:223],a[216:219]
ds_read_b64_tr_b16 v[60:61],v15 offset:49152
ds_read_b64_tr_b16 v[62:63],v15 offset:53248
v_mfma_f32_16x16x32_bf16 a[208:211],v[36:39],v[216:219],a[208:211]
v_accvgpr_read_b32 v128,a192
v_accvgpr_read_b32 v129,a193
v_accvgpr_read_b32 v130,a194
v_accvgpr_read_b32 v131,a195
v_mfma_f32_16x16x32_bf16 a[208:211],v[40:43],v[224:227],a[208:211]
ds_read_b64_tr_b16 v[32:33],v16
ds_read_b64_tr_b16 v[34:35],v16 offset:4096
v_accvgpr_read_b32 v132,a196
v_mfma_f32_16x16x32_bf16 a[216:219],v[40:43],v[228:231],a[216:219]
v_accvgpr_read_b32 v133,a197
v_accvgpr_read_b32 v134,a198
v_accvgpr_read_b32 v135,a199
v_cvt_pk_bf16_f32 v128,v128,v129
v_cvt_pk_bf16_f32 v129,v130,v131
L_tp_a10:
s_cbranch_execz L_tr_a10
v_mfma_f32_16x16x32_bf16 a[216:219],v[44:47],v[236:239],a[216:219]
ds_read_b64_tr_b16 v[36:37],v16 offset:8192
ds_read_b64_tr_b16 v[38:39],v16 offset:12288
v_cvt_pk_bf16_f32 v130,v132,v133
v_mfma_f32_16x16x32_bf16 a[208:211],v[44:47],v[232:235],a[208:211]
v_cvt_pk_bf16_f32 v131,v134,v135
buffer_store_dwordx4 v[128:131],v21,s[28:31],s73 offen sc1
s_waitcnt lgkmcnt(4)
v_mfma_f32_16x16x32_bf16 a[212:215],v[48:51],v[208:211],a[212:215]
ds_read_b64_tr_b16 v[40:41],v16 offset:57344
ds_read_b64_tr_b16 v[42:43],v16 offset:61440
v_mfma_f32_16x16x32_bf16 a[220:223],v[48:51],v[212:215],a[220:223]
v_accvgpr_read_b32 v136,a200
v_accvgpr_read_b32 v137,a201
v_accvgpr_read_b32 v138,a202
v_accvgpr_read_b32 v139,a203
v_mfma_f32_16x16x32_bf16 a[220:223],v[52:55],v[220:223],a[220:223]
ds_read_b64_tr_b16 v[44:45],v16 offset:49152
ds_read_b64_tr_b16 v[46:47],v16 offset:53248
v_accvgpr_read_b32 v140,a204
v_mfma_f32_16x16x32_bf16 a[212:215],v[52:55],v[216:219],a[212:215]
v_accvgpr_read_b32 v141,a205
v_accvgpr_read_b32 v142,a206
v_accvgpr_read_b32 v143,a207
v_cvt_pk_bf16_f32 v136,v136,v137
v_cvt_pk_bf16_f32 v137,v138,v139
v_mfma_f32_16x16x32_bf16 a[212:215],v[56:59],v[224:227],a[212:215]
ds_read_b64_tr_b16 v[48:49],v17
ds_read_b64_tr_b16 v[50:51],v17 offset:4096
v_cvt_pk_bf16_f32 v138,v140,v141
v_mfma_f32_16x16x32_bf16 a[220:223],v[56:59],v[228:231],a[220:223]
v_cvt_pk_bf16_f32 v139,v142,v143
buffer_store_dwordx4 v[136:139],v21,s[28:31],s73 offen offset:1024 sc1
v_mfma_f32_16x16x32_bf16 a[220:223],v[60:63],v[236:239],a[220:223]
ds_read_b64_tr_b16 v[52:53],v17 offset:8192
ds_read_b64_tr_b16 v[54:55],v17 offset:12288
v_mfma_f32_16x16x32_bf16 a[212:215],v[60:63],v[232:235],a[212:215]
s_waitcnt lgkmcnt(4)
v_mfma_f32_16x16x32_bf16 a[224:227],v[32:35],v[208:211],a[224:227]
ds_read_b64_tr_b16 v[56:57],v17 offset:57344
ds_read_b64_tr_b16 v[58:59],v17 offset:61440
v_mfma_f32_16x16x32_bf16 a[232:235],v[32:35],v[212:215],a[232:235]
v_mfma_f32_16x16x32_bf16 a[232:235],v[36:39],v[220:223],a[232:235]
ds_read_b64_tr_b16 v[60:61],v17 offset:49152
ds_read_b64_tr_b16 v[62:63],v17 offset:53248
v_mfma_f32_16x16x32_bf16 a[224:227],v[36:39],v[216:219],a[224:227]
v_accvgpr_read_b32 v144,a208
v_accvgpr_read_b32 v145,a209
v_accvgpr_read_b32 v146,a210
v_accvgpr_read_b32 v147,a211
v_accvgpr_read_b32 v148,a212
v_mfma_f32_16x16x32_bf16 a[224:227],v[40:43],v[224:227],a[224:227]
ds_read_b64_tr_b16 v[32:33],v18
ds_read_b64_tr_b16 v[34:35],v18 offset:4096
v_accvgpr_read_b32 v149,a213
v_mfma_f32_16x16x32_bf16 a[232:235],v[40:43],v[228:231],a[232:235]
v_accvgpr_read_b32 v150,a214
v_accvgpr_read_b32 v151,a215
v_cvt_pk_bf16_f32 v144,v144,v145
v_cvt_pk_bf16_f32 v145,v146,v147
v_cvt_pk_bf16_f32 v146,v148,v149
v_mfma_f32_16x16x32_bf16 a[232:235],v[44:47],v[236:239],a[232:235]
ds_read_b64_tr_b16 v[36:37],v18 offset:8192
ds_read_b64_tr_b16 v[38:39],v18 offset:12288
v_cvt_pk_bf16_f32 v147,v150,v151
v_mfma_f32_16x16x32_bf16 a[224:227],v[44:47],v[232:235],a[224:227]
buffer_store_dwordx4 v[144:147],v21,s[28:31],s73 offen offset:2048 sc1
v_accvgpr_read_b32 v152,a216
s_waitcnt lgkmcnt(4)
v_mfma_f32_16x16x32_bf16 a[228:231],v[48:51],v[208:211],a[228:231]
ds_read_b64_tr_b16 v[40:41],v18 offset:57344
ds_read_b64_tr_b16 v[42:43],v18 offset:61440
v_accvgpr_read_b32 v153,a217
v_accvgpr_read_b32 v154,a218
v_mfma_f32_16x16x32_bf16 a[236:239],v[48:51],v[212:215],a[236:239]
v_accvgpr_read_b32 v155,a219
v_accvgpr_read_b32 v156,a220
v_accvgpr_read_b32 v157,a221
v_accvgpr_read_b32 v158,a222
v_mfma_f32_16x16x32_bf16 a[236:239],v[52:55],v[220:223],a[236:239]
ds_read_b64_tr_b16 v[44:45],v18 offset:49152
ds_read_b64_tr_b16 v[46:47],v18 offset:53248
v_accvgpr_read_b32 v159,a223
v_cvt_pk_bf16_f32 v152,v152,v153
v_mfma_f32_16x16x32_bf16 a[228:231],v[52:55],v[216:219],a[228:231]
v_cvt_pk_bf16_f32 v153,v154,v155
v_cvt_pk_bf16_f32 v154,v156,v157
v_cvt_pk_bf16_f32 v155,v158,v159
v_mfma_f32_16x16x32_bf16 a[228:231],v[56:59],v[224:227],a[228:231]
ds_read_b64_tr_b16 v[48:49],v19
ds_read_b64_tr_b16 v[50:51],v19 offset:4096
buffer_store_dwordx4 v[152:155],v21,s[28:31],s73 offen offset:3072 sc1
v_mfma_f32_16x16x32_bf16 a[236:239],v[56:59],v[228:231],a[236:239]
s_waitcnt vmcnt(15)
buffer_store_dword v28,v2,s[28:31],s77 offen sc1
v_mfma_f32_16x16x32_bf16 a[236:239],v[60:63],v[236:239],a[236:239]
ds_read_b64_tr_b16 v[52:53],v19 offset:8192
ds_read_b64_tr_b16 v[54:55],v19 offset:12288
v_mfma_f32_16x16x32_bf16 a[228:231],v[60:63],v[232:235],a[228:231]
s_waitcnt lgkmcnt(4)
v_mfma_f32_16x16x32_bf16 a[240:243],v[32:35],v[208:211],a[240:243]
ds_read_b64_tr_b16 v[56:57],v19 offset:57344
ds_read_b64_tr_b16 v[58:59],v19 offset:61440
v_mfma_f32_16x16x32_bf16 a[248:251],v[32:35],v[212:215],a[248:251]
v_mfma_f32_16x16x32_bf16 a[248:251],v[36:39],v[220:223],a[248:251]
ds_read_b64_tr_b16 v[60:61],v19 offset:49152
ds_read_b64_tr_b16 v[62:63],v19 offset:53248
v_mfma_f32_16x16x32_bf16 a[240:243],v[36:39],v[216:219],a[240:243]
v_mfma_f32_16x16x32_bf16 a[240:243],v[40:43],v[224:227],a[240:243]
v_mfma_f32_16x16x32_bf16 a[248:251],v[40:43],v[228:231],a[248:251]
v_mfma_f32_16x16x32_bf16 a[248:251],v[44:47],v[236:239],a[248:251]
v_mfma_f32_16x16x32_bf16 a[240:243],v[44:47],v[232:235],a[240:243]
s_waitcnt lgkmcnt(0)
v_mfma_f32_16x16x32_bf16 a[244:247],v[48:51],v[208:211],a[244:247]
v_mfma_f32_16x16x32_bf16 a[252:255],v[48:51],v[212:215],a[252:255]
v_mfma_f32_16x16x32_bf16 a[252:255],v[52:55],v[220:223],a[252:255]
v_mfma_f32_16x16x32_bf16 a[244:247],v[52:55],v[216:219],a[244:247]
v_mfma_f32_16x16x32_bf16 a[244:247],v[56:59],v[224:227],a[244:247]
v_mfma_f32_16x16x32_bf16 a[252:255],v[56:59],v[228:231],a[252:255]
v_mfma_f32_16x16x32_bf16 a[252:255],v[60:63],v[236:239],a[252:255]
v_mfma_f32_16x16x32_bf16 a[244:247],v[60:63],v[232:235],a[244:247]
s_waitcnt vmcnt(11)
buffer_store_dword v28,v2,s[28:31],s78 offen sc1
s_waitcnt vmcnt(7)
buffer_store_dword v28,v2,s[28:31],s79 offen sc1
s_waitcnt vmcnt(3)
buffer_store_dword v28,v2,s[28:31],s80 offen sc1
v_lshrrev_b32 v23,4,v0
v_bfe_u32 v24,v0,2,2
v_cmp_eq_u32 vcc,v23,v24
v_and_b32 v23,1,v0
v_lshlrev_b32 v23,4,v23
v_mov_b32 v24,0x3f80
v_lshlrev_b32 v23,v23,v24
v_cndmask_b32 v23,0,v23,vcc
v_and_b32 v24,2,v0
v_cmp_eq_u32 vcc,0,v24
v_mov_b32 v194,0
v_mov_b32 v195,0
v_cndmask_b32 v192,0,v23,vcc
v_cndmask_b32 v193,v23,0,vcc
v_mov_b32 v196,v192
v_mov_b32 v197,v193
s_lshl_b32 s41,s32,12
v_add_u32 v23,s41,v21
v_add_u32 v24,98304,v23
v_accvgpr_read_b32 v208,a224
v_accvgpr_read_b32 v209,a225
v_accvgpr_read_b32 v210,a226
v_accvgpr_read_b32 v211,a227
v_accvgpr_read_b32 v212,a228
v_accvgpr_read_b32 v213,a229
v_accvgpr_read_b32 v214,a230
v_accvgpr_read_b32 v215,a231
v_accvgpr_read_b32 v216,a232
v_accvgpr_read_b32 v217,a233
v_accvgpr_read_b32 v218,a234
v_accvgpr_read_b32 v219,a235
v_accvgpr_read_b32 v220,a236
v_accvgpr_read_b32 v221,a237
v_accvgpr_read_b32 v222,a238
v_accvgpr_read_b32 v223,a239
v_accvgpr_read_b32 v224,a240
v_accvgpr_read_b32 v225,a241
v_accvgpr_read_b32 v226,a242
v_accvgpr_read_b32 v227,a243
v_accvgpr_read_b32 v228,a244
v_accvgpr_read_b32 v229,a245
v_accvgpr_read_b32 v230,a246
v_accvgpr_read_b32 v231,a247
v_accvgpr_read_b32 v232,a248
v_accvgpr_read_b32 v233,a249
v_accvgpr_read_b32 v234,a250
v_accvgpr_read_b32 v235,a251
v_accvgpr_read_b32 v236,a252
v_accvgpr_read_b32 v237,a253
v_accvgpr_read_b32 v238,a254
v_accvgpr_read_b32 v239,a255
s_barrier
ds_read_b128 v[64:67],v23 offset:49152
ds_read_b128 v[68:71],v23 offset:50176
ds_read_b128 v[72:75],v23 offset:51200
ds_read_b128 v[76:79],v23 offset:52224
ds_read_b128 v[80:83],v23 offset:61440
ds_read_b128 v[84:87],v23 offset:62464
s_waitcnt lgkmcnt(5)
v_mfma_f32_16x16x32_bf16 v[208:211],v[192:195],v[64:67],v[208:211]
ds_read_b128 v[88:91],v23 offset:63488
v_mfma_f32_16x16x32_bf16 v[212:215],v[194:197],v[64:67],v[212:215]
s_waitcnt lgkmcnt(5)
v_mfma_f32_16x16x32_bf16 v[216:219],v[192:195],v[68:71],v[216:219]
ds_read_b128 v[92:95],v23 offset:64512
v_mfma_f32_16x16x32_bf16 v[220:223],v[194:197],v[68:71],v[220:223]
s_waitcnt lgkmcnt(5)
v_mfma_f32_16x16x32_bf16 v[224:227],v[192:195],v[72:75],v[224:227]
ds_read_b128 v[96:99],v24
v_mfma_f32_16x16x32_bf16 v[228:231],v[194:197],v[72:75],v[228:231]
s_waitcnt lgkmcnt(5)
v_mfma_f32_16x16x32_bf16 v[232:235],v[192:195],v[76:79],v[232:235]
ds_read_b128 v[100:103],v24 offset:1024
v_mfma_f32_16x16x32_bf16 v[236:239],v[194:197],v[76:79],v[236:239]
s_waitcnt lgkmcnt(5)
v_mfma_f32_16x16x32_bf16 v[208:211],v[192:195],v[80:83],v[208:211]
ds_read_b128 v[104:107],v24 offset:2048
v_mfma_f32_16x16x32_bf16 v[212:215],v[194:197],v[80:83],v[212:215]
s_waitcnt lgkmcnt(5)
v_mfma_f32_16x16x32_bf16 v[216:219],v[192:195],v[84:87],v[216:219]
ds_read_b128 v[108:111],v24 offset:3072
v_mfma_f32_16x16x32_bf16 v[220:223],v[194:197],v[84:87],v[220:223]
s_waitcnt lgkmcnt(5)
v_mfma_f32_16x16x32_bf16 v[224:227],v[192:195],v[88:91],v[224:227]
ds_read_b128 v[112:115],v24 offset:12288
v_mfma_f32_16x16x32_bf16 v[228:231],v[194:197],v[88:91],v[228:231]
s_waitcnt lgkmcnt(5)
v_mfma_f32_16x16x32_bf16 v[232:235],v[192:195],v[92:95],v[232:235]
ds_read_b128 v[116:119],v24 offset:13312
v_mfma_f32_16x16x32_bf16 v[236:239],v[194:197],v[92:95],v[236:239]
s_waitcnt lgkmcnt(5)
v_mfma_f32_16x16x32_bf16 v[208:211],v[192:195],v[96:99],v[208:211]
ds_read_b128 v[120:123],v24 offset:14336
v_mfma_f32_16x16x32_bf16 v[212:215],v[194:197],v[96:99],v[212:215]
s_waitcnt lgkmcnt(5)
v_mfma_f32_16x16x32_bf16 v[216:219],v[192:195],v[100:103],v[216:219]
ds_read_b128 v[124:127],v24 offset:15360
v_mfma_f32_16x16x32_bf16 v[220:223],v[194:197],v[100:103],v[220:223]
s_waitcnt lgkmcnt(5)
v_mfma_f32_16x16x32_bf16 v[224:227],v[192:195],v[104:107],v[224:227]
ds_read_b128 v[128:131],v24 offset:24576
v_mfma_f32_16x16x32_bf16 v[228:231],v[194:197],v[104:107],v[228:231]
s_waitcnt lgkmcnt(5)
v_mfma_f32_16x16x32_bf16 v[232:235],v[192:195],v[108:111],v[232:235]
ds_read_b128 v[132:135],v24 offset:25600
v_mfma_f32_16x16x32_bf16 v[236:239],v[194:197],v[108:111],v[236:239]
s_waitcnt lgkmcnt(5)
v_mfma_f32_16x16x32_bf16 v[208:211],v[192:195],v[112:115],v[208:211]
ds_read_b128 v[136:139],v24 offset:26624
v_mfma_f32_16x16x32_bf16 v[212:215],v[194:197],v[112:115],v[212:215]
s_waitcnt lgkmcnt(5)
v_mfma_f32_16x16x32_bf16 v[216:219],v[192:195],v[116:119],v[216:219]
ds_read_b128 v[140:143],v24 offset:27648
v_mfma_f32_16x16x32_bf16 v[220:223],v[194:197],v[116:119],v[220:223]
s_waitcnt lgkmcnt(5)
v_mfma_f32_16x16x32_bf16 v[224:227],v[192:195],v[120:123],v[224:227]
ds_read_b128 v[144:147],v24 offset:36864
v_mfma_f32_16x16x32_bf16 v[228:231],v[194:197],v[120:123],v[228:231]
s_waitcnt lgkmcnt(5)
v_mfma_f32_16x16x32_bf16 v[232:235],v[192:195],v[124:127],v[232:235]
ds_read_b128 v[148:151],v24 offset:37888
v_mfma_f32_16x16x32_bf16 v[236:239],v[194:197],v[124:127],v[236:239]
s_waitcnt lgkmcnt(5)
v_mfma_f32_16x16x32_bf16 v[208:211],v[192:195],v[128:131],v[208:211]
ds_read_b128 v[152:155],v24 offset:38912
v_mfma_f32_16x16x32_bf16 v[212:215],v[194:197],v[128:131],v[212:215]
s_waitcnt lgkmcnt(5)
v_mfma_f32_16x16x32_bf16 v[216:219],v[192:195],v[132:135],v[216:219]
ds_read_b128 v[156:159],v24 offset:39936
v_mfma_f32_16x16x32_bf16 v[220:223],v[194:197],v[132:135],v[220:223]
s_waitcnt lgkmcnt(5)
v_mfma_f32_16x16x32_bf16 v[224:227],v[192:195],v[136:139],v[224:227]
v_mfma_f32_16x16x32_bf16 v[228:231],v[194:197],v[136:139],v[228:231]
s_waitcnt lgkmcnt(4)
v_mfma_f32_16x16x32_bf16 v[232:235],v[192:195],v[140:143],v[232:235]
v_mfma_f32_16x16x32_bf16 v[236:239],v[194:197],v[140:143],v[236:239]
s_waitcnt lgkmcnt(3)
v_mfma_f32_16x16x32_bf16 v[208:211],v[192:195],v[144:147],v[208:211]
v_mfma_f32_16x16x32_bf16 v[212:215],v[194:197],v[144:147],v[212:215]
s_waitcnt lgkmcnt(2)
v_mfma_f32_16x16x32_bf16 v[216:219],v[192:195],v[148:151],v[216:219]
v_mfma_f32_16x16x32_bf16 v[220:223],v[194:197],v[148:151],v[220:223]
s_waitcnt lgkmcnt(1)
v_mfma_f32_16x16x32_bf16 v[224:227],v[192:195],v[152:155],v[224:227]
v_mfma_f32_16x16x32_bf16 v[228:231],v[194:197],v[152:155],v[228:231]
s_waitcnt lgkmcnt(0)
v_mfma_f32_16x16x32_bf16 v[232:235],v[192:195],v[156:159],v[232:235]
v_mfma_f32_16x16x32_bf16 v[236:239],v[194:197],v[156:159],v[236:239]
s_barrier
ds_read_b128 v[160:163],v24 offset:49152
ds_read_b128 v[164:167],v24 offset:50176
ds_read_b128 v[168:171],v24 offset:51200
ds_read_b128 v[172:175],v24 offset:52224
s_waitcnt lgkmcnt(3)
v_mfma_f32_16x16x32_bf16 v[208:211],v[192:195],v[160:163],v[208:211]
v_mfma_f32_16x16x32_bf16 v[212:215],v[194:197],v[160:163],v[212:215]
s_waitcnt lgkmcnt(2)
v_mfma_f32_16x16x32_bf16 v[216:219],v[192:195],v[164:167],v[216:219]
v_mfma_f32_16x16x32_bf16 v[220:223],v[194:197],v[164:167],v[220:223]
s_waitcnt lgkmcnt(1)
v_mfma_f32_16x16x32_bf16 v[224:227],v[192:195],v[168:171],v[224:227]
v_mfma_f32_16x16x32_bf16 v[228:231],v[194:197],v[168:171],v[228:231]
s_waitcnt lgkmcnt(0)
v_mfma_f32_16x16x32_bf16 v[232:235],v[192:195],v[172:175],v[232:235]
v_mfma_f32_16x16x32_bf16 v[236:239],v[194:197],v[172:175],v[236:239]
v_cvt_pk_bf16_f32 v208,v208,v209
v_cvt_pk_bf16_f32 v209,v210,v211
v_cvt_pk_bf16_f32 v210,v212,v213
v_cvt_pk_bf16_f32 v211,v214,v215
s_nop 0
v_permlane16_swap_b32 v208,v210
v_permlane16_swap_b32 v209,v211
buffer_store_dwordx4 v[208:211],v3,s[4:7],s50 offen
v_cvt_pk_bf16_f32 v216,v216,v217
v_cvt_pk_bf16_f32 v217,v218,v219
v_cvt_pk_bf16_f32 v218,v220,v221
v_cvt_pk_bf16_f32 v219,v222,v223
s_nop 0
v_permlane16_swap_b32 v216,v218
v_permlane16_swap_b32 v217,v219
buffer_store_dwordx4 v[216:219],v3,s[4:7],s51 offen
v_cvt_pk_bf16_f32 v224,v224,v225
v_cvt_pk_bf16_f32 v225,v226,v227
v_cvt_pk_bf16_f32 v226,v228,v229
v_cvt_pk_bf16_f32 v227,v230,v231
s_nop 0
v_permlane16_swap_b32 v224,v226
v_permlane16_swap_b32 v225,v227
buffer_store_dwordx4 v[224:227],v3,s[4:7],s50 offen offset:64
v_cvt_pk_bf16_f32 v232,v232,v233
v_cvt_pk_bf16_f32 v233,v234,v235
v_cvt_pk_bf16_f32 v234,v236,v237
v_cvt_pk_bf16_f32 v235,v238,v239
s_nop 0
v_permlane16_swap_b32 v232,v234
v_permlane16_swap_b32 v233,v235
buffer_store_dwordx4 v[232:235],v3,s[4:7],s51 offen offset:64
s_endpgm
L_count1:
s_call_b64 s[46:47],L_count
s_branch L_counted1
L_count2:
s_call_b64 s[46:47],L_count
s_branch L_counted2
L_count3:
s_call_b64 s[46:47],L_count
s_branch L_counted3
L_count4:
s_call_b64 s[46:47],L_count
s_branch L_counted4
L_count5:
s_call_b64 s[46:47],L_count
s_branch L_counted5
L_count6:
s_call_b64 s[46:47],L_count
s_branch L_counted6
L_count15:
s_call_b64 s[46:47],L_count
s_branch L_counted15
L_count16:
s_call_b64 s[46:47],L_count
s_branch L_counted16
L_count:
v_lshlrev_b32 v1,10,v0
v_mov_b32 v23,1
s_waitcnt vmcnt(0)
buffer_atomic_add v23,v1,s[96:99],s52 offen sc1
s_nop 1
s_setpc_b64 s[46:47]
L_rare0:
s_call_b64 s[46:47],L_rescale1
s_branch L_back0
L_rare1:
s_call_b64 s[46:47],L_rescale0
s_branch L_back1
L_rare2:
s_call_b64 s[46:47],L_rescale1
s_branch L_back2
L_rare3:
s_call_b64 s[46:47],L_rescale0
s_branch L_back3
L_rare4:
s_call_b64 s[46:47],L_rescale1
s_branch L_back4
L_rare13:
s_call_b64 s[46:47],L_rescale0
s_branch L_back13
L_rare14:
s_call_b64 s[46:47],L_rescale1
s_branch L_back14
L_rare15:
s_call_b64 s[46:47],L_rescale1
s_branch L_back15
L_rare16:
s_call_b64 s[46:47],L_rescale0
s_branch L_back16
L_rare17:
s_call_b64 s[46:47],L_rescale1
s_branch L_back17
L_rare18:
s_call_b64 s[46:47],L_rescale0
s_branch L_back18
L_rare19:
s_call_b64 s[46:47],L_rescale1
s_branch L_back19
L_rare20:
s_call_b64 s[46:47],L_rescale0
s_branch L_back20
L_rare21:
s_call_b64 s[46:47],L_rescale1
s_branch L_back21
L_rare22:
s_call_b64 s[46:47],L_rescale0
s_branch L_back22
L_rare23:
s_call_b64 s[46:47],L_rescale1
s_branch L_back23
L_rare24:
s_call_b64 s[46:47],L_rescale0
s_branch L_back24
L_rare25:
s_call_b64 s[46:47],L_rescale1
s_branch L_back25
L_rare26:
s_call_b64 s[46:47],L_rescale0
s_branch L_back26
L_rare27:
s_call_b64 s[46:47],L_rescale1
s_branch L_back27
L_rare28:
s_call_b64 s[46:47],L_rescale0
s_branch L_back28
L_rare29:
s_call_b64 s[46:47],L_rescale1
s_branch L_back29
L_rare59:
s_call_b64 s[46:47],L_rescale1
s_branch L_back59
L_rescale0:
s_nop 11
v_max3_f32 v22,v128,v129,v130
v_max3_f32 v22,v22,v131,v132
v_max3_f32 v22,v22,v133,v134
v_max_f32 v22,v22,v135
v_mov_b32 v23,v22
s_nop 1
v_permlane16_swap_b32 v23,v22
v_max_f32 v22,v22,v23
v_mov_b32 v23,v22
s_nop 1
v_permlane32_swap_b32 v23,v22
v_max_f32 v22,v22,v23
v_max_f32 v22,0,v22
v_sub_f32 v23,0,v22
v_exp_f32 v23,v23
v_sub_f32 v160,v160,v22
v_sub_f32 v161,v161,v22
v_sub_f32 v162,v162,v22
v_sub_f32 v163,v163,v22
v_sub_f32 v128,v128,v22
v_sub_f32 v129,v129,v22
v_sub_f32 v130,v130,v22
v_sub_f32 v131,v131,v22
v_sub_f32 v132,v132,v22
v_sub_f32 v133,v133,v22
v_sub_f32 v134,v134,v22
v_sub_f32 v135,v135,v22
v_mul_f32 v168,v168,v23
v_mul_f32 v169,v169,v23
v_mul_f32 v170,v170,v23
v_mul_f32 v171,v171,v23
v_mul_f32 v64,v64,v23
v_mul_f32 v65,v65,v23
v_mul_f32 v66,v66,v23
v_mul_f32 v67,v67,v23
v_mul_f32 v68,v68,v23
v_mul_f32 v69,v69,v23
v_mul_f32 v70,v70,v23
v_mul_f32 v71,v71,v23
v_mul_f32 v80,v80,v23
v_mul_f32 v81,v81,v23
v_mul_f32 v82,v82,v23
v_mul_f32 v83,v83,v23
v_mul_f32 v84,v84,v23
v_mul_f32 v85,v85,v23
v_mul_f32 v86,v86,v23
v_mul_f32 v87,v87,v23
v_mul_f32 v96,v96,v23
v_mul_f32 v97,v97,v23
v_mul_f32 v98,v98,v23
v_mul_f32 v99,v99,v23
v_mul_f32 v100,v100,v23
v_mul_f32 v101,v101,v23
v_mul_f32 v102,v102,v23
v_mul_f32 v103,v103,v23
v_mul_f32 v112,v112,v23
v_mul_f32 v113,v113,v23
v_mul_f32 v114,v114,v23
v_mul_f32 v115,v115,v23
v_mul_f32 v116,v116,v23
v_mul_f32 v117,v117,v23
v_mul_f32 v118,v118,v23
v_mul_f32 v119,v119,v23
v_max3_f32 v22,v136,v137,v138
v_max3_f32 v22,v22,v139,v140
v_max3_f32 v22,v22,v141,v142
v_max_f32 v22,v22,v143
v_mov_b32 v23,v22
s_nop 1
v_permlane16_swap_b32 v23,v22
v_max_f32 v22,v22,v23
v_mov_b32 v23,v22
s_nop 1
v_permlane32_swap_b32 v23,v22
v_max_f32 v22,v22,v23
v_max_f32 v22,0,v22
v_sub_f32 v23,0,v22
v_exp_f32 v23,v23
v_sub_f32 v164,v164,v22
v_sub_f32 v165,v165,v22
v_sub_f32 v166,v166,v22
v_sub_f32 v167,v167,v22
v_sub_f32 v136,v136,v22
v_sub_f32 v137,v137,v22
v_sub_f32 v138,v138,v22
v_sub_f32 v139,v139,v22
v_sub_f32 v140,v140,v22
v_sub_f32 v141,v141,v22
v_sub_f32 v142,v142,v22
v_sub_f32 v143,v143,v22
v_mul_f32 v172,v172,v23
v_mul_f32 v173,v173,v23
v_mul_f32 v174,v174,v23
v_mul_f32 v175,v175,v23
v_mul_f32 v72,v72,v23
v_mul_f32 v73,v73,v23
v_mul_f32 v74,v74,v23
v_mul_f32 v75,v75,v23
v_mul_f32 v76,v76,v23
v_mul_f32 v77,v77,v23
v_mul_f32 v78,v78,v23
v_mul_f32 v79,v79,v23
v_mul_f32 v88,v88,v23
v_mul_f32 v89,v89,v23
v_mul_f32 v90,v90,v23
v_mul_f32 v91,v91,v23
v_mul_f32 v92,v92,v23
v_mul_f32 v93,v93,v23
v_mul_f32 v94,v94,v23
v_mul_f32 v95,v95,v23
v_mul_f32 v104,v104,v23
v_mul_f32 v105,v105,v23
v_mul_f32 v106,v106,v23
v_mul_f32 v107,v107,v23
v_mul_f32 v108,v108,v23
v_mul_f32 v109,v109,v23
v_mul_f32 v110,v110,v23
v_mul_f32 v111,v111,v23
v_mul_f32 v120,v120,v23
v_mul_f32 v121,v121,v23
v_mul_f32 v122,v122,v23
v_mul_f32 v123,v123,v23
v_mul_f32 v124,v124,v23
v_mul_f32 v125,v125,v23
v_mul_f32 v126,v126,v23
v_mul_f32 v127,v127,v23
s_nop 3
s_setpc_b64 s[46:47]
L_rescale1:
s_nop 11
v_max3_f32 v22,v144,v145,v146
v_max3_f32 v22,v22,v147,v148
v_max3_f32 v22,v22,v149,v150
v_max_f32 v22,v22,v151
v_mov_b32 v23,v22
s_nop 1
v_permlane16_swap_b32 v23,v22
v_max_f32 v22,v22,v23
v_mov_b32 v23,v22
s_nop 1
v_permlane32_swap_b32 v23,v22
v_max_f32 v22,v22,v23
v_max_f32 v22,0,v22
v_sub_f32 v23,0,v22
v_exp_f32 v23,v23
v_sub_f32 v160,v160,v22
v_sub_f32 v161,v161,v22
v_sub_f32 v162,v162,v22
v_sub_f32 v163,v163,v22
v_sub_f32 v144,v144,v22
v_sub_f32 v145,v145,v22
v_sub_f32 v146,v146,v22
v_sub_f32 v147,v147,v22
v_sub_f32 v148,v148,v22
v_sub_f32 v149,v149,v22
v_sub_f32 v150,v150,v22
v_sub_f32 v151,v151,v22
v_mul_f32 v168,v168,v23
v_mul_f32 v169,v169,v23
v_mul_f32 v170,v170,v23
v_mul_f32 v171,v171,v23
v_mul_f32 v64,v64,v23
v_mul_f32 v65,v65,v23
v_mul_f32 v66,v66,v23
v_mul_f32 v67,v67,v23
v_mul_f32 v68,v68,v23
v_mul_f32 v69,v69,v23
v_mul_f32 v70,v70,v23
v_mul_f32 v71,v71,v23
v_mul_f32 v80,v80,v23
v_mul_f32 v81,v81,v23
v_mul_f32 v82,v82,v23
v_mul_f32 v83,v83,v23
v_mul_f32 v84,v84,v23
v_mul_f32 v85,v85,v23
v_mul_f32 v86,v86,v23
v_mul_f32 v87,v87,v23
v_mul_f32 v96,v96,v23
v_mul_f32 v97,v97,v23
v_mul_f32 v98,v98,v23
v_mul_f32 v99,v99,v23
v_mul_f32 v100,v100,v23
v_mul_f32 v101,v101,v23
v_mul_f32 v102,v102,v23
v_mul_f32 v103,v103,v23
v_mul_f32 v112,v112,v23
v_mul_f32 v113,v113,v23
v_mul_f32 v114,v114,v23
v_mul_f32 v115,v115,v23
v_mul_f32 v116,v116,v23
v_mul_f32 v117,v117,v23
v_mul_f32 v118,v118,v23
v_mul_f32 v119,v119,v23
v_max3_f32 v22,v152,v153,v154
v_max3_f32 v22,v22,v155,v156
v_max3_f32 v22,v22,v157,v158
v_max_f32 v22,v22,v159
v_mov_b32 v23,v22
s_nop 1
v_permlane16_swap_b32 v23,v22
v_max_f32 v22,v22,v23
v_mov_b32 v23,v22
s_nop 1
v_permlane32_swap_b32 v23,v22
v_max_f32 v22,v22,v23
v_max_f32 v22,0,v22
v_sub_f32 v23,0,v22
v_exp_f32 v23,v23
v_sub_f32 v164,v164,v22
v_sub_f32 v165,v165,v22
v_sub_f32 v166,v166,v22
v_sub_f32 v167,v167,v22
v_sub_f32 v152,v152,v22
v_sub_f32 v153,v153,v22
v_sub_f32 v154,v154,v22
v_sub_f32 v155,v155,v22
v_sub_f32 v156,v156,v22
v_sub_f32 v157,v157,v22
v_sub_f32 v158,v158,v22
v_sub_f32 v159,v159,v22
v_mul_f32 v172,v172,v23
v_mul_f32 v173,v173,v23
v_mul_f32 v174,v174,v23
v_mul_f32 v175,v175,v23
v_mul_f32 v72,v72,v23
v_mul_f32 v73,v73,v23
v_mul_f32 v74,v74,v23
v_mul_f32 v75,v75,v23
v_mul_f32 v76,v76,v23
v_mul_f32 v77,v77,v23
v_mul_f32 v78,v78,v23
v_mul_f32 v79,v79,v23
v_mul_f32 v88,v88,v23
v_mul_f32 v89,v89,v23
v_mul_f32 v90,v90,v23
v_mul_f32 v91,v91,v23
v_mul_f32 v92,v92,v23
v_mul_f32 v93,v93,v23
v_mul_f32 v94,v94,v23
v_mul_f32 v95,v95,v23
v_mul_f32 v104,v104,v23
v_mul_f32 v105,v105,v23
v_mul_f32 v106,v106,v23
v_mul_f32 v107,v107,v23
v_mul_f32 v108,v108,v23
v_mul_f32 v109,v109,v23
v_mul_f32 v110,v110,v23
v_mul_f32 v111,v111,v23
v_mul_f32 v120,v120,v23
v_mul_f32 v121,v121,v23
v_mul_f32 v122,v122,v23
v_mul_f32 v123,v123,v23
v_mul_f32 v124,v124,v23
v_mul_f32 v125,v125,v23
v_mul_f32 v126,v126,v23
v_mul_f32 v127,v127,v23
s_nop 3
s_setpc_b64 s[46:47]
L_last:
s_endpgm
.section .rodata,"a"
.p2align 6
.amdhsa_kernel concat_heads__mha_block_cached__mha_block_cached__near_ridge_kernel
  .amdhsa_next_free_vgpr 512
  .amdhsa_next_free_sgpr 102
  .amdhsa_accum_offset 256
  .amdhsa_group_segment_fixed_size 0
  .amdhsa_kernarg_size 104
  .amdhsa_user_sgpr_count 2
  .amdhsa_user_sgpr_kernarg_segment_ptr 1
  .amdhsa_system_sgpr_workgroup_id_x 1
  .amdhsa_float_denorm_mode_32 3
.end_amdhsa_kernel
```
